```python
import torch

def _softmax(x, axis=-1):
    return torch.softmax(x, dim=axis)

def _gelu(x):
    return torch.nn.functional.gelu(x, approximate='tanh')

def _silu(x):
    return torch.nn.functional.silu(x)

def _sigmoid(x):
    return torch.sigmoid(x)

def _layernorm(x, axis=-1, eps=1e-05):
    m = x.mean(dim=axis, keepdim=True)
    v = x.var(dim=axis, keepdim=True, unbiased=False)
    return (x - m) / torch.sqrt(v + eps)

def _scatter_add(tgt, idx, src, axis=0):
    return tgt.clone().index_add_(axis, idx, src)

def _segment_sum(src, seg, n):
    out = torch.zeros((n,) + src.shape[1:], dtype=src.dtype)
    return out.index_add_(0, seg, src)

def _pad(x, pw):
    flat = tuple((v for pair in reversed(pw) for v in pair))
    return torch.nn.functional.pad(x, flat)
kernel_name = 'recurrent_scan__memory_aug_recurrent_mem_tr__dense_activation_gelu__prompt'

def setup_inputs():

    _w = lambda a: (lambda t: t.to(torch.bfloat16) if t.is_floating_point() else t)(torch.as_tensor(a))

    def _A_setup():
        B, S, Dm = (1, 2048, 1024)
        H, Dh = (32, 128)
        M, seg = (8, 32)
        seg = min(seg, S)
        S = S // seg * seg
        return {'x': _w((lambda *s: torch.randn(*s, dtype=torch.bfloat16) * 0.1)(B, S, Dm)), 'mem0': _w((lambda *s: torch.randn(*s, dtype=torch.bfloat16) * 1.6)(B, M, Dm)), 'Wq': _w((lambda *s: torch.randn(*s, dtype=torch.bfloat16) * 0.8)(Dm, H, Dh) * Dm ** (-0.5)), 'Wk': _w((lambda *s: torch.randn(*s, dtype=torch.bfloat16) * 0.8)(Dm, H, Dh) * Dm ** (-0.5)), 'Wv': _w((lambda *s: torch.randn(*s, dtype=torch.bfloat16) * 1.6)(Dm, H, Dh) * Dm ** (-0.5)), 'Wo': _w((lambda *s: torch.randn(*s, dtype=torch.bfloat16) * 1.6)(H, Dh, Dm) * (H * Dh) ** (-0.5)), 'seg_len': seg}
    _A_in = _A_setup()

    def _B_setup():
        B, S, D, F = (1, 2048, 1024, 3584)
        return {'x': _w((lambda *s: torch.randn(*s, dtype=torch.bfloat16) * 0.1)(B, S, D)), 'w1': _w((lambda *s: torch.randn(*s, dtype=torch.bfloat16) * 0.4)(D, F) * D ** (-0.5)), 'b1': _w((lambda *s: torch.randn(*s, dtype=torch.bfloat16) * 0.4)(F) * 0.01), 'w2': _w((lambda *s: torch.randn(*s, dtype=torch.bfloat16) * 0.4)(F, D) * F ** (-0.5)), 'b2': _w((lambda *s: torch.randn(*s, dtype=torch.bfloat16) * 0.4)(D) * 0.01)}
    _B_in = _B_setup()
    return {'A_x': _A_in['x'], 'A_mem0': _A_in['mem0'], 'A_Wq': _A_in['Wq'], 'A_Wk': _A_in['Wk'], 'A_Wv': _A_in['Wv'], 'A_Wo': _A_in['Wo'], 'A_seg_len': _A_in['seg_len'], 'B_x': _B_in['x'], 'B_w1': _B_in['w1'], 'B_b1': _B_in['b1'], 'B_w2': _B_in['w2'], 'B_b2': _B_in['b2']}

def reference(A_x, A_mem0, A_Wq, A_Wk, A_Wv, A_Wo, A_seg_len, B_x, B_w1, B_b1, B_w2, B_b2):

    def _A_ref(x, mem0, Wq, Wk, Wv, Wo, seg_len):
        B, S, Dm = x.shape
        H, Dh = (Wq.shape[1], Wq.shape[2])
        M = mem0.shape[1]
        scale = Dh ** (-0.5)
        n_seg = S // seg_len
        L = M + seg_len
        idx = torch.arange(L)
        mask = (idx[:, None] < M) | (idx[:, None] >= idx[None, :])
        mem = mem0
        outs = []
        for s in range(n_seg):
            xs = x[:, s * seg_len:(s + 1) * seg_len, :].clone()
            h = torch.concatenate([mem, xs], axis=1)
            q = torch.einsum('btd,dhe->bhte', h, Wq)
            k = torch.einsum('btd,dhe->bhte', h, Wk)
            v = torch.einsum('btd,dhe->bhte', h, Wv)
            scores = torch.einsum('bhqe,bhke->bhqk', q, k) * scale
            scores = torch.where(mask[None, None], scores, -1000000000.0)
            p = _softmax(scores, axis=-1)
            o = torch.einsum('bhqk,bhke->bhqe', p, v)
            o = torch.einsum('bhte,hed->btd', o, Wo)
            mem = o[:, :M, :].clone()
            outs.append(o[:, M:, :])
        return torch.concatenate(outs, axis=1)

    def _B_ref(x, w1, b1, w2, b2):
        h = torch.einsum('bsd,df->bsf', x, w1) + b1
        h = _gelu(h)
        return torch.einsum('bsf,fd->bsd', h, w2) + b2
    x = A_x
    xn = _layernorm(x, axis=-1)
    s = _A_ref(xn, A_mem0, A_Wq, A_Wk, A_Wv, A_Wo, A_seg_len)
    g = _silu(_B_ref(xn, B_w1, B_b1, B_w2, B_b2))
    return x + s * g
```

```asm
; @launch kernel=main_kernel grid=(256,1,1) block=(256,1,1) lds=161024
.amdgcn_target "amdgcn-amd-amdhsa--gfx950"
.text
.globl main_kernel
.p2align 8
.type main_kernel,@function
main_kernel:
s_cmp_ge_u32 s2, 256
s_cbranch_scc1 main_kernel_end
s_mov_b32 s3, 0
main_kernel_go:
s_load_dwordx4 s[92:95], s[0:1], 0
s_load_dwordx2 s[4:5], s[0:1], 112
s_load_dwordx8 s[76:83], s[0:1], 16
s_load_dwordx8 s[84:91], s[0:1], 64
s_load_dwordx4 s[96:99], s[0:1], 96
s_getreg_b32 s7, hwreg(HW_REG_XCC_ID)
v_and_b32 v180, 7, v0
v_lshrrev_b32 v181, 3, v0
v_lshlrev_b32 v182, 11, v180
v_lshl_add_u32 v182, v181, 6, v182
v_and_b32 v1, 63, v0
v_lshrrev_b32 v2, 6, v0
s_nop 0
v_readfirstlane_b32 s24, v2
s_and_b32 s7, s7, 7
s_lshr_b32 s73, s2, 3
s_and_b32 s20, s2, 7
s_cmp_eq_u32 s3, 0
s_cselect_b32 s72, s7, s20
s_lshl_b32 s20, s2, 14
s_lshl_b32 s74, s73, 8
s_and_b32 s21, s73, 3
s_mul_i32 s21, s21, 1835008
s_lshr_b32 s22, s73, 2
s_lshl_b32 s22, s22, 8
s_add_u32 s21, s21, s22
s_mov_b32 s30, 8192
s_mov_b32 s17, 0x800000
s_cmp_eq_u32 s72, 7
s_cselect_b32 s16, s21, s74
s_cselect_b32 s30, 2048, s30
s_cselect_b32 s17, 0x700000, s17
s_cmp_ge_u32 s73, 28
s_cselect_b32 s21, s74, 0x700000
s_cmp_eq_u32 s72, 5
s_cselect_b32 s30, 7168, s30
s_cselect_b32 s17, s21, s17
s_lshl_b32 s21, s72, 11
s_lshl_b32 s22, s73, 6
s_add_u32 s21, s21, s22
s_and_b32 s22, s73, 1
s_cmp_lt_u32 s72, 4
s_cselect_b32 s16, s21, s16
s_cselect_b32 s22, s22, 0
s_cselect_b32 s18, 8, 6
s_cselect_b32 s19, 2, 4
s_cselect_b32 s21, 15, 14
s_cselect_b32 s23, 4, 2
s_cselect_b32 s28, 0, 16
s_cselect_b64 vcc, 0, -1
s_lshl_b32 s18, s24, s18
s_lshl_b32 s21, s24, s21
s_lshl_b32 s61, s30, s23
s_lshl_b32 s23, s22, 13
s_add_u32 m0, s21, s23
s_lshl_b32 s60, s22, 20
s_lshl_b32 s23, s22, 14
s_sub_u32 s62, 1024, s23
s_lshl_b32 s23, s22, 21
s_sub_u32 s63, s61, s23
s_mov_b32 s49, s61
v_lshrrev_b32 v2, s19, v1
v_lshlrev_b32 v3, 2, v2
v_and_b32 v4, 15, v1
v_xor_b32 v4, v4, v3
v_and_b32 v3, 3, v1
v_cndmask_b32 v4, v3, v4, vcc
v_add_u32 v2, s18, v2
v_mul_lo_u32 v2, v2, s30
v_lshl_add_u32 v92, v4, 4, v2
v_xor_b32 v93, s28, v92
s_waitcnt lgkmcnt(0)
s_mov_b32 s68, s92
s_mov_b32 s69, s93
s_mov_b32 s70, 0x400000
s_mov_b32 s71, 0x00020000
buffer_load_dwordx4 v[128:131], v182, s[68:71], s20 offen offset:0
buffer_load_dwordx4 v[132:135], v182, s[68:71], s20 offen offset:16
buffer_load_dwordx4 v[136:139], v182, s[68:71], s20 offen offset:32
buffer_load_dwordx4 v[140:143], v182, s[68:71], s20 offen offset:48
s_mov_b64 s[22:23], s[76:77]
s_cmp_eq_u32 s72, 4
s_cselect_b64 s[22:23], s[78:79], s[22:23]
s_cmp_eq_u32 s72, 5
s_cselect_b64 s[22:23], s[84:85], s[22:23]
s_cmp_eq_u32 s72, 6
s_cselect_b64 s[22:23], s[80:81], s[22:23]
s_cmp_eq_u32 s72, 7
s_cselect_b64 s[22:23], s[88:89], s[22:23]
s_add_u32 s12, s22, s16
s_addc_u32 s13, s23, 0
s_sub_u32 s14, s17, s16
s_mov_b32 s15, 0x00020000
buffer_load_dwordx4 v92, s[12:15], s60 offen nt lds
s_add_u32 m0, m0, 1024
s_add_u32 s60, s60, s61
buffer_load_dwordx4 v93, s[12:15], s60 offen nt lds
s_add_u32 m0, m0, 1024
s_add_u32 s60, s60, s61
buffer_load_dwordx4 v92, s[12:15], s60 offen nt lds
s_add_u32 m0, m0, 1024
s_add_u32 s60, s60, s61
buffer_load_dwordx4 v93, s[12:15], s60 offen nt lds
s_add_u32 m0, m0, 1024
s_add_u32 s60, s60, s61
s_mov_b32 s8, s4
s_mov_b32 s9, s5
s_mov_b32 s10, 0x10000000
s_mov_b32 s11, 0x00020000
s_mov_b32 s64, s98
s_mov_b32 s65, s99
s_mov_b32 s66, 0x100
s_mov_b32 s67, 0x00020000
s_mov_b64 s[40:41], s[22:23]
s_mov_b32 s42, s17
s_mov_b32 s43, 0x00020000
v_lshlrev_b32 v209, 3, v0
v_mov_b32 v210, 0x40000000
v_cmp_gt_u32 vcc, 9, v0
s_nop 1
v_cndmask_b32 v209, v210, v209, vcc
s_cmp_lg_u32 s3, 0
s_cbranch_scc1 main_kernel_nl
v_bfe_u32 v183, v0, 2, 2
v_and_b32 v184, 1, v0
v_lshl_add_u32 v183, v183, 1, v184
v_lshlrev_b32 v183, 11, v183
v_bfe_u32 v184, v0, 1, 1
v_lshl_add_u32 v183, v184, 3, v183
v_bfe_u32 v184, v0, 4, 1
v_lshl_add_u32 v183, v184, 4, v183
v_lshrrev_b32 v184, 5, v0
v_lshl_add_u32 v183, v184, 6, v183
s_and_b32 s21, s2, 3
s_lshl_b32 s21, s21, 9
s_cmp_lt_u32 s2, 16
s_cselect_b32 s21, s21, 0x40000000
s_mov_b32 s56, s94
s_mov_b32 s57, s95
s_mov_b32 s58, 0x4000
s_mov_b32 s59, 0x00020000
buffer_load_dwordx2 v[176:177], v183, s[56:59], s21 offen
buffer_load_dwordx2 v[178:179], v183, s[56:59], s21 offen offset:32
v_mov_b32 v188, -1
v_mov_b32 v189, -1
v_mov_b32 v190, -1
v_mov_b32 v191, -1
s_mul_i32 s20, s2, 23040
v_lshlrev_b32 v182, 4, v0
v_add_u32 v182, s20, v182
v_mov_b32 v183, 0x40000000
s_mov_b32 s21, 0x6400000
v_add_u32 v184, 0, v182
v_subrev_u32 v185, 262144, v184
v_cmp_gt_u32 vcc, 0x10000, v185
s_nop 1
v_cndmask_b32 v184, v184, v183, vcc
buffer_store_dwordx4 v[188:191], v184, s[8:11], s21 offen sc1
v_add_u32 v184, 4096, v182
v_subrev_u32 v185, 262144, v184
v_cmp_gt_u32 vcc, 0x10000, v185
s_nop 1
v_cndmask_b32 v184, v184, v183, vcc
buffer_store_dwordx4 v[188:191], v184, s[8:11], s21 offen sc1
v_add_u32 v184, 8192, v182
v_subrev_u32 v185, 262144, v184
v_cmp_gt_u32 vcc, 0x10000, v185
s_nop 1
v_cndmask_b32 v184, v184, v183, vcc
buffer_store_dwordx4 v[188:191], v184, s[8:11], s21 offen sc1
v_add_u32 v184, 12288, v182
v_subrev_u32 v185, 262144, v184
v_cmp_gt_u32 vcc, 0x10000, v185
s_nop 1
v_cndmask_b32 v184, v184, v183, vcc
buffer_store_dwordx4 v[188:191], v184, s[8:11], s21 offen sc1
v_add_u32 v184, 16384, v182
v_subrev_u32 v185, 262144, v184
v_cmp_gt_u32 vcc, 0x10000, v185
s_nop 1
v_cndmask_b32 v184, v184, v183, vcc
buffer_store_dwordx4 v[188:191], v184, s[8:11], s21 offen sc1
v_add_u32 v184, 20480, v182
v_subrev_u32 v185, 262144, v184
v_cmp_gt_u32 vcc, 0x10000, v185
s_nop 1
v_cndmask_b32 v184, v184, v183, vcc
v_cmp_le_u32 vcc, 160, v0
s_nop 1
v_cndmask_b32 v184, v184, v183, vcc
buffer_store_dwordx4 v[188:191], v184, s[8:11], s21 offen sc1
v_mov_b32 v185, 0
s_lshl_b32 s20, s2, 7
s_add_u32 s20, s20, 0x6a00000
v_lshlrev_b32 v184, 2, v0
v_cmp_le_u32 vcc, 32, v0
s_nop 1
v_cndmask_b32 v184, v184, v183, vcc
buffer_store_dword v185, v184, s[8:11], s20 offen sc1
s_lshr_b32 s21, s2, 2
s_lshl_b32 s21, s21, 16
s_and_b32 s22, s2, 3
s_lshl_b32 s22, s22, 7
s_add_u32 s21, s21, s22
v_lshlrev_b32 v182, 4, v180
v_lshl_add_u32 v182, v181, 11, v182
v_lshrrev_b32 v183, 6, v0
v_lshlrev_b32 v183, 5, v183
v_lshl_add_u32 v183, v180, 2, v183
v_add_u32 v183, 131328, v183
v_lshlrev_b32 v184, 2, v180
v_add_u32 v184, 131328, v184
s_waitcnt vmcnt(13)
buffer_load_dwordx4 v92, s[12:15], s60 offen nt lds
s_add_u32 m0, m0, 1024
s_add_u32 s60, s60, s61
v_lshlrev_b32 v144, 16, v128
v_and_b32 v145, 0xffff0000, v128
v_lshlrev_b32 v146, 16, v129
v_and_b32 v147, 0xffff0000, v129
v_lshlrev_b32 v148, 16, v130
v_and_b32 v149, 0xffff0000, v130
v_lshlrev_b32 v150, 16, v131
v_and_b32 v151, 0xffff0000, v131
v_lshlrev_b32 v152, 16, v132
v_and_b32 v153, 0xffff0000, v132
v_lshlrev_b32 v154, 16, v133
v_and_b32 v155, 0xffff0000, v133
v_lshlrev_b32 v156, 16, v134
v_and_b32 v157, 0xffff0000, v134
v_lshlrev_b32 v158, 16, v135
v_and_b32 v159, 0xffff0000, v135
v_lshlrev_b32 v160, 16, v136
v_and_b32 v161, 0xffff0000, v136
v_lshlrev_b32 v162, 16, v137
v_and_b32 v163, 0xffff0000, v137
v_lshlrev_b32 v164, 16, v138
v_and_b32 v165, 0xffff0000, v138
v_lshlrev_b32 v166, 16, v139
v_and_b32 v167, 0xffff0000, v139
v_lshlrev_b32 v168, 16, v140
v_and_b32 v169, 0xffff0000, v140
v_lshlrev_b32 v170, 16, v141
v_and_b32 v171, 0xffff0000, v141
v_lshlrev_b32 v172, 16, v142
v_and_b32 v173, 0xffff0000, v142
v_lshlrev_b32 v174, 16, v143
v_and_b32 v175, 0xffff0000, v143
v_add_f32 v185, v144, v145
v_add_f32 v186, v146, v147
v_add_f32 v185, v185, v148
v_add_f32 v186, v186, v149
v_add_f32 v185, v185, v150
v_add_f32 v186, v186, v151
v_add_f32 v185, v185, v152
v_add_f32 v186, v186, v153
v_add_f32 v185, v185, v154
v_add_f32 v186, v186, v155
v_add_f32 v185, v185, v156
v_add_f32 v186, v186, v157
v_add_f32 v185, v185, v158
v_add_f32 v186, v186, v159
v_add_f32 v185, v185, v160
v_add_f32 v186, v186, v161
v_add_f32 v185, v185, v162
v_add_f32 v186, v186, v163
v_add_f32 v185, v185, v164
v_add_f32 v186, v186, v165
v_add_f32 v185, v185, v166
v_add_f32 v186, v186, v167
v_add_f32 v185, v185, v168
v_add_f32 v186, v186, v169
v_add_f32 v185, v185, v170
v_add_f32 v186, v186, v171
v_add_f32 v185, v185, v172
v_add_f32 v186, v186, v173
v_add_f32 v185, v185, v174
v_add_f32 v186, v186, v175
v_add_f32 v185, v185, v186
s_nop 1
v_add_f32_dpp v185, v185, v185 row_ror:8 row_mask:0xf bank_mask:0xf
v_mov_b32 v186, v185
s_nop 1
v_permlane16_swap_b32 v186, v185
v_add_f32 v185, v185, v186
v_mov_b32 v186, v185
s_nop 1
v_permlane32_swap_b32 v186, v185
v_add_f32 v185, v185, v186
ds_write_b32 v183, v185
s_waitcnt lgkmcnt(0)
s_barrier
ds_read2_b32 v[188:189], v184 offset0:0 offset1:8
ds_read2_b32 v[190:191], v184 offset0:16 offset1:24
s_waitcnt lgkmcnt(0)
v_add_f32 v188, v188, v189
v_add_f32 v190, v190, v191
v_add_f32 v188, v188, v190
v_mul_f32 v188, 0x3a800000, v188
v_sub_f32 v189, v144, v188
v_sub_f32 v190, v145, v188
v_mul_f32 v185, v189, v189
v_mul_f32 v186, v190, v190
v_sub_f32 v189, v146, v188
buffer_load_dwordx4 v93, s[12:15], s60 offen nt lds
s_add_u32 m0, m0, 1024
s_add_u32 s60, s60, s61
v_sub_f32 v190, v147, v188
v_fmac_f32 v185, v189, v189
v_fmac_f32 v186, v190, v190
v_sub_f32 v189, v148, v188
v_sub_f32 v190, v149, v188
v_fmac_f32 v185, v189, v189
v_fmac_f32 v186, v190, v190
v_sub_f32 v189, v150, v188
v_sub_f32 v190, v151, v188
v_fmac_f32 v185, v189, v189
v_fmac_f32 v186, v190, v190
v_sub_f32 v189, v152, v188
v_sub_f32 v190, v153, v188
v_fmac_f32 v185, v189, v189
v_fmac_f32 v186, v190, v190
v_sub_f32 v189, v154, v188
v_sub_f32 v190, v155, v188
v_fmac_f32 v185, v189, v189
v_fmac_f32 v186, v190, v190
v_sub_f32 v189, v156, v188
v_sub_f32 v190, v157, v188
v_fmac_f32 v185, v189, v189
v_fmac_f32 v186, v190, v190
v_sub_f32 v189, v158, v188
v_sub_f32 v190, v159, v188
v_fmac_f32 v185, v189, v189
v_fmac_f32 v186, v190, v190
v_sub_f32 v189, v160, v188
v_sub_f32 v190, v161, v188
v_fmac_f32 v185, v189, v189
v_fmac_f32 v186, v190, v190
v_sub_f32 v189, v162, v188
v_sub_f32 v190, v163, v188
v_fmac_f32 v185, v189, v189
v_fmac_f32 v186, v190, v190
v_sub_f32 v189, v164, v188
v_sub_f32 v190, v165, v188
v_fmac_f32 v185, v189, v189
v_fmac_f32 v186, v190, v190
v_sub_f32 v189, v166, v188
v_sub_f32 v190, v167, v188
v_fmac_f32 v185, v189, v189
v_fmac_f32 v186, v190, v190
v_sub_f32 v189, v168, v188
v_sub_f32 v190, v169, v188
v_fmac_f32 v185, v189, v189
v_fmac_f32 v186, v190, v190
v_sub_f32 v189, v170, v188
v_sub_f32 v190, v171, v188
v_fmac_f32 v185, v189, v189
v_fmac_f32 v186, v190, v190
v_sub_f32 v189, v172, v188
v_sub_f32 v190, v173, v188
v_fmac_f32 v185, v189, v189
v_fmac_f32 v186, v190, v190
v_sub_f32 v189, v174, v188
v_sub_f32 v190, v175, v188
v_fmac_f32 v185, v189, v189
v_fmac_f32 v186, v190, v190
v_add_f32 v185, v185, v186
s_nop 1
v_add_f32_dpp v185, v185, v185 row_ror:8 row_mask:0xf bank_mask:0xf
v_mov_b32 v186, v185
s_nop 1
v_permlane16_swap_b32 v186, v185
v_add_f32 v185, v185, v186
v_mov_b32 v186, v185
s_nop 1
v_permlane32_swap_b32 v186, v185
v_add_f32 v185, v185, v186
ds_write_b32 v183, v185 offset:128
s_waitcnt lgkmcnt(0)
s_barrier
ds_read2_b32 v[190:191], v184 offset0:32 offset1:40
ds_read2_b32 v[192:193], v184 offset0:48 offset1:56
s_waitcnt lgkmcnt(0)
v_add_f32 v190, v190, v191
v_add_f32 v192, v192, v193
v_add_f32 v190, v190, v192
v_mul_f32 v190, 0x3a800000, v190
v_cvt_pk_bf16_f32 v188, v188, v188
v_and_b32 v188, 0xffff0000, v188
v_cvt_pk_bf16_f32 v190, v190, v190
v_and_b32 v190, 0xffff0000, v190
v_add_f32 v190, 0x3727c5ac, v190
v_cvt_pk_bf16_f32 v190, v190, v190
v_and_b32 v190, 0xffff0000, v190
v_sqrt_f32 v190, v190
buffer_load_dwordx4 v92, s[12:15], s60 offen nt lds
s_add_u32 m0, m0, 1024
s_add_u32 s60, s60, s61
v_cvt_pk_bf16_f32 v190, v190, v190
v_and_b32 v190, 0xffff0000, v190
v_rcp_f32 v191, v190
v_sub_f32 v144, v144, v188
v_sub_f32 v145, v145, v188
v_cvt_pk_bf16_f32 v192, v144, v145
v_lshlrev_b32 v144, 16, v192
v_and_b32 v145, 0xffff0000, v192
v_mul_f32 v193, v144, v191
v_fma_f32 v194, -v193, v190, v144
v_fma_f32 v144, v194, v191, v193
v_mul_f32 v193, v145, v191
v_fma_f32 v194, -v193, v190, v145
v_fma_f32 v145, v194, v191, v193
v_sub_f32 v146, v146, v188
v_sub_f32 v147, v147, v188
v_cvt_pk_bf16_f32 v192, v146, v147
v_lshlrev_b32 v146, 16, v192
v_and_b32 v147, 0xffff0000, v192
v_mul_f32 v193, v146, v191
v_fma_f32 v194, -v193, v190, v146
v_fma_f32 v146, v194, v191, v193
v_mul_f32 v193, v147, v191
v_fma_f32 v194, -v193, v190, v147
v_fma_f32 v147, v194, v191, v193
v_sub_f32 v148, v148, v188
v_sub_f32 v149, v149, v188
v_cvt_pk_bf16_f32 v192, v148, v149
v_lshlrev_b32 v148, 16, v192
v_and_b32 v149, 0xffff0000, v192
v_mul_f32 v193, v148, v191
v_fma_f32 v194, -v193, v190, v148
v_fma_f32 v148, v194, v191, v193
v_mul_f32 v193, v149, v191
v_fma_f32 v194, -v193, v190, v149
v_fma_f32 v149, v194, v191, v193
v_sub_f32 v150, v150, v188
v_sub_f32 v151, v151, v188
v_cvt_pk_bf16_f32 v192, v150, v151
v_lshlrev_b32 v150, 16, v192
v_and_b32 v151, 0xffff0000, v192
v_mul_f32 v193, v150, v191
v_fma_f32 v194, -v193, v190, v150
v_fma_f32 v150, v194, v191, v193
v_mul_f32 v193, v151, v191
v_fma_f32 v194, -v193, v190, v151
v_fma_f32 v151, v194, v191, v193
v_sub_f32 v152, v152, v188
v_sub_f32 v153, v153, v188
v_cvt_pk_bf16_f32 v192, v152, v153
v_lshlrev_b32 v152, 16, v192
v_and_b32 v153, 0xffff0000, v192
v_mul_f32 v193, v152, v191
v_fma_f32 v194, -v193, v190, v152
v_fma_f32 v152, v194, v191, v193
v_mul_f32 v193, v153, v191
v_fma_f32 v194, -v193, v190, v153
v_fma_f32 v153, v194, v191, v193
v_sub_f32 v154, v154, v188
v_sub_f32 v155, v155, v188
v_cvt_pk_bf16_f32 v192, v154, v155
v_lshlrev_b32 v154, 16, v192
v_and_b32 v155, 0xffff0000, v192
v_mul_f32 v193, v154, v191
v_fma_f32 v194, -v193, v190, v154
v_fma_f32 v154, v194, v191, v193
v_mul_f32 v193, v155, v191
v_fma_f32 v194, -v193, v190, v155
v_fma_f32 v155, v194, v191, v193
v_sub_f32 v156, v156, v188
v_sub_f32 v157, v157, v188
v_cvt_pk_bf16_f32 v192, v156, v157
v_lshlrev_b32 v156, 16, v192
v_and_b32 v157, 0xffff0000, v192
v_mul_f32 v193, v156, v191
v_fma_f32 v194, -v193, v190, v156
v_fma_f32 v156, v194, v191, v193
v_mul_f32 v193, v157, v191
v_fma_f32 v194, -v193, v190, v157
v_fma_f32 v157, v194, v191, v193
v_sub_f32 v158, v158, v188
v_sub_f32 v159, v159, v188
v_cvt_pk_bf16_f32 v192, v158, v159
v_lshlrev_b32 v158, 16, v192
v_and_b32 v159, 0xffff0000, v192
v_mul_f32 v193, v158, v191
v_fma_f32 v194, -v193, v190, v158
v_fma_f32 v158, v194, v191, v193
buffer_load_dwordx4 v93, s[12:15], s60 offen nt lds
s_add_u32 m0, m0, s62
s_add_u32 s60, s60, s63
v_mul_f32 v193, v159, v191
v_fma_f32 v194, -v193, v190, v159
v_fma_f32 v159, v194, v191, v193
v_sub_f32 v160, v160, v188
v_sub_f32 v161, v161, v188
v_cvt_pk_bf16_f32 v192, v160, v161
v_lshlrev_b32 v160, 16, v192
v_and_b32 v161, 0xffff0000, v192
v_mul_f32 v193, v160, v191
v_fma_f32 v194, -v193, v190, v160
v_fma_f32 v160, v194, v191, v193
v_mul_f32 v193, v161, v191
v_fma_f32 v194, -v193, v190, v161
v_fma_f32 v161, v194, v191, v193
v_sub_f32 v162, v162, v188
v_sub_f32 v163, v163, v188
v_cvt_pk_bf16_f32 v192, v162, v163
v_lshlrev_b32 v162, 16, v192
v_and_b32 v163, 0xffff0000, v192
v_mul_f32 v193, v162, v191
v_fma_f32 v194, -v193, v190, v162
v_fma_f32 v162, v194, v191, v193
v_mul_f32 v193, v163, v191
v_fma_f32 v194, -v193, v190, v163
v_fma_f32 v163, v194, v191, v193
v_sub_f32 v164, v164, v188
v_sub_f32 v165, v165, v188
v_cvt_pk_bf16_f32 v192, v164, v165
v_lshlrev_b32 v164, 16, v192
v_and_b32 v165, 0xffff0000, v192
v_mul_f32 v193, v164, v191
v_fma_f32 v194, -v193, v190, v164
v_fma_f32 v164, v194, v191, v193
v_mul_f32 v193, v165, v191
v_fma_f32 v194, -v193, v190, v165
v_fma_f32 v165, v194, v191, v193
v_sub_f32 v166, v166, v188
v_sub_f32 v167, v167, v188
v_cvt_pk_bf16_f32 v192, v166, v167
v_lshlrev_b32 v166, 16, v192
v_and_b32 v167, 0xffff0000, v192
v_mul_f32 v193, v166, v191
v_fma_f32 v194, -v193, v190, v166
v_fma_f32 v166, v194, v191, v193
v_mul_f32 v193, v167, v191
v_fma_f32 v194, -v193, v190, v167
v_fma_f32 v167, v194, v191, v193
v_sub_f32 v168, v168, v188
v_sub_f32 v169, v169, v188
v_cvt_pk_bf16_f32 v192, v168, v169
v_lshlrev_b32 v168, 16, v192
v_and_b32 v169, 0xffff0000, v192
v_mul_f32 v193, v168, v191
v_fma_f32 v194, -v193, v190, v168
v_fma_f32 v168, v194, v191, v193
v_mul_f32 v193, v169, v191
v_fma_f32 v194, -v193, v190, v169
v_fma_f32 v169, v194, v191, v193
v_sub_f32 v170, v170, v188
v_sub_f32 v171, v171, v188
v_cvt_pk_bf16_f32 v192, v170, v171
v_lshlrev_b32 v170, 16, v192
v_and_b32 v171, 0xffff0000, v192
v_mul_f32 v193, v170, v191
v_fma_f32 v194, -v193, v190, v170
v_fma_f32 v170, v194, v191, v193
v_mul_f32 v193, v171, v191
v_fma_f32 v194, -v193, v190, v171
v_fma_f32 v171, v194, v191, v193
v_sub_f32 v172, v172, v188
v_sub_f32 v173, v173, v188
v_cvt_pk_bf16_f32 v192, v172, v173
v_lshlrev_b32 v172, 16, v192
v_and_b32 v173, 0xffff0000, v192
v_mul_f32 v193, v172, v191
v_fma_f32 v194, -v193, v190, v172
v_fma_f32 v172, v194, v191, v193
v_mul_f32 v193, v173, v191
v_fma_f32 v194, -v193, v190, v173
v_fma_f32 v173, v194, v191, v193
v_sub_f32 v174, v174, v188
v_sub_f32 v175, v175, v188
v_cvt_pk_bf16_f32 v192, v174, v175
v_lshlrev_b32 v174, 16, v192
v_and_b32 v175, 0xffff0000, v192
v_mul_f32 v193, v174, v191
v_fma_f32 v194, -v193, v190, v174
v_fma_f32 v174, v194, v191, v193
v_mul_f32 v193, v175, v191
v_fma_f32 v194, -v193, v190, v175
v_fma_f32 v175, v194, v191, v193
v_cvt_pk_bf16_f32 v128, v144, v145
v_cvt_pk_bf16_f32 v129, v146, v147
v_cvt_pk_bf16_f32 v130, v152, v153
v_cvt_pk_bf16_f32 v131, v154, v155
buffer_store_dwordx4 v[128:131], v182, s[8:11], s21 offen offset:0 sc1
v_cvt_pk_bf16_f32 v132, v148, v149
v_cvt_pk_bf16_f32 v133, v150, v151
v_cvt_pk_bf16_f32 v134, v156, v157
v_cvt_pk_bf16_f32 v135, v158, v159
buffer_store_dwordx4 v[132:135], v182, s[8:11], s21 offen offset:512 sc1
v_cvt_pk_bf16_f32 v136, v160, v161
v_cvt_pk_bf16_f32 v137, v162, v163
v_cvt_pk_bf16_f32 v138, v168, v169
v_cvt_pk_bf16_f32 v139, v170, v171
buffer_store_dwordx4 v[136:139], v182, s[8:11], s21 offen offset:1024 sc1
v_cvt_pk_bf16_f32 v140, v164, v165
v_cvt_pk_bf16_f32 v141, v166, v167
v_cvt_pk_bf16_f32 v142, v172, v173
v_cvt_pk_bf16_f32 v143, v174, v175
buffer_store_dwordx4 v[140:143], v182, s[8:11], s21 offen offset:1536 sc1
s_mov_b32 s21, 0x05040100
s_mov_b32 s22, 0x07060302
s_lshl_b32 s20, s2, 12
s_add_u32 s20, s20, 0x6440000
s_cmp_lt_u32 s2, 16
s_cselect_b32 s20, s20, 0x40000000
v_lshlrev_b32 v182, 4, v0
s_waitcnt vmcnt(15)
v_perm_b32 v144, v178, v176, s21
v_perm_b32 v145, v178, v176, s22
v_perm_b32 v146, v179, v177, s21
v_perm_b32 v147, v179, v177, s22
buffer_store_dwordx4 v[144:147], v182, s[8:11], s20 offen sc1
main_kernel_nk:
buffer_load_dwordx4 v92, s[12:15], s60 offen nt lds
s_add_u32 m0, m0, 1024
s_add_u32 s60, s60, s61
buffer_load_dwordx4 v93, s[12:15], s60 offen nt lds
s_add_u32 m0, m0, 1024
s_add_u32 s60, s60, s61
buffer_load_dwordx4 v92, s[12:15], s60 offen nt lds
s_add_u32 m0, m0, 1024
s_add_u32 s60, s60, s61
buffer_load_dwordx4 v93, s[12:15], s60 offen nt lds
s_add_u32 m0, m0, 1024
s_add_u32 s60, s60, s61
buffer_load_dwordx4 v92, s[12:15], s60 offen nt lds
s_add_u32 m0, m0, 1024
s_add_u32 s60, s60, s61
buffer_load_dwordx4 v93, s[12:15], s60 offen nt lds
s_add_u32 m0, m0, 1024
s_add_u32 s60, s60, s61
buffer_load_dwordx4 v92, s[12:15], s60 offen nt lds
s_add_u32 m0, m0, 1024
s_add_u32 s60, s60, s61
buffer_load_dwordx4 v93, s[12:15], s60 offen nt lds
s_waitcnt vmcnt(8)
s_barrier
s_lshr_b32 s56, s2, 3
s_lshl_b32 s56, 1, s56
v_mov_b32 v212, s56
v_mov_b32 v213, 0x100
s_lshl_b32 s56, s7, 3
s_add_u32 s56, s56, 128
s_cmp_eq_u32 s3, 0
s_cselect_b32 s56, s56, 0x40000000
v_cmp_eq_u32 vcc, 0, v0
v_mov_b32 v214, 0x40000000
s_nop 0
v_cndmask_b32 v214, v214, 0, vcc
buffer_atomic_add_x2 v[212:213], v214, s[64:67], s56 offen sc1
s_mov_b32 s25, s24
s_cmp_ge_u32 s72, 4
s_cbranch_scc1 main_kernel_w1
s_mov_b32 s25, s72
s_mov_b32 s26, s73
s_mov_b32 s27, s24
v_lshrrev_b32 v2, 2, v1
v_and_b32 v3, 3, v1
v_lshlrev_b32 v3, 4, v3
s_lshl_b32 s36, s25, 5
s_add_u32 s36, s36, s26
s_lshl_b32 s36, s36, 6
s_lshl_b32 s37, s27, 21
s_add_u32 s36, s36, s37
v_lshl_add_u32 v100, v2, 13, v3
v_add_u32 v100, s36, v100
s_lshl_b32 s36, s25, 21
s_lshl_b32 s37, s27, 19
s_add_u32 s36, s36, s37
s_lshl_b32 s37, s26, 6
s_add_u32 s36, s36, s37
v_lshl_add_u32 v101, v2, 11, v3
v_add_u32 v101, s36, v101
s_lshl_b32 s38, s27, 15
s_mov_b32 s40, s78
s_mov_b32 s41, s79
s_mov_b32 s42, 0x800000
s_mov_b32 s43, 0x00020000
s_lshr_b32 s20, s78, 7
s_sub_u32 s20, 3, s20
s_and_b32 s20, s20, 7
s_lshl_b32 s20, s20, 7
s_lshl_b32 s21, s72, 11
s_add_u32 s20, s20, s21
s_lshl_b32 s21, s73, 18
s_add_u32 s20, s20, s21
s_cmp_eq_u32 s24, 0
s_cselect_b32 s20, s20, 0x40000000
v_lshrrev_b32 v2, 1, v1
v_lshlrev_b32 v2, 13, v2
v_and_b32 v3, 1, v1
v_lshl_add_u32 v3, v3, 10, v2
buffer_load_dword v216, v3, s[40:43], s20 offen
s_add_u32 s21, s21, 8064
s_lshl_b32 s20, s72, 2
s_add_u32 s20, s20, s24
s_cmp_eq_u32 s20, 14
s_cselect_b32 s20, s21, 0x40000000
buffer_load_dword v216, v2, s[40:43], s20 offen
s_mov_b32 s40, s80
s_mov_b32 s41, s81
s_mov_b32 s42, 0x800000
s_mov_b32 s43, 0x00020000
s_lshr_b32 s20, s80, 7
s_sub_u32 s20, 3, s20
s_and_b32 s20, s20, 7
s_lshl_b32 s20, s20, 7
s_lshl_b32 s21, s72, 11
s_add_u32 s20, s20, s21
s_lshl_b32 s21, s73, 18
s_add_u32 s20, s20, s21
s_cmp_eq_u32 s24, 1
s_cselect_b32 s20, s20, 0x40000000
v_lshrrev_b32 v2, 1, v1
v_lshlrev_b32 v2, 13, v2
v_and_b32 v3, 1, v1
v_lshl_add_u32 v3, v3, 10, v2
buffer_load_dword v216, v3, s[40:43], s20 offen
s_add_u32 s21, s21, 8064
s_lshl_b32 s20, s72, 2
s_add_u32 s20, s20, s24
s_cmp_eq_u32 s20, 15
s_cselect_b32 s20, s21, 0x40000000
buffer_load_dword v216, v2, s[40:43], s20 offen
s_mov_b32 s12, s82
s_mov_b32 s13, s83
s_mov_b32 s14, 0x800000
s_mov_b32 s15, 0x00020000
s_and_b32 s36, s26, 1
s_lshl_b32 s37, s36, 13
s_add_u32 s37, s37, s38
s_add_u32 m0, s37, 16384
s_mul_i32 s39, s36, 262144
buffer_load_dwordx4 v101, s[12:15], s39 offen nt lds
s_add_u32 m0, m0, 1024
s_add_u32 s39, s39, 32768
buffer_load_dwordx4 v101, s[12:15], s39 offen nt lds
s_add_u32 m0, m0, 1024
s_add_u32 s39, s39, 32768
buffer_load_dwordx4 v101, s[12:15], s39 offen nt lds
s_add_u32 m0, m0, 1024
s_add_u32 s39, s39, 32768
buffer_load_dwordx4 v101, s[12:15], s39 offen nt lds
s_add_u32 m0, m0, 1024
s_add_u32 s39, s39, 32768
buffer_load_dwordx4 v101, s[12:15], s39 offen nt lds
s_add_u32 m0, m0, 1024
s_add_u32 s39, s39, 32768
buffer_load_dwordx4 v101, s[12:15], s39 offen nt lds
s_add_u32 m0, m0, 1024
s_add_u32 s39, s39, 32768
buffer_load_dwordx4 v101, s[12:15], s39 offen nt lds
s_add_u32 m0, m0, 1024
s_add_u32 s39, s39, 32768
buffer_load_dwordx4 v101, s[12:15], s39 offen nt lds
s_xor_b32 s36, s36, 1
s_lshl_b32 s37, s36, 13
s_add_u32 s37, s37, s38
s_add_u32 m0, s37, 16384
s_mul_i32 s39, s36, 262144
buffer_load_dwordx4 v101, s[12:15], s39 offen nt lds
s_add_u32 m0, m0, 1024
s_add_u32 s39, s39, 32768
buffer_load_dwordx4 v101, s[12:15], s39 offen nt lds
s_add_u32 m0, m0, 1024
s_add_u32 s39, s39, 32768
buffer_load_dwordx4 v101, s[12:15], s39 offen nt lds
s_add_u32 m0, m0, 1024
s_add_u32 s39, s39, 32768
buffer_load_dwordx4 v101, s[12:15], s39 offen nt lds
s_add_u32 m0, m0, 1024
s_add_u32 s39, s39, 32768
buffer_load_dwordx4 v101, s[12:15], s39 offen nt lds
s_add_u32 m0, m0, 1024
s_add_u32 s39, s39, 32768
buffer_load_dwordx4 v101, s[12:15], s39 offen nt lds
s_add_u32 m0, m0, 1024
s_add_u32 s39, s39, 32768
buffer_load_dwordx4 v101, s[12:15], s39 offen nt lds
s_add_u32 m0, m0, 1024
s_add_u32 s39, s39, 32768
buffer_load_dwordx4 v101, s[12:15], s39 offen nt lds
s_lshl_b32 s38, s27, 15
v_and_b32 v2, 3, v1
v_lshl_add_u32 v2, v2, 3, s38
v_bfe_u32 v6, v1, 2, 1
v_bfe_u32 v3, v1, 3, 1
v_bfe_u32 v4, v1, 4, 1
v_lshrrev_b32 v5, 5, v1
v_lshl_add_u32 v2, v3, 8, v2
v_lshl_add_u32 v2, v5, 9, v2
v_lshl_add_u32 v102, v6, 10, v2
v_lshl_add_u32 v102, v4, 7, v102
v_lshl_add_u32 v103, v6, 6, v2
v_lshl_add_u32 v103, v4, 10, v103
s_waitcnt vmcnt(16)
ds_read_b64_tr_b16 a[0:1], v102 offset:0
ds_read_b64_tr_b16 a[2:3], v102 offset:64
ds_read_b64_tr_b16 a[4:5], v102 offset:2048
ds_read_b64_tr_b16 a[6:7], v102 offset:2112
ds_read_b64_tr_b16 a[8:9], v102 offset:4096
ds_read_b64_tr_b16 a[10:11], v102 offset:4160
ds_read_b64_tr_b16 a[12:13], v102 offset:6144
ds_read_b64_tr_b16 a[14:15], v102 offset:6208
ds_read_b64_tr_b16 a[16:17], v102 offset:8192
ds_read_b64_tr_b16 a[18:19], v102 offset:8256
ds_read_b64_tr_b16 a[20:21], v102 offset:10240
ds_read_b64_tr_b16 a[22:23], v102 offset:10304
ds_read_b64_tr_b16 a[24:25], v102 offset:12288
ds_read_b64_tr_b16 a[26:27], v102 offset:12352
ds_read_b64_tr_b16 a[28:29], v102 offset:14336
ds_read_b64_tr_b16 a[30:31], v102 offset:14400
ds_read_b64_tr_b16 a[32:33], v102 offset:32
ds_read_b64_tr_b16 a[34:35], v102 offset:96
ds_read_b64_tr_b16 a[36:37], v102 offset:2080
ds_read_b64_tr_b16 a[38:39], v102 offset:2144
ds_read_b64_tr_b16 a[40:41], v102 offset:4128
ds_read_b64_tr_b16 a[42:43], v102 offset:4192
ds_read_b64_tr_b16 a[44:45], v102 offset:6176
ds_read_b64_tr_b16 a[46:47], v102 offset:6240
ds_read_b64_tr_b16 a[48:49], v102 offset:8224
ds_read_b64_tr_b16 a[50:51], v102 offset:8288
ds_read_b64_tr_b16 a[52:53], v102 offset:10272
ds_read_b64_tr_b16 a[54:55], v102 offset:10336
ds_read_b64_tr_b16 a[56:57], v102 offset:12320
ds_read_b64_tr_b16 a[58:59], v102 offset:12384
ds_read_b64_tr_b16 a[60:61], v102 offset:14368
ds_read_b64_tr_b16 a[62:63], v102 offset:14432
s_waitcnt lgkmcnt(0)
s_mov_b32 s12, s78
s_mov_b32 s13, s79
s_mov_b32 s14, 0x800000
s_mov_b32 s15, 0x00020000
s_and_b32 s36, s26, 1
s_lshl_b32 s37, s36, 13
s_add_u32 s37, s37, s38
s_add_u32 m0, s37, 0
s_mul_i32 s39, s36, 1048576
buffer_load_dwordx4 v100, s[12:15], s39 offen nt lds
s_add_u32 m0, m0, 1024
s_add_u32 s39, s39, 131072
buffer_load_dwordx4 v100, s[12:15], s39 offen nt lds
s_add_u32 m0, m0, 1024
s_add_u32 s39, s39, 131072
buffer_load_dwordx4 v100, s[12:15], s39 offen nt lds
s_add_u32 m0, m0, 1024
s_add_u32 s39, s39, 131072
buffer_load_dwordx4 v100, s[12:15], s39 offen nt lds
s_add_u32 m0, m0, 1024
s_add_u32 s39, s39, 131072
buffer_load_dwordx4 v100, s[12:15], s39 offen nt lds
s_add_u32 m0, m0, 1024
s_add_u32 s39, s39, 131072
buffer_load_dwordx4 v100, s[12:15], s39 offen nt lds
s_add_u32 m0, m0, 1024
s_add_u32 s39, s39, 131072
buffer_load_dwordx4 v100, s[12:15], s39 offen nt lds
s_add_u32 m0, m0, 1024
s_add_u32 s39, s39, 131072
buffer_load_dwordx4 v100, s[12:15], s39 offen nt lds
s_xor_b32 s36, s36, 1
s_lshl_b32 s37, s36, 13
s_add_u32 s37, s37, s38
s_add_u32 m0, s37, 0
s_mul_i32 s39, s36, 1048576
buffer_load_dwordx4 v100, s[12:15], s39 offen nt lds
s_add_u32 m0, m0, 1024
s_add_u32 s39, s39, 131072
buffer_load_dwordx4 v100, s[12:15], s39 offen nt lds
s_add_u32 m0, m0, 1024
s_add_u32 s39, s39, 131072
buffer_load_dwordx4 v100, s[12:15], s39 offen nt lds
s_add_u32 m0, m0, 1024
s_add_u32 s39, s39, 131072
buffer_load_dwordx4 v100, s[12:15], s39 offen nt lds
s_add_u32 m0, m0, 1024
s_add_u32 s39, s39, 131072
buffer_load_dwordx4 v100, s[12:15], s39 offen nt lds
s_add_u32 m0, m0, 1024
s_add_u32 s39, s39, 131072
buffer_load_dwordx4 v100, s[12:15], s39 offen nt lds
s_add_u32 m0, m0, 1024
s_add_u32 s39, s39, 131072
buffer_load_dwordx4 v100, s[12:15], s39 offen nt lds
s_add_u32 m0, m0, 1024
s_add_u32 s39, s39, 131072
buffer_load_dwordx4 v100, s[12:15], s39 offen nt lds
s_waitcnt vmcnt(16)
ds_read_b64_tr_b16 a[192:193], v103 offset:16384
ds_read_b64_tr_b16 a[194:195], v103 offset:16512
ds_read_b64_tr_b16 a[196:197], v103 offset:18432
ds_read_b64_tr_b16 a[198:199], v103 offset:18560
ds_read_b64_tr_b16 a[200:201], v103 offset:20480
ds_read_b64_tr_b16 a[202:203], v103 offset:20608
ds_read_b64_tr_b16 a[204:205], v103 offset:22528
ds_read_b64_tr_b16 a[206:207], v103 offset:22656
ds_read_b64_tr_b16 a[208:209], v103 offset:24576
ds_read_b64_tr_b16 a[210:211], v103 offset:24704
ds_read_b64_tr_b16 a[212:213], v103 offset:26624
ds_read_b64_tr_b16 a[214:215], v103 offset:26752
ds_read_b64_tr_b16 a[216:217], v103 offset:28672
ds_read_b64_tr_b16 a[218:219], v103 offset:28800
ds_read_b64_tr_b16 a[220:221], v103 offset:30720
ds_read_b64_tr_b16 a[222:223], v103 offset:30848
ds_read_b64_tr_b16 a[224:225], v103 offset:16416
ds_read_b64_tr_b16 a[226:227], v103 offset:16544
ds_read_b64_tr_b16 a[228:229], v103 offset:18464
ds_read_b64_tr_b16 a[230:231], v103 offset:18592
ds_read_b64_tr_b16 a[232:233], v103 offset:20512
ds_read_b64_tr_b16 a[234:235], v103 offset:20640
ds_read_b64_tr_b16 a[236:237], v103 offset:22560
ds_read_b64_tr_b16 a[238:239], v103 offset:22688
ds_read_b64_tr_b16 a[240:241], v103 offset:24608
ds_read_b64_tr_b16 a[242:243], v103 offset:24736
ds_read_b64_tr_b16 a[244:245], v103 offset:26656
ds_read_b64_tr_b16 a[246:247], v103 offset:26784
ds_read_b64_tr_b16 a[248:249], v103 offset:28704
ds_read_b64_tr_b16 a[250:251], v103 offset:28832
ds_read_b64_tr_b16 a[252:253], v103 offset:30752
ds_read_b64_tr_b16 a[254:255], v103 offset:30880
s_waitcnt lgkmcnt(0)
s_mov_b32 s12, s80
s_mov_b32 s13, s81
s_mov_b32 s14, 0x800000
s_mov_b32 s15, 0x00020000
s_and_b32 s36, s26, 1
s_lshl_b32 s37, s36, 13
s_add_u32 s37, s37, s38
s_add_u32 m0, s37, 16384
s_mul_i32 s39, s36, 1048576
buffer_load_dwordx4 v100, s[12:15], s39 offen nt lds
s_add_u32 m0, m0, 1024
s_add_u32 s39, s39, 131072
buffer_load_dwordx4 v100, s[12:15], s39 offen nt lds
s_add_u32 m0, m0, 1024
s_add_u32 s39, s39, 131072
buffer_load_dwordx4 v100, s[12:15], s39 offen nt lds
s_add_u32 m0, m0, 1024
s_add_u32 s39, s39, 131072
buffer_load_dwordx4 v100, s[12:15], s39 offen nt lds
s_add_u32 m0, m0, 1024
s_add_u32 s39, s39, 131072
buffer_load_dwordx4 v100, s[12:15], s39 offen nt lds
s_add_u32 m0, m0, 1024
s_add_u32 s39, s39, 131072
buffer_load_dwordx4 v100, s[12:15], s39 offen nt lds
s_add_u32 m0, m0, 1024
s_add_u32 s39, s39, 131072
buffer_load_dwordx4 v100, s[12:15], s39 offen nt lds
s_add_u32 m0, m0, 1024
s_add_u32 s39, s39, 131072
buffer_load_dwordx4 v100, s[12:15], s39 offen nt lds
s_xor_b32 s36, s36, 1
s_lshl_b32 s37, s36, 13
s_add_u32 s37, s37, s38
s_add_u32 m0, s37, 16384
s_mul_i32 s39, s36, 1048576
buffer_load_dwordx4 v100, s[12:15], s39 offen nt lds
s_add_u32 m0, m0, 1024
s_add_u32 s39, s39, 131072
buffer_load_dwordx4 v100, s[12:15], s39 offen nt lds
s_add_u32 m0, m0, 1024
s_add_u32 s39, s39, 131072
buffer_load_dwordx4 v100, s[12:15], s39 offen nt lds
s_add_u32 m0, m0, 1024
s_add_u32 s39, s39, 131072
buffer_load_dwordx4 v100, s[12:15], s39 offen nt lds
s_add_u32 m0, m0, 1024
s_add_u32 s39, s39, 131072
buffer_load_dwordx4 v100, s[12:15], s39 offen nt lds
s_add_u32 m0, m0, 1024
s_add_u32 s39, s39, 131072
buffer_load_dwordx4 v100, s[12:15], s39 offen nt lds
s_add_u32 m0, m0, 1024
s_add_u32 s39, s39, 131072
buffer_load_dwordx4 v100, s[12:15], s39 offen nt lds
s_add_u32 m0, m0, 1024
s_add_u32 s39, s39, 131072
buffer_load_dwordx4 v100, s[12:15], s39 offen nt lds
s_add_u32 s8, s4, 0x6400000
s_addc_u32 s9, s5, 0
s_mov_b32 s10, 0x220000
s_mov_b32 s11, 0x00020000
s_add_u32 s12, s4, 0x1400000
s_addc_u32 s13, s5, 0
s_mov_b32 s14, 0x2000000
s_mov_b32 s15, 0x00020000
s_add_u32 s16, s4, 0x5c00000
s_addc_u32 s17, s5, 0
s_mov_b32 s18, 0x800000
s_mov_b32 s19, 0x00020000
v_and_b32 v3, 15, v1
v_lshrrev_b32 v4, 4, v1
v_lshrrev_b32 v5, 5, v1
v_and_b32 v6, 1, v4
v_and_b32 v7, 7, v1
v_mov_b32 v8, 0x4444
v_mov_b32 v2, 0xeeee
v_and_b32 v11, 2, v1
v_cmp_ne_u32 vcc, 0, v11
s_nop 1
v_cndmask_b32 v8, v8, v2, vcc
v_lshlrev_b32 v2, 4, v1
v_and_b32 v11, 1, v1
s_lshl_b32 s36, s25, 14
s_lshl_b32 s37, s27, 12
s_add_u32 s37, s37, s36
s_add_u32 s37, s37, 262144
v_add_u32 v9, s37, v2
v_add_u32 v10, 65536, v9
v_mul_u32_u24 v11, 288, v11
v_lshl_add_u32 v11, v6, 4, v11
v_bfe_u32 v2, v1, 1, 2
v_lshl_add_u32 v11, v2, 6, v11
v_bfe_u32 v2, v1, 3, 1
v_lshl_add_u32 v2, v5, 1, v2
v_mul_u32_u24 v2, 768, v2
v_add_u32 v11, v11, v2
s_lshl_b32 s37, s27, 10
s_add_u32 s38, s37, 12288
v_lshl_add_u32 v12, v1, 3, s38
s_add_u32 s38, s37, 16384
v_lshl_add_u32 v14, v1, 4, s38
v_lshlrev_b32 v15, 4, v1
v_add_u32 v15, 16384, v15
v_lshlrev_b32 v13, 3, v1
v_lshl_add_u32 v2, v5, 5, v3
v_lshlrev_b32 v2, 3, v2
v_lshl_add_u32 v2, v6, 9, v2
s_cmp_eq_u32 s27, 1
s_cselect_b64 vcc, -1, 0
v_cndmask_b32 v13, v13, v2, vcc
v_add_u32 v13, 12288, v13
s_lshr_b32 s36, s26, 2
s_lshl_b32 s37, s25, 3
s_add_u32 s36, s36, s37
s_and_b32 s37, s26, 3
s_mul_i32 s38, s36, 5120
s_add_u32 s38, s38, 393216
s_mul_i32 s39, s37, 1280
s_add_u32 s39, s39, s38
v_lshl_add_u32 v2, v4, 3, v7
v_lshlrev_b32 v2, 4, v2
v_mov_b32 v29, 0x40000000
v_add_u32 v16, s39, v2
v_cmp_gt_u32 vcc, 8, v3
s_nop 1
v_cndmask_b32 v16, v29, v16, vcc
v_add_u32 v17, 768, v16
v_cmp_lt_u32 vcc, 1, v4
s_nop 1
v_cndmask_b32 v17, v29, v17, vcc
v_bfe_u32 v19, v1, 3, 1
v_lshl_add_u32 v18, v19, 9, v2
v_add_u32 v18, s38, v18
v_lshl_add_u32 v19, v6, 1, v19
v_lshlrev_b32 v19, 2, v19
v_lshl_add_u32 v19, v5, 7, v19
v_lshl_add_u32 v19, v7, 4, v19
s_add_u32 s38, s38, 1024
v_add_u32 v19, s38, v19
s_lshl_b32 s38, s25, 14
s_lshl_b32 s37, s26, 9
s_add_u32 s38, s38, s37
v_lshlrev_b32 v20, 8, v5
v_lshl_add_u32 v20, v6, 5, v20
v_bfe_u32 v25, v1, 1, 2
v_lshl_add_u32 v20, v25, 6, v20
v_and_b32 v25, 1, v1
v_lshl_add_u32 v20, v25, 4, v20
v_add_u32 v20, s38, v20
v_add_u32 v20, 327680, v20
v_cmp_gt_u32 vcc, 8, v3
s_nop 1
v_cndmask_b32 v20, v29, v20, vcc
v_bfe_u32 v25, v1, 3, 1
v_lshlrev_b32 v25, 8, v25
v_lshl_add_u32 v25, v4, 6, v25
v_bfe_u32 v28, v1, 2, 1
v_lshl_add_u32 v25, v28, 5, v25
v_and_b32 v28, 3, v1
v_lshl_add_u32 v25, v28, 2, v25
v_add_u32 v25, s38, v25
v_add_u32 v25, 262144, v25
s_cmp_eq_u32 s27, 1
s_cselect_b32 s37, 65536, 0
s_add_u32 s37, s37, 262144
s_add_u32 s37, s37, s38
v_lshl_add_u32 v31, v1, 4, s37
v_cmp_gt_u32 vcc, 32, v1
s_nop 1
v_cndmask_b32 v31, v29, v31, vcc
s_add_u32 s37, s39, 1024
v_lshl_add_u32 v30, v1, 4, s37
v_cmp_gt_u32 vcc, 16, v1
s_nop 1
v_cndmask_b32 v30, v29, v30, vcc
s_lshl_b32 s36, s25, 5
s_add_u32 s36, s36, s26
s_lshl_b32 s37, s36, 9
v_add_u32 v28, s37, v2
v_cmp_lt_u32 vcc, 7, v3
s_nop 1
v_cndmask_b32 v28, v29, v28, vcc
s_add_u32 s37, s37, 4194304
v_lshl_add_u32 v2, v1, 3, s37
s_cmp_eq_u32 s27, 1
s_cselect_b64 vcc, -1, 0
v_cndmask_b32 v28, v28, v2, vcc
s_lshr_b32 s37, s26, 1
s_lshl_b32 s37, s37, 14
s_and_b32 s38, s26, 1
s_lshl_b32 s38, s38, 12
s_add_u32 s37, s37, s38
s_lshl_b32 s38, s25, 10
s_add_u32 s37, s37, s38
v_lshl_add_u32 v21, v1, 4, s37
v_xor_b32 v22, 1024, v21
v_xor_b32 v23, 2048, v21
v_xor_b32 v24, 3072, v21
v_lshl_add_u32 v2, v1, 4, s39
v_cndmask_b32 v29, v21, v2, vcc
s_lshl_b32 s37, s36, 11
v_lshlrev_b32 v2, 10, v5
v_lshl_add_u32 v2, v6, 9, v2
v_add_u32 v2, s37, v2
v_lshl_add_u32 v27, v3, 4, v2
v_add_u32 v27, 16777216, v27
v_and_b32 v26, 8, v1
v_lshl_add_u32 v26, v26, 1, v7
v_lshl_add_u32 v26, v26, 4, v2
v_mov_b32 v196, -1
v_mov_b32 v180, 0
v_mov_b32 v197, -1
v_mov_b32 v181, 0
v_mov_b32 v198, -1
v_mov_b32 v182, 0
v_mov_b32 v199, -1
v_mov_b32 v183, 0
v_mov_b32 v172, 0
v_mov_b32 v173, 0
v_mov_b32 v174, 0
v_mov_b32 v175, 0
v_mov_b32 v176, 0
v_mov_b32 v177, 0
v_mov_b32 v178, 0
v_mov_b32 v179, 0
s_mov_b32 s32, 0
s_mov_b32 s35, 0x3e0293ee
s_waitcnt vmcnt(16)
buffer_load_dwordx2 v[210:211], v209, s[64:67], 0 offen offset:128
ds_read_b64_tr_b16 a[64:65], v102 offset:0
ds_read_b64_tr_b16 a[66:67], v102 offset:64
ds_read_b64_tr_b16 a[68:69], v102 offset:2048
ds_read_b64_tr_b16 a[70:71], v102 offset:2112
ds_read_b64_tr_b16 a[72:73], v102 offset:4096
ds_read_b64_tr_b16 a[74:75], v102 offset:4160
ds_read_b64_tr_b16 a[76:77], v102 offset:6144
ds_read_b64_tr_b16 a[78:79], v102 offset:6208
ds_read_b64_tr_b16 a[80:81], v102 offset:8192
ds_read_b64_tr_b16 a[82:83], v102 offset:8256
ds_read_b64_tr_b16 a[84:85], v102 offset:10240
ds_read_b64_tr_b16 a[86:87], v102 offset:10304
ds_read_b64_tr_b16 a[88:89], v102 offset:12288
ds_read_b64_tr_b16 a[90:91], v102 offset:12352
ds_read_b64_tr_b16 a[92:93], v102 offset:14336
ds_read_b64_tr_b16 a[94:95], v102 offset:14400
ds_read_b64_tr_b16 a[96:97], v102 offset:32
ds_read_b64_tr_b16 a[98:99], v102 offset:96
ds_read_b64_tr_b16 a[100:101], v102 offset:2080
ds_read_b64_tr_b16 a[102:103], v102 offset:2144
ds_read_b64_tr_b16 a[104:105], v102 offset:4128
ds_read_b64_tr_b16 a[106:107], v102 offset:4192
ds_read_b64_tr_b16 a[108:109], v102 offset:6176
ds_read_b64_tr_b16 a[110:111], v102 offset:6240
ds_read_b64_tr_b16 a[112:113], v102 offset:8224
ds_read_b64_tr_b16 a[114:115], v102 offset:8288
ds_read_b64_tr_b16 a[116:117], v102 offset:10272
ds_read_b64_tr_b16 a[118:119], v102 offset:10336
ds_read_b64_tr_b16 a[120:121], v102 offset:12320
ds_read_b64_tr_b16 a[122:123], v102 offset:12384
ds_read_b64_tr_b16 a[124:125], v102 offset:14368
ds_read_b64_tr_b16 a[126:127], v102 offset:14432
s_waitcnt lgkmcnt(0)
s_waitcnt vmcnt(0)
ds_read_b64_tr_b16 a[128:129], v102 offset:16384
ds_read_b64_tr_b16 a[130:131], v102 offset:16448
ds_read_b64_tr_b16 a[132:133], v102 offset:18432
ds_read_b64_tr_b16 a[134:135], v102 offset:18496
ds_read_b64_tr_b16 a[136:137], v102 offset:20480
ds_read_b64_tr_b16 a[138:139], v102 offset:20544
ds_read_b64_tr_b16 a[140:141], v102 offset:22528
ds_read_b64_tr_b16 a[142:143], v102 offset:22592
ds_read_b64_tr_b16 a[144:145], v102 offset:24576
ds_read_b64_tr_b16 a[146:147], v102 offset:24640
ds_read_b64_tr_b16 a[148:149], v102 offset:26624
ds_read_b64_tr_b16 a[150:151], v102 offset:26688
ds_read_b64_tr_b16 a[152:153], v102 offset:28672
ds_read_b64_tr_b16 a[154:155], v102 offset:28736
ds_read_b64_tr_b16 a[156:157], v102 offset:30720
ds_read_b64_tr_b16 a[158:159], v102 offset:30784
ds_read_b64_tr_b16 a[160:161], v102 offset:16416
ds_read_b64_tr_b16 a[162:163], v102 offset:16480
ds_read_b64_tr_b16 a[164:165], v102 offset:18464
ds_read_b64_tr_b16 a[166:167], v102 offset:18528
ds_read_b64_tr_b16 a[168:169], v102 offset:20512
ds_read_b64_tr_b16 a[170:171], v102 offset:20576
ds_read_b64_tr_b16 a[172:173], v102 offset:22560
ds_read_b64_tr_b16 a[174:175], v102 offset:22624
ds_read_b64_tr_b16 a[176:177], v102 offset:24608
ds_read_b64_tr_b16 a[178:179], v102 offset:24672
ds_read_b64_tr_b16 a[180:181], v102 offset:26656
ds_read_b64_tr_b16 a[182:183], v102 offset:26720
ds_read_b64_tr_b16 a[184:185], v102 offset:28704
ds_read_b64_tr_b16 a[186:187], v102 offset:28768
ds_read_b64_tr_b16 a[188:189], v102 offset:30752
ds_read_b64_tr_b16 a[190:191], v102 offset:30816
s_waitcnt lgkmcnt(0)
s_mul_i32 m0, s27, 3072
s_cmp_lg_u32 s27, 0
s_cbranch_scc1 main_kernel_c_ysk
s_mov_b32 s56, 2
s_cmp_lg_u32 s3, 0
s_cbranch_scc1 main_kernel_c_yok
main_kernel_c_ylp:
v_cmp_eq_u32 vcc, -1, v210
s_mov_b32 s57, 0x2000
v_cmp_eq_u32 s[58:59], s57, v211
s_and_b32 s58, s58, vcc_lo
s_and_b32 s58, s58, 0xff
v_readlane_b32 s56, v210, 8
s_cmp_eq_u32 s58, 0xff
s_cbranch_scc1 main_kernel_c_yfa
s_mov_b32 s57, 0
v_readlane_b32 s58, v211, 0
s_lshr_b32 s58, s58, 8
s_add_u32 s57, s57, s58
v_readlane_b32 s58, v211, 1
s_lshr_b32 s58, s58, 8
s_add_u32 s57, s57, s58
v_readlane_b32 s58, v211, 2
s_lshr_b32 s58, s58, 8
s_add_u32 s57, s57, s58
v_readlane_b32 s58, v211, 3
s_lshr_b32 s58, s58, 8
s_add_u32 s57, s57, s58
v_readlane_b32 s58, v211, 4
s_lshr_b32 s58, s58, 8
s_add_u32 s57, s57, s58
v_readlane_b32 s58, v211, 5
s_lshr_b32 s58, s58, 8
s_add_u32 s57, s57, s58
v_readlane_b32 s58, v211, 6
s_lshr_b32 s58, s58, 8
s_add_u32 s57, s57, s58
v_readlane_b32 s58, v211, 7
s_lshr_b32 s58, s58, 8
s_add_u32 s57, s57, s58
s_mov_b32 s56, 2
s_cmp_eq_u32 s57, 256
s_cbranch_scc1 main_kernel_c_yok
main_kernel_c_ylpr:
s_add_u32 s32, s32, 1
s_cmp_ge_u32 s32, 131072
s_cbranch_scc1 main_kernel_c_yok
s_sleep 4
buffer_load_dwordx2 v[210:211], v209, s[64:67], 0 offen offset:128 sc1
s_waitcnt vmcnt(0)
s_branch main_kernel_c_ylp
main_kernel_c_yfa:
s_cmp_lt_u32 s56, 0x4000000
s_cbranch_scc1 main_kernel_c_ylpr
s_cmp_gt_u32 s56, 0x4000400
s_cselect_b32 s56, 5, 1
main_kernel_c_yok:
v_mov_b32 v210, s56
v_mov_b32 v211, 131136
ds_write_b32 v211, v210
s_waitcnt lgkmcnt(0)
main_kernel_c_ysk:
s_barrier
v_mov_b32 v211, 131136
ds_read_b32 v210, v211
s_waitcnt lgkmcnt(0)
v_readfirstlane_b32 s6, v210
s_and_b32 s56, s6, 3
s_sub_u32 s56, s56, s3
s_cmp_eq_u32 s56, 2
s_cbranch_scc1 main_kernel_again
s_lshl_b32 s33, s6, 11
s_and_b32 s33, s33, 8192
v_add_u32 v21, s33, v21
v_add_u32 v22, s33, v22
v_add_u32 v23, s33, v23
v_add_u32 v24, s33, v24
s_cmp_eq_u32 s27, 1
s_cselect_b32 s36, 0, s33
v_add_u32 v29, s36, v29
s_cmp_lg_u32 s3, 0
s_cbranch_scc1 main_kernel_slow
s_add_u32 s20, s4, 0x6a00000
s_addc_u32 s21, s5, 0
s_mov_b32 s22, 0x8000
s_mov_b32 s23, 0x00020000
s_mov_b32 s92, 0
s_lshl_b32 s36, s25, 5
s_add_u32 s36, s36, s26
s_lshr_b32 s37, s36, 2
s_lshl_b32 s37, s37, 7
s_and_b32 s36, s36, 3
s_lshl_b32 s36, s36, 2
s_add_u32 s36, s36, s37
v_mov_b32 v33, 0x40000000
v_mov_b32 v34, 0x40000000
s_add_u32 s37, s36, 19968
v_writelane_b32 v33, s37, 0
s_add_u32 s37, s36, 0
v_writelane_b32 v34, s37, 0
s_add_u32 s37, s36, 4096
v_writelane_b32 v34, s37, 1
s_mov_b32 s24, 0
s_mov_b32 s33, 0
s_mov_b32 s34, 0
s_mov_b32 s28, 0
s_mov_b32 s29, 557056
s_mov_b32 s30, 1114112
s_mov_b32 s31, 1671168
v_mov_b32 v52, 0
v_mov_b32 v53, 0
v_mov_b32 v54, 0
v_mov_b32 v55, 0
v_mov_b32 v56, 0
v_mov_b32 v57, 0
v_mov_b32 v58, 0
v_mov_b32 v59, 0
v_mov_b32 v60, 0
v_mov_b32 v61, 0
v_mov_b32 v62, 0
v_mov_b32 v63, 0
v_mov_b32 v64, 0
v_mov_b32 v65, 0
v_mov_b32 v66, 0
v_mov_b32 v67, 0
v_mov_b32 v68, 0
v_mov_b32 v69, 0
v_mov_b32 v70, 0
v_mov_b32 v71, 0
v_mov_b32 v72, 0
v_mov_b32 v73, 0
v_mov_b32 v74, 0
v_mov_b32 v75, 0
v_mov_b32 v76, 0
v_mov_b32 v77, 0
v_mov_b32 v78, 0
v_mov_b32 v79, 0
v_mov_b32 v80, 0
v_mov_b32 v81, 0
v_mov_b32 v82, 0
v_mov_b32 v83, 0
s_cmp_lg_u32 s27, 0
s_cbranch_scc1 main_kernel_f_step
s_lshr_b32 s94, s33, 18
s_cmp_ge_u32 s94, s92
s_cbranch_scc1 Lkl_3
Lkg_1:
buffer_load_dwordx4 v[84:87], v26, s[12:15], s33 offen
buffer_load_dwordx4 v[88:91], v26, s[12:15], s33 offen offset:128
buffer_load_dwordx4 v[92:95], v27, s[12:15], s33 offen
buffer_load_dwordx4 v[96:99], v27, s[12:15], s33 offen offset:256
s_add_u32 s94, s94, 1
s_cmp_lt_u32 s94, s92
s_cbranch_scc1 Lkn_4
buffer_load_dword v32, v34, s[20:23], 0 offen sc1
Lkn_4:
main_kernel_f_step:
buffer_load_dwordx4 v[36:39], v9, s[8:11], s28 offen offset:0 sc1
buffer_load_dwordx4 v[40:43], v9, s[8:11], s28 offen offset:1024 sc1
buffer_load_dwordx4 v[44:47], v9, s[8:11], s28 offen offset:2048 sc1
buffer_load_dwordx4 v[48:51], v9, s[8:11], s28 offen offset:3072 sc1
s_waitcnt vmcnt(3)
v_max3_u32 v2, v36, v37, v38
v_max_u32 v2, v2, v39
v_cmp_eq_u32 vcc, -1, v2
s_cbranch_vccnz Lr_9
Lk_5:
v_smfmac_f32_16x16x64_bf16 v[52:55], v[36:39], a[0:7], v8
v_smfmac_f32_16x16x64_bf16 v[56:59], v[36:39], a[32:39], v8
s_waitcnt vmcnt(2)
v_max3_u32 v2, v40, v41, v42
v_max_u32 v2, v2, v43
v_cmp_eq_u32 vcc, -1, v2
v_smfmac_f32_16x16x64_bf16 v[60:63], v[36:39], a[64:71], v8
v_smfmac_f32_16x16x64_bf16 v[64:67], v[36:39], a[96:103], v8
s_cbranch_vccnz Lr_10
Lk_6:
v_smfmac_f32_16x16x64_bf16 v[52:55], v[40:43], a[8:15], v8
v_smfmac_f32_16x16x64_bf16 v[56:59], v[40:43], a[40:47], v8
s_waitcnt vmcnt(1)
v_max3_u32 v2, v44, v45, v46
v_max_u32 v2, v2, v47
v_cmp_eq_u32 vcc, -1, v2
v_smfmac_f32_16x16x64_bf16 v[60:63], v[40:43], a[72:79], v8
v_smfmac_f32_16x16x64_bf16 v[64:67], v[40:43], a[104:111], v8
s_cbranch_vccnz Lr_11
Lk_7:
v_smfmac_f32_16x16x64_bf16 v[52:55], v[44:47], a[16:23], v8
v_smfmac_f32_16x16x64_bf16 v[56:59], v[44:47], a[48:55], v8
s_waitcnt vmcnt(0)
v_max3_u32 v2, v48, v49, v50
v_max_u32 v2, v2, v51
v_cmp_eq_u32 vcc, -1, v2
v_smfmac_f32_16x16x64_bf16 v[60:63], v[44:47], a[80:87], v8
v_smfmac_f32_16x16x64_bf16 v[64:67], v[44:47], a[112:119], v8
s_cbranch_vccnz Lr_12
Lk_8:
v_smfmac_f32_16x16x64_bf16 v[52:55], v[48:51], a[24:31], v8
v_smfmac_f32_16x16x64_bf16 v[56:59], v[48:51], a[56:63], v8
v_smfmac_f32_16x16x64_bf16 v[60:63], v[48:51], a[88:95], v8
v_smfmac_f32_16x16x64_bf16 v[64:67], v[48:51], a[120:127], v8
v_smfmac_f32_16x16x64_bf16 v[68:71], v[36:39], a[128:135], v8
v_smfmac_f32_16x16x64_bf16 v[72:75], v[36:39], a[160:167], v8
s_nop 2
v_pk_add_f32 v[52:53], v[52:53], v[54:55]
ds_write_addtid_b32 v52 offset:0
ds_write_addtid_b32 v53 offset:288
v_pk_add_f32 v[56:57], v[56:57], v[58:59]
ds_write_addtid_b32 v56 offset:1536
ds_write_addtid_b32 v57 offset:1824
v_pk_add_f32 v[60:61], v[60:61], v[62:63]
ds_write_addtid_b32 v60 offset:768
ds_write_addtid_b32 v61 offset:1056
v_pk_add_f32 v[64:65], v[64:65], v[66:67]
ds_write_addtid_b32 v64 offset:2304
ds_write_addtid_b32 v65 offset:2592
s_cmp_eq_u32 s27, 0
s_waitcnt lgkmcnt(0)
s_barrier
s_cbranch_scc1 main_kernel_f_w0
v_smfmac_f32_16x16x64_bf16 v[68:71], v[40:43], a[136:143], v8
v_smfmac_f32_16x16x64_bf16 v[72:75], v[40:43], a[168:175], v8
v_smfmac_f32_16x16x64_bf16 v[68:71], v[44:47], a[144:151], v8
v_smfmac_f32_16x16x64_bf16 v[72:75], v[44:47], a[176:183], v8
v_smfmac_f32_16x16x64_bf16 v[68:71], v[48:51], a[152:159], v8
v_smfmac_f32_16x16x64_bf16 v[72:75], v[48:51], a[184:191], v8
s_nop 6
v_pk_add_f32 v[68:69], v[68:69], v[70:71]
v_pk_add_f32 v[70:71], v[72:73], v[74:75]
ds_write2st64_b64 v12, v[68:69], v[70:71] offset0:0 offset1:1
s_waitcnt lgkmcnt(0)
s_barrier
s_cmp_eq_u32 s27, 2
s_cbranch_scc1 main_kernel_f_w2
s_cmp_eq_u32 s27, 3
s_cbranch_scc1 main_kernel_f_b4
ds_read2_b64 v[100:103], v13 offset0:0 offset1:16
v_add_u32 v2, 2048, v13
ds_read2_b64 v[104:107], v13 offset0:128 offset1:144
ds_read2_b64 v[108:111], v2 offset0:0 offset1:16
ds_read2_b64 v[112:115], v2 offset0:128 offset1:144
s_waitcnt lgkmcnt(0)
v_pk_add_f32 v[100:101], v[100:101], v[104:105]
v_pk_add_f32 v[108:109], v[108:109], v[112:113]
v_pk_add_f32 v[102:103], v[102:103], v[106:107]
v_pk_add_f32 v[110:111], v[110:111], v[114:115]
v_pk_add_f32 v[100:101], v[100:101], v[108:109]
v_pk_add_f32 v[102:103], v[102:103], v[110:111]
v_cvt_pk_bf16_f32 v132, v100, v101
v_cvt_pk_bf16_f32 v133, v102, v103
s_cmp_lt_u32 s24, 58
s_cbranch_scc1 main_kernel_f_b4
buffer_store_dwordx2 v[132:133], v28, s[16:19], s34 offen sc1
s_branch main_kernel_f_b4
main_kernel_f_w2:
ds_read_b128 v[100:103], v11 offset:0
ds_read_b128 v[104:107], v11 offset:32
ds_read_b128 v[108:111], v11 offset:3072
ds_read_b128 v[112:115], v11 offset:3104
ds_read_b128 v[116:119], v11 offset:6144
ds_read_b128 v[120:123], v11 offset:6176
ds_read_b128 v[124:127], v11 offset:9216
ds_read_b128 v[128:131], v11 offset:9248
s_waitcnt lgkmcnt(4)
v_pk_add_f32 v[100:101], v[100:101], v[108:109]
v_pk_add_f32 v[102:103], v[102:103], v[110:111]
v_pk_add_f32 v[104:105], v[104:105], v[112:113]
v_pk_add_f32 v[106:107], v[106:107], v[114:115]
s_waitcnt lgkmcnt(0)
v_pk_add_f32 v[116:117], v[116:117], v[124:125]
v_pk_add_f32 v[118:119], v[118:119], v[126:127]
v_pk_add_f32 v[120:121], v[120:121], v[128:129]
v_pk_add_f32 v[122:123], v[122:123], v[130:131]
v_pk_add_f32 v[100:101], v[100:101], v[116:117]
v_pk_add_f32 v[102:103], v[102:103], v[118:119]
v_pk_add_f32 v[104:105], v[104:105], v[120:121]
v_pk_add_f32 v[106:107], v[106:107], v[122:123]
v_cvt_pk_bf16_f32 v132, v100, v101
v_cvt_pk_bf16_f32 v133, v102, v103
v_cvt_pk_bf16_f32 v134, v104, v105
v_cvt_pk_bf16_f32 v135, v106, v107
s_cmp_lt_u32 s24, 58
s_cbranch_scc1 main_kernel_f_b4
buffer_store_dwordx4 v[132:135], v28, s[16:19], s34 offen sc1
s_branch main_kernel_f_b4
main_kernel_f_w0:
ds_read_b128 v[100:103], v11 offset:0
ds_read_b128 v[104:107], v11 offset:32
ds_read_b128 v[108:111], v11 offset:3072
ds_read_b128 v[112:115], v11 offset:3104
ds_read_b128 v[116:119], v11 offset:6144
ds_read_b128 v[120:123], v11 offset:6176
ds_read_b128 v[124:127], v11 offset:9216
ds_read_b128 v[128:131], v11 offset:9248
v_smfmac_f32_16x16x64_bf16 v[68:71], v[40:43], a[136:143], v8
v_smfmac_f32_16x16x64_bf16 v[72:75], v[40:43], a[168:175], v8
v_smfmac_f32_16x16x64_bf16 v[68:71], v[44:47], a[144:151], v8
v_smfmac_f32_16x16x64_bf16 v[72:75], v[44:47], a[176:183], v8
v_smfmac_f32_16x16x64_bf16 v[68:71], v[48:51], a[152:159], v8
v_smfmac_f32_16x16x64_bf16 v[72:75], v[48:51], a[184:191], v8
s_waitcnt lgkmcnt(4)
v_pk_add_f32 v[100:101], v[100:101], v[108:109]
v_pk_add_f32 v[102:103], v[102:103], v[110:111]
v_pk_add_f32 v[104:105], v[104:105], v[112:113]
v_pk_add_f32 v[106:107], v[106:107], v[114:115]
s_waitcnt lgkmcnt(0)
v_pk_add_f32 v[116:117], v[116:117], v[124:125]
v_pk_add_f32 v[118:119], v[118:119], v[126:127]
v_pk_add_f32 v[120:121], v[120:121], v[128:129]
v_pk_add_f32 v[122:123], v[122:123], v[130:131]
v_pk_add_f32 v[100:101], v[100:101], v[116:117]
v_pk_add_f32 v[102:103], v[102:103], v[118:119]
v_pk_add_f32 v[104:105], v[104:105], v[120:121]
v_pk_add_f32 v[106:107], v[106:107], v[122:123]
v_cvt_pk_bf16_f32 v132, v100, v101
v_cvt_pk_bf16_f32 v133, v102, v103
v_cvt_pk_bf16_f32 v134, v104, v105
v_cvt_pk_bf16_f32 v135, v106, v107
s_nop 1
v_mfma_f32_16x16x32_bf16 v[136:139], v[84:87], v[132:135], 0
v_mfma_f32_16x16x32_bf16 v[140:143], v[88:91], v[132:135], 0
v_mfma_f32_16x16x32_bf16 v[144:147], v[132:135], v[132:135], 0
s_nop 5
buffer_store_dwordx4 v[136:139], v16, s[8:11], s28 offen
buffer_store_dwordx4 v[140:143], v16, s[8:11], s28 offen offset:512
buffer_store_dwordx4 v[144:147], v17, s[8:11], s28 offen
v_pk_add_f32 v[68:69], v[68:69], v[70:71]
v_pk_add_f32 v[70:71], v[72:73], v[74:75]
ds_write2st64_b64 v12, v[68:69], v[70:71] offset0:0 offset1:1
s_cmp_eq_u32 s24, 63
s_waitcnt lgkmcnt(0)
s_barrier
s_cbranch_scc1 main_kernel_f_done
ds_read2st64_b64 v[104:107], v13 offset0:2 offset1:3
ds_read2st64_b64 v[108:111], v13 offset0:4 offset1:5
ds_read2st64_b64 v[112:115], v13 offset0:6 offset1:7
s_waitcnt lgkmcnt(0)
v_pk_add_f32 v[104:105], v[68:69], v[104:105]
v_pk_add_f32 v[108:109], v[108:109], v[112:113]
v_pk_add_f32 v[106:107], v[70:71], v[106:107]
v_pk_add_f32 v[110:111], v[110:111], v[114:115]
v_pk_add_f32 v[104:105], v[104:105], v[108:109]
v_pk_add_f32 v[106:107], v[106:107], v[110:111]
v_cvt_pk_bf16_f32 v172, v104, v105
v_cvt_pk_bf16_f32 v176, v106, v107
buffer_load_dwordx4 v[148:151], v18, s[8:11], s28 offen offset:0 sc1
buffer_load_dword v164, v19, s[8:11], s28 offen offset:0 sc1
buffer_load_dwordx4 v[152:155], v18, s[8:11], s28 offen offset:1280 sc1
buffer_load_dword v165, v19, s[8:11], s28 offen offset:1280 sc1
buffer_load_dwordx4 v[156:159], v18, s[8:11], s28 offen offset:2560 sc1
buffer_load_dword v166, v19, s[8:11], s28 offen offset:2560 sc1
buffer_load_dwordx4 v[160:163], v18, s[8:11], s28 offen offset:3840 sc1
buffer_load_dword v167, v19, s[8:11], s28 offen offset:3840 sc1
Lps_15:
s_waitcnt vmcnt(4)
v_pk_add_f32 v[100:101], v[148:149], v[152:153]
v_pk_add_f32 v[102:103], v[150:151], v[154:155]
v_add_f32 v104, v164, v165
s_waitcnt vmcnt(0)
v_pk_add_f32 v[106:107], v[156:157], v[160:161]
v_pk_add_f32 v[108:109], v[158:159], v[162:163]
v_add_f32 v105, v166, v167
v_pk_add_f32 v[100:101], v[100:101], v[106:107]
v_pk_add_f32 v[102:103], v[102:103], v[108:109]
v_add_f32 v104, v104, v105
v_maximum3_f32 v110, v100, v101, v102
v_maximum3_f32 v110, v110, v103, v104
v_cmp_u_f32 vcc, v110, v110
s_nop 0
v_max_f32_dpp v110, v110, v110 row_ror:8 row_mask:0xf bank_mask:0xf
v_mov_b32 v111, v110
s_nop 1
v_permlane16_swap_b32 v111, v110
v_max_f32 v110, v110, v111
v_mov_b32 v111, v110
s_cbranch_vccnz Lrs_17
Lks_16:
s_nop 0
v_permlane32_swap_b32 v111, v110
v_max_f32 v110, v110, v111
v_mul_f32 v110, s35, v110
v_fma_f32 v100, v100, s35, -v110
v_fma_f32 v101, v101, s35, -v110
v_fma_f32 v102, v102, s35, -v110
v_fma_f32 v103, v103, s35, -v110
v_fma_f32 v104, v104, s35, -v110
v_exp_f32 v100, v100
v_exp_f32 v101, v101
v_exp_f32 v102, v102
v_exp_f32 v103, v103
v_exp_f32 v104, v104
v_cvt_pk_bf16_f32 v184, v100, v101
v_cvt_pk_bf16_f32 v185, v102, v103
v_mov_b32_dpp v105, v104 row_ror:8 row_mask:0xf bank_mask:0xf
v_mov_b32_dpp v186, v184 row_ror:8 row_mask:0xf bank_mask:0xf
v_mov_b32_dpp v187, v185 row_ror:8 row_mask:0xf bank_mask:0xf
v_cvt_pk_bf16_f32 v180, v104, v105
v_add_f32 v110, v100, v101
v_mfma_f32_16x16x32_bf16 v[188:191], v[92:95], v[184:187], 0
v_add_f32 v111, v102, v103
v_add_f32 v110, v110, v104
v_mfma_f32_16x16x32_bf16 v[192:195], v[96:99], v[184:187], 0
v_add_f32 v110, v110, v111
v_mfma_f32_16x16x32_bf16 v[188:191], v[172:175], v[180:183], v[188:191]
s_nop 0
v_add_f32_dpp v110, v110, v110 row_ror:8 row_mask:0xf bank_mask:0xf
v_mov_b32 v111, v110
v_mfma_f32_16x16x32_bf16 v[192:195], v[176:179], v[180:183], v[192:195]
s_nop 0
v_permlane16_swap_b32 v111, v110
v_add_f32 v110, v110, v111
v_mov_b32 v111, v110
s_nop 1
v_permlane32_swap_b32 v111, v110
v_add_f32 v110, v110, v111
v_rcp_f32 v110, v110
s_nop 0
v_pk_mul_f32 v[188:189], v[188:189], v[110:111] op_sel_hi:[1,0]
v_pk_mul_f32 v[190:191], v[190:191], v[110:111] op_sel_hi:[1,0]
v_pk_mul_f32 v[192:193], v[192:193], v[110:111] op_sel_hi:[1,0]
v_pk_mul_f32 v[194:195], v[194:195], v[110:111] op_sel_hi:[1,0]
v_cvt_pk_bf16_f32 v132, v188, v189
v_cvt_pk_bf16_f32 v133, v190, v191
v_cvt_pk_bf16_f32 v134, v192, v193
v_cvt_pk_bf16_f32 v135, v194, v195
buffer_store_dwordx4 v[132:135], v20, s[8:11], s28 offen
main_kernel_f_b4:
s_cmp_eq_u32 s24, 63
s_cbranch_scc1 main_kernel_f_done
s_barrier
buffer_load_dwordx4 v[36:39], v10, s[8:11], s28 offen offset:0 sc1
buffer_load_dwordx4 v[40:43], v10, s[8:11], s28 offen offset:1024 sc1
buffer_load_dwordx4 v[44:47], v10, s[8:11], s28 offen offset:2048 sc1
buffer_load_dwordx4 v[48:51], v10, s[8:11], s28 offen offset:3072 sc1
s_waitcnt vmcnt(3)
v_max3_u32 v2, v36, v37, v38
v_max_u32 v2, v2, v39
v_cmp_eq_u32 vcc, -1, v2
s_cbranch_vccnz Lr_22
Lk_18:
v_smfmac_f32_16x16x64_bf16 v[76:79], v[36:39], a[192:199], v8
s_waitcnt vmcnt(2)
v_max3_u32 v2, v40, v41, v42
v_max_u32 v2, v2, v43
v_cmp_eq_u32 vcc, -1, v2
v_smfmac_f32_16x16x64_bf16 v[80:83], v[36:39], a[224:231], v8
s_cbranch_vccnz Lr_23
Lk_19:
v_smfmac_f32_16x16x64_bf16 v[76:79], v[40:43], a[200:207], v8
s_waitcnt vmcnt(1)
v_max3_u32 v2, v44, v45, v46
v_max_u32 v2, v2, v47
v_cmp_eq_u32 vcc, -1, v2
v_smfmac_f32_16x16x64_bf16 v[80:83], v[40:43], a[232:239], v8
s_cbranch_vccnz Lr_24
Lk_20:
v_smfmac_f32_16x16x64_bf16 v[76:79], v[44:47], a[208:215], v8
s_waitcnt vmcnt(0)
v_max3_u32 v2, v48, v49, v50
v_max_u32 v2, v2, v51
v_cmp_eq_u32 vcc, -1, v2
v_smfmac_f32_16x16x64_bf16 v[80:83], v[44:47], a[240:247], v8
s_cbranch_vccnz Lr_25
Lk_21:
v_smfmac_f32_16x16x64_bf16 v[76:79], v[48:51], a[216:223], v8
v_smfmac_f32_16x16x64_bf16 v[80:83], v[48:51], a[248:255], v8
s_add_u32 s33, s33, 262144
s_cmp_eq_u32 s27, 3
s_nop 4
v_pk_add_f32 v[76:77], v[76:77], v[78:79]
v_pk_add_f32 v[78:79], v[80:81], v[82:83]
s_cbranch_scc1 main_kernel_f_w3
ds_write_b128 v14, v[76:79]
s_waitcnt lgkmcnt(0)
s_barrier
v_mov_b32 v52, 0
v_mov_b32 v53, 0
v_mov_b32 v54, 0
v_mov_b32 v55, 0
v_mov_b32 v56, 0
v_mov_b32 v57, 0
v_mov_b32 v58, 0
v_mov_b32 v59, 0
v_mov_b32 v60, 0
v_mov_b32 v61, 0
v_mov_b32 v62, 0
v_mov_b32 v63, 0
v_mov_b32 v64, 0
v_mov_b32 v65, 0
v_mov_b32 v66, 0
v_mov_b32 v67, 0
v_mov_b32 v68, 0
v_mov_b32 v69, 0
v_mov_b32 v70, 0
v_mov_b32 v71, 0
v_mov_b32 v72, 0
v_mov_b32 v73, 0
v_mov_b32 v74, 0
v_mov_b32 v75, 0
v_mov_b32 v76, 0
v_mov_b32 v77, 0
v_mov_b32 v78, 0
v_mov_b32 v79, 0
v_mov_b32 v80, 0
v_mov_b32 v81, 0
v_mov_b32 v82, 0
v_mov_b32 v83, 0
s_cmp_eq_u32 s27, 1
s_barrier
s_cbranch_scc1 main_kernel_f_w1b
s_cmp_eq_u32 s27, 2
s_cbranch_scc1 main_kernel_f_w2b
s_barrier
s_lshr_b32 s94, s33, 18
s_cmp_ge_u32 s94, s92
s_cbranch_scc1 Lkc_29
Lkg_28:
buffer_load_dwordx4 v[84:87], v26, s[12:15], s33 offen
buffer_load_dwordx4 v[88:91], v26, s[12:15], s33 offen offset:128
buffer_load_dwordx4 v[92:95], v27, s[12:15], s33 offen
buffer_load_dwordx4 v[96:99], v27, s[12:15], s33 offen offset:256
s_add_u32 s94, s94, 1
s_cmp_lt_u32 s94, s92
s_cbranch_scc1 Lkn_31
buffer_load_dword v32, v34, s[20:23], 0 offen sc1
Lkn_31:
s_branch main_kernel_f_b5
main_kernel_f_w1b:
buffer_store_dwordx2 v[132:133], v28, s[16:19], s34 offen sc1
buffer_store_dwordx4 v[196:199], v29, s[8:11], s30 offen
buffer_store_dwordx4 v[196:199], v30, s[8:11], s30 offen
buffer_store_dwordx4 v[196:199], v31, s[8:11], s30 offen
s_cmp_lg_u32 s24, 8
s_cbranch_scc1 main_kernel_f_m1
s_mov_b32 s36, 3801088
buffer_store_dwordx2 v[196:197], v28, s[16:19], s36 offen sc1
s_mov_b32 s36, 3866624
buffer_store_dwordx2 v[196:197], v28, s[16:19], s36 offen sc1
s_mov_b32 s36, 3932160
buffer_store_dwordx2 v[196:197], v28, s[16:19], s36 offen sc1
s_mov_b32 s36, 3997696
buffer_store_dwordx2 v[196:197], v28, s[16:19], s36 offen sc1
s_mov_b32 s36, 4063232
buffer_store_dwordx2 v[196:197], v28, s[16:19], s36 offen sc1
s_mov_b32 s36, 4128768
buffer_store_dwordx2 v[196:197], v28, s[16:19], s36 offen sc1
main_kernel_f_m1:
s_barrier
s_branch main_kernel_f_b5
main_kernel_f_w2b:
buffer_store_dwordx4 v[132:135], v28, s[16:19], s34 offen sc1
buffer_store_dwordx4 v[196:199], v29, s[8:11], s30 offen sc1
buffer_store_dwordx4 v[196:199], v31, s[8:11], s31 offen
s_cmp_ge_u32 s24, 58
s_addc_u32 s36, s24, 0
v_mov_b32 v2, s36
buffer_store_dword v2, v33, s[20:23], 0 offen sc1
s_cmp_lg_u32 s24, 8
s_cbranch_scc1 main_kernel_f_m2
s_mov_b32 s36, 3801088
buffer_store_dwordx4 v[196:199], v28, s[16:19], s36 offen sc1
s_mov_b32 s36, 3866624
buffer_store_dwordx4 v[196:199], v28, s[16:19], s36 offen sc1
s_mov_b32 s36, 3932160
buffer_store_dwordx4 v[196:199], v28, s[16:19], s36 offen sc1
s_mov_b32 s36, 3997696
buffer_store_dwordx4 v[196:199], v28, s[16:19], s36 offen sc1
s_mov_b32 s36, 4063232
buffer_store_dwordx4 v[196:199], v28, s[16:19], s36 offen sc1
s_mov_b32 s36, 4128768
buffer_store_dwordx4 v[196:199], v28, s[16:19], s36 offen sc1
main_kernel_f_m2:
s_barrier
s_branch main_kernel_f_b5
main_kernel_f_w3:
s_barrier
ds_read_b128 v[100:103], v15 offset:0
ds_read_b128 v[104:107], v15 offset:1024
ds_read_b128 v[108:111], v15 offset:2048
s_waitcnt lgkmcnt(1)
v_pk_add_f32 v[100:101], v[100:101], v[104:105]
v_pk_add_f32 v[102:103], v[102:103], v[106:107]
s_waitcnt lgkmcnt(0)
v_pk_add_f32 v[108:109], v[108:109], v[76:77]
v_pk_add_f32 v[110:111], v[110:111], v[78:79]
v_pk_add_f32 v[100:101], v[100:101], v[108:109]
v_pk_add_f32 v[102:103], v[102:103], v[110:111]
buffer_store_dwordx4 v[100:103], v21, s[8:11], s28 offen sc1
s_barrier
v_mov_b32 v52, 0
v_mov_b32 v53, 0
v_mov_b32 v54, 0
v_mov_b32 v55, 0
v_mov_b32 v56, 0
v_mov_b32 v57, 0
v_mov_b32 v58, 0
v_mov_b32 v59, 0
v_mov_b32 v60, 0
v_mov_b32 v61, 0
v_mov_b32 v62, 0
v_mov_b32 v63, 0
v_mov_b32 v64, 0
v_mov_b32 v65, 0
v_mov_b32 v66, 0
v_mov_b32 v67, 0
v_mov_b32 v68, 0
v_mov_b32 v69, 0
v_mov_b32 v70, 0
v_mov_b32 v71, 0
v_mov_b32 v72, 0
v_mov_b32 v73, 0
v_mov_b32 v74, 0
v_mov_b32 v75, 0
v_mov_b32 v76, 0
v_mov_b32 v77, 0
v_mov_b32 v78, 0
v_mov_b32 v79, 0
v_mov_b32 v80, 0
v_mov_b32 v81, 0
v_mov_b32 v82, 0
v_mov_b32 v83, 0
s_waitcnt vmcnt(0)
buffer_load_dwordx4 v[148:151], v22, s[8:11], s28 offen sc1
buffer_load_dwordx4 v[152:155], v23, s[8:11], s28 offen sc1
buffer_load_dwordx4 v[156:159], v24, s[8:11], s28 offen sc1
s_barrier
Lpp_33:
s_waitcnt vmcnt(2)
v_pk_add_f32 v[104:105], v[100:101], v[148:149]
v_pk_add_f32 v[106:107], v[102:103], v[150:151]
s_waitcnt vmcnt(0)
v_pk_add_f32 v[108:109], v[152:153], v[156:157]
v_pk_add_f32 v[110:111], v[154:155], v[158:159]
v_pk_add_f32 v[104:105], v[104:105], v[108:109]
v_pk_add_f32 v[106:107], v[106:107], v[110:111]
v_maximum3_f32 v112, v104, v105, v106
v_cmp_u_f32 vcc, v112, v107
v_cvt_pk_bf16_f32 v132, v104, v106
v_cvt_pk_bf16_f32 v133, v105, v107
s_cbranch_vccnz Lrp_34
Lkp_32:
buffer_store_dword v132, v25, s[8:11], s29 offen
buffer_store_dword v133, v25, s[8:11], s29 offen offset:16
main_kernel_f_b5:
s_mov_b32 s36, s28
s_mov_b32 s28, s29
s_mov_b32 s29, s30
s_mov_b32 s30, s31
s_mov_b32 s31, s36
s_add_u32 s34, s34, 65536
s_add_u32 s24, s24, 1
s_barrier
s_branch main_kernel_f_step
Lkc_2:
v_readlane_b32 s92, v32, 0
v_readlane_b32 s36, v32, 1
s_min_u32 s92, s92, s36
s_cmp_lt_u32 s94, s92
s_cbranch_scc1 Lkg_1
s_add_u32 s32, s32, 1
s_cmp_ge_u32 s32, 32768
s_cbranch_scc1 Lkg_1
s_sleep 2
Lkl_3:
buffer_load_dword v32, v34, s[20:23], 0 offen sc1
s_waitcnt vmcnt(0)
s_branch Lkc_2
Lr_9:
s_add_u32 s32, s32, 1
s_cmp_ge_u32 s32, 32768
s_cbranch_scc1 Lk_5
buffer_load_dwordx4 v[36:39], v9, s[8:11], s28 offen offset:0 sc1
buffer_load_dwordx4 v[40:43], v9, s[8:11], s28 offen offset:1024 sc1
buffer_load_dwordx4 v[44:47], v9, s[8:11], s28 offen offset:2048 sc1
buffer_load_dwordx4 v[48:51], v9, s[8:11], s28 offen offset:3072 sc1
s_waitcnt vmcnt(3)
v_max3_u32 v2, v36, v37, v38
v_max_u32 v2, v2, v39
v_cmp_eq_u32 vcc, -1, v2
s_cbranch_vccnz Lr_9
s_branch Lk_5
Lr_10:
s_add_u32 s32, s32, 1
s_cmp_ge_u32 s32, 32768
s_cbranch_scc1 Lk_6
buffer_load_dwordx4 v[40:43], v9, s[8:11], s28 offen offset:1024 sc1
buffer_load_dwordx4 v[44:47], v9, s[8:11], s28 offen offset:2048 sc1
buffer_load_dwordx4 v[48:51], v9, s[8:11], s28 offen offset:3072 sc1
s_waitcnt vmcnt(2)
v_max3_u32 v2, v40, v41, v42
v_max_u32 v2, v2, v43
v_cmp_eq_u32 vcc, -1, v2
s_cbranch_vccnz Lr_10
s_branch Lk_6
Lr_11:
s_add_u32 s32, s32, 1
s_cmp_ge_u32 s32, 32768
s_cbranch_scc1 Lk_7
buffer_load_dwordx4 v[44:47], v9, s[8:11], s28 offen offset:2048 sc1
buffer_load_dwordx4 v[48:51], v9, s[8:11], s28 offen offset:3072 sc1
s_waitcnt vmcnt(1)
v_max3_u32 v2, v44, v45, v46
v_max_u32 v2, v2, v47
v_cmp_eq_u32 vcc, -1, v2
s_cbranch_vccnz Lr_11
s_branch Lk_7
Lr_12:
s_add_u32 s32, s32, 1
s_cmp_ge_u32 s32, 32768
s_cbranch_scc1 Lk_8
buffer_load_dwordx4 v[48:51], v9, s[8:11], s28 offen offset:3072 sc1
s_waitcnt vmcnt(0)
v_max3_u32 v2, v48, v49, v50
v_max_u32 v2, v2, v51
v_cmp_eq_u32 vcc, -1, v2
s_cbranch_vccnz Lr_12
s_branch Lk_8
Lrs_17:
v_max3_u32 v2, v148, v149, v150
v_max3_u32 v2, v2, v151, v152
v_max3_u32 v2, v2, v153, v154
v_max3_u32 v2, v2, v155, v156
v_max3_u32 v2, v2, v157, v158
v_max3_u32 v2, v2, v159, v160
v_max3_u32 v2, v2, v161, v162
v_max3_u32 v2, v2, v163, v164
v_max3_u32 v2, v2, v165, v166
v_max_u32 v2, v2, v167
v_cmp_eq_u32 vcc, -1, v2
s_cbranch_vccz Lks_16
s_add_u32 s32, s32, 1
s_cmp_ge_u32 s32, 32768
s_cbranch_scc1 Lks_16
buffer_load_dwordx4 v[148:151], v18, s[8:11], s28 offen offset:0 sc1
buffer_load_dword v164, v19, s[8:11], s28 offen offset:0 sc1
buffer_load_dwordx4 v[152:155], v18, s[8:11], s28 offen offset:1280 sc1
buffer_load_dword v165, v19, s[8:11], s28 offen offset:1280 sc1
buffer_load_dwordx4 v[156:159], v18, s[8:11], s28 offen offset:2560 sc1
buffer_load_dword v166, v19, s[8:11], s28 offen offset:2560 sc1
buffer_load_dwordx4 v[160:163], v18, s[8:11], s28 offen offset:3840 sc1
buffer_load_dword v167, v19, s[8:11], s28 offen offset:3840 sc1
s_branch Lps_15
Lr_22:
s_add_u32 s32, s32, 1
s_cmp_ge_u32 s32, 32768
s_cbranch_scc1 Lk_18
buffer_load_dwordx4 v[36:39], v10, s[8:11], s28 offen offset:0 sc1
buffer_load_dwordx4 v[40:43], v10, s[8:11], s28 offen offset:1024 sc1
buffer_load_dwordx4 v[44:47], v10, s[8:11], s28 offen offset:2048 sc1
buffer_load_dwordx4 v[48:51], v10, s[8:11], s28 offen offset:3072 sc1
s_waitcnt vmcnt(3)
v_max3_u32 v2, v36, v37, v38
v_max_u32 v2, v2, v39
v_cmp_eq_u32 vcc, -1, v2
s_cbranch_vccnz Lr_22
s_branch Lk_18
Lr_23:
s_add_u32 s32, s32, 1
s_cmp_ge_u32 s32, 32768
s_cbranch_scc1 Lk_19
buffer_load_dwordx4 v[40:43], v10, s[8:11], s28 offen offset:1024 sc1
buffer_load_dwordx4 v[44:47], v10, s[8:11], s28 offen offset:2048 sc1
buffer_load_dwordx4 v[48:51], v10, s[8:11], s28 offen offset:3072 sc1
s_waitcnt vmcnt(2)
v_max3_u32 v2, v40, v41, v42
v_max_u32 v2, v2, v43
v_cmp_eq_u32 vcc, -1, v2
s_cbranch_vccnz Lr_23
s_branch Lk_19
Lr_24:
s_add_u32 s32, s32, 1
s_cmp_ge_u32 s32, 32768
s_cbranch_scc1 Lk_20
buffer_load_dwordx4 v[44:47], v10, s[8:11], s28 offen offset:2048 sc1
buffer_load_dwordx4 v[48:51], v10, s[8:11], s28 offen offset:3072 sc1
s_waitcnt vmcnt(1)
v_max3_u32 v2, v44, v45, v46
v_max_u32 v2, v2, v47
v_cmp_eq_u32 vcc, -1, v2
s_cbranch_vccnz Lr_24
s_branch Lk_20
Lr_25:
s_add_u32 s32, s32, 1
s_cmp_ge_u32 s32, 32768
s_cbranch_scc1 Lk_21
buffer_load_dwordx4 v[48:51], v10, s[8:11], s28 offen offset:3072 sc1
s_waitcnt vmcnt(0)
v_max3_u32 v2, v48, v49, v50
v_max_u32 v2, v2, v51
v_cmp_eq_u32 vcc, -1, v2
s_cbranch_vccnz Lr_25
s_branch Lk_21
Lkc_29:
v_readlane_b32 s92, v32, 0
v_readlane_b32 s36, v32, 1
s_min_u32 s92, s92, s36
s_cmp_lt_u32 s94, s92
s_cbranch_scc1 Lkg_28
s_add_u32 s32, s32, 1
s_cmp_ge_u32 s32, 32768
s_cbranch_scc1 Lkg_28
s_sleep 2
Lkl_30:
buffer_load_dword v32, v34, s[20:23], 0 offen sc1
s_waitcnt vmcnt(0)
s_branch Lkc_29
Lrp_34:
v_max3_u32 v2, v148, v149, v150
v_max3_u32 v2, v2, v151, v152
v_max3_u32 v2, v2, v153, v154
v_max3_u32 v2, v2, v155, v156
v_max3_u32 v2, v2, v157, v158
v_max_u32 v2, v2, v159
v_cmp_eq_u32 vcc, -1, v2
s_cbranch_vccz Lkp_32
s_add_u32 s32, s32, 1
s_cmp_ge_u32 s32, 32768
s_cbranch_scc1 Lkp_32
buffer_load_dwordx4 v[148:151], v22, s[8:11], s28 offen sc1
buffer_load_dwordx4 v[152:155], v23, s[8:11], s28 offen sc1
buffer_load_dwordx4 v[156:159], v24, s[8:11], s28 offen sc1
s_branch Lpp_33
main_kernel_f_done:
s_waitcnt vmcnt(0)
s_barrier
v_mov_b32 v2, 64
s_cmp_eq_u32 s27, 2
s_cselect_b32 s36, 0, 0x40000000
buffer_store_dword v2, v33, s[20:23], s36 offen sc1
main_kernel_end:
s_endpgm
main_kernel_again:
s_mov_b32 s3, 1
s_barrier
s_branch main_kernel_go
main_kernel_nl:
buffer_load_dwordx4 v92, s[12:15], s60 offen nt lds
s_add_u32 m0, m0, 1024
s_add_u32 s60, s60, s61
buffer_load_dwordx4 v93, s[12:15], s60 offen nt lds
s_add_u32 m0, m0, 1024
s_add_u32 s60, s60, s61
buffer_load_dwordx4 v92, s[12:15], s60 offen nt lds
s_add_u32 m0, m0, 1024
s_add_u32 s60, s60, s61
buffer_load_dwordx4 v93, s[12:15], s60 offen nt lds
s_add_u32 m0, m0, s62
s_add_u32 s60, s60, s63
s_branch main_kernel_nk
main_kernel_slow:
s_add_u32 s20, s4, 0x6a00000
s_addc_u32 s21, s5, 0
s_mov_b32 s22, 0x8000
s_mov_b32 s23, 0x00020000
s_mov_b32 s92, 0
s_lshl_b32 s36, s25, 5
s_add_u32 s36, s36, s26
s_lshr_b32 s37, s36, 2
s_lshl_b32 s37, s37, 7
s_and_b32 s36, s36, 3
s_lshl_b32 s36, s36, 2
s_add_u32 s36, s36, s37
v_mov_b32 v33, 0x40000000
v_mov_b32 v34, 0x40000000
s_add_u32 s37, s36, 19968
v_writelane_b32 v33, s37, 0
s_add_u32 s37, s36, 0
v_writelane_b32 v34, s37, 0
s_add_u32 s37, s36, 4096
v_writelane_b32 v34, s37, 1
s_mov_b32 s24, 0
s_mov_b32 s33, 0
s_mov_b32 s34, 0
s_mov_b32 s28, 0
s_mov_b32 s29, 557056
s_mov_b32 s30, 1114112
s_mov_b32 s31, 1671168
v_mov_b32 v52, 0
v_mov_b32 v53, 0
v_mov_b32 v54, 0
v_mov_b32 v55, 0
v_mov_b32 v56, 0
v_mov_b32 v57, 0
v_mov_b32 v58, 0
v_mov_b32 v59, 0
v_mov_b32 v60, 0
v_mov_b32 v61, 0
v_mov_b32 v62, 0
v_mov_b32 v63, 0
v_mov_b32 v64, 0
v_mov_b32 v65, 0
v_mov_b32 v66, 0
v_mov_b32 v67, 0
v_mov_b32 v68, 0
v_mov_b32 v69, 0
v_mov_b32 v70, 0
v_mov_b32 v71, 0
v_mov_b32 v72, 0
v_mov_b32 v73, 0
v_mov_b32 v74, 0
v_mov_b32 v75, 0
v_mov_b32 v76, 0
v_mov_b32 v77, 0
v_mov_b32 v78, 0
v_mov_b32 v79, 0
v_mov_b32 v80, 0
v_mov_b32 v81, 0
v_mov_b32 v82, 0
v_mov_b32 v83, 0
s_cmp_lg_u32 s27, 0
s_cbranch_scc1 main_kernel_s_step
s_lshr_b32 s94, s33, 18
s_cmp_ge_u32 s94, s92
s_cbranch_scc1 Lkl_37
Lkg_35:
buffer_load_dwordx4 v[84:87], v26, s[12:15], s33 offen
buffer_load_dwordx4 v[88:91], v26, s[12:15], s33 offen offset:128
buffer_load_dwordx4 v[92:95], v27, s[12:15], s33 offen
buffer_load_dwordx4 v[96:99], v27, s[12:15], s33 offen offset:256
s_add_u32 s94, s94, 1
s_cmp_lt_u32 s94, s92
s_cbranch_scc1 Lkn_38
buffer_load_dword v32, v34, s[20:23], 0 offen sc1
Lkn_38:
main_kernel_s_step:
buffer_load_dwordx4 v[36:39], v9, s[8:11], s28 offen offset:0 sc1
buffer_load_dwordx4 v[40:43], v9, s[8:11], s28 offen offset:1024 sc1
buffer_load_dwordx4 v[44:47], v9, s[8:11], s28 offen offset:2048 sc1
buffer_load_dwordx4 v[48:51], v9, s[8:11], s28 offen offset:3072 sc1
s_waitcnt vmcnt(3)
v_max3_u32 v2, v36, v37, v38
v_max_u32 v2, v2, v39
v_cmp_eq_u32 vcc, -1, v2
s_cbranch_vccnz Lr_43
Lk_39:
v_smfmac_f32_16x16x64_bf16 v[52:55], v[36:39], a[0:7], v8
v_smfmac_f32_16x16x64_bf16 v[56:59], v[36:39], a[32:39], v8
s_waitcnt vmcnt(2)
v_max3_u32 v2, v40, v41, v42
v_max_u32 v2, v2, v43
v_cmp_eq_u32 vcc, -1, v2
v_smfmac_f32_16x16x64_bf16 v[60:63], v[36:39], a[64:71], v8
v_smfmac_f32_16x16x64_bf16 v[64:67], v[36:39], a[96:103], v8
s_cbranch_vccnz Lr_44
Lk_40:
v_smfmac_f32_16x16x64_bf16 v[52:55], v[40:43], a[8:15], v8
v_smfmac_f32_16x16x64_bf16 v[56:59], v[40:43], a[40:47], v8
s_waitcnt vmcnt(1)
v_max3_u32 v2, v44, v45, v46
v_max_u32 v2, v2, v47
v_cmp_eq_u32 vcc, -1, v2
v_smfmac_f32_16x16x64_bf16 v[60:63], v[40:43], a[72:79], v8
v_smfmac_f32_16x16x64_bf16 v[64:67], v[40:43], a[104:111], v8
s_cbranch_vccnz Lr_45
Lk_41:
v_smfmac_f32_16x16x64_bf16 v[52:55], v[44:47], a[16:23], v8
v_smfmac_f32_16x16x64_bf16 v[56:59], v[44:47], a[48:55], v8
s_waitcnt vmcnt(0)
v_max3_u32 v2, v48, v49, v50
v_max_u32 v2, v2, v51
v_cmp_eq_u32 vcc, -1, v2
v_smfmac_f32_16x16x64_bf16 v[60:63], v[44:47], a[80:87], v8
v_smfmac_f32_16x16x64_bf16 v[64:67], v[44:47], a[112:119], v8
s_cbranch_vccnz Lr_46
Lk_42:
v_smfmac_f32_16x16x64_bf16 v[52:55], v[48:51], a[24:31], v8
v_smfmac_f32_16x16x64_bf16 v[56:59], v[48:51], a[56:63], v8
v_smfmac_f32_16x16x64_bf16 v[60:63], v[48:51], a[88:95], v8
v_smfmac_f32_16x16x64_bf16 v[64:67], v[48:51], a[120:127], v8
v_smfmac_f32_16x16x64_bf16 v[68:71], v[36:39], a[128:135], v8
v_smfmac_f32_16x16x64_bf16 v[72:75], v[36:39], a[160:167], v8
s_nop 2
v_pk_add_f32 v[52:53], v[52:53], v[54:55]
ds_write_addtid_b32 v52 offset:0
ds_write_addtid_b32 v53 offset:288
v_pk_add_f32 v[56:57], v[56:57], v[58:59]
ds_write_addtid_b32 v56 offset:1536
ds_write_addtid_b32 v57 offset:1824
v_pk_add_f32 v[60:61], v[60:61], v[62:63]
ds_write_addtid_b32 v60 offset:768
ds_write_addtid_b32 v61 offset:1056
v_pk_add_f32 v[64:65], v[64:65], v[66:67]
ds_write_addtid_b32 v64 offset:2304
ds_write_addtid_b32 v65 offset:2592
s_cmp_eq_u32 s27, 0
s_waitcnt lgkmcnt(0)
s_barrier
s_cbranch_scc1 main_kernel_s_w0
v_smfmac_f32_16x16x64_bf16 v[68:71], v[40:43], a[136:143], v8
v_smfmac_f32_16x16x64_bf16 v[72:75], v[40:43], a[168:175], v8
v_smfmac_f32_16x16x64_bf16 v[68:71], v[44:47], a[144:151], v8
v_smfmac_f32_16x16x64_bf16 v[72:75], v[44:47], a[176:183], v8
v_smfmac_f32_16x16x64_bf16 v[68:71], v[48:51], a[152:159], v8
v_smfmac_f32_16x16x64_bf16 v[72:75], v[48:51], a[184:191], v8
s_nop 6
v_pk_add_f32 v[68:69], v[68:69], v[70:71]
v_pk_add_f32 v[70:71], v[72:73], v[74:75]
ds_write2st64_b64 v12, v[68:69], v[70:71] offset0:0 offset1:1
s_waitcnt lgkmcnt(0)
s_barrier
s_cmp_eq_u32 s27, 2
s_cbranch_scc1 main_kernel_s_w2
s_cmp_eq_u32 s27, 3
s_cbranch_scc1 main_kernel_s_b4
ds_read2_b64 v[100:103], v13 offset0:0 offset1:16
v_add_u32 v2, 2048, v13
ds_read2_b64 v[104:107], v13 offset0:128 offset1:144
ds_read2_b64 v[108:111], v2 offset0:0 offset1:16
ds_read2_b64 v[112:115], v2 offset0:128 offset1:144
s_waitcnt lgkmcnt(0)
v_pk_add_f32 v[100:101], v[100:101], v[104:105]
v_pk_add_f32 v[108:109], v[108:109], v[112:113]
v_pk_add_f32 v[102:103], v[102:103], v[106:107]
v_pk_add_f32 v[110:111], v[110:111], v[114:115]
v_pk_add_f32 v[100:101], v[100:101], v[108:109]
v_pk_add_f32 v[102:103], v[102:103], v[110:111]
v_cvt_pk_bf16_f32 v132, v100, v101
v_cvt_pk_bf16_f32 v133, v102, v103
s_cmp_lt_u32 s24, 58
s_cbranch_scc1 main_kernel_s_b4
buffer_store_dwordx2 v[132:133], v28, s[16:19], s34 offen sc1
s_branch main_kernel_s_b4
main_kernel_s_w2:
ds_read_b128 v[100:103], v11 offset:0
ds_read_b128 v[104:107], v11 offset:32
ds_read_b128 v[108:111], v11 offset:3072
ds_read_b128 v[112:115], v11 offset:3104
ds_read_b128 v[116:119], v11 offset:6144
ds_read_b128 v[120:123], v11 offset:6176
ds_read_b128 v[124:127], v11 offset:9216
ds_read_b128 v[128:131], v11 offset:9248
s_waitcnt lgkmcnt(4)
v_pk_add_f32 v[100:101], v[100:101], v[108:109]
v_pk_add_f32 v[102:103], v[102:103], v[110:111]
v_pk_add_f32 v[104:105], v[104:105], v[112:113]
v_pk_add_f32 v[106:107], v[106:107], v[114:115]
s_waitcnt lgkmcnt(0)
v_pk_add_f32 v[116:117], v[116:117], v[124:125]
v_pk_add_f32 v[118:119], v[118:119], v[126:127]
v_pk_add_f32 v[120:121], v[120:121], v[128:129]
v_pk_add_f32 v[122:123], v[122:123], v[130:131]
v_pk_add_f32 v[100:101], v[100:101], v[116:117]
v_pk_add_f32 v[102:103], v[102:103], v[118:119]
v_pk_add_f32 v[104:105], v[104:105], v[120:121]
v_pk_add_f32 v[106:107], v[106:107], v[122:123]
v_cvt_pk_bf16_f32 v132, v100, v101
v_cvt_pk_bf16_f32 v133, v102, v103
v_cvt_pk_bf16_f32 v134, v104, v105
v_cvt_pk_bf16_f32 v135, v106, v107
s_cmp_lt_u32 s24, 58
s_cbranch_scc1 main_kernel_s_b4
buffer_store_dwordx4 v[132:135], v28, s[16:19], s34 offen sc1
s_branch main_kernel_s_b4
main_kernel_s_w0:
ds_read_b128 v[100:103], v11 offset:0
ds_read_b128 v[104:107], v11 offset:32
ds_read_b128 v[108:111], v11 offset:3072
ds_read_b128 v[112:115], v11 offset:3104
ds_read_b128 v[116:119], v11 offset:6144
ds_read_b128 v[120:123], v11 offset:6176
ds_read_b128 v[124:127], v11 offset:9216
ds_read_b128 v[128:131], v11 offset:9248
v_smfmac_f32_16x16x64_bf16 v[68:71], v[40:43], a[136:143], v8
v_smfmac_f32_16x16x64_bf16 v[72:75], v[40:43], a[168:175], v8
v_smfmac_f32_16x16x64_bf16 v[68:71], v[44:47], a[144:151], v8
v_smfmac_f32_16x16x64_bf16 v[72:75], v[44:47], a[176:183], v8
v_smfmac_f32_16x16x64_bf16 v[68:71], v[48:51], a[152:159], v8
v_smfmac_f32_16x16x64_bf16 v[72:75], v[48:51], a[184:191], v8
s_waitcnt lgkmcnt(4)
v_pk_add_f32 v[100:101], v[100:101], v[108:109]
v_pk_add_f32 v[102:103], v[102:103], v[110:111]
v_pk_add_f32 v[104:105], v[104:105], v[112:113]
v_pk_add_f32 v[106:107], v[106:107], v[114:115]
s_waitcnt lgkmcnt(0)
v_pk_add_f32 v[116:117], v[116:117], v[124:125]
v_pk_add_f32 v[118:119], v[118:119], v[126:127]
v_pk_add_f32 v[120:121], v[120:121], v[128:129]
v_pk_add_f32 v[122:123], v[122:123], v[130:131]
v_pk_add_f32 v[100:101], v[100:101], v[116:117]
v_pk_add_f32 v[102:103], v[102:103], v[118:119]
v_pk_add_f32 v[104:105], v[104:105], v[120:121]
v_pk_add_f32 v[106:107], v[106:107], v[122:123]
v_cvt_pk_bf16_f32 v132, v100, v101
v_cvt_pk_bf16_f32 v133, v102, v103
v_cvt_pk_bf16_f32 v134, v104, v105
v_cvt_pk_bf16_f32 v135, v106, v107
s_nop 1
v_mfma_f32_16x16x32_bf16 v[136:139], v[84:87], v[132:135], 0
v_mfma_f32_16x16x32_bf16 v[140:143], v[88:91], v[132:135], 0
v_mfma_f32_16x16x32_bf16 v[144:147], v[132:135], v[132:135], 0
s_nop 5
buffer_store_dwordx4 v[136:139], v16, s[8:11], s28 offen sc1
buffer_store_dwordx4 v[140:143], v16, s[8:11], s28 offen offset:512 sc1
buffer_store_dwordx4 v[144:147], v17, s[8:11], s28 offen sc1
v_pk_add_f32 v[68:69], v[68:69], v[70:71]
v_pk_add_f32 v[70:71], v[72:73], v[74:75]
ds_write2st64_b64 v12, v[68:69], v[70:71] offset0:0 offset1:1
s_cmp_eq_u32 s24, 63
s_waitcnt lgkmcnt(0)
s_barrier
s_cbranch_scc1 main_kernel_s_done
ds_read2st64_b64 v[104:107], v13 offset0:2 offset1:3
ds_read2st64_b64 v[108:111], v13 offset0:4 offset1:5
ds_read2st64_b64 v[112:115], v13 offset0:6 offset1:7
s_waitcnt lgkmcnt(0)
v_pk_add_f32 v[104:105], v[68:69], v[104:105]
v_pk_add_f32 v[108:109], v[108:109], v[112:113]
v_pk_add_f32 v[106:107], v[70:71], v[106:107]
v_pk_add_f32 v[110:111], v[110:111], v[114:115]
v_pk_add_f32 v[104:105], v[104:105], v[108:109]
v_pk_add_f32 v[106:107], v[106:107], v[110:111]
v_cvt_pk_bf16_f32 v172, v104, v105
v_cvt_pk_bf16_f32 v176, v106, v107
buffer_load_dwordx4 v[148:151], v18, s[8:11], s28 offen offset:0 sc1
buffer_load_dword v164, v19, s[8:11], s28 offen offset:0 sc1
buffer_load_dwordx4 v[152:155], v18, s[8:11], s28 offen offset:1280 sc1
buffer_load_dword v165, v19, s[8:11], s28 offen offset:1280 sc1
buffer_load_dwordx4 v[156:159], v18, s[8:11], s28 offen offset:2560 sc1
buffer_load_dword v166, v19, s[8:11], s28 offen offset:2560 sc1
buffer_load_dwordx4 v[160:163], v18, s[8:11], s28 offen offset:3840 sc1
buffer_load_dword v167, v19, s[8:11], s28 offen offset:3840 sc1
Lps_49:
s_waitcnt vmcnt(4)
v_pk_add_f32 v[100:101], v[148:149], v[152:153]
v_pk_add_f32 v[102:103], v[150:151], v[154:155]
v_add_f32 v104, v164, v165
s_waitcnt vmcnt(0)
v_pk_add_f32 v[106:107], v[156:157], v[160:161]
v_pk_add_f32 v[108:109], v[158:159], v[162:163]
v_add_f32 v105, v166, v167
v_pk_add_f32 v[100:101], v[100:101], v[106:107]
v_pk_add_f32 v[102:103], v[102:103], v[108:109]
v_add_f32 v104, v104, v105
v_maximum3_f32 v110, v100, v101, v102
v_maximum3_f32 v110, v110, v103, v104
v_cmp_u_f32 vcc, v110, v110
s_nop 0
v_max_f32_dpp v110, v110, v110 row_ror:8 row_mask:0xf bank_mask:0xf
v_mov_b32 v111, v110
s_nop 1
v_permlane16_swap_b32 v111, v110
v_max_f32 v110, v110, v111
v_mov_b32 v111, v110
s_cbranch_vccnz Lrs_51
Lks_50:
s_nop 0
v_permlane32_swap_b32 v111, v110
v_max_f32 v110, v110, v111
v_mul_f32 v110, s35, v110
v_fma_f32 v100, v100, s35, -v110
v_fma_f32 v101, v101, s35, -v110
v_fma_f32 v102, v102, s35, -v110
v_fma_f32 v103, v103, s35, -v110
v_fma_f32 v104, v104, s35, -v110
v_exp_f32 v100, v100
v_exp_f32 v101, v101
v_exp_f32 v102, v102
v_exp_f32 v103, v103
v_exp_f32 v104, v104
v_cvt_pk_bf16_f32 v184, v100, v101
v_cvt_pk_bf16_f32 v185, v102, v103
v_mov_b32_dpp v105, v104 row_ror:8 row_mask:0xf bank_mask:0xf
v_mov_b32_dpp v186, v184 row_ror:8 row_mask:0xf bank_mask:0xf
v_mov_b32_dpp v187, v185 row_ror:8 row_mask:0xf bank_mask:0xf
v_cvt_pk_bf16_f32 v180, v104, v105
v_add_f32 v110, v100, v101
v_mfma_f32_16x16x32_bf16 v[188:191], v[92:95], v[184:187], 0
v_add_f32 v111, v102, v103
v_add_f32 v110, v110, v104
v_mfma_f32_16x16x32_bf16 v[192:195], v[96:99], v[184:187], 0
v_add_f32 v110, v110, v111
v_mfma_f32_16x16x32_bf16 v[188:191], v[172:175], v[180:183], v[188:191]
s_nop 0
v_add_f32_dpp v110, v110, v110 row_ror:8 row_mask:0xf bank_mask:0xf
v_mov_b32 v111, v110
v_mfma_f32_16x16x32_bf16 v[192:195], v[176:179], v[180:183], v[192:195]
s_nop 0
v_permlane16_swap_b32 v111, v110
v_add_f32 v110, v110, v111
v_mov_b32 v111, v110
s_nop 1
v_permlane32_swap_b32 v111, v110
v_add_f32 v110, v110, v111
v_rcp_f32 v110, v110
s_nop 0
v_pk_mul_f32 v[188:189], v[188:189], v[110:111] op_sel_hi:[1,0]
v_pk_mul_f32 v[190:191], v[190:191], v[110:111] op_sel_hi:[1,0]
v_pk_mul_f32 v[192:193], v[192:193], v[110:111] op_sel_hi:[1,0]
v_pk_mul_f32 v[194:195], v[194:195], v[110:111] op_sel_hi:[1,0]
v_cvt_pk_bf16_f32 v132, v188, v189
v_cvt_pk_bf16_f32 v133, v190, v191
v_cvt_pk_bf16_f32 v134, v192, v193
v_cvt_pk_bf16_f32 v135, v194, v195
buffer_store_dwordx4 v[132:135], v20, s[8:11], s28 offen sc1
main_kernel_s_b4:
s_cmp_eq_u32 s24, 63
s_cbranch_scc1 main_kernel_s_done
s_barrier
buffer_load_dwordx4 v[36:39], v10, s[8:11], s28 offen offset:0 sc1
buffer_load_dwordx4 v[40:43], v10, s[8:11], s28 offen offset:1024 sc1
buffer_load_dwordx4 v[44:47], v10, s[8:11], s28 offen offset:2048 sc1
buffer_load_dwordx4 v[48:51], v10, s[8:11], s28 offen offset:3072 sc1
s_waitcnt vmcnt(3)
v_max3_u32 v2, v36, v37, v38
v_max_u32 v2, v2, v39
v_cmp_eq_u32 vcc, -1, v2
s_cbranch_vccnz Lr_56
Lk_52:
v_smfmac_f32_16x16x64_bf16 v[76:79], v[36:39], a[192:199], v8
s_waitcnt vmcnt(2)
v_max3_u32 v2, v40, v41, v42
v_max_u32 v2, v2, v43
v_cmp_eq_u32 vcc, -1, v2
v_smfmac_f32_16x16x64_bf16 v[80:83], v[36:39], a[224:231], v8
s_cbranch_vccnz Lr_57
Lk_53:
v_smfmac_f32_16x16x64_bf16 v[76:79], v[40:43], a[200:207], v8
s_waitcnt vmcnt(1)
v_max3_u32 v2, v44, v45, v46
v_max_u32 v2, v2, v47
v_cmp_eq_u32 vcc, -1, v2
v_smfmac_f32_16x16x64_bf16 v[80:83], v[40:43], a[232:239], v8
s_cbranch_vccnz Lr_58
Lk_54:
v_smfmac_f32_16x16x64_bf16 v[76:79], v[44:47], a[208:215], v8
s_waitcnt vmcnt(0)
v_max3_u32 v2, v48, v49, v50
v_max_u32 v2, v2, v51
v_cmp_eq_u32 vcc, -1, v2
v_smfmac_f32_16x16x64_bf16 v[80:83], v[44:47], a[240:247], v8
s_cbranch_vccnz Lr_59
Lk_55:
v_smfmac_f32_16x16x64_bf16 v[76:79], v[48:51], a[216:223], v8
v_smfmac_f32_16x16x64_bf16 v[80:83], v[48:51], a[248:255], v8
s_add_u32 s33, s33, 262144
s_cmp_eq_u32 s27, 3
s_nop 4
v_pk_add_f32 v[76:77], v[76:77], v[78:79]
v_pk_add_f32 v[78:79], v[80:81], v[82:83]
s_cbranch_scc1 main_kernel_s_w3
ds_write_b128 v14, v[76:79]
s_waitcnt lgkmcnt(0)
s_barrier
v_mov_b32 v52, 0
v_mov_b32 v53, 0
v_mov_b32 v54, 0
v_mov_b32 v55, 0
v_mov_b32 v56, 0
v_mov_b32 v57, 0
v_mov_b32 v58, 0
v_mov_b32 v59, 0
v_mov_b32 v60, 0
v_mov_b32 v61, 0
v_mov_b32 v62, 0
v_mov_b32 v63, 0
v_mov_b32 v64, 0
v_mov_b32 v65, 0
v_mov_b32 v66, 0
v_mov_b32 v67, 0
v_mov_b32 v68, 0
v_mov_b32 v69, 0
v_mov_b32 v70, 0
v_mov_b32 v71, 0
v_mov_b32 v72, 0
v_mov_b32 v73, 0
v_mov_b32 v74, 0
v_mov_b32 v75, 0
v_mov_b32 v76, 0
v_mov_b32 v77, 0
v_mov_b32 v78, 0
v_mov_b32 v79, 0
v_mov_b32 v80, 0
v_mov_b32 v81, 0
v_mov_b32 v82, 0
v_mov_b32 v83, 0
s_cmp_eq_u32 s27, 1
s_barrier
s_cbranch_scc1 main_kernel_s_w1b
s_cmp_eq_u32 s27, 2
s_cbranch_scc1 main_kernel_s_w2b
s_barrier
s_lshr_b32 s94, s33, 18
s_cmp_ge_u32 s94, s92
s_cbranch_scc1 Lkc_63
Lkg_62:
buffer_load_dwordx4 v[84:87], v26, s[12:15], s33 offen
buffer_load_dwordx4 v[88:91], v26, s[12:15], s33 offen offset:128
buffer_load_dwordx4 v[92:95], v27, s[12:15], s33 offen
buffer_load_dwordx4 v[96:99], v27, s[12:15], s33 offen offset:256
s_add_u32 s94, s94, 1
s_cmp_lt_u32 s94, s92
s_cbranch_scc1 Lkn_65
buffer_load_dword v32, v34, s[20:23], 0 offen sc1
Lkn_65:
s_branch main_kernel_s_b5
main_kernel_s_w1b:
buffer_store_dwordx2 v[132:133], v28, s[16:19], s34 offen sc1
buffer_store_dwordx4 v[196:199], v29, s[8:11], s30 offen sc1
buffer_store_dwordx4 v[196:199], v30, s[8:11], s30 offen sc1
buffer_store_dwordx4 v[196:199], v31, s[8:11], s30 offen sc1
s_cmp_lg_u32 s24, 8
s_cbranch_scc1 main_kernel_s_m1
s_mov_b32 s36, 3801088
buffer_store_dwordx2 v[196:197], v28, s[16:19], s36 offen sc1
s_mov_b32 s36, 3866624
buffer_store_dwordx2 v[196:197], v28, s[16:19], s36 offen sc1
s_mov_b32 s36, 3932160
buffer_store_dwordx2 v[196:197], v28, s[16:19], s36 offen sc1
s_mov_b32 s36, 3997696
buffer_store_dwordx2 v[196:197], v28, s[16:19], s36 offen sc1
s_mov_b32 s36, 4063232
buffer_store_dwordx2 v[196:197], v28, s[16:19], s36 offen sc1
s_mov_b32 s36, 4128768
buffer_store_dwordx2 v[196:197], v28, s[16:19], s36 offen sc1
main_kernel_s_m1:
s_barrier
s_branch main_kernel_s_b5
main_kernel_s_w2b:
buffer_store_dwordx4 v[132:135], v28, s[16:19], s34 offen sc1
buffer_store_dwordx4 v[196:199], v29, s[8:11], s30 offen sc1
buffer_store_dwordx4 v[196:199], v31, s[8:11], s31 offen sc1
s_cmp_ge_u32 s24, 58
s_addc_u32 s36, s24, 0
v_mov_b32 v2, s36
buffer_store_dword v2, v33, s[20:23], 0 offen sc1
s_cmp_lg_u32 s24, 8
s_cbranch_scc1 main_kernel_s_m2
s_mov_b32 s36, 3801088
buffer_store_dwordx4 v[196:199], v28, s[16:19], s36 offen sc1
s_mov_b32 s36, 3866624
buffer_store_dwordx4 v[196:199], v28, s[16:19], s36 offen sc1
s_mov_b32 s36, 3932160
buffer_store_dwordx4 v[196:199], v28, s[16:19], s36 offen sc1
s_mov_b32 s36, 3997696
buffer_store_dwordx4 v[196:199], v28, s[16:19], s36 offen sc1
s_mov_b32 s36, 4063232
buffer_store_dwordx4 v[196:199], v28, s[16:19], s36 offen sc1
s_mov_b32 s36, 4128768
buffer_store_dwordx4 v[196:199], v28, s[16:19], s36 offen sc1
main_kernel_s_m2:
s_barrier
s_branch main_kernel_s_b5
main_kernel_s_w3:
s_barrier
ds_read_b128 v[100:103], v15 offset:0
ds_read_b128 v[104:107], v15 offset:1024
ds_read_b128 v[108:111], v15 offset:2048
s_waitcnt lgkmcnt(1)
v_pk_add_f32 v[100:101], v[100:101], v[104:105]
v_pk_add_f32 v[102:103], v[102:103], v[106:107]
s_waitcnt lgkmcnt(0)
v_pk_add_f32 v[108:109], v[108:109], v[76:77]
v_pk_add_f32 v[110:111], v[110:111], v[78:79]
v_pk_add_f32 v[100:101], v[100:101], v[108:109]
v_pk_add_f32 v[102:103], v[102:103], v[110:111]
buffer_store_dwordx4 v[100:103], v21, s[8:11], s28 offen sc1
s_barrier
v_mov_b32 v52, 0
v_mov_b32 v53, 0
v_mov_b32 v54, 0
v_mov_b32 v55, 0
v_mov_b32 v56, 0
v_mov_b32 v57, 0
v_mov_b32 v58, 0
v_mov_b32 v59, 0
v_mov_b32 v60, 0
v_mov_b32 v61, 0
v_mov_b32 v62, 0
v_mov_b32 v63, 0
v_mov_b32 v64, 0
v_mov_b32 v65, 0
v_mov_b32 v66, 0
v_mov_b32 v67, 0
v_mov_b32 v68, 0
v_mov_b32 v69, 0
v_mov_b32 v70, 0
v_mov_b32 v71, 0
v_mov_b32 v72, 0
v_mov_b32 v73, 0
v_mov_b32 v74, 0
v_mov_b32 v75, 0
v_mov_b32 v76, 0
v_mov_b32 v77, 0
v_mov_b32 v78, 0
v_mov_b32 v79, 0
v_mov_b32 v80, 0
v_mov_b32 v81, 0
v_mov_b32 v82, 0
v_mov_b32 v83, 0
s_waitcnt vmcnt(0)
buffer_load_dwordx4 v[148:151], v22, s[8:11], s28 offen sc1
buffer_load_dwordx4 v[152:155], v23, s[8:11], s28 offen sc1
buffer_load_dwordx4 v[156:159], v24, s[8:11], s28 offen sc1
s_barrier
Lpp_67:
s_waitcnt vmcnt(2)
v_pk_add_f32 v[104:105], v[100:101], v[148:149]
v_pk_add_f32 v[106:107], v[102:103], v[150:151]
s_waitcnt vmcnt(0)
v_pk_add_f32 v[108:109], v[152:153], v[156:157]
v_pk_add_f32 v[110:111], v[154:155], v[158:159]
v_pk_add_f32 v[104:105], v[104:105], v[108:109]
v_pk_add_f32 v[106:107], v[106:107], v[110:111]
v_maximum3_f32 v112, v104, v105, v106
v_cmp_u_f32 vcc, v112, v107
v_cvt_pk_bf16_f32 v132, v104, v106
v_cvt_pk_bf16_f32 v133, v105, v107
s_cbranch_vccnz Lrp_68
Lkp_66:
buffer_store_dword v132, v25, s[8:11], s29 offen sc1
buffer_store_dword v133, v25, s[8:11], s29 offen offset:16 sc1
main_kernel_s_b5:
s_mov_b32 s36, s28
s_mov_b32 s28, s29
s_mov_b32 s29, s30
s_mov_b32 s30, s31
s_mov_b32 s31, s36
s_add_u32 s34, s34, 65536
s_add_u32 s24, s24, 1
s_barrier
s_branch main_kernel_s_step
Lkc_36:
v_readlane_b32 s92, v32, 0
v_readlane_b32 s36, v32, 1
s_min_u32 s92, s92, s36
s_cmp_lt_u32 s94, s92
s_cbranch_scc1 Lkg_35
s_add_u32 s32, s32, 1
s_cmp_ge_u32 s32, 32768
s_cbranch_scc1 Lkg_35
s_sleep 2
Lkl_37:
buffer_load_dword v32, v34, s[20:23], 0 offen sc1
s_waitcnt vmcnt(0)
s_branch Lkc_36
Lr_43:
s_add_u32 s32, s32, 1
s_cmp_ge_u32 s32, 32768
s_cbranch_scc1 Lk_39
buffer_load_dwordx4 v[36:39], v9, s[8:11], s28 offen offset:0 sc1
buffer_load_dwordx4 v[40:43], v9, s[8:11], s28 offen offset:1024 sc1
buffer_load_dwordx4 v[44:47], v9, s[8:11], s28 offen offset:2048 sc1
buffer_load_dwordx4 v[48:51], v9, s[8:11], s28 offen offset:3072 sc1
s_waitcnt vmcnt(3)
v_max3_u32 v2, v36, v37, v38
v_max_u32 v2, v2, v39
v_cmp_eq_u32 vcc, -1, v2
s_cbranch_vccnz Lr_43
s_branch Lk_39
Lr_44:
s_add_u32 s32, s32, 1
s_cmp_ge_u32 s32, 32768
s_cbranch_scc1 Lk_40
buffer_load_dwordx4 v[40:43], v9, s[8:11], s28 offen offset:1024 sc1
buffer_load_dwordx4 v[44:47], v9, s[8:11], s28 offen offset:2048 sc1
buffer_load_dwordx4 v[48:51], v9, s[8:11], s28 offen offset:3072 sc1
s_waitcnt vmcnt(2)
v_max3_u32 v2, v40, v41, v42
v_max_u32 v2, v2, v43
v_cmp_eq_u32 vcc, -1, v2
s_cbranch_vccnz Lr_44
s_branch Lk_40
Lr_45:
s_add_u32 s32, s32, 1
s_cmp_ge_u32 s32, 32768
s_cbranch_scc1 Lk_41
buffer_load_dwordx4 v[44:47], v9, s[8:11], s28 offen offset:2048 sc1
buffer_load_dwordx4 v[48:51], v9, s[8:11], s28 offen offset:3072 sc1
s_waitcnt vmcnt(1)
v_max3_u32 v2, v44, v45, v46
v_max_u32 v2, v2, v47
v_cmp_eq_u32 vcc, -1, v2
s_cbranch_vccnz Lr_45
s_branch Lk_41
Lr_46:
s_add_u32 s32, s32, 1
s_cmp_ge_u32 s32, 32768
s_cbranch_scc1 Lk_42
buffer_load_dwordx4 v[48:51], v9, s[8:11], s28 offen offset:3072 sc1
s_waitcnt vmcnt(0)
v_max3_u32 v2, v48, v49, v50
v_max_u32 v2, v2, v51
v_cmp_eq_u32 vcc, -1, v2
s_cbranch_vccnz Lr_46
s_branch Lk_42
Lrs_51:
v_max3_u32 v2, v148, v149, v150
v_max3_u32 v2, v2, v151, v152
v_max3_u32 v2, v2, v153, v154
v_max3_u32 v2, v2, v155, v156
v_max3_u32 v2, v2, v157, v158
v_max3_u32 v2, v2, v159, v160
v_max3_u32 v2, v2, v161, v162
v_max3_u32 v2, v2, v163, v164
v_max3_u32 v2, v2, v165, v166
v_max_u32 v2, v2, v167
v_cmp_eq_u32 vcc, -1, v2
s_cbranch_vccz Lks_50
s_add_u32 s32, s32, 1
s_cmp_ge_u32 s32, 32768
s_cbranch_scc1 Lks_50
buffer_load_dwordx4 v[148:151], v18, s[8:11], s28 offen offset:0 sc1
buffer_load_dword v164, v19, s[8:11], s28 offen offset:0 sc1
buffer_load_dwordx4 v[152:155], v18, s[8:11], s28 offen offset:1280 sc1
buffer_load_dword v165, v19, s[8:11], s28 offen offset:1280 sc1
buffer_load_dwordx4 v[156:159], v18, s[8:11], s28 offen offset:2560 sc1
buffer_load_dword v166, v19, s[8:11], s28 offen offset:2560 sc1
buffer_load_dwordx4 v[160:163], v18, s[8:11], s28 offen offset:3840 sc1
buffer_load_dword v167, v19, s[8:11], s28 offen offset:3840 sc1
s_branch Lps_49
Lr_56:
s_add_u32 s32, s32, 1
s_cmp_ge_u32 s32, 32768
s_cbranch_scc1 Lk_52
buffer_load_dwordx4 v[36:39], v10, s[8:11], s28 offen offset:0 sc1
buffer_load_dwordx4 v[40:43], v10, s[8:11], s28 offen offset:1024 sc1
buffer_load_dwordx4 v[44:47], v10, s[8:11], s28 offen offset:2048 sc1
buffer_load_dwordx4 v[48:51], v10, s[8:11], s28 offen offset:3072 sc1
s_waitcnt vmcnt(3)
v_max3_u32 v2, v36, v37, v38
v_max_u32 v2, v2, v39
v_cmp_eq_u32 vcc, -1, v2
s_cbranch_vccnz Lr_56
s_branch Lk_52
Lr_57:
s_add_u32 s32, s32, 1
s_cmp_ge_u32 s32, 32768
s_cbranch_scc1 Lk_53
buffer_load_dwordx4 v[40:43], v10, s[8:11], s28 offen offset:1024 sc1
buffer_load_dwordx4 v[44:47], v10, s[8:11], s28 offen offset:2048 sc1
buffer_load_dwordx4 v[48:51], v10, s[8:11], s28 offen offset:3072 sc1
s_waitcnt vmcnt(2)
v_max3_u32 v2, v40, v41, v42
v_max_u32 v2, v2, v43
v_cmp_eq_u32 vcc, -1, v2
s_cbranch_vccnz Lr_57
s_branch Lk_53
Lr_58:
s_add_u32 s32, s32, 1
s_cmp_ge_u32 s32, 32768
s_cbranch_scc1 Lk_54
buffer_load_dwordx4 v[44:47], v10, s[8:11], s28 offen offset:2048 sc1
buffer_load_dwordx4 v[48:51], v10, s[8:11], s28 offen offset:3072 sc1
s_waitcnt vmcnt(1)
v_max3_u32 v2, v44, v45, v46
v_max_u32 v2, v2, v47
v_cmp_eq_u32 vcc, -1, v2
s_cbranch_vccnz Lr_58
s_branch Lk_54
Lr_59:
s_add_u32 s32, s32, 1
s_cmp_ge_u32 s32, 32768
s_cbranch_scc1 Lk_55
buffer_load_dwordx4 v[48:51], v10, s[8:11], s28 offen offset:3072 sc1
s_waitcnt vmcnt(0)
v_max3_u32 v2, v48, v49, v50
v_max_u32 v2, v2, v51
v_cmp_eq_u32 vcc, -1, v2
s_cbranch_vccnz Lr_59
s_branch Lk_55
Lkc_63:
v_readlane_b32 s92, v32, 0
v_readlane_b32 s36, v32, 1
s_min_u32 s92, s92, s36
s_cmp_lt_u32 s94, s92
s_cbranch_scc1 Lkg_62
s_add_u32 s32, s32, 1
s_cmp_ge_u32 s32, 32768
s_cbranch_scc1 Lkg_62
s_sleep 2
Lkl_64:
buffer_load_dword v32, v34, s[20:23], 0 offen sc1
s_waitcnt vmcnt(0)
s_branch Lkc_63
Lrp_68:
v_max3_u32 v2, v148, v149, v150
v_max3_u32 v2, v2, v151, v152
v_max3_u32 v2, v2, v153, v154
v_max3_u32 v2, v2, v155, v156
v_max3_u32 v2, v2, v157, v158
v_max_u32 v2, v2, v159
v_cmp_eq_u32 vcc, -1, v2
s_cbranch_vccz Lkp_66
s_add_u32 s32, s32, 1
s_cmp_ge_u32 s32, 32768
s_cbranch_scc1 Lkp_66
buffer_load_dwordx4 v[148:151], v22, s[8:11], s28 offen sc1
buffer_load_dwordx4 v[152:155], v23, s[8:11], s28 offen sc1
buffer_load_dwordx4 v[156:159], v24, s[8:11], s28 offen sc1
s_branch Lpp_67
main_kernel_s_done:
s_waitcnt vmcnt(0)
s_barrier
v_mov_b32 v2, 64
s_cmp_eq_u32 s27, 2
s_cselect_b32 s36, 0, 0x40000000
buffer_store_dword v2, v33, s[20:23], s36 offen sc1
s_endpgm
main_kernel_w1:
s_lshr_b32 s20, s40, 7
s_sub_u32 s20, 3, s20
s_and_b32 s20, s20, 7
s_lshl_b32 s20, s20, 7
s_lshl_b32 s21, s73, 4
s_lshl_b32 s22, s24, 3
s_add_u32 s21, s21, s22
s_add_u32 s21, s21, 512
s_mul_i32 s21, s21, s30
s_add_u32 s20, s20, s21
s_cmp_lt_u32 s24, 2
s_cselect_b32 s20, s20, 0x40000000
s_cmp_lt_u32 s72, 7
s_cselect_b32 s20, s20, 0x40000000
v_lshrrev_b32 v2, 3, v1
v_mul_lo_u32 v2, v2, s30
v_and_b32 v3, 7, v1
v_lshl_add_u32 v2, v3, 10, v2
buffer_load_dword v216, v2, s[40:43], s20 offen
s_cmp_lg_u32 s72, 7
s_cbranch_scc1 main_kernel_nlate
s_mov_b32 s54, 0
buffer_load_dwordx2 v[210:211], v209, s[64:67], 0 offen offset:128 sc1
s_waitcnt vmcnt(0)
s_cmp_lg_u32 s25, 0
s_cbranch_scc1 main_kernel_lt_ysk
s_mov_b32 s56, 2
s_cmp_lg_u32 s3, 0
s_cbranch_scc1 main_kernel_lt_yok
main_kernel_lt_ylp:
v_cmp_eq_u32 vcc, -1, v210
s_mov_b32 s57, 0x2000
v_cmp_eq_u32 s[58:59], s57, v211
s_and_b32 s58, s58, vcc_lo
s_and_b32 s58, s58, 0xff
v_readlane_b32 s56, v210, 8
s_cmp_eq_u32 s58, 0xff
s_cbranch_scc1 main_kernel_lt_yfa
s_mov_b32 s57, 0
v_readlane_b32 s58, v211, 0
s_lshr_b32 s58, s58, 8
s_add_u32 s57, s57, s58
v_readlane_b32 s58, v211, 1
s_lshr_b32 s58, s58, 8
s_add_u32 s57, s57, s58
v_readlane_b32 s58, v211, 2
s_lshr_b32 s58, s58, 8
s_add_u32 s57, s57, s58
v_readlane_b32 s58, v211, 3
s_lshr_b32 s58, s58, 8
s_add_u32 s57, s57, s58
v_readlane_b32 s58, v211, 4
s_lshr_b32 s58, s58, 8
s_add_u32 s57, s57, s58
v_readlane_b32 s58, v211, 5
s_lshr_b32 s58, s58, 8
s_add_u32 s57, s57, s58
v_readlane_b32 s58, v211, 6
s_lshr_b32 s58, s58, 8
s_add_u32 s57, s57, s58
v_readlane_b32 s58, v211, 7
s_lshr_b32 s58, s58, 8
s_add_u32 s57, s57, s58
s_mov_b32 s56, 2
s_cmp_eq_u32 s57, 256
s_cbranch_scc1 main_kernel_lt_yok
main_kernel_lt_ylpr:
s_add_u32 s54, s54, 1
s_cmp_ge_u32 s54, 131072
s_cbranch_scc1 main_kernel_lt_yok
s_sleep 4
buffer_load_dwordx2 v[210:211], v209, s[64:67], 0 offen offset:128 sc1
s_waitcnt vmcnt(0)
s_branch main_kernel_lt_ylp
main_kernel_lt_yfa:
s_cmp_lt_u32 s56, 0x4000000
s_cbranch_scc1 main_kernel_lt_ylpr
s_cmp_gt_u32 s56, 0x4000400
s_cselect_b32 s56, 5, 1
main_kernel_lt_yok:
v_mov_b32 v210, s56
v_mov_b32 v211, 131136
ds_write_b32 v211, v210
s_waitcnt lgkmcnt(0)
main_kernel_lt_ysk:
s_barrier
main_kernel_nlate:
s_lshl_b32 m0, s25, 14
s_add_u32 m0, m0, 0x10000
s_mul_i32 s26, s30, 256
buffer_load_dwordx4 v92, s[12:15], s26 offen nt lds
s_add_u32 m0, m0, 1024
s_add_u32 s26, s26, s49
buffer_load_dwordx4 v93, s[12:15], s26 offen nt lds
s_add_u32 m0, m0, 1024
s_add_u32 s26, s26, s49
buffer_load_dwordx4 v92, s[12:15], s26 offen nt lds
s_add_u32 m0, m0, 1024
s_add_u32 s26, s26, s49
buffer_load_dwordx4 v93, s[12:15], s26 offen nt lds
s_add_u32 m0, m0, 1024
s_add_u32 s26, s26, s49
buffer_load_dwordx4 v92, s[12:15], s26 offen nt lds
s_add_u32 m0, m0, 1024
s_add_u32 s26, s26, s49
buffer_load_dwordx4 v93, s[12:15], s26 offen nt lds
s_add_u32 m0, m0, 1024
s_add_u32 s26, s26, s49
buffer_load_dwordx4 v92, s[12:15], s26 offen nt lds
s_add_u32 m0, m0, 1024
s_add_u32 s26, s26, s49
buffer_load_dwordx4 v93, s[12:15], s26 offen nt lds
s_add_u32 m0, m0, 1024
s_add_u32 s26, s26, s49
buffer_load_dwordx4 v92, s[12:15], s26 offen nt lds
s_add_u32 m0, m0, 1024
s_add_u32 s26, s26, s49
buffer_load_dwordx4 v93, s[12:15], s26 offen nt lds
s_add_u32 m0, m0, 1024
s_add_u32 s26, s26, s49
buffer_load_dwordx4 v92, s[12:15], s26 offen nt lds
s_add_u32 m0, m0, 1024
s_add_u32 s26, s26, s49
buffer_load_dwordx4 v93, s[12:15], s26 offen nt lds
s_add_u32 m0, m0, 1024
s_add_u32 s26, s26, s49
buffer_load_dwordx4 v92, s[12:15], s26 offen nt lds
s_add_u32 m0, m0, 1024
s_add_u32 s26, s26, s49
buffer_load_dwordx4 v93, s[12:15], s26 offen nt lds
s_add_u32 m0, m0, 1024
s_add_u32 s26, s26, s49
buffer_load_dwordx4 v92, s[12:15], s26 offen nt lds
s_add_u32 m0, m0, 1024
s_add_u32 s26, s26, s49
buffer_load_dwordx4 v93, s[12:15], s26 offen nt lds
s_sub_u32 s72, s72, 4
v_and_b32 v2, 15, v1
v_lshrrev_b32 v3, 4, v1
v_lshlrev_b32 v3, 9, v3
v_lshl_add_u32 v6, v2, 4, v3
v_add_u32 v7, 0x10000, v6
s_lshl_b32 s26, s25, 11
v_add_u32 v9, s26, v6
s_lshl_b32 s22, s25, 12
v_mov_b32 v11, 0x40000000
s_lshl_b32 s26, s25, 2
s_add_u32 s26, s26, 131072
v_mov_b32 v110, s26
v_mov_b32 v113, 131072
s_mov_b32 s54, 0
s_lshr_b32 s98, s72, 1
s_and_b32 s94, s73, 3
s_lshr_b32 s95, s73, 2
s_mov_b32 s23, 16384
s_cmp_eq_u32 s72, 3
s_cbranch_scc1 main_kernel_f2
s_mov_b32 s52, 0
s_mov_b32 s53, 65536
s_mov_b32 s28, 16384
s_mov_b32 s37, 64
s_cmp_eq_u32 s72, 1
s_cbranch_scc1 main_kernel_f1
s_cmp_eq_u32 s72, 2
s_cbranch_scc1 main_kernel_v
s_lshl_b32 s75, s73, 7
s_add_u32 s75, s75, 0x6a00000
s_lshl_b32 s26, s25, 2
s_add_u32 s26, s26, s75
v_mov_b32 v108, 0x40000000
v_writelane_b32 v108, s26, 0
v_lshl_add_u32 v8, v1, 4, s22
s_lshl_b32 s75, s73, 13
s_add_u32 s31, s75, 0x1400000
s_mov_b32 s29, 262144
v_lshrrev_b32 v2, 5, v1
v_lshlrev_b32 v2, 12, v2
v_bfe_u32 v3, v1, 4, 1
v_lshl_add_u32 v2, v3, 10, v2
v_and_b32 v4, 1, v1
v_lshl_add_u32 v2, v4, 3, v2
v_bfe_u32 v4, v1, 2, 2
v_lshl_add_u32 v2, v4, 8, v2
v_xor_b32 v4, s25, v4
v_lshl_add_u32 v3, v4, 2, v3
v_and_b32 v4, 2, v1
v_xor_b32 v3, v3, v4
v_lshl_add_u32 v94, v3, 4, v2
v_xor_b32 v95, 16, v94
v_add_u32 v96, 0x10000, v94
v_add_u32 v97, 0x10000, v95
s_waitcnt vmcnt(16)
s_barrier
ds_read_b64_tr_b16 a[0:1], v94 offset:0
ds_read_b64_tr_b16 a[2:3], v94 offset:2048
ds_read_b64_tr_b16 a[4:5], v95 offset:0
ds_read_b64_tr_b16 a[6:7], v95 offset:2048
ds_read_b64_tr_b16 a[8:9], v94 offset:8192
ds_read_b64_tr_b16 a[10:11], v94 offset:10240
ds_read_b64_tr_b16 a[12:13], v95 offset:8192
ds_read_b64_tr_b16 a[14:15], v95 offset:10240
ds_read_b64_tr_b16 a[16:17], v94 offset:16384
ds_read_b64_tr_b16 a[18:19], v94 offset:18432
ds_read_b64_tr_b16 a[20:21], v95 offset:16384
ds_read_b64_tr_b16 a[22:23], v95 offset:18432
ds_read_b64_tr_b16 a[24:25], v94 offset:24576
ds_read_b64_tr_b16 a[26:27], v94 offset:26624
ds_read_b64_tr_b16 a[28:29], v95 offset:24576
ds_read_b64_tr_b16 a[30:31], v95 offset:26624
ds_read_b64_tr_b16 a[32:33], v94 offset:32768
ds_read_b64_tr_b16 a[34:35], v94 offset:34816
ds_read_b64_tr_b16 a[36:37], v95 offset:32768
ds_read_b64_tr_b16 a[38:39], v95 offset:34816
ds_read_b64_tr_b16 a[40:41], v94 offset:40960
ds_read_b64_tr_b16 a[42:43], v94 offset:43008
ds_read_b64_tr_b16 a[44:45], v95 offset:40960
ds_read_b64_tr_b16 a[46:47], v95 offset:43008
ds_read_b64_tr_b16 a[48:49], v94 offset:49152
ds_read_b64_tr_b16 a[50:51], v94 offset:51200
ds_read_b64_tr_b16 a[52:53], v95 offset:49152
ds_read_b64_tr_b16 a[54:55], v95 offset:51200
ds_read_b64_tr_b16 a[56:57], v94 offset:57344
ds_read_b64_tr_b16 a[58:59], v94 offset:59392
ds_read_b64_tr_b16 a[60:61], v95 offset:57344
ds_read_b64_tr_b16 a[62:63], v95 offset:59392
s_waitcnt lgkmcnt(0)
s_barrier
s_lshl_b32 m0, s25, 14
s_mul_i32 s26, s30, 512
buffer_load_dwordx4 v92, s[12:15], s26 offen nt lds
s_add_u32 m0, m0, 1024
s_add_u32 s26, s26, s49
buffer_load_dwordx4 v93, s[12:15], s26 offen nt lds
s_add_u32 m0, m0, 1024
s_add_u32 s26, s26, s49
buffer_load_dwordx4 v92, s[12:15], s26 offen nt lds
s_add_u32 m0, m0, 1024
s_add_u32 s26, s26, s49
buffer_load_dwordx4 v93, s[12:15], s26 offen nt lds
s_add_u32 m0, m0, 1024
s_add_u32 s26, s26, s49
buffer_load_dwordx4 v92, s[12:15], s26 offen nt lds
s_add_u32 m0, m0, 1024
s_add_u32 s26, s26, s49
buffer_load_dwordx4 v93, s[12:15], s26 offen nt lds
s_add_u32 m0, m0, 1024
s_add_u32 s26, s26, s49
buffer_load_dwordx4 v92, s[12:15], s26 offen nt lds
s_add_u32 m0, m0, 1024
s_add_u32 s26, s26, s49
buffer_load_dwordx4 v93, s[12:15], s26 offen nt lds
s_add_u32 m0, m0, 1024
s_add_u32 s26, s26, s49
buffer_load_dwordx4 v92, s[12:15], s26 offen nt lds
s_add_u32 m0, m0, 1024
s_add_u32 s26, s26, s49
buffer_load_dwordx4 v93, s[12:15], s26 offen nt lds
s_add_u32 m0, m0, 1024
s_add_u32 s26, s26, s49
buffer_load_dwordx4 v92, s[12:15], s26 offen nt lds
s_add_u32 m0, m0, 1024
s_add_u32 s26, s26, s49
buffer_load_dwordx4 v93, s[12:15], s26 offen nt lds
s_add_u32 m0, m0, 1024
s_add_u32 s26, s26, s49
buffer_load_dwordx4 v92, s[12:15], s26 offen nt lds
s_add_u32 m0, m0, 1024
s_add_u32 s26, s26, s49
buffer_load_dwordx4 v93, s[12:15], s26 offen nt lds
s_add_u32 m0, m0, 1024
s_add_u32 s26, s26, s49
buffer_load_dwordx4 v92, s[12:15], s26 offen nt lds
s_add_u32 m0, m0, 1024
s_add_u32 s26, s26, s49
buffer_load_dwordx4 v93, s[12:15], s26 offen nt lds
s_waitcnt vmcnt(16)
s_barrier
ds_read_b64_tr_b16 a[64:65], v96 offset:0
ds_read_b64_tr_b16 a[66:67], v96 offset:2048
ds_read_b64_tr_b16 a[68:69], v97 offset:0
ds_read_b64_tr_b16 a[70:71], v97 offset:2048
ds_read_b64_tr_b16 a[72:73], v96 offset:8192
ds_read_b64_tr_b16 a[74:75], v96 offset:10240
ds_read_b64_tr_b16 a[76:77], v97 offset:8192
ds_read_b64_tr_b16 a[78:79], v97 offset:10240
ds_read_b64_tr_b16 a[80:81], v96 offset:16384
ds_read_b64_tr_b16 a[82:83], v96 offset:18432
ds_read_b64_tr_b16 a[84:85], v97 offset:16384
ds_read_b64_tr_b16 a[86:87], v97 offset:18432
ds_read_b64_tr_b16 a[88:89], v96 offset:24576
ds_read_b64_tr_b16 a[90:91], v96 offset:26624
ds_read_b64_tr_b16 a[92:93], v97 offset:24576
ds_read_b64_tr_b16 a[94:95], v97 offset:26624
ds_read_b64_tr_b16 a[96:97], v96 offset:32768
ds_read_b64_tr_b16 a[98:99], v96 offset:34816
ds_read_b64_tr_b16 a[100:101], v97 offset:32768
ds_read_b64_tr_b16 a[102:103], v97 offset:34816
ds_read_b64_tr_b16 a[104:105], v96 offset:40960
ds_read_b64_tr_b16 a[106:107], v96 offset:43008
ds_read_b64_tr_b16 a[108:109], v97 offset:40960
ds_read_b64_tr_b16 a[110:111], v97 offset:43008
ds_read_b64_tr_b16 a[112:113], v96 offset:49152
ds_read_b64_tr_b16 a[114:115], v96 offset:51200
ds_read_b64_tr_b16 a[116:117], v97 offset:49152
ds_read_b64_tr_b16 a[118:119], v97 offset:51200
ds_read_b64_tr_b16 a[120:121], v96 offset:57344
ds_read_b64_tr_b16 a[122:123], v96 offset:59392
ds_read_b64_tr_b16 a[124:125], v97 offset:57344
ds_read_b64_tr_b16 a[126:127], v97 offset:59392
s_waitcnt lgkmcnt(0)
s_barrier
s_lshl_b32 m0, s25, 14
s_add_u32 m0, m0, 0x10000
s_mul_i32 s26, s30, 768
buffer_load_dwordx4 v92, s[12:15], s26 offen nt lds
s_add_u32 m0, m0, 1024
s_add_u32 s26, s26, s49
buffer_load_dwordx4 v93, s[12:15], s26 offen nt lds
s_add_u32 m0, m0, 1024
s_add_u32 s26, s26, s49
buffer_load_dwordx4 v92, s[12:15], s26 offen nt lds
s_add_u32 m0, m0, 1024
s_add_u32 s26, s26, s49
buffer_load_dwordx4 v93, s[12:15], s26 offen nt lds
s_add_u32 m0, m0, 1024
s_add_u32 s26, s26, s49
buffer_load_dwordx4 v92, s[12:15], s26 offen nt lds
s_add_u32 m0, m0, 1024
s_add_u32 s26, s26, s49
buffer_load_dwordx4 v93, s[12:15], s26 offen nt lds
s_add_u32 m0, m0, 1024
s_add_u32 s26, s26, s49
buffer_load_dwordx4 v92, s[12:15], s26 offen nt lds
s_add_u32 m0, m0, 1024
s_add_u32 s26, s26, s49
buffer_load_dwordx4 v93, s[12:15], s26 offen nt lds
s_add_u32 m0, m0, 1024
s_add_u32 s26, s26, s49
buffer_load_dwordx4 v92, s[12:15], s26 offen nt lds
s_add_u32 m0, m0, 1024
s_add_u32 s26, s26, s49
buffer_load_dwordx4 v93, s[12:15], s26 offen nt lds
s_add_u32 m0, m0, 1024
s_add_u32 s26, s26, s49
buffer_load_dwordx4 v92, s[12:15], s26 offen nt lds
s_add_u32 m0, m0, 1024
s_add_u32 s26, s26, s49
buffer_load_dwordx4 v93, s[12:15], s26 offen nt lds
s_add_u32 m0, m0, 1024
s_add_u32 s26, s26, s49
buffer_load_dwordx4 v92, s[12:15], s26 offen nt lds
s_add_u32 m0, m0, 1024
s_add_u32 s26, s26, s49
buffer_load_dwordx4 v93, s[12:15], s26 offen nt lds
s_add_u32 m0, m0, 1024
s_add_u32 s26, s26, s49
buffer_load_dwordx4 v92, s[12:15], s26 offen nt lds
s_add_u32 m0, m0, 1024
s_add_u32 s26, s26, s49
buffer_load_dwordx4 v93, s[12:15], s26 offen nt lds
s_waitcnt vmcnt(16)
s_barrier
buffer_load_dwordx2 v[210:211], v209, s[64:67], 0 offen offset:128
ds_read_b64_tr_b16 a[128:129], v94 offset:0
ds_read_b64_tr_b16 a[130:131], v94 offset:2048
ds_read_b64_tr_b16 a[132:133], v95 offset:0
ds_read_b64_tr_b16 a[134:135], v95 offset:2048
ds_read_b64_tr_b16 a[136:137], v94 offset:8192
ds_read_b64_tr_b16 a[138:139], v94 offset:10240
ds_read_b64_tr_b16 a[140:141], v95 offset:8192
ds_read_b64_tr_b16 a[142:143], v95 offset:10240
ds_read_b64_tr_b16 a[144:145], v94 offset:16384
ds_read_b64_tr_b16 a[146:147], v94 offset:18432
ds_read_b64_tr_b16 a[148:149], v95 offset:16384
ds_read_b64_tr_b16 a[150:151], v95 offset:18432
ds_read_b64_tr_b16 a[152:153], v94 offset:24576
ds_read_b64_tr_b16 a[154:155], v94 offset:26624
ds_read_b64_tr_b16 a[156:157], v95 offset:24576
ds_read_b64_tr_b16 a[158:159], v95 offset:26624
ds_read_b64_tr_b16 a[160:161], v94 offset:32768
ds_read_b64_tr_b16 a[162:163], v94 offset:34816
ds_read_b64_tr_b16 a[164:165], v95 offset:32768
ds_read_b64_tr_b16 a[166:167], v95 offset:34816
ds_read_b64_tr_b16 a[168:169], v94 offset:40960
ds_read_b64_tr_b16 a[170:171], v94 offset:43008
ds_read_b64_tr_b16 a[172:173], v95 offset:40960
ds_read_b64_tr_b16 a[174:175], v95 offset:43008
ds_read_b64_tr_b16 a[176:177], v94 offset:49152
ds_read_b64_tr_b16 a[178:179], v94 offset:51200
ds_read_b64_tr_b16 a[180:181], v95 offset:49152
ds_read_b64_tr_b16 a[182:183], v95 offset:51200
ds_read_b64_tr_b16 a[184:185], v94 offset:57344
ds_read_b64_tr_b16 a[186:187], v94 offset:59392
ds_read_b64_tr_b16 a[188:189], v95 offset:57344
ds_read_b64_tr_b16 a[190:191], v95 offset:59392
s_waitcnt lgkmcnt(0)
s_barrier
s_waitcnt vmcnt(0)
s_cmp_lg_u32 s25, 0
s_cbranch_scc1 main_kernel_k_ysk
s_mov_b32 s56, 2
s_cmp_lg_u32 s3, 0
s_cbranch_scc1 main_kernel_k_yok
main_kernel_k_ylp:
v_cmp_eq_u32 vcc, -1, v210
s_mov_b32 s57, 0x2000
v_cmp_eq_u32 s[58:59], s57, v211
s_and_b32 s58, s58, vcc_lo
s_and_b32 s58, s58, 0xff
v_readlane_b32 s56, v210, 8
s_cmp_eq_u32 s58, 0xff
s_cbranch_scc1 main_kernel_k_yfa
s_mov_b32 s57, 0
v_readlane_b32 s58, v211, 0
s_lshr_b32 s58, s58, 8
s_add_u32 s57, s57, s58
v_readlane_b32 s58, v211, 1
s_lshr_b32 s58, s58, 8
s_add_u32 s57, s57, s58
v_readlane_b32 s58, v211, 2
s_lshr_b32 s58, s58, 8
s_add_u32 s57, s57, s58
v_readlane_b32 s58, v211, 3
s_lshr_b32 s58, s58, 8
s_add_u32 s57, s57, s58
v_readlane_b32 s58, v211, 4
s_lshr_b32 s58, s58, 8
s_add_u32 s57, s57, s58
v_readlane_b32 s58, v211, 5
s_lshr_b32 s58, s58, 8
s_add_u32 s57, s57, s58
v_readlane_b32 s58, v211, 6
s_lshr_b32 s58, s58, 8
s_add_u32 s57, s57, s58
v_readlane_b32 s58, v211, 7
s_lshr_b32 s58, s58, 8
s_add_u32 s57, s57, s58
s_mov_b32 s56, 2
s_cmp_eq_u32 s57, 256
s_cbranch_scc1 main_kernel_k_yok
main_kernel_k_ylpr:
s_add_u32 s54, s54, 1
s_cmp_ge_u32 s54, 131072
s_cbranch_scc1 main_kernel_k_yok
s_sleep 4
buffer_load_dwordx2 v[210:211], v209, s[64:67], 0 offen offset:128 sc1
s_waitcnt vmcnt(0)
s_branch main_kernel_k_ylp
main_kernel_k_yfa:
s_mov_b32 s56, 1
main_kernel_k_yok:
v_mov_b32 v210, s56
v_mov_b32 v211, 131136
ds_write_b32 v211, v210
s_waitcnt lgkmcnt(0)
main_kernel_k_ysk:
s_barrier
v_mov_b32 v211, 131136
ds_read_b32 v210, v211
ds_read_b64_tr_b16 a[192:193], v96 offset:0
ds_read_b64_tr_b16 a[194:195], v96 offset:2048
ds_read_b64_tr_b16 a[196:197], v97 offset:0
ds_read_b64_tr_b16 a[198:199], v97 offset:2048
ds_read_b64_tr_b16 a[200:201], v96 offset:8192
ds_read_b64_tr_b16 a[202:203], v96 offset:10240
ds_read_b64_tr_b16 a[204:205], v97 offset:8192
ds_read_b64_tr_b16 a[206:207], v97 offset:10240
ds_read_b64_tr_b16 a[208:209], v96 offset:16384
ds_read_b64_tr_b16 a[210:211], v96 offset:18432
ds_read_b64_tr_b16 a[212:213], v97 offset:16384
ds_read_b64_tr_b16 a[214:215], v97 offset:18432
ds_read_b64_tr_b16 a[216:217], v96 offset:24576
ds_read_b64_tr_b16 a[218:219], v96 offset:26624
ds_read_b64_tr_b16 a[220:221], v97 offset:24576
ds_read_b64_tr_b16 a[222:223], v97 offset:26624
ds_read_b64_tr_b16 a[224:225], v96 offset:32768
ds_read_b64_tr_b16 a[226:227], v96 offset:34816
ds_read_b64_tr_b16 a[228:229], v97 offset:32768
ds_read_b64_tr_b16 a[230:231], v97 offset:34816
ds_read_b64_tr_b16 a[232:233], v96 offset:40960
ds_read_b64_tr_b16 a[234:235], v96 offset:43008
ds_read_b64_tr_b16 a[236:237], v97 offset:40960
ds_read_b64_tr_b16 a[238:239], v97 offset:43008
ds_read_b64_tr_b16 a[240:241], v96 offset:49152
ds_read_b64_tr_b16 a[242:243], v96 offset:51200
ds_read_b64_tr_b16 a[244:245], v97 offset:49152
ds_read_b64_tr_b16 a[246:247], v97 offset:51200
ds_read_b64_tr_b16 a[248:249], v96 offset:57344
ds_read_b64_tr_b16 a[250:251], v96 offset:59392
ds_read_b64_tr_b16 a[252:253], v97 offset:57344
ds_read_b64_tr_b16 a[254:255], v97 offset:59392
s_waitcnt lgkmcnt(0)
s_barrier
v_readfirstlane_b32 s6, v210
s_and_b32 s56, s6, 3
s_sub_u32 s56, s56, s3
s_cmp_eq_u32 s56, 2
s_cbranch_scc1 main_kernel_again
s_mov_b32 s21, 0x40000000
s_mov_b32 s39, 0
s_mov_b32 s36, 0
s_add_u32 s12, s76, s74
s_addc_u32 s13, s77, 0
s_sub_u32 s14, 0x800000, s74
s_mov_b32 s15, 0x00020000
s_mov_b32 s68, 0
s_mov_b32 s75, 524288
v_lshrrev_b32 v2, 4, v1
v_lshlrev_b32 v3, 2, v2
v_and_b32 v4, 15, v1
v_xor_b32 v4, v4, v3
s_lshl_b32 s26, s25, 4
v_add_u32 v2, s26, v2
v_mul_u32_u24 v2, 8192, v2
v_lshl_add_u32 v200, v4, 4, v2
v_xor_b32 v2, 16, v200
v_add_u32 v201, 31744, v2
v_add_u32 v202, 63488, v200
v_add_u32 v203, 95232, v2
s_mov_b32 s20, s52
s_mov_b32 s36, 0
s_lshr_b32 s24, s37, 1
s_sub_u32 s24, s24, 2
s_mov_b32 m0, s22
s_nop 0
buffer_load_dwordx4 v8, s[8:11], s20 offen sc1 lds
s_add_u32 s36, s36, 1
buffer_load_dwordx4 v8, s[8:11], s20 offen offset:1024 sc1 lds
buffer_load_dwordx4 v8, s[8:11], s20 offen offset:2048 sc1 lds
buffer_load_dwordx4 v8, s[8:11], s20 offen offset:3072 sc1 lds
s_add_u32 s20, s20, s23
s_add_u32 m0, s22, 16384
s_nop 0
buffer_load_dwordx4 v8, s[8:11], s20 offen sc1 lds
buffer_load_dwordx4 v8, s[8:11], s20 offen offset:1024 sc1 lds
buffer_load_dwordx4 v8, s[8:11], s20 offen offset:2048 sc1 lds
buffer_load_dword v2, v11, s[8:11], 0 offen
buffer_load_dwordx4 v8, s[8:11], s20 offen offset:3072 sc1 lds
s_add_u32 s20, s20, s23
s_add_u32 m0, s22, 32768
buffer_load_dword v2, v11, s[8:11], 0 offen
buffer_load_dwordx4 v8, s[8:11], s20 offen sc1 lds
buffer_load_dwordx4 v8, s[8:11], s20 offen offset:1024 sc1 lds
buffer_load_dwordx4 v8, s[8:11], s20 offen offset:2048 sc1 lds
buffer_load_dwordx4 v8, s[8:11], s20 offen offset:3072 sc1 lds
s_add_u32 s20, s20, s23
s_add_u32 m0, s22, 49152
s_nop 0
buffer_load_dwordx4 v8, s[8:11], s20 offen sc1 lds
buffer_load_dwordx4 v8, s[8:11], s20 offen offset:1024 sc1 lds
buffer_load_dwordx4 v8, s[8:11], s20 offen offset:2048 sc1 lds
buffer_load_dwordx4 v8, s[8:11], s20 offen offset:3072 sc1 lds
s_add_u32 s20, s20, s28
s_add_u32 m0, s22, 65536
s_cmp_lt_u32 s36, s37
s_cselect_b32 s20, s20, 0x40000000
buffer_load_dword v2, v11, s[8:11], 0 offen
buffer_load_dwordx4 v8, s[8:11], s20 offen sc1 lds
s_add_u32 s36, s36, 1
buffer_load_dwordx4 v8, s[8:11], s20 offen offset:1024 sc1 lds
buffer_load_dwordx4 v8, s[8:11], s20 offen offset:2048 sc1 lds
buffer_load_dwordx4 v8, s[8:11], s20 offen offset:3072 sc1 lds
s_add_u32 s20, s20, s23
s_add_u32 m0, s22, 81920
s_nop 0
buffer_load_dwordx4 v8, s[8:11], s20 offen sc1 lds
buffer_load_dwordx4 v8, s[8:11], s20 offen offset:1024 sc1 lds
s_waitcnt vmcnt(16)
s_barrier
ds_read_b128 v[12:15], v6 offset:0
ds_read_b128 v[16:19], v6 offset:256
ds_read_b128 v[20:23], v6 offset:2048
ds_read_b128 v[24:27], v6 offset:2304
ds_read_b128 v[28:31], v6 offset:4096
ds_read_b128 v[32:35], v6 offset:4352
s_waitcnt lgkmcnt(0)
.p2align 3
main_kernel_kj_lp:
v_mfma_f32_16x16x32_bf16 v[44:47], a[0:3], v[12:15], 0
ds_read_b128 v[36:39], v6 offset:6144
v_mfma_f32_16x16x32_bf16 v[52:55], a[0:3], v[16:19], 0
ds_read_b128 v[40:43], v6 offset:6400
v_cvt_pk_bf16_f32 v84, v60, v61
v_mfma_f32_16x16x32_bf16 v[56:59], a[4:7], v[16:19], 0
v_cvt_pk_bf16_f32 v85, v62, v63
v_mfma_f32_16x16x32_bf16 v[48:51], a[4:7], v[12:15], 0
s_waitcnt lgkmcnt(4)
v_cvt_pk_bf16_f32 v86, v64, v65
v_mfma_f32_16x16x32_bf16 v[44:47], a[8:11], v[20:23], v[44:47]
ds_read_b128 v[12:15], v6 offset:8192
v_cvt_pk_bf16_f32 v87, v66, v67
v_mfma_f32_16x16x32_bf16 v[52:55], a[8:11], v[24:27], v[52:55]
ds_read_b128 v[16:19], v6 offset:8448
v_cvt_pk_bf16_f32 v88, v68, v69
v_mfma_f32_16x16x32_bf16 v[56:59], a[12:15], v[24:27], v[56:59]
buffer_load_dwordx4 v8, s[8:11], s20 offen offset:2048 sc1 lds
v_cvt_pk_bf16_f32 v89, v70, v71
v_mfma_f32_16x16x32_bf16 v[48:51], a[12:15], v[20:23], v[48:51]
s_waitcnt lgkmcnt(4)
v_cvt_pk_bf16_f32 v90, v72, v73
v_mfma_f32_16x16x32_bf16 v[44:47], a[16:19], v[28:31], v[44:47]
ds_read_b128 v[20:23], v6 offset:10240
v_cvt_pk_bf16_f32 v91, v74, v75
v_mfma_f32_16x16x32_bf16 v[52:55], a[16:19], v[32:35], v[52:55]
ds_read_b128 v[24:27], v6 offset:10496
v_mfma_f32_16x16x32_bf16 v[56:59], a[20:23], v[32:35], v[56:59]
buffer_store_dwordx4 v[84:87], v9, s[8:11], s21 offen sc1
v_mfma_f32_16x16x32_bf16 v[48:51], a[20:23], v[28:31], v[48:51]
s_waitcnt lgkmcnt(4)
v_mfma_f32_16x16x32_bf16 v[44:47], a[24:27], v[36:39], v[44:47]
ds_read_b128 v[28:31], v6 offset:12288
v_mfma_f32_16x16x32_bf16 v[52:55], a[24:27], v[40:43], v[52:55]
ds_read_b128 v[32:35], v6 offset:12544
v_mfma_f32_16x16x32_bf16 v[56:59], a[28:31], v[40:43], v[56:59]
buffer_load_dwordx4 v8, s[8:11], s20 offen offset:3072 sc1 lds
v_mfma_f32_16x16x32_bf16 v[48:51], a[28:31], v[36:39], v[48:51]
s_waitcnt lgkmcnt(4)
s_add_u32 s20, s20, s23
s_add_u32 m0, s22, 98304
v_mfma_f32_16x16x32_bf16 v[44:47], a[32:35], v[12:15], v[44:47]
ds_read_b128 v[36:39], v6 offset:14336
v_mfma_f32_16x16x32_bf16 v[52:55], a[32:35], v[16:19], v[52:55]
ds_read_b128 v[40:43], v6 offset:14592
v_mfma_f32_16x16x32_bf16 v[56:59], a[36:39], v[16:19], v[56:59]
buffer_store_dwordx4 v[88:91], v9, s[8:11], s21 offen offset:256 sc1
s_mov_b32 s21, s31
v_mfma_f32_16x16x32_bf16 v[48:51], a[36:39], v[12:15], v[48:51]
s_waitcnt lgkmcnt(4)
s_add_u32 s31, s31, s29
v_mfma_f32_16x16x32_bf16 v[44:47], a[40:43], v[20:23], v[44:47]
ds_read_b128 v[12:15], v6 offset:16384
v_mfma_f32_16x16x32_bf16 v[52:55], a[40:43], v[24:27], v[52:55]
ds_read_b128 v[16:19], v6 offset:16640
v_mfma_f32_16x16x32_bf16 v[56:59], a[44:47], v[24:27], v[56:59]
buffer_load_dwordx4 v8, s[8:11], s20 offen sc1 lds
v_mfma_f32_16x16x32_bf16 v[48:51], a[44:47], v[20:23], v[48:51]
s_waitcnt lgkmcnt(4)
v_mfma_f32_16x16x32_bf16 v[44:47], a[48:51], v[28:31], v[44:47]
ds_read_b128 v[20:23], v6 offset:18432
v_mfma_f32_16x16x32_bf16 v[52:55], a[48:51], v[32:35], v[52:55]
ds_read_b128 v[24:27], v6 offset:18688
v_mfma_f32_16x16x32_bf16 v[56:59], a[52:55], v[32:35], v[56:59]
v_mfma_f32_16x16x32_bf16 v[48:51], a[52:55], v[28:31], v[48:51]
s_waitcnt lgkmcnt(4)
v_mfma_f32_16x16x32_bf16 v[44:47], a[56:59], v[36:39], v[44:47]
ds_read_b128 v[28:31], v6 offset:20480
v_mfma_f32_16x16x32_bf16 v[52:55], a[56:59], v[40:43], v[52:55]
ds_read_b128 v[32:35], v6 offset:20736
v_mfma_f32_16x16x32_bf16 v[56:59], a[60:63], v[40:43], v[56:59]
buffer_load_dwordx4 v8, s[8:11], s20 offen offset:1024 sc1 lds
v_mfma_f32_16x16x32_bf16 v[48:51], a[60:63], v[36:39], v[48:51]
s_waitcnt lgkmcnt(4)
v_mfma_f32_16x16x32_bf16 v[44:47], a[64:67], v[12:15], v[44:47]
ds_read_b128 v[36:39], v6 offset:22528
v_mfma_f32_16x16x32_bf16 v[52:55], a[64:67], v[16:19], v[52:55]
ds_read_b128 v[40:43], v6 offset:22784
v_mfma_f32_16x16x32_bf16 v[56:59], a[68:71], v[16:19], v[56:59]
v_mfma_f32_16x16x32_bf16 v[48:51], a[68:71], v[12:15], v[48:51]
s_waitcnt lgkmcnt(4)
v_mfma_f32_16x16x32_bf16 v[44:47], a[72:75], v[20:23], v[44:47]
ds_read_b128 v[12:15], v6 offset:24576
v_mfma_f32_16x16x32_bf16 v[52:55], a[72:75], v[24:27], v[52:55]
ds_read_b128 v[16:19], v6 offset:24832
v_mfma_f32_16x16x32_bf16 v[56:59], a[76:79], v[24:27], v[56:59]
buffer_load_dwordx4 v8, s[8:11], s20 offen offset:2048 sc1 lds
v_mfma_f32_16x16x32_bf16 v[48:51], a[76:79], v[20:23], v[48:51]
s_waitcnt lgkmcnt(4)
v_mfma_f32_16x16x32_bf16 v[44:47], a[80:83], v[28:31], v[44:47]
ds_read_b128 v[20:23], v6 offset:26624
v_mfma_f32_16x16x32_bf16 v[52:55], a[80:83], v[32:35], v[52:55]
ds_read_b128 v[24:27], v6 offset:26880
v_mfma_f32_16x16x32_bf16 v[56:59], a[84:87], v[32:35], v[56:59]
v_mfma_f32_16x16x32_bf16 v[48:51], a[84:87], v[28:31], v[48:51]
s_waitcnt lgkmcnt(4)
v_mfma_f32_16x16x32_bf16 v[44:47], a[88:91], v[36:39], v[44:47]
ds_read_b128 v[28:31], v6 offset:28672
v_mfma_f32_16x16x32_bf16 v[52:55], a[88:91], v[40:43], v[52:55]
ds_read_b128 v[32:35], v6 offset:28928
v_mfma_f32_16x16x32_bf16 v[56:59], a[92:95], v[40:43], v[56:59]
buffer_load_dwordx4 v8, s[8:11], s20 offen offset:3072 sc1 lds
v_mfma_f32_16x16x32_bf16 v[48:51], a[92:95], v[36:39], v[48:51]
s_waitcnt lgkmcnt(4)
s_add_u32 s20, s20, s23
s_add_u32 m0, s22, 114688
v_mfma_f32_16x16x32_bf16 v[44:47], a[96:99], v[12:15], v[44:47]
ds_read_b128 v[36:39], v6 offset:30720
v_mfma_f32_16x16x32_bf16 v[52:55], a[96:99], v[16:19], v[52:55]
ds_read_b128 v[40:43], v6 offset:30976
v_mfma_f32_16x16x32_bf16 v[56:59], a[100:103], v[16:19], v[56:59]
v_mfma_f32_16x16x32_bf16 v[48:51], a[100:103], v[12:15], v[48:51]
s_waitcnt lgkmcnt(4)
v_mfma_f32_16x16x32_bf16 v[44:47], a[104:107], v[20:23], v[44:47]
s_waitcnt vmcnt(15)
s_barrier
ds_read_b128 v[12:15], v6 offset:32768
v_mfma_f32_16x16x32_bf16 v[52:55], a[104:107], v[24:27], v[52:55]
ds_read_b128 v[16:19], v6 offset:33024
v_mfma_f32_16x16x32_bf16 v[56:59], a[108:111], v[24:27], v[56:59]
buffer_load_dwordx4 v8, s[8:11], s20 offen sc1 lds
v_mfma_f32_16x16x32_bf16 v[48:51], a[108:111], v[20:23], v[48:51]
s_waitcnt lgkmcnt(4)
v_mfma_f32_16x16x32_bf16 v[44:47], a[112:115], v[28:31], v[44:47]
ds_read_b128 v[20:23], v6 offset:34816
v_mfma_f32_16x16x32_bf16 v[52:55], a[112:115], v[32:35], v[52:55]
ds_read_b128 v[24:27], v6 offset:35072
v_mfma_f32_16x16x32_bf16 v[56:59], a[116:119], v[32:35], v[56:59]
v_mfma_f32_16x16x32_bf16 v[48:51], a[116:119], v[28:31], v[48:51]
s_waitcnt lgkmcnt(4)
v_mfma_f32_16x16x32_bf16 v[44:47], a[120:123], v[36:39], v[44:47]
ds_read_b128 v[28:31], v6 offset:36864
v_mfma_f32_16x16x32_bf16 v[52:55], a[120:123], v[40:43], v[52:55]
ds_read_b128 v[32:35], v6 offset:37120
v_mfma_f32_16x16x32_bf16 v[56:59], a[124:127], v[40:43], v[56:59]
buffer_load_dwordx4 v8, s[8:11], s20 offen offset:1024 sc1 lds
v_mfma_f32_16x16x32_bf16 v[48:51], a[124:127], v[36:39], v[48:51]
s_waitcnt lgkmcnt(4)
v_mfma_f32_16x16x32_bf16 v[44:47], a[128:131], v[12:15], v[44:47]
ds_read_b128 v[36:39], v6 offset:38912
v_mfma_f32_16x16x32_bf16 v[52:55], a[128:131], v[16:19], v[52:55]
ds_read_b128 v[40:43], v6 offset:39168
v_mfma_f32_16x16x32_bf16 v[56:59], a[132:135], v[16:19], v[56:59]
v_mfma_f32_16x16x32_bf16 v[48:51], a[132:135], v[12:15], v[48:51]
s_waitcnt lgkmcnt(4)
v_mfma_f32_16x16x32_bf16 v[44:47], a[136:139], v[20:23], v[44:47]
ds_read_b128 v[12:15], v6 offset:40960
v_mfma_f32_16x16x32_bf16 v[52:55], a[136:139], v[24:27], v[52:55]
ds_read_b128 v[16:19], v6 offset:41216
v_mfma_f32_16x16x32_bf16 v[56:59], a[140:143], v[24:27], v[56:59]
buffer_load_dwordx4 v8, s[8:11], s20 offen offset:2048 sc1 lds
v_mfma_f32_16x16x32_bf16 v[48:51], a[140:143], v[20:23], v[48:51]
s_waitcnt lgkmcnt(4)
v_mfma_f32_16x16x32_bf16 v[44:47], a[144:147], v[28:31], v[44:47]
ds_read_b128 v[20:23], v6 offset:43008
v_mfma_f32_16x16x32_bf16 v[52:55], a[144:147], v[32:35], v[52:55]
ds_read_b128 v[24:27], v6 offset:43264
v_mfma_f32_16x16x32_bf16 v[56:59], a[148:151], v[32:35], v[56:59]
v_mfma_f32_16x16x32_bf16 v[48:51], a[148:151], v[28:31], v[48:51]
s_waitcnt lgkmcnt(4)
v_mfma_f32_16x16x32_bf16 v[44:47], a[152:155], v[36:39], v[44:47]
ds_read_b128 v[28:31], v6 offset:45056
v_mfma_f32_16x16x32_bf16 v[52:55], a[152:155], v[40:43], v[52:55]
ds_read_b128 v[32:35], v6 offset:45312
v_mfma_f32_16x16x32_bf16 v[56:59], a[156:159], v[40:43], v[56:59]
buffer_load_dwordx4 v8, s[8:11], s20 offen offset:3072 sc1 lds
v_mfma_f32_16x16x32_bf16 v[48:51], a[156:159], v[36:39], v[48:51]
s_waitcnt lgkmcnt(4)
s_add_u32 s20, s20, s28
s_add_u32 m0, s22, 0
v_mfma_f32_16x16x32_bf16 v[44:47], a[160:163], v[12:15], v[44:47]
s_cmp_lt_u32 s36, s37
ds_read_b128 v[36:39], v6 offset:47104
s_cselect_b32 s20, s20, 0x40000000
v_mfma_f32_16x16x32_bf16 v[52:55], a[160:163], v[16:19], v[52:55]
s_waitcnt vmcnt(8)
ds_read_b128 v[40:43], v6 offset:47360
s_max_i32 s27, s39, 0
v_mfma_f32_16x16x32_bf16 v[56:59], a[164:167], v[16:19], v[56:59]
s_add_u32 s39, s39, 1
v_mov_b32 v112, s27
v_mfma_f32_16x16x32_bf16 v[48:51], a[164:167], v[12:15], v[48:51]
s_waitcnt lgkmcnt(4)
v_mfma_f32_16x16x32_bf16 v[44:47], a[168:171], v[20:23], v[44:47]
buffer_store_dword v112, v108, s[8:11], 0 offen sc1
ds_read_b128 v[12:15], v6 offset:49152
v_mfma_f32_16x16x32_bf16 v[52:55], a[168:171], v[24:27], v[52:55]
ds_read_b128 v[16:19], v6 offset:49408
v_mfma_f32_16x16x32_bf16 v[56:59], a[172:175], v[24:27], v[56:59]
buffer_load_dwordx4 v8, s[8:11], s20 offen sc1 lds
v_mfma_f32_16x16x32_bf16 v[48:51], a[172:175], v[20:23], v[48:51]
s_waitcnt lgkmcnt(4)
s_add_u32 s36, s36, 1
v_mfma_f32_16x16x32_bf16 v[44:47], a[176:179], v[28:31], v[44:47]
ds_read_b128 v[20:23], v6 offset:51200
v_mfma_f32_16x16x32_bf16 v[52:55], a[176:179], v[32:35], v[52:55]
ds_read_b128 v[24:27], v6 offset:51456
v_mfma_f32_16x16x32_bf16 v[56:59], a[180:183], v[32:35], v[56:59]
v_mfma_f32_16x16x32_bf16 v[48:51], a[180:183], v[28:31], v[48:51]
s_waitcnt lgkmcnt(4)
v_mfma_f32_16x16x32_bf16 v[44:47], a[184:187], v[36:39], v[44:47]
ds_read_b128 v[28:31], v6 offset:53248
v_mfma_f32_16x16x32_bf16 v[52:55], a[184:187], v[40:43], v[52:55]
ds_read_b128 v[32:35], v6 offset:53504
v_mfma_f32_16x16x32_bf16 v[56:59], a[188:191], v[40:43], v[56:59]
buffer_load_dwordx4 v8, s[8:11], s20 offen offset:1024 sc1 lds
v_mfma_f32_16x16x32_bf16 v[48:51], a[188:191], v[36:39], v[48:51]
s_waitcnt lgkmcnt(4)
v_mfma_f32_16x16x32_bf16 v[44:47], a[192:195], v[12:15], v[44:47]
ds_read_b128 v[36:39], v6 offset:55296
v_mfma_f32_16x16x32_bf16 v[52:55], a[192:195], v[16:19], v[52:55]
ds_read_b128 v[40:43], v6 offset:55552
v_mfma_f32_16x16x32_bf16 v[56:59], a[196:199], v[16:19], v[56:59]
v_mfma_f32_16x16x32_bf16 v[48:51], a[196:199], v[12:15], v[48:51]
s_waitcnt lgkmcnt(4)
v_mfma_f32_16x16x32_bf16 v[44:47], a[200:203], v[20:23], v[44:47]
ds_read_b128 v[12:15], v6 offset:57344
v_mfma_f32_16x16x32_bf16 v[52:55], a[200:203], v[24:27], v[52:55]
ds_read_b128 v[16:19], v6 offset:57600
v_mfma_f32_16x16x32_bf16 v[56:59], a[204:207], v[24:27], v[56:59]
buffer_load_dwordx4 v8, s[8:11], s20 offen offset:2048 sc1 lds
v_mfma_f32_16x16x32_bf16 v[48:51], a[204:207], v[20:23], v[48:51]
s_waitcnt lgkmcnt(4)
v_mfma_f32_16x16x32_bf16 v[44:47], a[208:211], v[28:31], v[44:47]
ds_read_b128 v[20:23], v6 offset:59392
v_mfma_f32_16x16x32_bf16 v[52:55], a[208:211], v[32:35], v[52:55]
ds_read_b128 v[24:27], v6 offset:59648
v_mfma_f32_16x16x32_bf16 v[56:59], a[212:215], v[32:35], v[56:59]
v_mfma_f32_16x16x32_bf16 v[48:51], a[212:215], v[28:31], v[48:51]
s_waitcnt lgkmcnt(4)
v_mfma_f32_16x16x32_bf16 v[44:47], a[216:219], v[36:39], v[44:47]
ds_read_b128 v[28:31], v6 offset:61440
v_mfma_f32_16x16x32_bf16 v[52:55], a[216:219], v[40:43], v[52:55]
ds_read_b128 v[32:35], v6 offset:61696
v_mfma_f32_16x16x32_bf16 v[56:59], a[220:223], v[40:43], v[56:59]
buffer_load_dwordx4 v8, s[8:11], s20 offen offset:3072 sc1 lds
v_mfma_f32_16x16x32_bf16 v[48:51], a[220:223], v[36:39], v[48:51]
s_waitcnt lgkmcnt(4)
s_add_u32 s20, s20, s23
s_add_u32 m0, s22, 16384
v_mfma_f32_16x16x32_bf16 v[44:47], a[224:227], v[12:15], v[44:47]
ds_read_b128 v[36:39], v6 offset:63488
v_mfma_f32_16x16x32_bf16 v[52:55], a[224:227], v[16:19], v[52:55]
ds_read_b128 v[40:43], v6 offset:63744
v_mfma_f32_16x16x32_bf16 v[56:59], a[228:231], v[16:19], v[56:59]
v_mfma_f32_16x16x32_bf16 v[48:51], a[228:231], v[12:15], v[48:51]
s_waitcnt lgkmcnt(4)
v_mfma_f32_16x16x32_bf16 v[44:47], a[232:235], v[20:23], v[44:47]
s_waitcnt vmcnt(14)
s_barrier
ds_read_b128 v[12:15], v7 offset:0
v_mfma_f32_16x16x32_bf16 v[52:55], a[232:235], v[24:27], v[52:55]
ds_read_b128 v[16:19], v7 offset:256
v_mfma_f32_16x16x32_bf16 v[56:59], a[236:239], v[24:27], v[56:59]
buffer_load_dwordx4 v8, s[8:11], s20 offen sc1 lds
v_mfma_f32_16x16x32_bf16 v[48:51], a[236:239], v[20:23], v[48:51]
s_waitcnt lgkmcnt(4)
v_mfma_f32_16x16x32_bf16 v[44:47], a[240:243], v[28:31], v[44:47]
ds_read_b128 v[20:23], v7 offset:2048
v_mfma_f32_16x16x32_bf16 v[52:55], a[240:243], v[32:35], v[52:55]
ds_read_b128 v[24:27], v7 offset:2304
v_mfma_f32_16x16x32_bf16 v[56:59], a[244:247], v[32:35], v[56:59]
v_mfma_f32_16x16x32_bf16 v[48:51], a[244:247], v[28:31], v[48:51]
s_waitcnt lgkmcnt(4)
v_mfma_f32_16x16x32_bf16 v[44:47], a[248:251], v[36:39], v[44:47]
ds_read_b128 v[28:31], v7 offset:4096
v_mfma_f32_16x16x32_bf16 v[52:55], a[248:251], v[40:43], v[52:55]
ds_read_b128 v[32:35], v7 offset:4352
v_mfma_f32_16x16x32_bf16 v[56:59], a[252:255], v[40:43], v[56:59]
buffer_load_dwordx4 v8, s[8:11], s20 offen offset:1024 sc1 lds
v_mfma_f32_16x16x32_bf16 v[48:51], a[252:255], v[36:39], v[48:51]
s_waitcnt lgkmcnt(4)
v_mfma_f32_16x16x32_bf16 v[60:63], a[0:3], v[12:15], 0
ds_read_b128 v[36:39], v7 offset:6144
v_mfma_f32_16x16x32_bf16 v[68:71], a[0:3], v[16:19], 0
ds_read_b128 v[40:43], v7 offset:6400
v_cvt_pk_bf16_f32 v84, v44, v45
v_mfma_f32_16x16x32_bf16 v[72:75], a[4:7], v[16:19], 0
v_cvt_pk_bf16_f32 v85, v46, v47
v_mfma_f32_16x16x32_bf16 v[64:67], a[4:7], v[12:15], 0
s_waitcnt lgkmcnt(4)
v_cvt_pk_bf16_f32 v86, v48, v49
v_mfma_f32_16x16x32_bf16 v[60:63], a[8:11], v[20:23], v[60:63]
ds_read_b128 v[12:15], v7 offset:8192
v_cvt_pk_bf16_f32 v87, v50, v51
v_mfma_f32_16x16x32_bf16 v[68:71], a[8:11], v[24:27], v[68:71]
ds_read_b128 v[16:19], v7 offset:8448
v_cvt_pk_bf16_f32 v88, v52, v53
v_mfma_f32_16x16x32_bf16 v[72:75], a[12:15], v[24:27], v[72:75]
buffer_load_dwordx4 v8, s[8:11], s20 offen offset:2048 sc1 lds
v_cvt_pk_bf16_f32 v89, v54, v55
v_mfma_f32_16x16x32_bf16 v[64:67], a[12:15], v[20:23], v[64:67]
s_waitcnt lgkmcnt(4)
v_cvt_pk_bf16_f32 v90, v56, v57
v_mfma_f32_16x16x32_bf16 v[60:63], a[16:19], v[28:31], v[60:63]
ds_read_b128 v[20:23], v7 offset:10240
v_cvt_pk_bf16_f32 v91, v58, v59
v_mfma_f32_16x16x32_bf16 v[68:71], a[16:19], v[32:35], v[68:71]
ds_read_b128 v[24:27], v7 offset:10496
v_mfma_f32_16x16x32_bf16 v[72:75], a[20:23], v[32:35], v[72:75]
buffer_store_dwordx4 v[84:87], v9, s[8:11], s21 offen sc1
v_mfma_f32_16x16x32_bf16 v[64:67], a[20:23], v[28:31], v[64:67]
s_waitcnt lgkmcnt(4)
v_mfma_f32_16x16x32_bf16 v[60:63], a[24:27], v[36:39], v[60:63]
ds_read_b128 v[28:31], v7 offset:12288
v_mfma_f32_16x16x32_bf16 v[68:71], a[24:27], v[40:43], v[68:71]
ds_read_b128 v[32:35], v7 offset:12544
v_mfma_f32_16x16x32_bf16 v[72:75], a[28:31], v[40:43], v[72:75]
buffer_load_dwordx4 v8, s[8:11], s20 offen offset:3072 sc1 lds
v_mfma_f32_16x16x32_bf16 v[64:67], a[28:31], v[36:39], v[64:67]
s_waitcnt lgkmcnt(4)
s_add_u32 s20, s20, s23
s_add_u32 m0, s22, 32768
v_mfma_f32_16x16x32_bf16 v[60:63], a[32:35], v[12:15], v[60:63]
ds_read_b128 v[36:39], v7 offset:14336
v_mfma_f32_16x16x32_bf16 v[68:71], a[32:35], v[16:19], v[68:71]
ds_read_b128 v[40:43], v7 offset:14592
v_mfma_f32_16x16x32_bf16 v[72:75], a[36:39], v[16:19], v[72:75]
buffer_store_dwordx4 v[88:91], v9, s[8:11], s21 offen offset:256 sc1
s_mov_b32 s21, s31
v_mfma_f32_16x16x32_bf16 v[64:67], a[36:39], v[12:15], v[64:67]
s_waitcnt lgkmcnt(4)
s_add_u32 s31, s31, s29
v_mfma_f32_16x16x32_bf16 v[60:63], a[40:43], v[20:23], v[60:63]
ds_read_b128 v[12:15], v7 offset:16384
v_mfma_f32_16x16x32_bf16 v[68:71], a[40:43], v[24:27], v[68:71]
ds_read_b128 v[16:19], v7 offset:16640
v_mfma_f32_16x16x32_bf16 v[72:75], a[44:47], v[24:27], v[72:75]
buffer_load_dwordx4 v8, s[8:11], s20 offen sc1 lds
v_mfma_f32_16x16x32_bf16 v[64:67], a[44:47], v[20:23], v[64:67]
s_waitcnt lgkmcnt(4)
v_mfma_f32_16x16x32_bf16 v[60:63], a[48:51], v[28:31], v[60:63]
ds_read_b128 v[20:23], v7 offset:18432
v_mfma_f32_16x16x32_bf16 v[68:71], a[48:51], v[32:35], v[68:71]
ds_read_b128 v[24:27], v7 offset:18688
v_mfma_f32_16x16x32_bf16 v[72:75], a[52:55], v[32:35], v[72:75]
v_mfma_f32_16x16x32_bf16 v[64:67], a[52:55], v[28:31], v[64:67]
s_waitcnt lgkmcnt(4)
v_mfma_f32_16x16x32_bf16 v[60:63], a[56:59], v[36:39], v[60:63]
ds_read_b128 v[28:31], v7 offset:20480
v_mfma_f32_16x16x32_bf16 v[68:71], a[56:59], v[40:43], v[68:71]
ds_read_b128 v[32:35], v7 offset:20736
v_mfma_f32_16x16x32_bf16 v[72:75], a[60:63], v[40:43], v[72:75]
buffer_load_dwordx4 v8, s[8:11], s20 offen offset:1024 sc1 lds
v_mfma_f32_16x16x32_bf16 v[64:67], a[60:63], v[36:39], v[64:67]
s_waitcnt lgkmcnt(4)
v_mfma_f32_16x16x32_bf16 v[60:63], a[64:67], v[12:15], v[60:63]
ds_read_b128 v[36:39], v7 offset:22528
v_mfma_f32_16x16x32_bf16 v[68:71], a[64:67], v[16:19], v[68:71]
ds_read_b128 v[40:43], v7 offset:22784
v_mfma_f32_16x16x32_bf16 v[72:75], a[68:71], v[16:19], v[72:75]
v_mfma_f32_16x16x32_bf16 v[64:67], a[68:71], v[12:15], v[64:67]
s_waitcnt lgkmcnt(4)
v_mfma_f32_16x16x32_bf16 v[60:63], a[72:75], v[20:23], v[60:63]
ds_read_b128 v[12:15], v7 offset:24576
v_mfma_f32_16x16x32_bf16 v[68:71], a[72:75], v[24:27], v[68:71]
ds_read_b128 v[16:19], v7 offset:24832
v_mfma_f32_16x16x32_bf16 v[72:75], a[76:79], v[24:27], v[72:75]
buffer_load_dwordx4 v8, s[8:11], s20 offen offset:2048 sc1 lds
v_mfma_f32_16x16x32_bf16 v[64:67], a[76:79], v[20:23], v[64:67]
s_waitcnt lgkmcnt(4)
v_mfma_f32_16x16x32_bf16 v[60:63], a[80:83], v[28:31], v[60:63]
ds_read_b128 v[20:23], v7 offset:26624
v_mfma_f32_16x16x32_bf16 v[68:71], a[80:83], v[32:35], v[68:71]
ds_read_b128 v[24:27], v7 offset:26880
v_mfma_f32_16x16x32_bf16 v[72:75], a[84:87], v[32:35], v[72:75]
v_mfma_f32_16x16x32_bf16 v[64:67], a[84:87], v[28:31], v[64:67]
s_waitcnt lgkmcnt(4)
v_mfma_f32_16x16x32_bf16 v[60:63], a[88:91], v[36:39], v[60:63]
ds_read_b128 v[28:31], v7 offset:28672
v_mfma_f32_16x16x32_bf16 v[68:71], a[88:91], v[40:43], v[68:71]
ds_read_b128 v[32:35], v7 offset:28928
v_mfma_f32_16x16x32_bf16 v[72:75], a[92:95], v[40:43], v[72:75]
buffer_load_dwordx4 v8, s[8:11], s20 offen offset:3072 sc1 lds
v_mfma_f32_16x16x32_bf16 v[64:67], a[92:95], v[36:39], v[64:67]
s_waitcnt lgkmcnt(4)
s_add_u32 s20, s20, s23
s_add_u32 m0, s22, 49152
v_mfma_f32_16x16x32_bf16 v[60:63], a[96:99], v[12:15], v[60:63]
ds_read_b128 v[36:39], v7 offset:30720
v_mfma_f32_16x16x32_bf16 v[68:71], a[96:99], v[16:19], v[68:71]
ds_read_b128 v[40:43], v7 offset:30976
v_mfma_f32_16x16x32_bf16 v[72:75], a[100:103], v[16:19], v[72:75]
v_mfma_f32_16x16x32_bf16 v[64:67], a[100:103], v[12:15], v[64:67]
s_waitcnt lgkmcnt(4)
v_mfma_f32_16x16x32_bf16 v[60:63], a[104:107], v[20:23], v[60:63]
s_waitcnt vmcnt(15)
s_barrier
ds_read_b128 v[12:15], v7 offset:32768
v_mfma_f32_16x16x32_bf16 v[68:71], a[104:107], v[24:27], v[68:71]
ds_read_b128 v[16:19], v7 offset:33024
v_mfma_f32_16x16x32_bf16 v[72:75], a[108:111], v[24:27], v[72:75]
buffer_load_dwordx4 v8, s[8:11], s20 offen sc1 lds
v_mfma_f32_16x16x32_bf16 v[64:67], a[108:111], v[20:23], v[64:67]
s_waitcnt lgkmcnt(4)
v_mfma_f32_16x16x32_bf16 v[60:63], a[112:115], v[28:31], v[60:63]
ds_read_b128 v[20:23], v7 offset:34816
v_mfma_f32_16x16x32_bf16 v[68:71], a[112:115], v[32:35], v[68:71]
ds_read_b128 v[24:27], v7 offset:35072
v_mfma_f32_16x16x32_bf16 v[72:75], a[116:119], v[32:35], v[72:75]
v_mfma_f32_16x16x32_bf16 v[64:67], a[116:119], v[28:31], v[64:67]
s_waitcnt lgkmcnt(4)
v_mfma_f32_16x16x32_bf16 v[60:63], a[120:123], v[36:39], v[60:63]
ds_read_b128 v[28:31], v7 offset:36864
v_mfma_f32_16x16x32_bf16 v[68:71], a[120:123], v[40:43], v[68:71]
ds_read_b128 v[32:35], v7 offset:37120
v_mfma_f32_16x16x32_bf16 v[72:75], a[124:127], v[40:43], v[72:75]
buffer_load_dwordx4 v8, s[8:11], s20 offen offset:1024 sc1 lds
v_mfma_f32_16x16x32_bf16 v[64:67], a[124:127], v[36:39], v[64:67]
s_waitcnt lgkmcnt(4)
v_mfma_f32_16x16x32_bf16 v[60:63], a[128:131], v[12:15], v[60:63]
ds_read_b128 v[36:39], v7 offset:38912
v_mfma_f32_16x16x32_bf16 v[68:71], a[128:131], v[16:19], v[68:71]
ds_read_b128 v[40:43], v7 offset:39168
v_mfma_f32_16x16x32_bf16 v[72:75], a[132:135], v[16:19], v[72:75]
v_mfma_f32_16x16x32_bf16 v[64:67], a[132:135], v[12:15], v[64:67]
s_waitcnt lgkmcnt(4)
v_mfma_f32_16x16x32_bf16 v[60:63], a[136:139], v[20:23], v[60:63]
ds_read_b128 v[12:15], v7 offset:40960
v_mfma_f32_16x16x32_bf16 v[68:71], a[136:139], v[24:27], v[68:71]
ds_read_b128 v[16:19], v7 offset:41216
v_mfma_f32_16x16x32_bf16 v[72:75], a[140:143], v[24:27], v[72:75]
buffer_load_dwordx4 v8, s[8:11], s20 offen offset:2048 sc1 lds
v_mfma_f32_16x16x32_bf16 v[64:67], a[140:143], v[20:23], v[64:67]
s_waitcnt lgkmcnt(4)
v_mfma_f32_16x16x32_bf16 v[60:63], a[144:147], v[28:31], v[60:63]
ds_read_b128 v[20:23], v7 offset:43008
v_mfma_f32_16x16x32_bf16 v[68:71], a[144:147], v[32:35], v[68:71]
ds_read_b128 v[24:27], v7 offset:43264
v_mfma_f32_16x16x32_bf16 v[72:75], a[148:151], v[32:35], v[72:75]
v_mfma_f32_16x16x32_bf16 v[64:67], a[148:151], v[28:31], v[64:67]
s_waitcnt lgkmcnt(4)
v_mfma_f32_16x16x32_bf16 v[60:63], a[152:155], v[36:39], v[60:63]
ds_read_b128 v[28:31], v7 offset:45056
v_mfma_f32_16x16x32_bf16 v[68:71], a[152:155], v[40:43], v[68:71]
ds_read_b128 v[32:35], v7 offset:45312
v_mfma_f32_16x16x32_bf16 v[72:75], a[156:159], v[40:43], v[72:75]
buffer_load_dwordx4 v8, s[8:11], s20 offen offset:3072 sc1 lds
v_mfma_f32_16x16x32_bf16 v[64:67], a[156:159], v[36:39], v[64:67]
s_waitcnt lgkmcnt(4)
s_add_u32 s20, s20, s28
s_add_u32 m0, s22, 65536
v_mfma_f32_16x16x32_bf16 v[60:63], a[160:163], v[12:15], v[60:63]
s_cmp_lt_u32 s36, s37
ds_read_b128 v[36:39], v7 offset:47104
s_cselect_b32 s20, s20, 0x40000000
v_mfma_f32_16x16x32_bf16 v[68:71], a[160:163], v[16:19], v[68:71]
s_waitcnt vmcnt(8)
ds_read_b128 v[40:43], v7 offset:47360
s_max_i32 s27, s39, 0
v_mfma_f32_16x16x32_bf16 v[72:75], a[164:167], v[16:19], v[72:75]
s_add_u32 s39, s39, 1
v_mov_b32 v112, s27
v_mfma_f32_16x16x32_bf16 v[64:67], a[164:167], v[12:15], v[64:67]
s_waitcnt lgkmcnt(4)
v_mfma_f32_16x16x32_bf16 v[60:63], a[168:171], v[20:23], v[60:63]
buffer_store_dword v112, v108, s[8:11], 0 offen sc1
ds_read_b128 v[12:15], v7 offset:49152
v_mfma_f32_16x16x32_bf16 v[68:71], a[168:171], v[24:27], v[68:71]
ds_read_b128 v[16:19], v7 offset:49408
v_mfma_f32_16x16x32_bf16 v[72:75], a[172:175], v[24:27], v[72:75]
buffer_load_dwordx4 v8, s[8:11], s20 offen sc1 lds
v_mfma_f32_16x16x32_bf16 v[64:67], a[172:175], v[20:23], v[64:67]
s_waitcnt lgkmcnt(4)
s_add_u32 s36, s36, 1
v_mfma_f32_16x16x32_bf16 v[60:63], a[176:179], v[28:31], v[60:63]
ds_read_b128 v[20:23], v7 offset:51200
v_mfma_f32_16x16x32_bf16 v[68:71], a[176:179], v[32:35], v[68:71]
ds_read_b128 v[24:27], v7 offset:51456
v_mfma_f32_16x16x32_bf16 v[72:75], a[180:183], v[32:35], v[72:75]
v_mfma_f32_16x16x32_bf16 v[64:67], a[180:183], v[28:31], v[64:67]
s_waitcnt lgkmcnt(4)
v_mfma_f32_16x16x32_bf16 v[60:63], a[184:187], v[36:39], v[60:63]
ds_read_b128 v[28:31], v7 offset:53248
v_mfma_f32_16x16x32_bf16 v[68:71], a[184:187], v[40:43], v[68:71]
ds_read_b128 v[32:35], v7 offset:53504
v_mfma_f32_16x16x32_bf16 v[72:75], a[188:191], v[40:43], v[72:75]
buffer_load_dwordx4 v8, s[8:11], s20 offen offset:1024 sc1 lds
v_mfma_f32_16x16x32_bf16 v[64:67], a[188:191], v[36:39], v[64:67]
s_waitcnt lgkmcnt(4)
v_mfma_f32_16x16x32_bf16 v[60:63], a[192:195], v[12:15], v[60:63]
ds_read_b128 v[36:39], v7 offset:55296
v_mfma_f32_16x16x32_bf16 v[68:71], a[192:195], v[16:19], v[68:71]
ds_read_b128 v[40:43], v7 offset:55552
v_mfma_f32_16x16x32_bf16 v[72:75], a[196:199], v[16:19], v[72:75]
v_mfma_f32_16x16x32_bf16 v[64:67], a[196:199], v[12:15], v[64:67]
s_waitcnt lgkmcnt(4)
v_mfma_f32_16x16x32_bf16 v[60:63], a[200:203], v[20:23], v[60:63]
ds_read_b128 v[12:15], v7 offset:57344
v_mfma_f32_16x16x32_bf16 v[68:71], a[200:203], v[24:27], v[68:71]
ds_read_b128 v[16:19], v7 offset:57600
v_mfma_f32_16x16x32_bf16 v[72:75], a[204:207], v[24:27], v[72:75]
buffer_load_dwordx4 v8, s[8:11], s20 offen offset:2048 sc1 lds
v_mfma_f32_16x16x32_bf16 v[64:67], a[204:207], v[20:23], v[64:67]
s_waitcnt lgkmcnt(4)
v_mfma_f32_16x16x32_bf16 v[60:63], a[208:211], v[28:31], v[60:63]
ds_read_b128 v[20:23], v7 offset:59392
v_mfma_f32_16x16x32_bf16 v[68:71], a[208:211], v[32:35], v[68:71]
ds_read_b128 v[24:27], v7 offset:59648
v_mfma_f32_16x16x32_bf16 v[72:75], a[212:215], v[32:35], v[72:75]
v_mfma_f32_16x16x32_bf16 v[64:67], a[212:215], v[28:31], v[64:67]
s_waitcnt lgkmcnt(4)
v_mfma_f32_16x16x32_bf16 v[60:63], a[216:219], v[36:39], v[60:63]
ds_read_b128 v[28:31], v7 offset:61440
v_mfma_f32_16x16x32_bf16 v[68:71], a[216:219], v[40:43], v[68:71]
ds_read_b128 v[32:35], v7 offset:61696
v_mfma_f32_16x16x32_bf16 v[72:75], a[220:223], v[40:43], v[72:75]
buffer_load_dwordx4 v8, s[8:11], s20 offen offset:3072 sc1 lds
v_mfma_f32_16x16x32_bf16 v[64:67], a[220:223], v[36:39], v[64:67]
s_waitcnt lgkmcnt(4)
s_add_u32 s20, s20, s23
s_add_u32 m0, s22, 81920
v_mfma_f32_16x16x32_bf16 v[60:63], a[224:227], v[12:15], v[60:63]
ds_read_b128 v[36:39], v7 offset:63488
v_mfma_f32_16x16x32_bf16 v[68:71], a[224:227], v[16:19], v[68:71]
ds_read_b128 v[40:43], v7 offset:63744
v_mfma_f32_16x16x32_bf16 v[72:75], a[228:231], v[16:19], v[72:75]
v_mfma_f32_16x16x32_bf16 v[64:67], a[228:231], v[12:15], v[64:67]
s_waitcnt lgkmcnt(4)
v_mfma_f32_16x16x32_bf16 v[60:63], a[232:235], v[20:23], v[60:63]
s_waitcnt vmcnt(14)
s_barrier
ds_read_b128 v[12:15], v6 offset:0
v_mfma_f32_16x16x32_bf16 v[68:71], a[232:235], v[24:27], v[68:71]
ds_read_b128 v[16:19], v6 offset:256
v_mfma_f32_16x16x32_bf16 v[72:75], a[236:239], v[24:27], v[72:75]
buffer_load_dwordx4 v8, s[8:11], s20 offen sc1 lds
v_mfma_f32_16x16x32_bf16 v[64:67], a[236:239], v[20:23], v[64:67]
s_waitcnt lgkmcnt(4)
v_mfma_f32_16x16x32_bf16 v[60:63], a[240:243], v[28:31], v[60:63]
ds_read_b128 v[20:23], v6 offset:2048
v_mfma_f32_16x16x32_bf16 v[68:71], a[240:243], v[32:35], v[68:71]
ds_read_b128 v[24:27], v6 offset:2304
v_mfma_f32_16x16x32_bf16 v[72:75], a[244:247], v[32:35], v[72:75]
v_mfma_f32_16x16x32_bf16 v[64:67], a[244:247], v[28:31], v[64:67]
s_waitcnt lgkmcnt(4)
v_mfma_f32_16x16x32_bf16 v[60:63], a[248:251], v[36:39], v[60:63]
ds_read_b128 v[28:31], v6 offset:4096
v_mfma_f32_16x16x32_bf16 v[68:71], a[248:251], v[40:43], v[68:71]
ds_read_b128 v[32:35], v6 offset:4352
v_mfma_f32_16x16x32_bf16 v[72:75], a[252:255], v[40:43], v[72:75]
s_sub_u32 s24, s24, 1
buffer_load_dwordx4 v8, s[8:11], s20 offen offset:1024 sc1 lds
v_mfma_f32_16x16x32_bf16 v[64:67], a[252:255], v[36:39], v[64:67]
s_waitcnt lgkmcnt(4)
s_cbranch_scc0 main_kernel_kj_lp
v_mfma_f32_16x16x32_bf16 v[44:47], a[0:3], v[12:15], 0
ds_read_b128 v[36:39], v6 offset:6144
v_mfma_f32_16x16x32_bf16 v[52:55], a[0:3], v[16:19], 0
ds_read_b128 v[40:43], v6 offset:6400
v_cvt_pk_bf16_f32 v84, v60, v61
v_mfma_f32_16x16x32_bf16 v[56:59], a[4:7], v[16:19], 0
v_cvt_pk_bf16_f32 v85, v62, v63
v_mfma_f32_16x16x32_bf16 v[48:51], a[4:7], v[12:15], 0
s_waitcnt lgkmcnt(4)
v_cvt_pk_bf16_f32 v86, v64, v65
v_mfma_f32_16x16x32_bf16 v[44:47], a[8:11], v[20:23], v[44:47]
ds_read_b128 v[12:15], v6 offset:8192
v_cvt_pk_bf16_f32 v87, v66, v67
v_mfma_f32_16x16x32_bf16 v[52:55], a[8:11], v[24:27], v[52:55]
ds_read_b128 v[16:19], v6 offset:8448
v_cvt_pk_bf16_f32 v88, v68, v69
v_mfma_f32_16x16x32_bf16 v[56:59], a[12:15], v[24:27], v[56:59]
buffer_load_dwordx4 v8, s[8:11], s20 offen offset:2048 sc1 lds
v_cvt_pk_bf16_f32 v89, v70, v71
v_mfma_f32_16x16x32_bf16 v[48:51], a[12:15], v[20:23], v[48:51]
s_waitcnt lgkmcnt(4)
v_cvt_pk_bf16_f32 v90, v72, v73
v_mfma_f32_16x16x32_bf16 v[44:47], a[16:19], v[28:31], v[44:47]
ds_read_b128 v[20:23], v6 offset:10240
v_cvt_pk_bf16_f32 v91, v74, v75
v_mfma_f32_16x16x32_bf16 v[52:55], a[16:19], v[32:35], v[52:55]
ds_read_b128 v[24:27], v6 offset:10496
v_mfma_f32_16x16x32_bf16 v[56:59], a[20:23], v[32:35], v[56:59]
buffer_store_dwordx4 v[84:87], v9, s[8:11], s21 offen sc1
v_mfma_f32_16x16x32_bf16 v[48:51], a[20:23], v[28:31], v[48:51]
s_waitcnt lgkmcnt(4)
v_mfma_f32_16x16x32_bf16 v[44:47], a[24:27], v[36:39], v[44:47]
ds_read_b128 v[28:31], v6 offset:12288
v_mfma_f32_16x16x32_bf16 v[52:55], a[24:27], v[40:43], v[52:55]
ds_read_b128 v[32:35], v6 offset:12544
v_mfma_f32_16x16x32_bf16 v[56:59], a[28:31], v[40:43], v[56:59]
buffer_load_dwordx4 v8, s[8:11], s20 offen offset:3072 sc1 lds
v_mfma_f32_16x16x32_bf16 v[48:51], a[28:31], v[36:39], v[48:51]
s_waitcnt lgkmcnt(4)
s_add_u32 s20, s20, s23
s_add_u32 m0, s22, 98304
v_mfma_f32_16x16x32_bf16 v[44:47], a[32:35], v[12:15], v[44:47]
ds_read_b128 v[36:39], v6 offset:14336
v_mfma_f32_16x16x32_bf16 v[52:55], a[32:35], v[16:19], v[52:55]
ds_read_b128 v[40:43], v6 offset:14592
v_mfma_f32_16x16x32_bf16 v[56:59], a[36:39], v[16:19], v[56:59]
buffer_store_dwordx4 v[88:91], v9, s[8:11], s21 offen offset:256 sc1
s_mov_b32 s21, s31
v_mfma_f32_16x16x32_bf16 v[48:51], a[36:39], v[12:15], v[48:51]
s_waitcnt lgkmcnt(4)
s_add_u32 s31, s31, s29
v_mfma_f32_16x16x32_bf16 v[44:47], a[40:43], v[20:23], v[44:47]
ds_read_b128 v[12:15], v6 offset:16384
v_mfma_f32_16x16x32_bf16 v[52:55], a[40:43], v[24:27], v[52:55]
ds_read_b128 v[16:19], v6 offset:16640
v_mfma_f32_16x16x32_bf16 v[56:59], a[44:47], v[24:27], v[56:59]
buffer_load_dwordx4 v8, s[8:11], s20 offen sc1 lds
v_mfma_f32_16x16x32_bf16 v[48:51], a[44:47], v[20:23], v[48:51]
s_waitcnt lgkmcnt(4)
v_mfma_f32_16x16x32_bf16 v[44:47], a[48:51], v[28:31], v[44:47]
ds_read_b128 v[20:23], v6 offset:18432
v_mfma_f32_16x16x32_bf16 v[52:55], a[48:51], v[32:35], v[52:55]
ds_read_b128 v[24:27], v6 offset:18688
v_mfma_f32_16x16x32_bf16 v[56:59], a[52:55], v[32:35], v[56:59]
v_mfma_f32_16x16x32_bf16 v[48:51], a[52:55], v[28:31], v[48:51]
s_waitcnt lgkmcnt(4)
v_mfma_f32_16x16x32_bf16 v[44:47], a[56:59], v[36:39], v[44:47]
ds_read_b128 v[28:31], v6 offset:20480
v_mfma_f32_16x16x32_bf16 v[52:55], a[56:59], v[40:43], v[52:55]
ds_read_b128 v[32:35], v6 offset:20736
v_mfma_f32_16x16x32_bf16 v[56:59], a[60:63], v[40:43], v[56:59]
buffer_load_dwordx4 v8, s[8:11], s20 offen offset:1024 sc1 lds
v_mfma_f32_16x16x32_bf16 v[48:51], a[60:63], v[36:39], v[48:51]
s_waitcnt lgkmcnt(4)
v_mfma_f32_16x16x32_bf16 v[44:47], a[64:67], v[12:15], v[44:47]
ds_read_b128 v[36:39], v6 offset:22528
v_mfma_f32_16x16x32_bf16 v[52:55], a[64:67], v[16:19], v[52:55]
ds_read_b128 v[40:43], v6 offset:22784
v_mfma_f32_16x16x32_bf16 v[56:59], a[68:71], v[16:19], v[56:59]
v_mfma_f32_16x16x32_bf16 v[48:51], a[68:71], v[12:15], v[48:51]
s_waitcnt lgkmcnt(4)
v_mfma_f32_16x16x32_bf16 v[44:47], a[72:75], v[20:23], v[44:47]
ds_read_b128 v[12:15], v6 offset:24576
v_mfma_f32_16x16x32_bf16 v[52:55], a[72:75], v[24:27], v[52:55]
ds_read_b128 v[16:19], v6 offset:24832
v_mfma_f32_16x16x32_bf16 v[56:59], a[76:79], v[24:27], v[56:59]
buffer_load_dwordx4 v8, s[8:11], s20 offen offset:2048 sc1 lds
v_mfma_f32_16x16x32_bf16 v[48:51], a[76:79], v[20:23], v[48:51]
s_waitcnt lgkmcnt(4)
v_mfma_f32_16x16x32_bf16 v[44:47], a[80:83], v[28:31], v[44:47]
ds_read_b128 v[20:23], v6 offset:26624
v_mfma_f32_16x16x32_bf16 v[52:55], a[80:83], v[32:35], v[52:55]
ds_read_b128 v[24:27], v6 offset:26880
v_mfma_f32_16x16x32_bf16 v[56:59], a[84:87], v[32:35], v[56:59]
v_mfma_f32_16x16x32_bf16 v[48:51], a[84:87], v[28:31], v[48:51]
s_waitcnt lgkmcnt(4)
v_mfma_f32_16x16x32_bf16 v[44:47], a[88:91], v[36:39], v[44:47]
ds_read_b128 v[28:31], v6 offset:28672
v_mfma_f32_16x16x32_bf16 v[52:55], a[88:91], v[40:43], v[52:55]
ds_read_b128 v[32:35], v6 offset:28928
v_mfma_f32_16x16x32_bf16 v[56:59], a[92:95], v[40:43], v[56:59]
buffer_load_dwordx4 v8, s[8:11], s20 offen offset:3072 sc1 lds
v_mfma_f32_16x16x32_bf16 v[48:51], a[92:95], v[36:39], v[48:51]
s_waitcnt lgkmcnt(4)
s_add_u32 s20, s20, s23
s_add_u32 m0, s22, 114688
v_mfma_f32_16x16x32_bf16 v[44:47], a[96:99], v[12:15], v[44:47]
ds_read_b128 v[36:39], v6 offset:30720
v_mfma_f32_16x16x32_bf16 v[52:55], a[96:99], v[16:19], v[52:55]
ds_read_b128 v[40:43], v6 offset:30976
v_mfma_f32_16x16x32_bf16 v[56:59], a[100:103], v[16:19], v[56:59]
v_mfma_f32_16x16x32_bf16 v[48:51], a[100:103], v[12:15], v[48:51]
s_waitcnt lgkmcnt(4)
v_mfma_f32_16x16x32_bf16 v[44:47], a[104:107], v[20:23], v[44:47]
s_waitcnt vmcnt(15)
s_barrier
ds_read_b128 v[12:15], v6 offset:32768
v_mfma_f32_16x16x32_bf16 v[52:55], a[104:107], v[24:27], v[52:55]
ds_read_b128 v[16:19], v6 offset:33024
v_mfma_f32_16x16x32_bf16 v[56:59], a[108:111], v[24:27], v[56:59]
buffer_load_dwordx4 v8, s[8:11], s20 offen sc1 lds
v_mfma_f32_16x16x32_bf16 v[48:51], a[108:111], v[20:23], v[48:51]
s_waitcnt lgkmcnt(4)
v_mfma_f32_16x16x32_bf16 v[44:47], a[112:115], v[28:31], v[44:47]
ds_read_b128 v[20:23], v6 offset:34816
v_mfma_f32_16x16x32_bf16 v[52:55], a[112:115], v[32:35], v[52:55]
ds_read_b128 v[24:27], v6 offset:35072
v_mfma_f32_16x16x32_bf16 v[56:59], a[116:119], v[32:35], v[56:59]
v_mfma_f32_16x16x32_bf16 v[48:51], a[116:119], v[28:31], v[48:51]
s_waitcnt lgkmcnt(4)
v_mfma_f32_16x16x32_bf16 v[44:47], a[120:123], v[36:39], v[44:47]
ds_read_b128 v[28:31], v6 offset:36864
v_mfma_f32_16x16x32_bf16 v[52:55], a[120:123], v[40:43], v[52:55]
ds_read_b128 v[32:35], v6 offset:37120
v_mfma_f32_16x16x32_bf16 v[56:59], a[124:127], v[40:43], v[56:59]
buffer_load_dwordx4 v8, s[8:11], s20 offen offset:1024 sc1 lds
v_mfma_f32_16x16x32_bf16 v[48:51], a[124:127], v[36:39], v[48:51]
s_waitcnt lgkmcnt(4)
v_mfma_f32_16x16x32_bf16 v[44:47], a[128:131], v[12:15], v[44:47]
ds_read_b128 v[36:39], v6 offset:38912
v_mfma_f32_16x16x32_bf16 v[52:55], a[128:131], v[16:19], v[52:55]
ds_read_b128 v[40:43], v6 offset:39168
v_mfma_f32_16x16x32_bf16 v[56:59], a[132:135], v[16:19], v[56:59]
v_mfma_f32_16x16x32_bf16 v[48:51], a[132:135], v[12:15], v[48:51]
s_waitcnt lgkmcnt(4)
v_mfma_f32_16x16x32_bf16 v[44:47], a[136:139], v[20:23], v[44:47]
ds_read_b128 v[12:15], v6 offset:40960
v_mfma_f32_16x16x32_bf16 v[52:55], a[136:139], v[24:27], v[52:55]
ds_read_b128 v[16:19], v6 offset:41216
v_mfma_f32_16x16x32_bf16 v[56:59], a[140:143], v[24:27], v[56:59]
buffer_load_dwordx4 v8, s[8:11], s20 offen offset:2048 sc1 lds
v_mfma_f32_16x16x32_bf16 v[48:51], a[140:143], v[20:23], v[48:51]
s_waitcnt lgkmcnt(4)
v_mfma_f32_16x16x32_bf16 v[44:47], a[144:147], v[28:31], v[44:47]
ds_read_b128 v[20:23], v6 offset:43008
v_mfma_f32_16x16x32_bf16 v[52:55], a[144:147], v[32:35], v[52:55]
ds_read_b128 v[24:27], v6 offset:43264
v_mfma_f32_16x16x32_bf16 v[56:59], a[148:151], v[32:35], v[56:59]
v_mfma_f32_16x16x32_bf16 v[48:51], a[148:151], v[28:31], v[48:51]
s_waitcnt lgkmcnt(4)
v_mfma_f32_16x16x32_bf16 v[44:47], a[152:155], v[36:39], v[44:47]
ds_read_b128 v[28:31], v6 offset:45056
v_mfma_f32_16x16x32_bf16 v[52:55], a[152:155], v[40:43], v[52:55]
ds_read_b128 v[32:35], v6 offset:45312
v_mfma_f32_16x16x32_bf16 v[56:59], a[156:159], v[40:43], v[56:59]
buffer_load_dwordx4 v8, s[8:11], s20 offen offset:3072 sc1 lds
v_mfma_f32_16x16x32_bf16 v[48:51], a[156:159], v[36:39], v[48:51]
s_waitcnt lgkmcnt(4)
s_add_u32 s20, s20, s28
s_add_u32 m0, s22, 0
v_mfma_f32_16x16x32_bf16 v[44:47], a[160:163], v[12:15], v[44:47]
s_cmp_lt_u32 s36, s37
ds_read_b128 v[36:39], v6 offset:47104
s_cselect_b32 s20, s20, 0x40000000
v_mfma_f32_16x16x32_bf16 v[52:55], a[160:163], v[16:19], v[52:55]
s_waitcnt vmcnt(8)
ds_read_b128 v[40:43], v6 offset:47360
s_max_i32 s27, s39, 0
v_mfma_f32_16x16x32_bf16 v[56:59], a[164:167], v[16:19], v[56:59]
s_add_u32 s39, s39, 1
v_mov_b32 v112, s27
v_mfma_f32_16x16x32_bf16 v[48:51], a[164:167], v[12:15], v[48:51]
s_waitcnt lgkmcnt(4)
v_mfma_f32_16x16x32_bf16 v[44:47], a[168:171], v[20:23], v[44:47]
buffer_store_dword v112, v108, s[8:11], 0 offen sc1
ds_read_b128 v[12:15], v6 offset:49152
v_mfma_f32_16x16x32_bf16 v[52:55], a[168:171], v[24:27], v[52:55]
ds_read_b128 v[16:19], v6 offset:49408
v_mfma_f32_16x16x32_bf16 v[56:59], a[172:175], v[24:27], v[56:59]
buffer_load_dwordx4 v200, s[12:15], s68 offen nt lds
v_mfma_f32_16x16x32_bf16 v[48:51], a[172:175], v[20:23], v[48:51]
s_waitcnt lgkmcnt(4)
s_add_u32 s36, s36, 1
v_mfma_f32_16x16x32_bf16 v[44:47], a[176:179], v[28:31], v[44:47]
ds_read_b128 v[20:23], v6 offset:51200
v_mfma_f32_16x16x32_bf16 v[52:55], a[176:179], v[32:35], v[52:55]
ds_read_b128 v[24:27], v6 offset:51456
v_mfma_f32_16x16x32_bf16 v[56:59], a[180:183], v[32:35], v[56:59]
v_mfma_f32_16x16x32_bf16 v[48:51], a[180:183], v[28:31], v[48:51]
s_waitcnt lgkmcnt(4)
v_mfma_f32_16x16x32_bf16 v[44:47], a[184:187], v[36:39], v[44:47]
ds_read_b128 v[28:31], v6 offset:53248
v_mfma_f32_16x16x32_bf16 v[52:55], a[184:187], v[40:43], v[52:55]
ds_read_b128 v[32:35], v6 offset:53504
v_mfma_f32_16x16x32_bf16 v[56:59], a[188:191], v[40:43], v[56:59]
buffer_load_dwordx4 v201, s[12:15], s68 offen offset:1024 nt lds
v_mfma_f32_16x16x32_bf16 v[48:51], a[188:191], v[36:39], v[48:51]
s_waitcnt lgkmcnt(4)
v_mfma_f32_16x16x32_bf16 v[44:47], a[192:195], v[12:15], v[44:47]
ds_read_b128 v[36:39], v6 offset:55296
v_mfma_f32_16x16x32_bf16 v[52:55], a[192:195], v[16:19], v[52:55]
ds_read_b128 v[40:43], v6 offset:55552
v_mfma_f32_16x16x32_bf16 v[56:59], a[196:199], v[16:19], v[56:59]
v_mfma_f32_16x16x32_bf16 v[48:51], a[196:199], v[12:15], v[48:51]
s_waitcnt lgkmcnt(4)
v_mfma_f32_16x16x32_bf16 v[44:47], a[200:203], v[20:23], v[44:47]
ds_read_b128 v[12:15], v6 offset:57344
v_mfma_f32_16x16x32_bf16 v[52:55], a[200:203], v[24:27], v[52:55]
ds_read_b128 v[16:19], v6 offset:57600
v_mfma_f32_16x16x32_bf16 v[56:59], a[204:207], v[24:27], v[56:59]
buffer_load_dwordx4 v202, s[12:15], s68 offen offset:2048 nt lds
v_mfma_f32_16x16x32_bf16 v[48:51], a[204:207], v[20:23], v[48:51]
s_waitcnt lgkmcnt(4)
v_mfma_f32_16x16x32_bf16 v[44:47], a[208:211], v[28:31], v[44:47]
ds_read_b128 v[20:23], v6 offset:59392
v_mfma_f32_16x16x32_bf16 v[52:55], a[208:211], v[32:35], v[52:55]
ds_read_b128 v[24:27], v6 offset:59648
v_mfma_f32_16x16x32_bf16 v[56:59], a[212:215], v[32:35], v[56:59]
v_mfma_f32_16x16x32_bf16 v[48:51], a[212:215], v[28:31], v[48:51]
s_waitcnt lgkmcnt(4)
v_mfma_f32_16x16x32_bf16 v[44:47], a[216:219], v[36:39], v[44:47]
ds_read_b128 v[28:31], v6 offset:61440
v_mfma_f32_16x16x32_bf16 v[52:55], a[216:219], v[40:43], v[52:55]
ds_read_b128 v[32:35], v6 offset:61696
v_mfma_f32_16x16x32_bf16 v[56:59], a[220:223], v[40:43], v[56:59]
buffer_load_dwordx4 v203, s[12:15], s68 offen offset:3072 nt lds
v_mfma_f32_16x16x32_bf16 v[48:51], a[220:223], v[36:39], v[48:51]
s_waitcnt lgkmcnt(4)
s_add_u32 s68, s68, s75
s_add_u32 m0, s22, 16384
v_mfma_f32_16x16x32_bf16 v[44:47], a[224:227], v[12:15], v[44:47]
ds_read_b128 v[36:39], v6 offset:63488
v_mfma_f32_16x16x32_bf16 v[52:55], a[224:227], v[16:19], v[52:55]
ds_read_b128 v[40:43], v6 offset:63744
v_mfma_f32_16x16x32_bf16 v[56:59], a[228:231], v[16:19], v[56:59]
v_mfma_f32_16x16x32_bf16 v[48:51], a[228:231], v[12:15], v[48:51]
s_waitcnt lgkmcnt(4)
v_mfma_f32_16x16x32_bf16 v[44:47], a[232:235], v[20:23], v[44:47]
s_waitcnt vmcnt(14)
s_barrier
ds_read_b128 v[12:15], v7 offset:0
v_mfma_f32_16x16x32_bf16 v[52:55], a[232:235], v[24:27], v[52:55]
ds_read_b128 v[16:19], v7 offset:256
v_mfma_f32_16x16x32_bf16 v[56:59], a[236:239], v[24:27], v[56:59]
buffer_load_dwordx4 v200, s[12:15], s68 offen nt lds
v_mfma_f32_16x16x32_bf16 v[48:51], a[236:239], v[20:23], v[48:51]
s_waitcnt lgkmcnt(4)
v_mfma_f32_16x16x32_bf16 v[44:47], a[240:243], v[28:31], v[44:47]
ds_read_b128 v[20:23], v7 offset:2048
v_mfma_f32_16x16x32_bf16 v[52:55], a[240:243], v[32:35], v[52:55]
ds_read_b128 v[24:27], v7 offset:2304
v_mfma_f32_16x16x32_bf16 v[56:59], a[244:247], v[32:35], v[56:59]
v_mfma_f32_16x16x32_bf16 v[48:51], a[244:247], v[28:31], v[48:51]
s_waitcnt lgkmcnt(4)
v_mfma_f32_16x16x32_bf16 v[44:47], a[248:251], v[36:39], v[44:47]
ds_read_b128 v[28:31], v7 offset:4096
v_mfma_f32_16x16x32_bf16 v[52:55], a[248:251], v[40:43], v[52:55]
ds_read_b128 v[32:35], v7 offset:4352
v_mfma_f32_16x16x32_bf16 v[56:59], a[252:255], v[40:43], v[56:59]
buffer_load_dwordx4 v201, s[12:15], s68 offen offset:1024 nt lds
v_mfma_f32_16x16x32_bf16 v[48:51], a[252:255], v[36:39], v[48:51]
s_waitcnt lgkmcnt(4)
v_mfma_f32_16x16x32_bf16 v[60:63], a[0:3], v[12:15], 0
ds_read_b128 v[36:39], v7 offset:6144
v_mfma_f32_16x16x32_bf16 v[68:71], a[0:3], v[16:19], 0
ds_read_b128 v[40:43], v7 offset:6400
v_cvt_pk_bf16_f32 v84, v44, v45
v_mfma_f32_16x16x32_bf16 v[72:75], a[4:7], v[16:19], 0
v_cvt_pk_bf16_f32 v85, v46, v47
v_mfma_f32_16x16x32_bf16 v[64:67], a[4:7], v[12:15], 0
s_waitcnt lgkmcnt(4)
v_cvt_pk_bf16_f32 v86, v48, v49
v_mfma_f32_16x16x32_bf16 v[60:63], a[8:11], v[20:23], v[60:63]
ds_read_b128 v[12:15], v7 offset:8192
v_cvt_pk_bf16_f32 v87, v50, v51
v_mfma_f32_16x16x32_bf16 v[68:71], a[8:11], v[24:27], v[68:71]
ds_read_b128 v[16:19], v7 offset:8448
v_cvt_pk_bf16_f32 v88, v52, v53
v_mfma_f32_16x16x32_bf16 v[72:75], a[12:15], v[24:27], v[72:75]
buffer_load_dwordx4 v202, s[12:15], s68 offen offset:2048 nt lds
v_cvt_pk_bf16_f32 v89, v54, v55
v_mfma_f32_16x16x32_bf16 v[64:67], a[12:15], v[20:23], v[64:67]
s_waitcnt lgkmcnt(4)
v_cvt_pk_bf16_f32 v90, v56, v57
v_mfma_f32_16x16x32_bf16 v[60:63], a[16:19], v[28:31], v[60:63]
ds_read_b128 v[20:23], v7 offset:10240
v_cvt_pk_bf16_f32 v91, v58, v59
v_mfma_f32_16x16x32_bf16 v[68:71], a[16:19], v[32:35], v[68:71]
ds_read_b128 v[24:27], v7 offset:10496
v_mfma_f32_16x16x32_bf16 v[72:75], a[20:23], v[32:35], v[72:75]
buffer_store_dwordx4 v[84:87], v9, s[8:11], s21 offen sc1
v_mfma_f32_16x16x32_bf16 v[64:67], a[20:23], v[28:31], v[64:67]
s_waitcnt lgkmcnt(4)
v_mfma_f32_16x16x32_bf16 v[60:63], a[24:27], v[36:39], v[60:63]
ds_read_b128 v[28:31], v7 offset:12288
v_mfma_f32_16x16x32_bf16 v[68:71], a[24:27], v[40:43], v[68:71]
ds_read_b128 v[32:35], v7 offset:12544
v_mfma_f32_16x16x32_bf16 v[72:75], a[28:31], v[40:43], v[72:75]
buffer_load_dwordx4 v203, s[12:15], s68 offen offset:3072 nt lds
v_mfma_f32_16x16x32_bf16 v[64:67], a[28:31], v[36:39], v[64:67]
s_waitcnt lgkmcnt(4)
s_add_u32 s68, s68, s75
s_add_u32 m0, s22, 32768
v_mfma_f32_16x16x32_bf16 v[60:63], a[32:35], v[12:15], v[60:63]
ds_read_b128 v[36:39], v7 offset:14336
v_mfma_f32_16x16x32_bf16 v[68:71], a[32:35], v[16:19], v[68:71]
ds_read_b128 v[40:43], v7 offset:14592
v_mfma_f32_16x16x32_bf16 v[72:75], a[36:39], v[16:19], v[72:75]
buffer_store_dwordx4 v[88:91], v9, s[8:11], s21 offen offset:256 sc1
s_mov_b32 s21, s31
v_mfma_f32_16x16x32_bf16 v[64:67], a[36:39], v[12:15], v[64:67]
s_waitcnt lgkmcnt(4)
s_add_u32 s31, s31, s29
v_mfma_f32_16x16x32_bf16 v[60:63], a[40:43], v[20:23], v[60:63]
ds_read_b128 v[12:15], v7 offset:16384
v_mfma_f32_16x16x32_bf16 v[68:71], a[40:43], v[24:27], v[68:71]
ds_read_b128 v[16:19], v7 offset:16640
v_mfma_f32_16x16x32_bf16 v[72:75], a[44:47], v[24:27], v[72:75]
buffer_load_dwordx4 v200, s[12:15], s68 offen nt lds
v_mfma_f32_16x16x32_bf16 v[64:67], a[44:47], v[20:23], v[64:67]
s_waitcnt lgkmcnt(4)
v_mfma_f32_16x16x32_bf16 v[60:63], a[48:51], v[28:31], v[60:63]
ds_read_b128 v[20:23], v7 offset:18432
v_mfma_f32_16x16x32_bf16 v[68:71], a[48:51], v[32:35], v[68:71]
ds_read_b128 v[24:27], v7 offset:18688
v_mfma_f32_16x16x32_bf16 v[72:75], a[52:55], v[32:35], v[72:75]
v_mfma_f32_16x16x32_bf16 v[64:67], a[52:55], v[28:31], v[64:67]
s_waitcnt lgkmcnt(4)
v_mfma_f32_16x16x32_bf16 v[60:63], a[56:59], v[36:39], v[60:63]
ds_read_b128 v[28:31], v7 offset:20480
v_mfma_f32_16x16x32_bf16 v[68:71], a[56:59], v[40:43], v[68:71]
ds_read_b128 v[32:35], v7 offset:20736
v_mfma_f32_16x16x32_bf16 v[72:75], a[60:63], v[40:43], v[72:75]
buffer_load_dwordx4 v201, s[12:15], s68 offen offset:1024 nt lds
v_mfma_f32_16x16x32_bf16 v[64:67], a[60:63], v[36:39], v[64:67]
s_waitcnt lgkmcnt(4)
v_mfma_f32_16x16x32_bf16 v[60:63], a[64:67], v[12:15], v[60:63]
ds_read_b128 v[36:39], v7 offset:22528
v_mfma_f32_16x16x32_bf16 v[68:71], a[64:67], v[16:19], v[68:71]
ds_read_b128 v[40:43], v7 offset:22784
v_mfma_f32_16x16x32_bf16 v[72:75], a[68:71], v[16:19], v[72:75]
v_mfma_f32_16x16x32_bf16 v[64:67], a[68:71], v[12:15], v[64:67]
s_waitcnt lgkmcnt(4)
v_mfma_f32_16x16x32_bf16 v[60:63], a[72:75], v[20:23], v[60:63]
ds_read_b128 v[12:15], v7 offset:24576
v_mfma_f32_16x16x32_bf16 v[68:71], a[72:75], v[24:27], v[68:71]
ds_read_b128 v[16:19], v7 offset:24832
v_mfma_f32_16x16x32_bf16 v[72:75], a[76:79], v[24:27], v[72:75]
buffer_load_dwordx4 v202, s[12:15], s68 offen offset:2048 nt lds
v_mfma_f32_16x16x32_bf16 v[64:67], a[76:79], v[20:23], v[64:67]
s_waitcnt lgkmcnt(4)
v_mfma_f32_16x16x32_bf16 v[60:63], a[80:83], v[28:31], v[60:63]
ds_read_b128 v[20:23], v7 offset:26624
v_mfma_f32_16x16x32_bf16 v[68:71], a[80:83], v[32:35], v[68:71]
ds_read_b128 v[24:27], v7 offset:26880
v_mfma_f32_16x16x32_bf16 v[72:75], a[84:87], v[32:35], v[72:75]
v_mfma_f32_16x16x32_bf16 v[64:67], a[84:87], v[28:31], v[64:67]
s_waitcnt lgkmcnt(4)
v_mfma_f32_16x16x32_bf16 v[60:63], a[88:91], v[36:39], v[60:63]
ds_read_b128 v[28:31], v7 offset:28672
v_mfma_f32_16x16x32_bf16 v[68:71], a[88:91], v[40:43], v[68:71]
ds_read_b128 v[32:35], v7 offset:28928
v_mfma_f32_16x16x32_bf16 v[72:75], a[92:95], v[40:43], v[72:75]
buffer_load_dwordx4 v203, s[12:15], s68 offen offset:3072 nt lds
v_mfma_f32_16x16x32_bf16 v[64:67], a[92:95], v[36:39], v[64:67]
s_waitcnt lgkmcnt(4)
s_add_u32 s68, s68, s75
s_add_u32 m0, s22, 49152
v_mfma_f32_16x16x32_bf16 v[60:63], a[96:99], v[12:15], v[60:63]
ds_read_b128 v[36:39], v7 offset:30720
v_mfma_f32_16x16x32_bf16 v[68:71], a[96:99], v[16:19], v[68:71]
ds_read_b128 v[40:43], v7 offset:30976
v_mfma_f32_16x16x32_bf16 v[72:75], a[100:103], v[16:19], v[72:75]
v_mfma_f32_16x16x32_bf16 v[64:67], a[100:103], v[12:15], v[64:67]
s_waitcnt lgkmcnt(4)
v_mfma_f32_16x16x32_bf16 v[60:63], a[104:107], v[20:23], v[60:63]
s_waitcnt vmcnt(15)
s_barrier
ds_read_b128 v[12:15], v7 offset:32768
v_mfma_f32_16x16x32_bf16 v[68:71], a[104:107], v[24:27], v[68:71]
ds_read_b128 v[16:19], v7 offset:33024
v_mfma_f32_16x16x32_bf16 v[72:75], a[108:111], v[24:27], v[72:75]
buffer_load_dwordx4 v200, s[12:15], s68 offen nt lds
v_mfma_f32_16x16x32_bf16 v[64:67], a[108:111], v[20:23], v[64:67]
s_waitcnt lgkmcnt(4)
v_mfma_f32_16x16x32_bf16 v[60:63], a[112:115], v[28:31], v[60:63]
ds_read_b128 v[20:23], v7 offset:34816
v_mfma_f32_16x16x32_bf16 v[68:71], a[112:115], v[32:35], v[68:71]
ds_read_b128 v[24:27], v7 offset:35072
v_mfma_f32_16x16x32_bf16 v[72:75], a[116:119], v[32:35], v[72:75]
v_mfma_f32_16x16x32_bf16 v[64:67], a[116:119], v[28:31], v[64:67]
s_waitcnt lgkmcnt(4)
v_mfma_f32_16x16x32_bf16 v[60:63], a[120:123], v[36:39], v[60:63]
ds_read_b128 v[28:31], v7 offset:36864
v_mfma_f32_16x16x32_bf16 v[68:71], a[120:123], v[40:43], v[68:71]
ds_read_b128 v[32:35], v7 offset:37120
v_mfma_f32_16x16x32_bf16 v[72:75], a[124:127], v[40:43], v[72:75]
buffer_load_dwordx4 v201, s[12:15], s68 offen offset:1024 nt lds
v_mfma_f32_16x16x32_bf16 v[64:67], a[124:127], v[36:39], v[64:67]
s_waitcnt lgkmcnt(4)
v_mfma_f32_16x16x32_bf16 v[60:63], a[128:131], v[12:15], v[60:63]
ds_read_b128 v[36:39], v7 offset:38912
v_mfma_f32_16x16x32_bf16 v[68:71], a[128:131], v[16:19], v[68:71]
ds_read_b128 v[40:43], v7 offset:39168
v_mfma_f32_16x16x32_bf16 v[72:75], a[132:135], v[16:19], v[72:75]
v_mfma_f32_16x16x32_bf16 v[64:67], a[132:135], v[12:15], v[64:67]
s_waitcnt lgkmcnt(4)
v_mfma_f32_16x16x32_bf16 v[60:63], a[136:139], v[20:23], v[60:63]
ds_read_b128 v[12:15], v7 offset:40960
v_mfma_f32_16x16x32_bf16 v[68:71], a[136:139], v[24:27], v[68:71]
ds_read_b128 v[16:19], v7 offset:41216
v_mfma_f32_16x16x32_bf16 v[72:75], a[140:143], v[24:27], v[72:75]
buffer_load_dwordx4 v202, s[12:15], s68 offen offset:2048 nt lds
v_mfma_f32_16x16x32_bf16 v[64:67], a[140:143], v[20:23], v[64:67]
s_waitcnt lgkmcnt(4)
v_mfma_f32_16x16x32_bf16 v[60:63], a[144:147], v[28:31], v[60:63]
ds_read_b128 v[20:23], v7 offset:43008
v_mfma_f32_16x16x32_bf16 v[68:71], a[144:147], v[32:35], v[68:71]
ds_read_b128 v[24:27], v7 offset:43264
v_mfma_f32_16x16x32_bf16 v[72:75], a[148:151], v[32:35], v[72:75]
v_mfma_f32_16x16x32_bf16 v[64:67], a[148:151], v[28:31], v[64:67]
s_waitcnt lgkmcnt(4)
v_mfma_f32_16x16x32_bf16 v[60:63], a[152:155], v[36:39], v[60:63]
ds_read_b128 v[28:31], v7 offset:45056
v_mfma_f32_16x16x32_bf16 v[68:71], a[152:155], v[40:43], v[68:71]
ds_read_b128 v[32:35], v7 offset:45312
v_mfma_f32_16x16x32_bf16 v[72:75], a[156:159], v[40:43], v[72:75]
buffer_load_dwordx4 v203, s[12:15], s68 offen offset:3072 nt lds
v_mfma_f32_16x16x32_bf16 v[64:67], a[156:159], v[36:39], v[64:67]
s_waitcnt lgkmcnt(4)
s_add_u32 s68, s68, s75
s_add_u32 m0, s22, 65536
v_mfma_f32_16x16x32_bf16 v[60:63], a[160:163], v[12:15], v[60:63]
s_cmp_lt_u32 s36, s37
ds_read_b128 v[36:39], v7 offset:47104
s_cselect_b32 s20, s20, 0x40000000
v_mfma_f32_16x16x32_bf16 v[68:71], a[160:163], v[16:19], v[68:71]
s_waitcnt vmcnt(8)
ds_read_b128 v[40:43], v7 offset:47360
s_max_i32 s27, s39, 0
v_mfma_f32_16x16x32_bf16 v[72:75], a[164:167], v[16:19], v[72:75]
s_add_u32 s39, s39, 1
v_mov_b32 v112, s27
v_mfma_f32_16x16x32_bf16 v[64:67], a[164:167], v[12:15], v[64:67]
s_waitcnt lgkmcnt(4)
v_mfma_f32_16x16x32_bf16 v[60:63], a[168:171], v[20:23], v[60:63]
buffer_store_dword v112, v108, s[8:11], 0 offen sc1
ds_read_b128 v[12:15], v7 offset:49152
v_mfma_f32_16x16x32_bf16 v[68:71], a[168:171], v[24:27], v[68:71]
ds_read_b128 v[16:19], v7 offset:49408
v_mfma_f32_16x16x32_bf16 v[72:75], a[172:175], v[24:27], v[72:75]
buffer_load_dwordx4 v200, s[12:15], s68 offen nt lds
v_mfma_f32_16x16x32_bf16 v[64:67], a[172:175], v[20:23], v[64:67]
s_waitcnt lgkmcnt(4)
s_add_u32 s36, s36, 1
v_mfma_f32_16x16x32_bf16 v[60:63], a[176:179], v[28:31], v[60:63]
ds_read_b128 v[20:23], v7 offset:51200
v_mfma_f32_16x16x32_bf16 v[68:71], a[176:179], v[32:35], v[68:71]
ds_read_b128 v[24:27], v7 offset:51456
v_mfma_f32_16x16x32_bf16 v[72:75], a[180:183], v[32:35], v[72:75]
v_mfma_f32_16x16x32_bf16 v[64:67], a[180:183], v[28:31], v[64:67]
s_waitcnt lgkmcnt(4)
v_mfma_f32_16x16x32_bf16 v[60:63], a[184:187], v[36:39], v[60:63]
ds_read_b128 v[28:31], v7 offset:53248
v_mfma_f32_16x16x32_bf16 v[68:71], a[184:187], v[40:43], v[68:71]
ds_read_b128 v[32:35], v7 offset:53504
v_mfma_f32_16x16x32_bf16 v[72:75], a[188:191], v[40:43], v[72:75]
buffer_load_dwordx4 v201, s[12:15], s68 offen offset:1024 nt lds
v_mfma_f32_16x16x32_bf16 v[64:67], a[188:191], v[36:39], v[64:67]
s_waitcnt lgkmcnt(4)
v_mfma_f32_16x16x32_bf16 v[60:63], a[192:195], v[12:15], v[60:63]
ds_read_b128 v[36:39], v7 offset:55296
v_mfma_f32_16x16x32_bf16 v[68:71], a[192:195], v[16:19], v[68:71]
ds_read_b128 v[40:43], v7 offset:55552
v_mfma_f32_16x16x32_bf16 v[72:75], a[196:199], v[16:19], v[72:75]
v_mfma_f32_16x16x32_bf16 v[64:67], a[196:199], v[12:15], v[64:67]
s_waitcnt lgkmcnt(4)
v_mfma_f32_16x16x32_bf16 v[60:63], a[200:203], v[20:23], v[60:63]
ds_read_b128 v[12:15], v7 offset:57344
v_mfma_f32_16x16x32_bf16 v[68:71], a[200:203], v[24:27], v[68:71]
ds_read_b128 v[16:19], v7 offset:57600
v_mfma_f32_16x16x32_bf16 v[72:75], a[204:207], v[24:27], v[72:75]
buffer_load_dwordx4 v202, s[12:15], s68 offen offset:2048 nt lds
v_mfma_f32_16x16x32_bf16 v[64:67], a[204:207], v[20:23], v[64:67]
s_waitcnt lgkmcnt(4)
v_mfma_f32_16x16x32_bf16 v[60:63], a[208:211], v[28:31], v[60:63]
ds_read_b128 v[20:23], v7 offset:59392
v_mfma_f32_16x16x32_bf16 v[68:71], a[208:211], v[32:35], v[68:71]
ds_read_b128 v[24:27], v7 offset:59648
v_mfma_f32_16x16x32_bf16 v[72:75], a[212:215], v[32:35], v[72:75]
v_mfma_f32_16x16x32_bf16 v[64:67], a[212:215], v[28:31], v[64:67]
s_waitcnt lgkmcnt(4)
v_mfma_f32_16x16x32_bf16 v[60:63], a[216:219], v[36:39], v[60:63]
ds_read_b128 v[28:31], v7 offset:61440
v_mfma_f32_16x16x32_bf16 v[68:71], a[216:219], v[40:43], v[68:71]
ds_read_b128 v[32:35], v7 offset:61696
v_mfma_f32_16x16x32_bf16 v[72:75], a[220:223], v[40:43], v[72:75]
buffer_load_dwordx4 v203, s[12:15], s68 offen offset:3072 nt lds
v_mfma_f32_16x16x32_bf16 v[64:67], a[220:223], v[36:39], v[64:67]
s_waitcnt lgkmcnt(4)
s_add_u32 s68, s68, s75
s_add_u32 m0, s22, 81920
v_mfma_f32_16x16x32_bf16 v[60:63], a[224:227], v[12:15], v[60:63]
ds_read_b128 v[36:39], v7 offset:63488
v_mfma_f32_16x16x32_bf16 v[68:71], a[224:227], v[16:19], v[68:71]
ds_read_b128 v[40:43], v7 offset:63744
v_mfma_f32_16x16x32_bf16 v[72:75], a[228:231], v[16:19], v[72:75]
v_mfma_f32_16x16x32_bf16 v[64:67], a[228:231], v[12:15], v[64:67]
s_waitcnt lgkmcnt(4)
v_mfma_f32_16x16x32_bf16 v[60:63], a[232:235], v[20:23], v[60:63]
s_waitcnt vmcnt(24)
s_barrier
ds_read_b128 v[12:15], v6 offset:0
v_mfma_f32_16x16x32_bf16 v[68:71], a[232:235], v[24:27], v[68:71]
ds_read_b128 v[16:19], v6 offset:256
v_mfma_f32_16x16x32_bf16 v[72:75], a[236:239], v[24:27], v[72:75]
buffer_load_dwordx4 v200, s[12:15], s68 offen nt lds
v_mfma_f32_16x16x32_bf16 v[64:67], a[236:239], v[20:23], v[64:67]
s_waitcnt lgkmcnt(4)
v_mfma_f32_16x16x32_bf16 v[60:63], a[240:243], v[28:31], v[60:63]
ds_read_b128 v[20:23], v6 offset:2048
v_mfma_f32_16x16x32_bf16 v[68:71], a[240:243], v[32:35], v[68:71]
ds_read_b128 v[24:27], v6 offset:2304
v_mfma_f32_16x16x32_bf16 v[72:75], a[244:247], v[32:35], v[72:75]
v_mfma_f32_16x16x32_bf16 v[64:67], a[244:247], v[28:31], v[64:67]
s_waitcnt lgkmcnt(4)
v_mfma_f32_16x16x32_bf16 v[60:63], a[248:251], v[36:39], v[60:63]
ds_read_b128 v[28:31], v6 offset:4096
v_mfma_f32_16x16x32_bf16 v[68:71], a[248:251], v[40:43], v[68:71]
ds_read_b128 v[32:35], v6 offset:4352
v_mfma_f32_16x16x32_bf16 v[72:75], a[252:255], v[40:43], v[72:75]
s_sub_u32 s24, s24, 1
buffer_load_dwordx4 v201, s[12:15], s68 offen offset:1024 nt lds
v_mfma_f32_16x16x32_bf16 v[64:67], a[252:255], v[36:39], v[64:67]
s_waitcnt lgkmcnt(4)
s_barrier
s_add_u32 m0, s22, 81920
s_nop 0
buffer_load_dwordx4 v202, s[12:15], s68 offen offset:2048 nt lds
buffer_load_dwordx4 v203, s[12:15], s68 offen offset:3072 nt lds
s_add_u32 s68, s68, s75
s_add_u32 m0, s22, 98304
s_nop 0
buffer_load_dwordx4 v200, s[12:15], s68 offen nt lds
buffer_load_dwordx4 v201, s[12:15], s68 offen offset:1024 nt lds
buffer_load_dwordx4 v202, s[12:15], s68 offen offset:2048 nt lds
buffer_load_dwordx4 v203, s[12:15], s68 offen offset:3072 nt lds
s_add_u32 s68, s68, s75
s_add_u32 m0, s22, 114688
s_nop 0
buffer_load_dwordx4 v200, s[12:15], s68 offen nt lds
buffer_load_dwordx4 v201, s[12:15], s68 offen offset:1024 nt lds
buffer_load_dwordx4 v202, s[12:15], s68 offen offset:2048 nt lds
buffer_load_dwordx4 v203, s[12:15], s68 offen offset:3072 nt lds
v_cvt_pk_bf16_f32 v84, v60, v61
v_cvt_pk_bf16_f32 v85, v62, v63
v_cvt_pk_bf16_f32 v86, v64, v65
v_cvt_pk_bf16_f32 v87, v66, v67
v_cvt_pk_bf16_f32 v88, v68, v69
v_cvt_pk_bf16_f32 v89, v70, v71
v_cvt_pk_bf16_f32 v90, v72, v73
v_cvt_pk_bf16_f32 v91, v74, v75
buffer_store_dwordx4 v[84:87], v9, s[8:11], s21 offen sc1
buffer_store_dwordx4 v[88:91], v9, s[8:11], s21 offen offset:256 sc1
s_mov_b32 s21, s31
s_add_u32 s31, s31, s29
s_waitcnt vmcnt(0)
s_mov_b32 s39, s37
s_max_i32 s27, s39, 0
v_mov_b32 v112, s27
buffer_store_dword v112, v108, s[8:11], 0 offen sc1
s_branch main_kernel_qa
main_kernel_v:
s_lshl_b32 s75, s73, 7
s_add_u32 s75, s75, 0x6a01000
s_lshl_b32 s26, s25, 2
s_add_u32 s26, s26, s75
v_mov_b32 v108, 0x40000000
v_writelane_b32 v108, s26, 0
v_bfe_u32 v2, v1, 3, 1
v_bfe_u32 v3, v1, 4, 1
v_xor_b32 v2, v2, v3
v_mul_u32_u24 v2, 24, v2
v_xor_b32 v2, v2, v1
v_lshl_add_u32 v8, v2, 4, s22
s_lshl_b32 s75, s73, 13
s_add_u32 s31, s75, 0x2400000
s_mov_b32 s29, 262144
v_lshrrev_b32 v2, 5, v1
v_lshlrev_b32 v2, 12, v2
v_bfe_u32 v3, v1, 4, 1
v_lshl_add_u32 v2, v3, 10, v2
v_and_b32 v4, 1, v1
v_lshl_add_u32 v2, v4, 3, v2
v_bfe_u32 v4, v1, 2, 2
v_lshl_add_u32 v2, v4, 8, v2
v_xor_b32 v4, s25, v4
v_lshl_add_u32 v3, v4, 2, v3
v_bfe_u32 v4, v1, 1, 1
v_xor_b32 v3, v3, v4
v_lshl_add_u32 v94, v3, 4, v2
v_xor_b32 v95, 32, v94
v_add_u32 v96, 0x10000, v94
v_add_u32 v97, 0x10000, v95
s_waitcnt vmcnt(16)
s_barrier
ds_read_b64_tr_b16 a[0:1], v94 offset:0
ds_read_b64_tr_b16 a[2:3], v94 offset:2048
ds_read_b64_tr_b16 a[4:5], v95 offset:0
ds_read_b64_tr_b16 a[6:7], v95 offset:2048
ds_read_b64_tr_b16 a[8:9], v94 offset:8192
ds_read_b64_tr_b16 a[10:11], v94 offset:10240
ds_read_b64_tr_b16 a[12:13], v95 offset:8192
ds_read_b64_tr_b16 a[14:15], v95 offset:10240
ds_read_b64_tr_b16 a[16:17], v94 offset:16384
ds_read_b64_tr_b16 a[18:19], v94 offset:18432
ds_read_b64_tr_b16 a[20:21], v95 offset:16384
ds_read_b64_tr_b16 a[22:23], v95 offset:18432
ds_read_b64_tr_b16 a[24:25], v94 offset:24576
ds_read_b64_tr_b16 a[26:27], v94 offset:26624
ds_read_b64_tr_b16 a[28:29], v95 offset:24576
ds_read_b64_tr_b16 a[30:31], v95 offset:26624
ds_read_b64_tr_b16 a[32:33], v94 offset:32768
ds_read_b64_tr_b16 a[34:35], v94 offset:34816
ds_read_b64_tr_b16 a[36:37], v95 offset:32768
ds_read_b64_tr_b16 a[38:39], v95 offset:34816
ds_read_b64_tr_b16 a[40:41], v94 offset:40960
ds_read_b64_tr_b16 a[42:43], v94 offset:43008
ds_read_b64_tr_b16 a[44:45], v95 offset:40960
ds_read_b64_tr_b16 a[46:47], v95 offset:43008
ds_read_b64_tr_b16 a[48:49], v94 offset:49152
ds_read_b64_tr_b16 a[50:51], v94 offset:51200
ds_read_b64_tr_b16 a[52:53], v95 offset:49152
ds_read_b64_tr_b16 a[54:55], v95 offset:51200
ds_read_b64_tr_b16 a[56:57], v94 offset:57344
ds_read_b64_tr_b16 a[58:59], v94 offset:59392
ds_read_b64_tr_b16 a[60:61], v95 offset:57344
ds_read_b64_tr_b16 a[62:63], v95 offset:59392
s_waitcnt lgkmcnt(0)
s_barrier
s_lshl_b32 m0, s25, 14
s_mul_i32 s26, s30, 512
buffer_load_dwordx4 v92, s[12:15], s26 offen nt lds
s_add_u32 m0, m0, 1024
s_add_u32 s26, s26, s49
buffer_load_dwordx4 v93, s[12:15], s26 offen nt lds
s_add_u32 m0, m0, 1024
s_add_u32 s26, s26, s49
buffer_load_dwordx4 v92, s[12:15], s26 offen nt lds
s_add_u32 m0, m0, 1024
s_add_u32 s26, s26, s49
buffer_load_dwordx4 v93, s[12:15], s26 offen nt lds
s_add_u32 m0, m0, 1024
s_add_u32 s26, s26, s49
buffer_load_dwordx4 v92, s[12:15], s26 offen nt lds
s_add_u32 m0, m0, 1024
s_add_u32 s26, s26, s49
buffer_load_dwordx4 v93, s[12:15], s26 offen nt lds
s_add_u32 m0, m0, 1024
s_add_u32 s26, s26, s49
buffer_load_dwordx4 v92, s[12:15], s26 offen nt lds
s_add_u32 m0, m0, 1024
s_add_u32 s26, s26, s49
buffer_load_dwordx4 v93, s[12:15], s26 offen nt lds
s_add_u32 m0, m0, 1024
s_add_u32 s26, s26, s49
buffer_load_dwordx4 v92, s[12:15], s26 offen nt lds
s_add_u32 m0, m0, 1024
s_add_u32 s26, s26, s49
buffer_load_dwordx4 v93, s[12:15], s26 offen nt lds
s_add_u32 m0, m0, 1024
s_add_u32 s26, s26, s49
buffer_load_dwordx4 v92, s[12:15], s26 offen nt lds
s_add_u32 m0, m0, 1024
s_add_u32 s26, s26, s49
buffer_load_dwordx4 v93, s[12:15], s26 offen nt lds
s_add_u32 m0, m0, 1024
s_add_u32 s26, s26, s49
buffer_load_dwordx4 v92, s[12:15], s26 offen nt lds
s_add_u32 m0, m0, 1024
s_add_u32 s26, s26, s49
buffer_load_dwordx4 v93, s[12:15], s26 offen nt lds
s_add_u32 m0, m0, 1024
s_add_u32 s26, s26, s49
buffer_load_dwordx4 v92, s[12:15], s26 offen nt lds
s_add_u32 m0, m0, 1024
s_add_u32 s26, s26, s49
buffer_load_dwordx4 v93, s[12:15], s26 offen nt lds
s_waitcnt vmcnt(16)
s_barrier
ds_read_b64_tr_b16 a[64:65], v96 offset:0
ds_read_b64_tr_b16 a[66:67], v96 offset:2048
ds_read_b64_tr_b16 a[68:69], v97 offset:0
ds_read_b64_tr_b16 a[70:71], v97 offset:2048
ds_read_b64_tr_b16 a[72:73], v96 offset:8192
ds_read_b64_tr_b16 a[74:75], v96 offset:10240
ds_read_b64_tr_b16 a[76:77], v97 offset:8192
ds_read_b64_tr_b16 a[78:79], v97 offset:10240
ds_read_b64_tr_b16 a[80:81], v96 offset:16384
ds_read_b64_tr_b16 a[82:83], v96 offset:18432
ds_read_b64_tr_b16 a[84:85], v97 offset:16384
ds_read_b64_tr_b16 a[86:87], v97 offset:18432
ds_read_b64_tr_b16 a[88:89], v96 offset:24576
ds_read_b64_tr_b16 a[90:91], v96 offset:26624
ds_read_b64_tr_b16 a[92:93], v97 offset:24576
ds_read_b64_tr_b16 a[94:95], v97 offset:26624
ds_read_b64_tr_b16 a[96:97], v96 offset:32768
ds_read_b64_tr_b16 a[98:99], v96 offset:34816
ds_read_b64_tr_b16 a[100:101], v97 offset:32768
ds_read_b64_tr_b16 a[102:103], v97 offset:34816
ds_read_b64_tr_b16 a[104:105], v96 offset:40960
ds_read_b64_tr_b16 a[106:107], v96 offset:43008
ds_read_b64_tr_b16 a[108:109], v97 offset:40960
ds_read_b64_tr_b16 a[110:111], v97 offset:43008
ds_read_b64_tr_b16 a[112:113], v96 offset:49152
ds_read_b64_tr_b16 a[114:115], v96 offset:51200
ds_read_b64_tr_b16 a[116:117], v97 offset:49152
ds_read_b64_tr_b16 a[118:119], v97 offset:51200
ds_read_b64_tr_b16 a[120:121], v96 offset:57344
ds_read_b64_tr_b16 a[122:123], v96 offset:59392
ds_read_b64_tr_b16 a[124:125], v97 offset:57344
ds_read_b64_tr_b16 a[126:127], v97 offset:59392
s_waitcnt lgkmcnt(0)
s_barrier
s_lshl_b32 m0, s25, 14
s_add_u32 m0, m0, 0x10000
s_mul_i32 s26, s30, 768
buffer_load_dwordx4 v92, s[12:15], s26 offen nt lds
s_add_u32 m0, m0, 1024
s_add_u32 s26, s26, s49
buffer_load_dwordx4 v93, s[12:15], s26 offen nt lds
s_add_u32 m0, m0, 1024
s_add_u32 s26, s26, s49
buffer_load_dwordx4 v92, s[12:15], s26 offen nt lds
s_add_u32 m0, m0, 1024
s_add_u32 s26, s26, s49
buffer_load_dwordx4 v93, s[12:15], s26 offen nt lds
s_add_u32 m0, m0, 1024
s_add_u32 s26, s26, s49
buffer_load_dwordx4 v92, s[12:15], s26 offen nt lds
s_add_u32 m0, m0, 1024
s_add_u32 s26, s26, s49
buffer_load_dwordx4 v93, s[12:15], s26 offen nt lds
s_add_u32 m0, m0, 1024
s_add_u32 s26, s26, s49
buffer_load_dwordx4 v92, s[12:15], s26 offen nt lds
s_add_u32 m0, m0, 1024
s_add_u32 s26, s26, s49
buffer_load_dwordx4 v93, s[12:15], s26 offen nt lds
s_add_u32 m0, m0, 1024
s_add_u32 s26, s26, s49
buffer_load_dwordx4 v92, s[12:15], s26 offen nt lds
s_add_u32 m0, m0, 1024
s_add_u32 s26, s26, s49
buffer_load_dwordx4 v93, s[12:15], s26 offen nt lds
s_add_u32 m0, m0, 1024
s_add_u32 s26, s26, s49
buffer_load_dwordx4 v92, s[12:15], s26 offen nt lds
s_add_u32 m0, m0, 1024
s_add_u32 s26, s26, s49
buffer_load_dwordx4 v93, s[12:15], s26 offen nt lds
s_add_u32 m0, m0, 1024
s_add_u32 s26, s26, s49
buffer_load_dwordx4 v92, s[12:15], s26 offen nt lds
s_add_u32 m0, m0, 1024
s_add_u32 s26, s26, s49
buffer_load_dwordx4 v93, s[12:15], s26 offen nt lds
s_add_u32 m0, m0, 1024
s_add_u32 s26, s26, s49
buffer_load_dwordx4 v92, s[12:15], s26 offen nt lds
s_add_u32 m0, m0, 1024
s_add_u32 s26, s26, s49
buffer_load_dwordx4 v93, s[12:15], s26 offen nt lds
s_waitcnt vmcnt(16)
s_barrier
buffer_load_dwordx2 v[210:211], v209, s[64:67], 0 offen offset:128
ds_read_b64_tr_b16 a[128:129], v94 offset:0
ds_read_b64_tr_b16 a[130:131], v94 offset:2048
ds_read_b64_tr_b16 a[132:133], v95 offset:0
ds_read_b64_tr_b16 a[134:135], v95 offset:2048
ds_read_b64_tr_b16 a[136:137], v94 offset:8192
ds_read_b64_tr_b16 a[138:139], v94 offset:10240
ds_read_b64_tr_b16 a[140:141], v95 offset:8192
ds_read_b64_tr_b16 a[142:143], v95 offset:10240
ds_read_b64_tr_b16 a[144:145], v94 offset:16384
ds_read_b64_tr_b16 a[146:147], v94 offset:18432
ds_read_b64_tr_b16 a[148:149], v95 offset:16384
ds_read_b64_tr_b16 a[150:151], v95 offset:18432
ds_read_b64_tr_b16 a[152:153], v94 offset:24576
ds_read_b64_tr_b16 a[154:155], v94 offset:26624
ds_read_b64_tr_b16 a[156:157], v95 offset:24576
ds_read_b64_tr_b16 a[158:159], v95 offset:26624
ds_read_b64_tr_b16 a[160:161], v94 offset:32768
ds_read_b64_tr_b16 a[162:163], v94 offset:34816
ds_read_b64_tr_b16 a[164:165], v95 offset:32768
ds_read_b64_tr_b16 a[166:167], v95 offset:34816
ds_read_b64_tr_b16 a[168:169], v94 offset:40960
ds_read_b64_tr_b16 a[170:171], v94 offset:43008
ds_read_b64_tr_b16 a[172:173], v95 offset:40960
ds_read_b64_tr_b16 a[174:175], v95 offset:43008
ds_read_b64_tr_b16 a[176:177], v94 offset:49152
ds_read_b64_tr_b16 a[178:179], v94 offset:51200
ds_read_b64_tr_b16 a[180:181], v95 offset:49152
ds_read_b64_tr_b16 a[182:183], v95 offset:51200
ds_read_b64_tr_b16 a[184:185], v94 offset:57344
ds_read_b64_tr_b16 a[186:187], v94 offset:59392
ds_read_b64_tr_b16 a[188:189], v95 offset:57344
ds_read_b64_tr_b16 a[190:191], v95 offset:59392
s_waitcnt lgkmcnt(0)
s_barrier
s_waitcnt vmcnt(0)
s_cmp_lg_u32 s25, 0
s_cbranch_scc1 main_kernel_v_ysk
s_mov_b32 s56, 2
s_cmp_lg_u32 s3, 0
s_cbranch_scc1 main_kernel_v_yok
main_kernel_v_ylp:
v_cmp_eq_u32 vcc, -1, v210
s_mov_b32 s57, 0x2000
v_cmp_eq_u32 s[58:59], s57, v211
s_and_b32 s58, s58, vcc_lo
s_and_b32 s58, s58, 0xff
v_readlane_b32 s56, v210, 8
s_cmp_eq_u32 s58, 0xff
s_cbranch_scc1 main_kernel_v_yfa
s_mov_b32 s57, 0
v_readlane_b32 s58, v211, 0
s_lshr_b32 s58, s58, 8
s_add_u32 s57, s57, s58
v_readlane_b32 s58, v211, 1
s_lshr_b32 s58, s58, 8
s_add_u32 s57, s57, s58
v_readlane_b32 s58, v211, 2
s_lshr_b32 s58, s58, 8
s_add_u32 s57, s57, s58
v_readlane_b32 s58, v211, 3
s_lshr_b32 s58, s58, 8
s_add_u32 s57, s57, s58
v_readlane_b32 s58, v211, 4
s_lshr_b32 s58, s58, 8
s_add_u32 s57, s57, s58
v_readlane_b32 s58, v211, 5
s_lshr_b32 s58, s58, 8
s_add_u32 s57, s57, s58
v_readlane_b32 s58, v211, 6
s_lshr_b32 s58, s58, 8
s_add_u32 s57, s57, s58
v_readlane_b32 s58, v211, 7
s_lshr_b32 s58, s58, 8
s_add_u32 s57, s57, s58
s_mov_b32 s56, 2
s_cmp_eq_u32 s57, 256
s_cbranch_scc1 main_kernel_v_yok
main_kernel_v_ylpr:
s_add_u32 s54, s54, 1
s_cmp_ge_u32 s54, 131072
s_cbranch_scc1 main_kernel_v_yok
s_sleep 4
buffer_load_dwordx2 v[210:211], v209, s[64:67], 0 offen offset:128 sc1
s_waitcnt vmcnt(0)
s_branch main_kernel_v_ylp
main_kernel_v_yfa:
s_mov_b32 s56, 1
main_kernel_v_yok:
v_mov_b32 v210, s56
v_mov_b32 v211, 131136
ds_write_b32 v211, v210
s_waitcnt lgkmcnt(0)
main_kernel_v_ysk:
s_barrier
v_mov_b32 v211, 131136
ds_read_b32 v210, v211
ds_read_b64_tr_b16 a[192:193], v96 offset:0
ds_read_b64_tr_b16 a[194:195], v96 offset:2048
ds_read_b64_tr_b16 a[196:197], v97 offset:0
ds_read_b64_tr_b16 a[198:199], v97 offset:2048
ds_read_b64_tr_b16 a[200:201], v96 offset:8192
ds_read_b64_tr_b16 a[202:203], v96 offset:10240
ds_read_b64_tr_b16 a[204:205], v97 offset:8192
ds_read_b64_tr_b16 a[206:207], v97 offset:10240
ds_read_b64_tr_b16 a[208:209], v96 offset:16384
ds_read_b64_tr_b16 a[210:211], v96 offset:18432
ds_read_b64_tr_b16 a[212:213], v97 offset:16384
ds_read_b64_tr_b16 a[214:215], v97 offset:18432
ds_read_b64_tr_b16 a[216:217], v96 offset:24576
ds_read_b64_tr_b16 a[218:219], v96 offset:26624
ds_read_b64_tr_b16 a[220:221], v97 offset:24576
ds_read_b64_tr_b16 a[222:223], v97 offset:26624
ds_read_b64_tr_b16 a[224:225], v96 offset:32768
ds_read_b64_tr_b16 a[226:227], v96 offset:34816
ds_read_b64_tr_b16 a[228:229], v97 offset:32768
ds_read_b64_tr_b16 a[230:231], v97 offset:34816
ds_read_b64_tr_b16 a[232:233], v96 offset:40960
ds_read_b64_tr_b16 a[234:235], v96 offset:43008
ds_read_b64_tr_b16 a[236:237], v97 offset:40960
ds_read_b64_tr_b16 a[238:239], v97 offset:43008
ds_read_b64_tr_b16 a[240:241], v96 offset:49152
ds_read_b64_tr_b16 a[242:243], v96 offset:51200
ds_read_b64_tr_b16 a[244:245], v97 offset:49152
ds_read_b64_tr_b16 a[246:247], v97 offset:51200
ds_read_b64_tr_b16 a[248:249], v96 offset:57344
ds_read_b64_tr_b16 a[250:251], v96 offset:59392
ds_read_b64_tr_b16 a[252:253], v97 offset:57344
ds_read_b64_tr_b16 a[254:255], v97 offset:59392
s_waitcnt lgkmcnt(0)
s_barrier
v_readfirstlane_b32 s6, v210
s_and_b32 s56, s6, 3
s_sub_u32 s56, s56, s3
s_cmp_eq_u32 s56, 2
s_cbranch_scc1 main_kernel_again
s_mov_b32 s21, 0x40000000
s_mov_b32 s39, 0
s_mov_b32 s36, 0
s_add_u32 s12, s76, s74
s_addc_u32 s13, s77, 0
s_sub_u32 s14, 0x800000, s74
s_mov_b32 s15, 0x00020000
s_mov_b32 s68, 0
s_mov_b32 s75, 524288
v_lshrrev_b32 v2, 4, v1
v_lshlrev_b32 v3, 2, v2
v_and_b32 v4, 15, v1
v_xor_b32 v4, v4, v3
s_lshl_b32 s26, s25, 4
v_add_u32 v2, s26, v2
v_mul_u32_u24 v2, 8192, v2
v_lshl_add_u32 v200, v4, 4, v2
v_xor_b32 v2, 16, v200
v_add_u32 v201, 31744, v2
v_add_u32 v202, 63488, v200
v_add_u32 v203, 95232, v2
s_mov_b32 s20, s52
s_mov_b32 s36, 0
s_lshr_b32 s24, s37, 1
s_sub_u32 s24, s24, 2
s_mov_b32 m0, s22
s_nop 0
buffer_load_dwordx4 v8, s[8:11], s20 offen sc1 lds
s_add_u32 s36, s36, 1
buffer_load_dwordx4 v8, s[8:11], s20 offen offset:1024 sc1 lds
buffer_load_dwordx4 v8, s[8:11], s20 offen offset:2048 sc1 lds
buffer_load_dwordx4 v8, s[8:11], s20 offen offset:3072 sc1 lds
s_add_u32 s20, s20, s23
s_add_u32 m0, s22, 16384
s_nop 0
buffer_load_dwordx4 v8, s[8:11], s20 offen sc1 lds
buffer_load_dwordx4 v8, s[8:11], s20 offen offset:1024 sc1 lds
buffer_load_dwordx4 v8, s[8:11], s20 offen offset:2048 sc1 lds
buffer_load_dword v2, v11, s[8:11], 0 offen
buffer_load_dwordx4 v8, s[8:11], s20 offen offset:3072 sc1 lds
s_add_u32 s20, s20, s23
s_add_u32 m0, s22, 32768
buffer_load_dword v2, v11, s[8:11], 0 offen
buffer_load_dwordx4 v8, s[8:11], s20 offen sc1 lds
buffer_load_dwordx4 v8, s[8:11], s20 offen offset:1024 sc1 lds
buffer_load_dwordx4 v8, s[8:11], s20 offen offset:2048 sc1 lds
buffer_load_dwordx4 v8, s[8:11], s20 offen offset:3072 sc1 lds
s_add_u32 s20, s20, s23
s_add_u32 m0, s22, 49152
s_nop 0
buffer_load_dwordx4 v8, s[8:11], s20 offen sc1 lds
buffer_load_dwordx4 v8, s[8:11], s20 offen offset:1024 sc1 lds
buffer_load_dwordx4 v8, s[8:11], s20 offen offset:2048 sc1 lds
buffer_load_dwordx4 v8, s[8:11], s20 offen offset:3072 sc1 lds
s_add_u32 s20, s20, s28
s_add_u32 m0, s22, 65536
s_cmp_lt_u32 s36, s37
s_cselect_b32 s20, s20, 0x40000000
buffer_load_dword v2, v11, s[8:11], 0 offen
buffer_load_dwordx4 v8, s[8:11], s20 offen sc1 lds
s_add_u32 s36, s36, 1
buffer_load_dwordx4 v8, s[8:11], s20 offen offset:1024 sc1 lds
buffer_load_dwordx4 v8, s[8:11], s20 offen offset:2048 sc1 lds
buffer_load_dwordx4 v8, s[8:11], s20 offen offset:3072 sc1 lds
s_add_u32 s20, s20, s23
s_add_u32 m0, s22, 81920
s_nop 0
buffer_load_dwordx4 v8, s[8:11], s20 offen sc1 lds
buffer_load_dwordx4 v8, s[8:11], s20 offen offset:1024 sc1 lds
s_waitcnt vmcnt(16)
s_barrier
ds_read_b128 v[12:15], v6 offset:0
ds_read_b128 v[16:19], v6 offset:256
ds_read_b128 v[20:23], v6 offset:2048
ds_read_b128 v[24:27], v6 offset:2304
ds_read_b128 v[28:31], v6 offset:4096
ds_read_b128 v[32:35], v6 offset:4352
s_waitcnt lgkmcnt(0)
.p2align 3
main_kernel_vj_lp:
v_mfma_f32_16x16x32_bf16 v[44:47], v[12:15], a[0:3], 0
ds_read_b128 v[36:39], v6 offset:6144
v_mfma_f32_16x16x32_bf16 v[48:51], v[16:19], a[0:3], 0
ds_read_b128 v[40:43], v6 offset:6400
v_cvt_pk_bf16_f32 v84, v60, v61
v_mfma_f32_16x16x32_bf16 v[56:59], v[16:19], a[4:7], 0
v_cvt_pk_bf16_f32 v85, v62, v63
v_mfma_f32_16x16x32_bf16 v[52:55], v[12:15], a[4:7], 0
s_waitcnt lgkmcnt(4)
v_cvt_pk_bf16_f32 v86, v64, v65
v_mfma_f32_16x16x32_bf16 v[44:47], v[20:23], a[8:11], v[44:47]
ds_read_b128 v[12:15], v6 offset:8192
v_cvt_pk_bf16_f32 v87, v66, v67
v_mfma_f32_16x16x32_bf16 v[48:51], v[24:27], a[8:11], v[48:51]
ds_read_b128 v[16:19], v6 offset:8448
v_cvt_pk_bf16_f32 v88, v68, v69
v_mfma_f32_16x16x32_bf16 v[56:59], v[24:27], a[12:15], v[56:59]
buffer_load_dwordx4 v8, s[8:11], s20 offen offset:2048 sc1 lds
v_cvt_pk_bf16_f32 v89, v70, v71
v_mfma_f32_16x16x32_bf16 v[52:55], v[20:23], a[12:15], v[52:55]
s_waitcnt lgkmcnt(4)
v_cvt_pk_bf16_f32 v90, v72, v73
v_mfma_f32_16x16x32_bf16 v[44:47], v[28:31], a[16:19], v[44:47]
ds_read_b128 v[20:23], v6 offset:10240
v_cvt_pk_bf16_f32 v91, v74, v75
v_mfma_f32_16x16x32_bf16 v[48:51], v[32:35], a[16:19], v[48:51]
ds_read_b128 v[24:27], v6 offset:10496
v_mfma_f32_16x16x32_bf16 v[56:59], v[32:35], a[20:23], v[56:59]
buffer_store_dwordx4 v[84:87], v9, s[8:11], s21 offen sc1
v_mfma_f32_16x16x32_bf16 v[52:55], v[28:31], a[20:23], v[52:55]
s_waitcnt lgkmcnt(4)
v_mfma_f32_16x16x32_bf16 v[44:47], v[36:39], a[24:27], v[44:47]
ds_read_b128 v[28:31], v6 offset:12288
v_mfma_f32_16x16x32_bf16 v[48:51], v[40:43], a[24:27], v[48:51]
ds_read_b128 v[32:35], v6 offset:12544
v_mfma_f32_16x16x32_bf16 v[56:59], v[40:43], a[28:31], v[56:59]
buffer_load_dwordx4 v8, s[8:11], s20 offen offset:3072 sc1 lds
v_mfma_f32_16x16x32_bf16 v[52:55], v[36:39], a[28:31], v[52:55]
s_waitcnt lgkmcnt(4)
s_add_u32 s20, s20, s23
s_add_u32 m0, s22, 98304
v_mfma_f32_16x16x32_bf16 v[44:47], v[12:15], a[32:35], v[44:47]
ds_read_b128 v[36:39], v6 offset:14336
v_mfma_f32_16x16x32_bf16 v[48:51], v[16:19], a[32:35], v[48:51]
ds_read_b128 v[40:43], v6 offset:14592
v_mfma_f32_16x16x32_bf16 v[56:59], v[16:19], a[36:39], v[56:59]
buffer_store_dwordx4 v[88:91], v9, s[8:11], s21 offen offset:256 sc1
s_mov_b32 s21, s31
v_mfma_f32_16x16x32_bf16 v[52:55], v[12:15], a[36:39], v[52:55]
s_waitcnt lgkmcnt(4)
s_add_u32 s31, s31, s29
v_mfma_f32_16x16x32_bf16 v[44:47], v[20:23], a[40:43], v[44:47]
ds_read_b128 v[12:15], v6 offset:16384
v_mfma_f32_16x16x32_bf16 v[48:51], v[24:27], a[40:43], v[48:51]
ds_read_b128 v[16:19], v6 offset:16640
v_mfma_f32_16x16x32_bf16 v[56:59], v[24:27], a[44:47], v[56:59]
buffer_load_dwordx4 v8, s[8:11], s20 offen sc1 lds
v_mfma_f32_16x16x32_bf16 v[52:55], v[20:23], a[44:47], v[52:55]
s_waitcnt lgkmcnt(4)
v_mfma_f32_16x16x32_bf16 v[44:47], v[28:31], a[48:51], v[44:47]
ds_read_b128 v[20:23], v6 offset:18432
v_mfma_f32_16x16x32_bf16 v[48:51], v[32:35], a[48:51], v[48:51]
ds_read_b128 v[24:27], v6 offset:18688
v_mfma_f32_16x16x32_bf16 v[56:59], v[32:35], a[52:55], v[56:59]
v_mfma_f32_16x16x32_bf16 v[52:55], v[28:31], a[52:55], v[52:55]
s_waitcnt lgkmcnt(4)
v_mfma_f32_16x16x32_bf16 v[44:47], v[36:39], a[56:59], v[44:47]
ds_read_b128 v[28:31], v6 offset:20480
v_mfma_f32_16x16x32_bf16 v[48:51], v[40:43], a[56:59], v[48:51]
ds_read_b128 v[32:35], v6 offset:20736
v_mfma_f32_16x16x32_bf16 v[56:59], v[40:43], a[60:63], v[56:59]
buffer_load_dwordx4 v8, s[8:11], s20 offen offset:1024 sc1 lds
v_mfma_f32_16x16x32_bf16 v[52:55], v[36:39], a[60:63], v[52:55]
s_waitcnt lgkmcnt(4)
v_mfma_f32_16x16x32_bf16 v[44:47], v[12:15], a[64:67], v[44:47]
ds_read_b128 v[36:39], v6 offset:22528
v_mfma_f32_16x16x32_bf16 v[48:51], v[16:19], a[64:67], v[48:51]
ds_read_b128 v[40:43], v6 offset:22784
v_mfma_f32_16x16x32_bf16 v[56:59], v[16:19], a[68:71], v[56:59]
v_mfma_f32_16x16x32_bf16 v[52:55], v[12:15], a[68:71], v[52:55]
s_waitcnt lgkmcnt(4)
v_mfma_f32_16x16x32_bf16 v[44:47], v[20:23], a[72:75], v[44:47]
ds_read_b128 v[12:15], v6 offset:24576
v_mfma_f32_16x16x32_bf16 v[48:51], v[24:27], a[72:75], v[48:51]
ds_read_b128 v[16:19], v6 offset:24832
v_mfma_f32_16x16x32_bf16 v[56:59], v[24:27], a[76:79], v[56:59]
buffer_load_dwordx4 v8, s[8:11], s20 offen offset:2048 sc1 lds
v_mfma_f32_16x16x32_bf16 v[52:55], v[20:23], a[76:79], v[52:55]
s_waitcnt lgkmcnt(4)
v_mfma_f32_16x16x32_bf16 v[44:47], v[28:31], a[80:83], v[44:47]
ds_read_b128 v[20:23], v6 offset:26624
v_mfma_f32_16x16x32_bf16 v[48:51], v[32:35], a[80:83], v[48:51]
ds_read_b128 v[24:27], v6 offset:26880
v_mfma_f32_16x16x32_bf16 v[56:59], v[32:35], a[84:87], v[56:59]
v_mfma_f32_16x16x32_bf16 v[52:55], v[28:31], a[84:87], v[52:55]
s_waitcnt lgkmcnt(4)
v_mfma_f32_16x16x32_bf16 v[44:47], v[36:39], a[88:91], v[44:47]
ds_read_b128 v[28:31], v6 offset:28672
v_mfma_f32_16x16x32_bf16 v[48:51], v[40:43], a[88:91], v[48:51]
ds_read_b128 v[32:35], v6 offset:28928
v_mfma_f32_16x16x32_bf16 v[56:59], v[40:43], a[92:95], v[56:59]
buffer_load_dwordx4 v8, s[8:11], s20 offen offset:3072 sc1 lds
v_mfma_f32_16x16x32_bf16 v[52:55], v[36:39], a[92:95], v[52:55]
s_waitcnt lgkmcnt(4)
s_add_u32 s20, s20, s23
s_add_u32 m0, s22, 114688
v_mfma_f32_16x16x32_bf16 v[44:47], v[12:15], a[96:99], v[44:47]
ds_read_b128 v[36:39], v6 offset:30720
v_mfma_f32_16x16x32_bf16 v[48:51], v[16:19], a[96:99], v[48:51]
ds_read_b128 v[40:43], v6 offset:30976
v_mfma_f32_16x16x32_bf16 v[56:59], v[16:19], a[100:103], v[56:59]
v_mfma_f32_16x16x32_bf16 v[52:55], v[12:15], a[100:103], v[52:55]
s_waitcnt lgkmcnt(4)
v_mfma_f32_16x16x32_bf16 v[44:47], v[20:23], a[104:107], v[44:47]
s_waitcnt vmcnt(15)
s_barrier
ds_read_b128 v[12:15], v6 offset:32768
v_mfma_f32_16x16x32_bf16 v[48:51], v[24:27], a[104:107], v[48:51]
ds_read_b128 v[16:19], v6 offset:33024
v_mfma_f32_16x16x32_bf16 v[56:59], v[24:27], a[108:111], v[56:59]
buffer_load_dwordx4 v8, s[8:11], s20 offen sc1 lds
v_mfma_f32_16x16x32_bf16 v[52:55], v[20:23], a[108:111], v[52:55]
s_waitcnt lgkmcnt(4)
v_mfma_f32_16x16x32_bf16 v[44:47], v[28:31], a[112:115], v[44:47]
ds_read_b128 v[20:23], v6 offset:34816
v_mfma_f32_16x16x32_bf16 v[48:51], v[32:35], a[112:115], v[48:51]
ds_read_b128 v[24:27], v6 offset:35072
v_mfma_f32_16x16x32_bf16 v[56:59], v[32:35], a[116:119], v[56:59]
v_mfma_f32_16x16x32_bf16 v[52:55], v[28:31], a[116:119], v[52:55]
s_waitcnt lgkmcnt(4)
v_mfma_f32_16x16x32_bf16 v[44:47], v[36:39], a[120:123], v[44:47]
ds_read_b128 v[28:31], v6 offset:36864
v_mfma_f32_16x16x32_bf16 v[48:51], v[40:43], a[120:123], v[48:51]
ds_read_b128 v[32:35], v6 offset:37120
v_mfma_f32_16x16x32_bf16 v[56:59], v[40:43], a[124:127], v[56:59]
buffer_load_dwordx4 v8, s[8:11], s20 offen offset:1024 sc1 lds
v_mfma_f32_16x16x32_bf16 v[52:55], v[36:39], a[124:127], v[52:55]
s_waitcnt lgkmcnt(4)
v_mfma_f32_16x16x32_bf16 v[44:47], v[12:15], a[128:131], v[44:47]
ds_read_b128 v[36:39], v6 offset:38912
v_mfma_f32_16x16x32_bf16 v[48:51], v[16:19], a[128:131], v[48:51]
ds_read_b128 v[40:43], v6 offset:39168
v_mfma_f32_16x16x32_bf16 v[56:59], v[16:19], a[132:135], v[56:59]
v_mfma_f32_16x16x32_bf16 v[52:55], v[12:15], a[132:135], v[52:55]
s_waitcnt lgkmcnt(4)
v_mfma_f32_16x16x32_bf16 v[44:47], v[20:23], a[136:139], v[44:47]
ds_read_b128 v[12:15], v6 offset:40960
v_mfma_f32_16x16x32_bf16 v[48:51], v[24:27], a[136:139], v[48:51]
ds_read_b128 v[16:19], v6 offset:41216
v_mfma_f32_16x16x32_bf16 v[56:59], v[24:27], a[140:143], v[56:59]
buffer_load_dwordx4 v8, s[8:11], s20 offen offset:2048 sc1 lds
v_mfma_f32_16x16x32_bf16 v[52:55], v[20:23], a[140:143], v[52:55]
s_waitcnt lgkmcnt(4)
v_mfma_f32_16x16x32_bf16 v[44:47], v[28:31], a[144:147], v[44:47]
ds_read_b128 v[20:23], v6 offset:43008
v_mfma_f32_16x16x32_bf16 v[48:51], v[32:35], a[144:147], v[48:51]
ds_read_b128 v[24:27], v6 offset:43264
v_mfma_f32_16x16x32_bf16 v[56:59], v[32:35], a[148:151], v[56:59]
v_mfma_f32_16x16x32_bf16 v[52:55], v[28:31], a[148:151], v[52:55]
s_waitcnt lgkmcnt(4)
v_mfma_f32_16x16x32_bf16 v[44:47], v[36:39], a[152:155], v[44:47]
ds_read_b128 v[28:31], v6 offset:45056
v_mfma_f32_16x16x32_bf16 v[48:51], v[40:43], a[152:155], v[48:51]
ds_read_b128 v[32:35], v6 offset:45312
v_mfma_f32_16x16x32_bf16 v[56:59], v[40:43], a[156:159], v[56:59]
buffer_load_dwordx4 v8, s[8:11], s20 offen offset:3072 sc1 lds
v_mfma_f32_16x16x32_bf16 v[52:55], v[36:39], a[156:159], v[52:55]
s_waitcnt lgkmcnt(4)
s_add_u32 s20, s20, s28
s_add_u32 m0, s22, 0
v_mfma_f32_16x16x32_bf16 v[44:47], v[12:15], a[160:163], v[44:47]
s_cmp_lt_u32 s36, s37
ds_read_b128 v[36:39], v6 offset:47104
s_cselect_b32 s20, s20, 0x40000000
v_mfma_f32_16x16x32_bf16 v[48:51], v[16:19], a[160:163], v[48:51]
s_waitcnt vmcnt(8)
ds_read_b128 v[40:43], v6 offset:47360
s_max_i32 s27, s39, 0
v_mfma_f32_16x16x32_bf16 v[56:59], v[16:19], a[164:167], v[56:59]
s_add_u32 s39, s39, 1
v_mov_b32 v112, s27
v_mfma_f32_16x16x32_bf16 v[52:55], v[12:15], a[164:167], v[52:55]
s_waitcnt lgkmcnt(4)
v_mfma_f32_16x16x32_bf16 v[44:47], v[20:23], a[168:171], v[44:47]
buffer_store_dword v112, v108, s[8:11], 0 offen sc1
ds_read_b128 v[12:15], v6 offset:49152
v_mfma_f32_16x16x32_bf16 v[48:51], v[24:27], a[168:171], v[48:51]
ds_read_b128 v[16:19], v6 offset:49408
v_mfma_f32_16x16x32_bf16 v[56:59], v[24:27], a[172:175], v[56:59]
buffer_load_dwordx4 v8, s[8:11], s20 offen sc1 lds
v_mfma_f32_16x16x32_bf16 v[52:55], v[20:23], a[172:175], v[52:55]
s_waitcnt lgkmcnt(4)
s_add_u32 s36, s36, 1
v_mfma_f32_16x16x32_bf16 v[44:47], v[28:31], a[176:179], v[44:47]
ds_read_b128 v[20:23], v6 offset:51200
v_mfma_f32_16x16x32_bf16 v[48:51], v[32:35], a[176:179], v[48:51]
ds_read_b128 v[24:27], v6 offset:51456
v_mfma_f32_16x16x32_bf16 v[56:59], v[32:35], a[180:183], v[56:59]
v_mfma_f32_16x16x32_bf16 v[52:55], v[28:31], a[180:183], v[52:55]
s_waitcnt lgkmcnt(4)
v_mfma_f32_16x16x32_bf16 v[44:47], v[36:39], a[184:187], v[44:47]
ds_read_b128 v[28:31], v6 offset:53248
v_mfma_f32_16x16x32_bf16 v[48:51], v[40:43], a[184:187], v[48:51]
ds_read_b128 v[32:35], v6 offset:53504
v_mfma_f32_16x16x32_bf16 v[56:59], v[40:43], a[188:191], v[56:59]
buffer_load_dwordx4 v8, s[8:11], s20 offen offset:1024 sc1 lds
v_mfma_f32_16x16x32_bf16 v[52:55], v[36:39], a[188:191], v[52:55]
s_waitcnt lgkmcnt(4)
v_mfma_f32_16x16x32_bf16 v[44:47], v[12:15], a[192:195], v[44:47]
ds_read_b128 v[36:39], v6 offset:55296
v_mfma_f32_16x16x32_bf16 v[48:51], v[16:19], a[192:195], v[48:51]
ds_read_b128 v[40:43], v6 offset:55552
v_mfma_f32_16x16x32_bf16 v[56:59], v[16:19], a[196:199], v[56:59]
v_mfma_f32_16x16x32_bf16 v[52:55], v[12:15], a[196:199], v[52:55]
s_waitcnt lgkmcnt(4)
v_mfma_f32_16x16x32_bf16 v[44:47], v[20:23], a[200:203], v[44:47]
ds_read_b128 v[12:15], v6 offset:57344
v_mfma_f32_16x16x32_bf16 v[48:51], v[24:27], a[200:203], v[48:51]
ds_read_b128 v[16:19], v6 offset:57600
v_mfma_f32_16x16x32_bf16 v[56:59], v[24:27], a[204:207], v[56:59]
buffer_load_dwordx4 v8, s[8:11], s20 offen offset:2048 sc1 lds
v_mfma_f32_16x16x32_bf16 v[52:55], v[20:23], a[204:207], v[52:55]
s_waitcnt lgkmcnt(4)
v_mfma_f32_16x16x32_bf16 v[44:47], v[28:31], a[208:211], v[44:47]
ds_read_b128 v[20:23], v6 offset:59392
v_mfma_f32_16x16x32_bf16 v[48:51], v[32:35], a[208:211], v[48:51]
ds_read_b128 v[24:27], v6 offset:59648
v_mfma_f32_16x16x32_bf16 v[56:59], v[32:35], a[212:215], v[56:59]
v_mfma_f32_16x16x32_bf16 v[52:55], v[28:31], a[212:215], v[52:55]
s_waitcnt lgkmcnt(4)
v_mfma_f32_16x16x32_bf16 v[44:47], v[36:39], a[216:219], v[44:47]
ds_read_b128 v[28:31], v6 offset:61440
v_mfma_f32_16x16x32_bf16 v[48:51], v[40:43], a[216:219], v[48:51]
ds_read_b128 v[32:35], v6 offset:61696
v_mfma_f32_16x16x32_bf16 v[56:59], v[40:43], a[220:223], v[56:59]
buffer_load_dwordx4 v8, s[8:11], s20 offen offset:3072 sc1 lds
v_mfma_f32_16x16x32_bf16 v[52:55], v[36:39], a[220:223], v[52:55]
s_waitcnt lgkmcnt(4)
s_add_u32 s20, s20, s23
s_add_u32 m0, s22, 16384
v_mfma_f32_16x16x32_bf16 v[44:47], v[12:15], a[224:227], v[44:47]
ds_read_b128 v[36:39], v6 offset:63488
v_mfma_f32_16x16x32_bf16 v[48:51], v[16:19], a[224:227], v[48:51]
ds_read_b128 v[40:43], v6 offset:63744
v_mfma_f32_16x16x32_bf16 v[56:59], v[16:19], a[228:231], v[56:59]
v_mfma_f32_16x16x32_bf16 v[52:55], v[12:15], a[228:231], v[52:55]
s_waitcnt lgkmcnt(4)
v_mfma_f32_16x16x32_bf16 v[44:47], v[20:23], a[232:235], v[44:47]
s_waitcnt vmcnt(14)
s_barrier
ds_read_b128 v[12:15], v7 offset:0
v_mfma_f32_16x16x32_bf16 v[48:51], v[24:27], a[232:235], v[48:51]
ds_read_b128 v[16:19], v7 offset:256
v_mfma_f32_16x16x32_bf16 v[56:59], v[24:27], a[236:239], v[56:59]
buffer_load_dwordx4 v8, s[8:11], s20 offen sc1 lds
v_mfma_f32_16x16x32_bf16 v[52:55], v[20:23], a[236:239], v[52:55]
s_waitcnt lgkmcnt(4)
v_mfma_f32_16x16x32_bf16 v[44:47], v[28:31], a[240:243], v[44:47]
ds_read_b128 v[20:23], v7 offset:2048
v_mfma_f32_16x16x32_bf16 v[48:51], v[32:35], a[240:243], v[48:51]
ds_read_b128 v[24:27], v7 offset:2304
v_mfma_f32_16x16x32_bf16 v[56:59], v[32:35], a[244:247], v[56:59]
v_mfma_f32_16x16x32_bf16 v[52:55], v[28:31], a[244:247], v[52:55]
s_waitcnt lgkmcnt(4)
v_mfma_f32_16x16x32_bf16 v[44:47], v[36:39], a[248:251], v[44:47]
ds_read_b128 v[28:31], v7 offset:4096
v_mfma_f32_16x16x32_bf16 v[48:51], v[40:43], a[248:251], v[48:51]
ds_read_b128 v[32:35], v7 offset:4352
v_mfma_f32_16x16x32_bf16 v[56:59], v[40:43], a[252:255], v[56:59]
buffer_load_dwordx4 v8, s[8:11], s20 offen offset:1024 sc1 lds
v_mfma_f32_16x16x32_bf16 v[52:55], v[36:39], a[252:255], v[52:55]
s_waitcnt lgkmcnt(4)
v_mfma_f32_16x16x32_bf16 v[60:63], v[12:15], a[0:3], 0
ds_read_b128 v[36:39], v7 offset:6144
v_mfma_f32_16x16x32_bf16 v[64:67], v[16:19], a[0:3], 0
ds_read_b128 v[40:43], v7 offset:6400
v_cvt_pk_bf16_f32 v84, v44, v45
v_mfma_f32_16x16x32_bf16 v[72:75], v[16:19], a[4:7], 0
v_cvt_pk_bf16_f32 v85, v46, v47
v_mfma_f32_16x16x32_bf16 v[68:71], v[12:15], a[4:7], 0
s_waitcnt lgkmcnt(4)
v_cvt_pk_bf16_f32 v86, v48, v49
v_mfma_f32_16x16x32_bf16 v[60:63], v[20:23], a[8:11], v[60:63]
ds_read_b128 v[12:15], v7 offset:8192
v_cvt_pk_bf16_f32 v87, v50, v51
v_mfma_f32_16x16x32_bf16 v[64:67], v[24:27], a[8:11], v[64:67]
ds_read_b128 v[16:19], v7 offset:8448
v_cvt_pk_bf16_f32 v88, v52, v53
v_mfma_f32_16x16x32_bf16 v[72:75], v[24:27], a[12:15], v[72:75]
buffer_load_dwordx4 v8, s[8:11], s20 offen offset:2048 sc1 lds
v_cvt_pk_bf16_f32 v89, v54, v55
v_mfma_f32_16x16x32_bf16 v[68:71], v[20:23], a[12:15], v[68:71]
s_waitcnt lgkmcnt(4)
v_cvt_pk_bf16_f32 v90, v56, v57
v_mfma_f32_16x16x32_bf16 v[60:63], v[28:31], a[16:19], v[60:63]
ds_read_b128 v[20:23], v7 offset:10240
v_cvt_pk_bf16_f32 v91, v58, v59
v_mfma_f32_16x16x32_bf16 v[64:67], v[32:35], a[16:19], v[64:67]
ds_read_b128 v[24:27], v7 offset:10496
v_mfma_f32_16x16x32_bf16 v[72:75], v[32:35], a[20:23], v[72:75]
buffer_store_dwordx4 v[84:87], v9, s[8:11], s21 offen sc1
v_mfma_f32_16x16x32_bf16 v[68:71], v[28:31], a[20:23], v[68:71]
s_waitcnt lgkmcnt(4)
v_mfma_f32_16x16x32_bf16 v[60:63], v[36:39], a[24:27], v[60:63]
ds_read_b128 v[28:31], v7 offset:12288
v_mfma_f32_16x16x32_bf16 v[64:67], v[40:43], a[24:27], v[64:67]
ds_read_b128 v[32:35], v7 offset:12544
v_mfma_f32_16x16x32_bf16 v[72:75], v[40:43], a[28:31], v[72:75]
buffer_load_dwordx4 v8, s[8:11], s20 offen offset:3072 sc1 lds
v_mfma_f32_16x16x32_bf16 v[68:71], v[36:39], a[28:31], v[68:71]
s_waitcnt lgkmcnt(4)
s_add_u32 s20, s20, s23
s_add_u32 m0, s22, 32768
v_mfma_f32_16x16x32_bf16 v[60:63], v[12:15], a[32:35], v[60:63]
ds_read_b128 v[36:39], v7 offset:14336
v_mfma_f32_16x16x32_bf16 v[64:67], v[16:19], a[32:35], v[64:67]
ds_read_b128 v[40:43], v7 offset:14592
v_mfma_f32_16x16x32_bf16 v[72:75], v[16:19], a[36:39], v[72:75]
buffer_store_dwordx4 v[88:91], v9, s[8:11], s21 offen offset:256 sc1
s_mov_b32 s21, s31
v_mfma_f32_16x16x32_bf16 v[68:71], v[12:15], a[36:39], v[68:71]
s_waitcnt lgkmcnt(4)
s_add_u32 s31, s31, s29
v_mfma_f32_16x16x32_bf16 v[60:63], v[20:23], a[40:43], v[60:63]
ds_read_b128 v[12:15], v7 offset:16384
v_mfma_f32_16x16x32_bf16 v[64:67], v[24:27], a[40:43], v[64:67]
ds_read_b128 v[16:19], v7 offset:16640
v_mfma_f32_16x16x32_bf16 v[72:75], v[24:27], a[44:47], v[72:75]
buffer_load_dwordx4 v8, s[8:11], s20 offen sc1 lds
v_mfma_f32_16x16x32_bf16 v[68:71], v[20:23], a[44:47], v[68:71]
s_waitcnt lgkmcnt(4)
v_mfma_f32_16x16x32_bf16 v[60:63], v[28:31], a[48:51], v[60:63]
ds_read_b128 v[20:23], v7 offset:18432
v_mfma_f32_16x16x32_bf16 v[64:67], v[32:35], a[48:51], v[64:67]
ds_read_b128 v[24:27], v7 offset:18688
v_mfma_f32_16x16x32_bf16 v[72:75], v[32:35], a[52:55], v[72:75]
v_mfma_f32_16x16x32_bf16 v[68:71], v[28:31], a[52:55], v[68:71]
s_waitcnt lgkmcnt(4)
v_mfma_f32_16x16x32_bf16 v[60:63], v[36:39], a[56:59], v[60:63]
ds_read_b128 v[28:31], v7 offset:20480
v_mfma_f32_16x16x32_bf16 v[64:67], v[40:43], a[56:59], v[64:67]
ds_read_b128 v[32:35], v7 offset:20736
v_mfma_f32_16x16x32_bf16 v[72:75], v[40:43], a[60:63], v[72:75]
buffer_load_dwordx4 v8, s[8:11], s20 offen offset:1024 sc1 lds
v_mfma_f32_16x16x32_bf16 v[68:71], v[36:39], a[60:63], v[68:71]
s_waitcnt lgkmcnt(4)
v_mfma_f32_16x16x32_bf16 v[60:63], v[12:15], a[64:67], v[60:63]
ds_read_b128 v[36:39], v7 offset:22528
v_mfma_f32_16x16x32_bf16 v[64:67], v[16:19], a[64:67], v[64:67]
ds_read_b128 v[40:43], v7 offset:22784
v_mfma_f32_16x16x32_bf16 v[72:75], v[16:19], a[68:71], v[72:75]
v_mfma_f32_16x16x32_bf16 v[68:71], v[12:15], a[68:71], v[68:71]
s_waitcnt lgkmcnt(4)
v_mfma_f32_16x16x32_bf16 v[60:63], v[20:23], a[72:75], v[60:63]
ds_read_b128 v[12:15], v7 offset:24576
v_mfma_f32_16x16x32_bf16 v[64:67], v[24:27], a[72:75], v[64:67]
ds_read_b128 v[16:19], v7 offset:24832
v_mfma_f32_16x16x32_bf16 v[72:75], v[24:27], a[76:79], v[72:75]
buffer_load_dwordx4 v8, s[8:11], s20 offen offset:2048 sc1 lds
v_mfma_f32_16x16x32_bf16 v[68:71], v[20:23], a[76:79], v[68:71]
s_waitcnt lgkmcnt(4)
v_mfma_f32_16x16x32_bf16 v[60:63], v[28:31], a[80:83], v[60:63]
ds_read_b128 v[20:23], v7 offset:26624
v_mfma_f32_16x16x32_bf16 v[64:67], v[32:35], a[80:83], v[64:67]
ds_read_b128 v[24:27], v7 offset:26880
v_mfma_f32_16x16x32_bf16 v[72:75], v[32:35], a[84:87], v[72:75]
v_mfma_f32_16x16x32_bf16 v[68:71], v[28:31], a[84:87], v[68:71]
s_waitcnt lgkmcnt(4)
v_mfma_f32_16x16x32_bf16 v[60:63], v[36:39], a[88:91], v[60:63]
ds_read_b128 v[28:31], v7 offset:28672
v_mfma_f32_16x16x32_bf16 v[64:67], v[40:43], a[88:91], v[64:67]
ds_read_b128 v[32:35], v7 offset:28928
v_mfma_f32_16x16x32_bf16 v[72:75], v[40:43], a[92:95], v[72:75]
buffer_load_dwordx4 v8, s[8:11], s20 offen offset:3072 sc1 lds
v_mfma_f32_16x16x32_bf16 v[68:71], v[36:39], a[92:95], v[68:71]
s_waitcnt lgkmcnt(4)
s_add_u32 s20, s20, s23
s_add_u32 m0, s22, 49152
v_mfma_f32_16x16x32_bf16 v[60:63], v[12:15], a[96:99], v[60:63]
ds_read_b128 v[36:39], v7 offset:30720
v_mfma_f32_16x16x32_bf16 v[64:67], v[16:19], a[96:99], v[64:67]
ds_read_b128 v[40:43], v7 offset:30976
v_mfma_f32_16x16x32_bf16 v[72:75], v[16:19], a[100:103], v[72:75]
v_mfma_f32_16x16x32_bf16 v[68:71], v[12:15], a[100:103], v[68:71]
s_waitcnt lgkmcnt(4)
v_mfma_f32_16x16x32_bf16 v[60:63], v[20:23], a[104:107], v[60:63]
s_waitcnt vmcnt(15)
s_barrier
ds_read_b128 v[12:15], v7 offset:32768
v_mfma_f32_16x16x32_bf16 v[64:67], v[24:27], a[104:107], v[64:67]
ds_read_b128 v[16:19], v7 offset:33024
v_mfma_f32_16x16x32_bf16 v[72:75], v[24:27], a[108:111], v[72:75]
buffer_load_dwordx4 v8, s[8:11], s20 offen sc1 lds
v_mfma_f32_16x16x32_bf16 v[68:71], v[20:23], a[108:111], v[68:71]
s_waitcnt lgkmcnt(4)
v_mfma_f32_16x16x32_bf16 v[60:63], v[28:31], a[112:115], v[60:63]
ds_read_b128 v[20:23], v7 offset:34816
v_mfma_f32_16x16x32_bf16 v[64:67], v[32:35], a[112:115], v[64:67]
ds_read_b128 v[24:27], v7 offset:35072
v_mfma_f32_16x16x32_bf16 v[72:75], v[32:35], a[116:119], v[72:75]
v_mfma_f32_16x16x32_bf16 v[68:71], v[28:31], a[116:119], v[68:71]
s_waitcnt lgkmcnt(4)
v_mfma_f32_16x16x32_bf16 v[60:63], v[36:39], a[120:123], v[60:63]
ds_read_b128 v[28:31], v7 offset:36864
v_mfma_f32_16x16x32_bf16 v[64:67], v[40:43], a[120:123], v[64:67]
ds_read_b128 v[32:35], v7 offset:37120
v_mfma_f32_16x16x32_bf16 v[72:75], v[40:43], a[124:127], v[72:75]
buffer_load_dwordx4 v8, s[8:11], s20 offen offset:1024 sc1 lds
v_mfma_f32_16x16x32_bf16 v[68:71], v[36:39], a[124:127], v[68:71]
s_waitcnt lgkmcnt(4)
v_mfma_f32_16x16x32_bf16 v[60:63], v[12:15], a[128:131], v[60:63]
ds_read_b128 v[36:39], v7 offset:38912
v_mfma_f32_16x16x32_bf16 v[64:67], v[16:19], a[128:131], v[64:67]
ds_read_b128 v[40:43], v7 offset:39168
v_mfma_f32_16x16x32_bf16 v[72:75], v[16:19], a[132:135], v[72:75]
v_mfma_f32_16x16x32_bf16 v[68:71], v[12:15], a[132:135], v[68:71]
s_waitcnt lgkmcnt(4)
v_mfma_f32_16x16x32_bf16 v[60:63], v[20:23], a[136:139], v[60:63]
ds_read_b128 v[12:15], v7 offset:40960
v_mfma_f32_16x16x32_bf16 v[64:67], v[24:27], a[136:139], v[64:67]
ds_read_b128 v[16:19], v7 offset:41216
v_mfma_f32_16x16x32_bf16 v[72:75], v[24:27], a[140:143], v[72:75]
buffer_load_dwordx4 v8, s[8:11], s20 offen offset:2048 sc1 lds
v_mfma_f32_16x16x32_bf16 v[68:71], v[20:23], a[140:143], v[68:71]
s_waitcnt lgkmcnt(4)
v_mfma_f32_16x16x32_bf16 v[60:63], v[28:31], a[144:147], v[60:63]
ds_read_b128 v[20:23], v7 offset:43008
v_mfma_f32_16x16x32_bf16 v[64:67], v[32:35], a[144:147], v[64:67]
ds_read_b128 v[24:27], v7 offset:43264
v_mfma_f32_16x16x32_bf16 v[72:75], v[32:35], a[148:151], v[72:75]
v_mfma_f32_16x16x32_bf16 v[68:71], v[28:31], a[148:151], v[68:71]
s_waitcnt lgkmcnt(4)
v_mfma_f32_16x16x32_bf16 v[60:63], v[36:39], a[152:155], v[60:63]
ds_read_b128 v[28:31], v7 offset:45056
v_mfma_f32_16x16x32_bf16 v[64:67], v[40:43], a[152:155], v[64:67]
ds_read_b128 v[32:35], v7 offset:45312
v_mfma_f32_16x16x32_bf16 v[72:75], v[40:43], a[156:159], v[72:75]
buffer_load_dwordx4 v8, s[8:11], s20 offen offset:3072 sc1 lds
v_mfma_f32_16x16x32_bf16 v[68:71], v[36:39], a[156:159], v[68:71]
s_waitcnt lgkmcnt(4)
s_add_u32 s20, s20, s28
s_add_u32 m0, s22, 65536
v_mfma_f32_16x16x32_bf16 v[60:63], v[12:15], a[160:163], v[60:63]
s_cmp_lt_u32 s36, s37
ds_read_b128 v[36:39], v7 offset:47104
s_cselect_b32 s20, s20, 0x40000000
v_mfma_f32_16x16x32_bf16 v[64:67], v[16:19], a[160:163], v[64:67]
s_waitcnt vmcnt(8)
ds_read_b128 v[40:43], v7 offset:47360
s_max_i32 s27, s39, 0
v_mfma_f32_16x16x32_bf16 v[72:75], v[16:19], a[164:167], v[72:75]
s_add_u32 s39, s39, 1
v_mov_b32 v112, s27
v_mfma_f32_16x16x32_bf16 v[68:71], v[12:15], a[164:167], v[68:71]
s_waitcnt lgkmcnt(4)
v_mfma_f32_16x16x32_bf16 v[60:63], v[20:23], a[168:171], v[60:63]
buffer_store_dword v112, v108, s[8:11], 0 offen sc1
ds_read_b128 v[12:15], v7 offset:49152
v_mfma_f32_16x16x32_bf16 v[64:67], v[24:27], a[168:171], v[64:67]
ds_read_b128 v[16:19], v7 offset:49408
v_mfma_f32_16x16x32_bf16 v[72:75], v[24:27], a[172:175], v[72:75]
buffer_load_dwordx4 v8, s[8:11], s20 offen sc1 lds
v_mfma_f32_16x16x32_bf16 v[68:71], v[20:23], a[172:175], v[68:71]
s_waitcnt lgkmcnt(4)
s_add_u32 s36, s36, 1
v_mfma_f32_16x16x32_bf16 v[60:63], v[28:31], a[176:179], v[60:63]
ds_read_b128 v[20:23], v7 offset:51200
v_mfma_f32_16x16x32_bf16 v[64:67], v[32:35], a[176:179], v[64:67]
ds_read_b128 v[24:27], v7 offset:51456
v_mfma_f32_16x16x32_bf16 v[72:75], v[32:35], a[180:183], v[72:75]
v_mfma_f32_16x16x32_bf16 v[68:71], v[28:31], a[180:183], v[68:71]
s_waitcnt lgkmcnt(4)
v_mfma_f32_16x16x32_bf16 v[60:63], v[36:39], a[184:187], v[60:63]
ds_read_b128 v[28:31], v7 offset:53248
v_mfma_f32_16x16x32_bf16 v[64:67], v[40:43], a[184:187], v[64:67]
ds_read_b128 v[32:35], v7 offset:53504
v_mfma_f32_16x16x32_bf16 v[72:75], v[40:43], a[188:191], v[72:75]
buffer_load_dwordx4 v8, s[8:11], s20 offen offset:1024 sc1 lds
v_mfma_f32_16x16x32_bf16 v[68:71], v[36:39], a[188:191], v[68:71]
s_waitcnt lgkmcnt(4)
v_mfma_f32_16x16x32_bf16 v[60:63], v[12:15], a[192:195], v[60:63]
ds_read_b128 v[36:39], v7 offset:55296
v_mfma_f32_16x16x32_bf16 v[64:67], v[16:19], a[192:195], v[64:67]
ds_read_b128 v[40:43], v7 offset:55552
v_mfma_f32_16x16x32_bf16 v[72:75], v[16:19], a[196:199], v[72:75]
v_mfma_f32_16x16x32_bf16 v[68:71], v[12:15], a[196:199], v[68:71]
s_waitcnt lgkmcnt(4)
v_mfma_f32_16x16x32_bf16 v[60:63], v[20:23], a[200:203], v[60:63]
ds_read_b128 v[12:15], v7 offset:57344
v_mfma_f32_16x16x32_bf16 v[64:67], v[24:27], a[200:203], v[64:67]
ds_read_b128 v[16:19], v7 offset:57600
v_mfma_f32_16x16x32_bf16 v[72:75], v[24:27], a[204:207], v[72:75]
buffer_load_dwordx4 v8, s[8:11], s20 offen offset:2048 sc1 lds
v_mfma_f32_16x16x32_bf16 v[68:71], v[20:23], a[204:207], v[68:71]
s_waitcnt lgkmcnt(4)
v_mfma_f32_16x16x32_bf16 v[60:63], v[28:31], a[208:211], v[60:63]
ds_read_b128 v[20:23], v7 offset:59392
v_mfma_f32_16x16x32_bf16 v[64:67], v[32:35], a[208:211], v[64:67]
ds_read_b128 v[24:27], v7 offset:59648
v_mfma_f32_16x16x32_bf16 v[72:75], v[32:35], a[212:215], v[72:75]
v_mfma_f32_16x16x32_bf16 v[68:71], v[28:31], a[212:215], v[68:71]
s_waitcnt lgkmcnt(4)
v_mfma_f32_16x16x32_bf16 v[60:63], v[36:39], a[216:219], v[60:63]
ds_read_b128 v[28:31], v7 offset:61440
v_mfma_f32_16x16x32_bf16 v[64:67], v[40:43], a[216:219], v[64:67]
ds_read_b128 v[32:35], v7 offset:61696
v_mfma_f32_16x16x32_bf16 v[72:75], v[40:43], a[220:223], v[72:75]
buffer_load_dwordx4 v8, s[8:11], s20 offen offset:3072 sc1 lds
v_mfma_f32_16x16x32_bf16 v[68:71], v[36:39], a[220:223], v[68:71]
s_waitcnt lgkmcnt(4)
s_add_u32 s20, s20, s23
s_add_u32 m0, s22, 81920
v_mfma_f32_16x16x32_bf16 v[60:63], v[12:15], a[224:227], v[60:63]
ds_read_b128 v[36:39], v7 offset:63488
v_mfma_f32_16x16x32_bf16 v[64:67], v[16:19], a[224:227], v[64:67]
ds_read_b128 v[40:43], v7 offset:63744
v_mfma_f32_16x16x32_bf16 v[72:75], v[16:19], a[228:231], v[72:75]
v_mfma_f32_16x16x32_bf16 v[68:71], v[12:15], a[228:231], v[68:71]
s_waitcnt lgkmcnt(4)
v_mfma_f32_16x16x32_bf16 v[60:63], v[20:23], a[232:235], v[60:63]
s_waitcnt vmcnt(14)
s_barrier
ds_read_b128 v[12:15], v6 offset:0
v_mfma_f32_16x16x32_bf16 v[64:67], v[24:27], a[232:235], v[64:67]
ds_read_b128 v[16:19], v6 offset:256
v_mfma_f32_16x16x32_bf16 v[72:75], v[24:27], a[236:239], v[72:75]
buffer_load_dwordx4 v8, s[8:11], s20 offen sc1 lds
v_mfma_f32_16x16x32_bf16 v[68:71], v[20:23], a[236:239], v[68:71]
s_waitcnt lgkmcnt(4)
v_mfma_f32_16x16x32_bf16 v[60:63], v[28:31], a[240:243], v[60:63]
ds_read_b128 v[20:23], v6 offset:2048
v_mfma_f32_16x16x32_bf16 v[64:67], v[32:35], a[240:243], v[64:67]
ds_read_b128 v[24:27], v6 offset:2304
v_mfma_f32_16x16x32_bf16 v[72:75], v[32:35], a[244:247], v[72:75]
v_mfma_f32_16x16x32_bf16 v[68:71], v[28:31], a[244:247], v[68:71]
s_waitcnt lgkmcnt(4)
v_mfma_f32_16x16x32_bf16 v[60:63], v[36:39], a[248:251], v[60:63]
ds_read_b128 v[28:31], v6 offset:4096
v_mfma_f32_16x16x32_bf16 v[64:67], v[40:43], a[248:251], v[64:67]
ds_read_b128 v[32:35], v6 offset:4352
v_mfma_f32_16x16x32_bf16 v[72:75], v[40:43], a[252:255], v[72:75]
s_sub_u32 s24, s24, 1
buffer_load_dwordx4 v8, s[8:11], s20 offen offset:1024 sc1 lds
v_mfma_f32_16x16x32_bf16 v[68:71], v[36:39], a[252:255], v[68:71]
s_waitcnt lgkmcnt(4)
s_cbranch_scc0 main_kernel_vj_lp
v_mfma_f32_16x16x32_bf16 v[44:47], v[12:15], a[0:3], 0
ds_read_b128 v[36:39], v6 offset:6144
v_mfma_f32_16x16x32_bf16 v[48:51], v[16:19], a[0:3], 0
ds_read_b128 v[40:43], v6 offset:6400
v_cvt_pk_bf16_f32 v84, v60, v61
v_mfma_f32_16x16x32_bf16 v[56:59], v[16:19], a[4:7], 0
v_cvt_pk_bf16_f32 v85, v62, v63
v_mfma_f32_16x16x32_bf16 v[52:55], v[12:15], a[4:7], 0
s_waitcnt lgkmcnt(4)
v_cvt_pk_bf16_f32 v86, v64, v65
v_mfma_f32_16x16x32_bf16 v[44:47], v[20:23], a[8:11], v[44:47]
ds_read_b128 v[12:15], v6 offset:8192
v_cvt_pk_bf16_f32 v87, v66, v67
v_mfma_f32_16x16x32_bf16 v[48:51], v[24:27], a[8:11], v[48:51]
ds_read_b128 v[16:19], v6 offset:8448
v_cvt_pk_bf16_f32 v88, v68, v69
v_mfma_f32_16x16x32_bf16 v[56:59], v[24:27], a[12:15], v[56:59]
buffer_load_dwordx4 v8, s[8:11], s20 offen offset:2048 sc1 lds
v_cvt_pk_bf16_f32 v89, v70, v71
v_mfma_f32_16x16x32_bf16 v[52:55], v[20:23], a[12:15], v[52:55]
s_waitcnt lgkmcnt(4)
v_cvt_pk_bf16_f32 v90, v72, v73
v_mfma_f32_16x16x32_bf16 v[44:47], v[28:31], a[16:19], v[44:47]
ds_read_b128 v[20:23], v6 offset:10240
v_cvt_pk_bf16_f32 v91, v74, v75
v_mfma_f32_16x16x32_bf16 v[48:51], v[32:35], a[16:19], v[48:51]
ds_read_b128 v[24:27], v6 offset:10496
v_mfma_f32_16x16x32_bf16 v[56:59], v[32:35], a[20:23], v[56:59]
buffer_store_dwordx4 v[84:87], v9, s[8:11], s21 offen sc1
v_mfma_f32_16x16x32_bf16 v[52:55], v[28:31], a[20:23], v[52:55]
s_waitcnt lgkmcnt(4)
v_mfma_f32_16x16x32_bf16 v[44:47], v[36:39], a[24:27], v[44:47]
ds_read_b128 v[28:31], v6 offset:12288
v_mfma_f32_16x16x32_bf16 v[48:51], v[40:43], a[24:27], v[48:51]
ds_read_b128 v[32:35], v6 offset:12544
v_mfma_f32_16x16x32_bf16 v[56:59], v[40:43], a[28:31], v[56:59]
buffer_load_dwordx4 v8, s[8:11], s20 offen offset:3072 sc1 lds
v_mfma_f32_16x16x32_bf16 v[52:55], v[36:39], a[28:31], v[52:55]
s_waitcnt lgkmcnt(4)
s_add_u32 s20, s20, s23
s_add_u32 m0, s22, 98304
v_mfma_f32_16x16x32_bf16 v[44:47], v[12:15], a[32:35], v[44:47]
ds_read_b128 v[36:39], v6 offset:14336
v_mfma_f32_16x16x32_bf16 v[48:51], v[16:19], a[32:35], v[48:51]
ds_read_b128 v[40:43], v6 offset:14592
v_mfma_f32_16x16x32_bf16 v[56:59], v[16:19], a[36:39], v[56:59]
buffer_store_dwordx4 v[88:91], v9, s[8:11], s21 offen offset:256 sc1
s_mov_b32 s21, s31
v_mfma_f32_16x16x32_bf16 v[52:55], v[12:15], a[36:39], v[52:55]
s_waitcnt lgkmcnt(4)
s_add_u32 s31, s31, s29
v_mfma_f32_16x16x32_bf16 v[44:47], v[20:23], a[40:43], v[44:47]
ds_read_b128 v[12:15], v6 offset:16384
v_mfma_f32_16x16x32_bf16 v[48:51], v[24:27], a[40:43], v[48:51]
ds_read_b128 v[16:19], v6 offset:16640
v_mfma_f32_16x16x32_bf16 v[56:59], v[24:27], a[44:47], v[56:59]
buffer_load_dwordx4 v8, s[8:11], s20 offen sc1 lds
v_mfma_f32_16x16x32_bf16 v[52:55], v[20:23], a[44:47], v[52:55]
s_waitcnt lgkmcnt(4)
v_mfma_f32_16x16x32_bf16 v[44:47], v[28:31], a[48:51], v[44:47]
ds_read_b128 v[20:23], v6 offset:18432
v_mfma_f32_16x16x32_bf16 v[48:51], v[32:35], a[48:51], v[48:51]
ds_read_b128 v[24:27], v6 offset:18688
v_mfma_f32_16x16x32_bf16 v[56:59], v[32:35], a[52:55], v[56:59]
v_mfma_f32_16x16x32_bf16 v[52:55], v[28:31], a[52:55], v[52:55]
s_waitcnt lgkmcnt(4)
v_mfma_f32_16x16x32_bf16 v[44:47], v[36:39], a[56:59], v[44:47]
ds_read_b128 v[28:31], v6 offset:20480
v_mfma_f32_16x16x32_bf16 v[48:51], v[40:43], a[56:59], v[48:51]
ds_read_b128 v[32:35], v6 offset:20736
v_mfma_f32_16x16x32_bf16 v[56:59], v[40:43], a[60:63], v[56:59]
buffer_load_dwordx4 v8, s[8:11], s20 offen offset:1024 sc1 lds
v_mfma_f32_16x16x32_bf16 v[52:55], v[36:39], a[60:63], v[52:55]
s_waitcnt lgkmcnt(4)
v_mfma_f32_16x16x32_bf16 v[44:47], v[12:15], a[64:67], v[44:47]
ds_read_b128 v[36:39], v6 offset:22528
v_mfma_f32_16x16x32_bf16 v[48:51], v[16:19], a[64:67], v[48:51]
ds_read_b128 v[40:43], v6 offset:22784
v_mfma_f32_16x16x32_bf16 v[56:59], v[16:19], a[68:71], v[56:59]
v_mfma_f32_16x16x32_bf16 v[52:55], v[12:15], a[68:71], v[52:55]
s_waitcnt lgkmcnt(4)
v_mfma_f32_16x16x32_bf16 v[44:47], v[20:23], a[72:75], v[44:47]
ds_read_b128 v[12:15], v6 offset:24576
v_mfma_f32_16x16x32_bf16 v[48:51], v[24:27], a[72:75], v[48:51]
ds_read_b128 v[16:19], v6 offset:24832
v_mfma_f32_16x16x32_bf16 v[56:59], v[24:27], a[76:79], v[56:59]
buffer_load_dwordx4 v8, s[8:11], s20 offen offset:2048 sc1 lds
v_mfma_f32_16x16x32_bf16 v[52:55], v[20:23], a[76:79], v[52:55]
s_waitcnt lgkmcnt(4)
v_mfma_f32_16x16x32_bf16 v[44:47], v[28:31], a[80:83], v[44:47]
ds_read_b128 v[20:23], v6 offset:26624
v_mfma_f32_16x16x32_bf16 v[48:51], v[32:35], a[80:83], v[48:51]
ds_read_b128 v[24:27], v6 offset:26880
v_mfma_f32_16x16x32_bf16 v[56:59], v[32:35], a[84:87], v[56:59]
v_mfma_f32_16x16x32_bf16 v[52:55], v[28:31], a[84:87], v[52:55]
s_waitcnt lgkmcnt(4)
v_mfma_f32_16x16x32_bf16 v[44:47], v[36:39], a[88:91], v[44:47]
ds_read_b128 v[28:31], v6 offset:28672
v_mfma_f32_16x16x32_bf16 v[48:51], v[40:43], a[88:91], v[48:51]
ds_read_b128 v[32:35], v6 offset:28928
v_mfma_f32_16x16x32_bf16 v[56:59], v[40:43], a[92:95], v[56:59]
buffer_load_dwordx4 v8, s[8:11], s20 offen offset:3072 sc1 lds
v_mfma_f32_16x16x32_bf16 v[52:55], v[36:39], a[92:95], v[52:55]
s_waitcnt lgkmcnt(4)
s_add_u32 s20, s20, s23
s_add_u32 m0, s22, 114688
v_mfma_f32_16x16x32_bf16 v[44:47], v[12:15], a[96:99], v[44:47]
ds_read_b128 v[36:39], v6 offset:30720
v_mfma_f32_16x16x32_bf16 v[48:51], v[16:19], a[96:99], v[48:51]
ds_read_b128 v[40:43], v6 offset:30976
v_mfma_f32_16x16x32_bf16 v[56:59], v[16:19], a[100:103], v[56:59]
v_mfma_f32_16x16x32_bf16 v[52:55], v[12:15], a[100:103], v[52:55]
s_waitcnt lgkmcnt(4)
v_mfma_f32_16x16x32_bf16 v[44:47], v[20:23], a[104:107], v[44:47]
s_waitcnt vmcnt(15)
s_barrier
ds_read_b128 v[12:15], v6 offset:32768
v_mfma_f32_16x16x32_bf16 v[48:51], v[24:27], a[104:107], v[48:51]
ds_read_b128 v[16:19], v6 offset:33024
v_mfma_f32_16x16x32_bf16 v[56:59], v[24:27], a[108:111], v[56:59]
buffer_load_dwordx4 v8, s[8:11], s20 offen sc1 lds
v_mfma_f32_16x16x32_bf16 v[52:55], v[20:23], a[108:111], v[52:55]
s_waitcnt lgkmcnt(4)
v_mfma_f32_16x16x32_bf16 v[44:47], v[28:31], a[112:115], v[44:47]
ds_read_b128 v[20:23], v6 offset:34816
v_mfma_f32_16x16x32_bf16 v[48:51], v[32:35], a[112:115], v[48:51]
ds_read_b128 v[24:27], v6 offset:35072
v_mfma_f32_16x16x32_bf16 v[56:59], v[32:35], a[116:119], v[56:59]
v_mfma_f32_16x16x32_bf16 v[52:55], v[28:31], a[116:119], v[52:55]
s_waitcnt lgkmcnt(4)
v_mfma_f32_16x16x32_bf16 v[44:47], v[36:39], a[120:123], v[44:47]
ds_read_b128 v[28:31], v6 offset:36864
v_mfma_f32_16x16x32_bf16 v[48:51], v[40:43], a[120:123], v[48:51]
ds_read_b128 v[32:35], v6 offset:37120
v_mfma_f32_16x16x32_bf16 v[56:59], v[40:43], a[124:127], v[56:59]
buffer_load_dwordx4 v8, s[8:11], s20 offen offset:1024 sc1 lds
v_mfma_f32_16x16x32_bf16 v[52:55], v[36:39], a[124:127], v[52:55]
s_waitcnt lgkmcnt(4)
v_mfma_f32_16x16x32_bf16 v[44:47], v[12:15], a[128:131], v[44:47]
ds_read_b128 v[36:39], v6 offset:38912
v_mfma_f32_16x16x32_bf16 v[48:51], v[16:19], a[128:131], v[48:51]
ds_read_b128 v[40:43], v6 offset:39168
v_mfma_f32_16x16x32_bf16 v[56:59], v[16:19], a[132:135], v[56:59]
v_mfma_f32_16x16x32_bf16 v[52:55], v[12:15], a[132:135], v[52:55]
s_waitcnt lgkmcnt(4)
v_mfma_f32_16x16x32_bf16 v[44:47], v[20:23], a[136:139], v[44:47]
ds_read_b128 v[12:15], v6 offset:40960
v_mfma_f32_16x16x32_bf16 v[48:51], v[24:27], a[136:139], v[48:51]
ds_read_b128 v[16:19], v6 offset:41216
v_mfma_f32_16x16x32_bf16 v[56:59], v[24:27], a[140:143], v[56:59]
buffer_load_dwordx4 v8, s[8:11], s20 offen offset:2048 sc1 lds
v_mfma_f32_16x16x32_bf16 v[52:55], v[20:23], a[140:143], v[52:55]
s_waitcnt lgkmcnt(4)
v_mfma_f32_16x16x32_bf16 v[44:47], v[28:31], a[144:147], v[44:47]
ds_read_b128 v[20:23], v6 offset:43008
v_mfma_f32_16x16x32_bf16 v[48:51], v[32:35], a[144:147], v[48:51]
ds_read_b128 v[24:27], v6 offset:43264
v_mfma_f32_16x16x32_bf16 v[56:59], v[32:35], a[148:151], v[56:59]
v_mfma_f32_16x16x32_bf16 v[52:55], v[28:31], a[148:151], v[52:55]
s_waitcnt lgkmcnt(4)
v_mfma_f32_16x16x32_bf16 v[44:47], v[36:39], a[152:155], v[44:47]
ds_read_b128 v[28:31], v6 offset:45056
v_mfma_f32_16x16x32_bf16 v[48:51], v[40:43], a[152:155], v[48:51]
ds_read_b128 v[32:35], v6 offset:45312
v_mfma_f32_16x16x32_bf16 v[56:59], v[40:43], a[156:159], v[56:59]
buffer_load_dwordx4 v8, s[8:11], s20 offen offset:3072 sc1 lds
v_mfma_f32_16x16x32_bf16 v[52:55], v[36:39], a[156:159], v[52:55]
s_waitcnt lgkmcnt(4)
s_add_u32 s20, s20, s28
s_add_u32 m0, s22, 0
v_mfma_f32_16x16x32_bf16 v[44:47], v[12:15], a[160:163], v[44:47]
s_cmp_lt_u32 s36, s37
ds_read_b128 v[36:39], v6 offset:47104
s_cselect_b32 s20, s20, 0x40000000
v_mfma_f32_16x16x32_bf16 v[48:51], v[16:19], a[160:163], v[48:51]
s_waitcnt vmcnt(8)
ds_read_b128 v[40:43], v6 offset:47360
s_max_i32 s27, s39, 0
v_mfma_f32_16x16x32_bf16 v[56:59], v[16:19], a[164:167], v[56:59]
s_add_u32 s39, s39, 1
v_mov_b32 v112, s27
v_mfma_f32_16x16x32_bf16 v[52:55], v[12:15], a[164:167], v[52:55]
s_waitcnt lgkmcnt(4)
v_mfma_f32_16x16x32_bf16 v[44:47], v[20:23], a[168:171], v[44:47]
buffer_store_dword v112, v108, s[8:11], 0 offen sc1
ds_read_b128 v[12:15], v6 offset:49152
v_mfma_f32_16x16x32_bf16 v[48:51], v[24:27], a[168:171], v[48:51]
ds_read_b128 v[16:19], v6 offset:49408
v_mfma_f32_16x16x32_bf16 v[56:59], v[24:27], a[172:175], v[56:59]
buffer_load_dwordx4 v200, s[12:15], s68 offen nt lds
v_mfma_f32_16x16x32_bf16 v[52:55], v[20:23], a[172:175], v[52:55]
s_waitcnt lgkmcnt(4)
s_add_u32 s36, s36, 1
v_mfma_f32_16x16x32_bf16 v[44:47], v[28:31], a[176:179], v[44:47]
ds_read_b128 v[20:23], v6 offset:51200
v_mfma_f32_16x16x32_bf16 v[48:51], v[32:35], a[176:179], v[48:51]
ds_read_b128 v[24:27], v6 offset:51456
v_mfma_f32_16x16x32_bf16 v[56:59], v[32:35], a[180:183], v[56:59]
v_mfma_f32_16x16x32_bf16 v[52:55], v[28:31], a[180:183], v[52:55]
s_waitcnt lgkmcnt(4)
v_mfma_f32_16x16x32_bf16 v[44:47], v[36:39], a[184:187], v[44:47]
ds_read_b128 v[28:31], v6 offset:53248
v_mfma_f32_16x16x32_bf16 v[48:51], v[40:43], a[184:187], v[48:51]
ds_read_b128 v[32:35], v6 offset:53504
v_mfma_f32_16x16x32_bf16 v[56:59], v[40:43], a[188:191], v[56:59]
buffer_load_dwordx4 v201, s[12:15], s68 offen offset:1024 nt lds
v_mfma_f32_16x16x32_bf16 v[52:55], v[36:39], a[188:191], v[52:55]
s_waitcnt lgkmcnt(4)
v_mfma_f32_16x16x32_bf16 v[44:47], v[12:15], a[192:195], v[44:47]
ds_read_b128 v[36:39], v6 offset:55296
v_mfma_f32_16x16x32_bf16 v[48:51], v[16:19], a[192:195], v[48:51]
ds_read_b128 v[40:43], v6 offset:55552
v_mfma_f32_16x16x32_bf16 v[56:59], v[16:19], a[196:199], v[56:59]
v_mfma_f32_16x16x32_bf16 v[52:55], v[12:15], a[196:199], v[52:55]
s_waitcnt lgkmcnt(4)
v_mfma_f32_16x16x32_bf16 v[44:47], v[20:23], a[200:203], v[44:47]
ds_read_b128 v[12:15], v6 offset:57344
v_mfma_f32_16x16x32_bf16 v[48:51], v[24:27], a[200:203], v[48:51]
ds_read_b128 v[16:19], v6 offset:57600
v_mfma_f32_16x16x32_bf16 v[56:59], v[24:27], a[204:207], v[56:59]
buffer_load_dwordx4 v202, s[12:15], s68 offen offset:2048 nt lds
v_mfma_f32_16x16x32_bf16 v[52:55], v[20:23], a[204:207], v[52:55]
s_waitcnt lgkmcnt(4)
v_mfma_f32_16x16x32_bf16 v[44:47], v[28:31], a[208:211], v[44:47]
ds_read_b128 v[20:23], v6 offset:59392
v_mfma_f32_16x16x32_bf16 v[48:51], v[32:35], a[208:211], v[48:51]
ds_read_b128 v[24:27], v6 offset:59648
v_mfma_f32_16x16x32_bf16 v[56:59], v[32:35], a[212:215], v[56:59]
v_mfma_f32_16x16x32_bf16 v[52:55], v[28:31], a[212:215], v[52:55]
s_waitcnt lgkmcnt(4)
v_mfma_f32_16x16x32_bf16 v[44:47], v[36:39], a[216:219], v[44:47]
ds_read_b128 v[28:31], v6 offset:61440
v_mfma_f32_16x16x32_bf16 v[48:51], v[40:43], a[216:219], v[48:51]
ds_read_b128 v[32:35], v6 offset:61696
v_mfma_f32_16x16x32_bf16 v[56:59], v[40:43], a[220:223], v[56:59]
buffer_load_dwordx4 v203, s[12:15], s68 offen offset:3072 nt lds
v_mfma_f32_16x16x32_bf16 v[52:55], v[36:39], a[220:223], v[52:55]
s_waitcnt lgkmcnt(4)
s_add_u32 s68, s68, s75
s_add_u32 m0, s22, 16384
v_mfma_f32_16x16x32_bf16 v[44:47], v[12:15], a[224:227], v[44:47]
ds_read_b128 v[36:39], v6 offset:63488
v_mfma_f32_16x16x32_bf16 v[48:51], v[16:19], a[224:227], v[48:51]
ds_read_b128 v[40:43], v6 offset:63744
v_mfma_f32_16x16x32_bf16 v[56:59], v[16:19], a[228:231], v[56:59]
v_mfma_f32_16x16x32_bf16 v[52:55], v[12:15], a[228:231], v[52:55]
s_waitcnt lgkmcnt(4)
v_mfma_f32_16x16x32_bf16 v[44:47], v[20:23], a[232:235], v[44:47]
s_waitcnt vmcnt(14)
s_barrier
ds_read_b128 v[12:15], v7 offset:0
v_mfma_f32_16x16x32_bf16 v[48:51], v[24:27], a[232:235], v[48:51]
ds_read_b128 v[16:19], v7 offset:256
v_mfma_f32_16x16x32_bf16 v[56:59], v[24:27], a[236:239], v[56:59]
buffer_load_dwordx4 v200, s[12:15], s68 offen nt lds
v_mfma_f32_16x16x32_bf16 v[52:55], v[20:23], a[236:239], v[52:55]
s_waitcnt lgkmcnt(4)
v_mfma_f32_16x16x32_bf16 v[44:47], v[28:31], a[240:243], v[44:47]
ds_read_b128 v[20:23], v7 offset:2048
v_mfma_f32_16x16x32_bf16 v[48:51], v[32:35], a[240:243], v[48:51]
ds_read_b128 v[24:27], v7 offset:2304
v_mfma_f32_16x16x32_bf16 v[56:59], v[32:35], a[244:247], v[56:59]
v_mfma_f32_16x16x32_bf16 v[52:55], v[28:31], a[244:247], v[52:55]
s_waitcnt lgkmcnt(4)
v_mfma_f32_16x16x32_bf16 v[44:47], v[36:39], a[248:251], v[44:47]
ds_read_b128 v[28:31], v7 offset:4096
v_mfma_f32_16x16x32_bf16 v[48:51], v[40:43], a[248:251], v[48:51]
ds_read_b128 v[32:35], v7 offset:4352
v_mfma_f32_16x16x32_bf16 v[56:59], v[40:43], a[252:255], v[56:59]
buffer_load_dwordx4 v201, s[12:15], s68 offen offset:1024 nt lds
v_mfma_f32_16x16x32_bf16 v[52:55], v[36:39], a[252:255], v[52:55]
s_waitcnt lgkmcnt(4)
v_mfma_f32_16x16x32_bf16 v[60:63], v[12:15], a[0:3], 0
ds_read_b128 v[36:39], v7 offset:6144
v_mfma_f32_16x16x32_bf16 v[64:67], v[16:19], a[0:3], 0
ds_read_b128 v[40:43], v7 offset:6400
v_cvt_pk_bf16_f32 v84, v44, v45
v_mfma_f32_16x16x32_bf16 v[72:75], v[16:19], a[4:7], 0
v_cvt_pk_bf16_f32 v85, v46, v47
v_mfma_f32_16x16x32_bf16 v[68:71], v[12:15], a[4:7], 0
s_waitcnt lgkmcnt(4)
v_cvt_pk_bf16_f32 v86, v48, v49
v_mfma_f32_16x16x32_bf16 v[60:63], v[20:23], a[8:11], v[60:63]
ds_read_b128 v[12:15], v7 offset:8192
v_cvt_pk_bf16_f32 v87, v50, v51
v_mfma_f32_16x16x32_bf16 v[64:67], v[24:27], a[8:11], v[64:67]
ds_read_b128 v[16:19], v7 offset:8448
v_cvt_pk_bf16_f32 v88, v52, v53
v_mfma_f32_16x16x32_bf16 v[72:75], v[24:27], a[12:15], v[72:75]
buffer_load_dwordx4 v202, s[12:15], s68 offen offset:2048 nt lds
v_cvt_pk_bf16_f32 v89, v54, v55
v_mfma_f32_16x16x32_bf16 v[68:71], v[20:23], a[12:15], v[68:71]
s_waitcnt lgkmcnt(4)
v_cvt_pk_bf16_f32 v90, v56, v57
v_mfma_f32_16x16x32_bf16 v[60:63], v[28:31], a[16:19], v[60:63]
ds_read_b128 v[20:23], v7 offset:10240
v_cvt_pk_bf16_f32 v91, v58, v59
v_mfma_f32_16x16x32_bf16 v[64:67], v[32:35], a[16:19], v[64:67]
ds_read_b128 v[24:27], v7 offset:10496
v_mfma_f32_16x16x32_bf16 v[72:75], v[32:35], a[20:23], v[72:75]
buffer_store_dwordx4 v[84:87], v9, s[8:11], s21 offen sc1
v_mfma_f32_16x16x32_bf16 v[68:71], v[28:31], a[20:23], v[68:71]
s_waitcnt lgkmcnt(4)
v_mfma_f32_16x16x32_bf16 v[60:63], v[36:39], a[24:27], v[60:63]
ds_read_b128 v[28:31], v7 offset:12288
v_mfma_f32_16x16x32_bf16 v[64:67], v[40:43], a[24:27], v[64:67]
ds_read_b128 v[32:35], v7 offset:12544
v_mfma_f32_16x16x32_bf16 v[72:75], v[40:43], a[28:31], v[72:75]
buffer_load_dwordx4 v203, s[12:15], s68 offen offset:3072 nt lds
v_mfma_f32_16x16x32_bf16 v[68:71], v[36:39], a[28:31], v[68:71]
s_waitcnt lgkmcnt(4)
s_add_u32 s68, s68, s75
s_add_u32 m0, s22, 32768
v_mfma_f32_16x16x32_bf16 v[60:63], v[12:15], a[32:35], v[60:63]
ds_read_b128 v[36:39], v7 offset:14336
v_mfma_f32_16x16x32_bf16 v[64:67], v[16:19], a[32:35], v[64:67]
ds_read_b128 v[40:43], v7 offset:14592
v_mfma_f32_16x16x32_bf16 v[72:75], v[16:19], a[36:39], v[72:75]
buffer_store_dwordx4 v[88:91], v9, s[8:11], s21 offen offset:256 sc1
s_mov_b32 s21, s31
v_mfma_f32_16x16x32_bf16 v[68:71], v[12:15], a[36:39], v[68:71]
s_waitcnt lgkmcnt(4)
s_add_u32 s31, s31, s29
v_mfma_f32_16x16x32_bf16 v[60:63], v[20:23], a[40:43], v[60:63]
ds_read_b128 v[12:15], v7 offset:16384
v_mfma_f32_16x16x32_bf16 v[64:67], v[24:27], a[40:43], v[64:67]
ds_read_b128 v[16:19], v7 offset:16640
v_mfma_f32_16x16x32_bf16 v[72:75], v[24:27], a[44:47], v[72:75]
buffer_load_dwordx4 v200, s[12:15], s68 offen nt lds
v_mfma_f32_16x16x32_bf16 v[68:71], v[20:23], a[44:47], v[68:71]
s_waitcnt lgkmcnt(4)
v_mfma_f32_16x16x32_bf16 v[60:63], v[28:31], a[48:51], v[60:63]
ds_read_b128 v[20:23], v7 offset:18432
v_mfma_f32_16x16x32_bf16 v[64:67], v[32:35], a[48:51], v[64:67]
ds_read_b128 v[24:27], v7 offset:18688
v_mfma_f32_16x16x32_bf16 v[72:75], v[32:35], a[52:55], v[72:75]
v_mfma_f32_16x16x32_bf16 v[68:71], v[28:31], a[52:55], v[68:71]
s_waitcnt lgkmcnt(4)
v_mfma_f32_16x16x32_bf16 v[60:63], v[36:39], a[56:59], v[60:63]
ds_read_b128 v[28:31], v7 offset:20480
v_mfma_f32_16x16x32_bf16 v[64:67], v[40:43], a[56:59], v[64:67]
ds_read_b128 v[32:35], v7 offset:20736
v_mfma_f32_16x16x32_bf16 v[72:75], v[40:43], a[60:63], v[72:75]
buffer_load_dwordx4 v201, s[12:15], s68 offen offset:1024 nt lds
v_mfma_f32_16x16x32_bf16 v[68:71], v[36:39], a[60:63], v[68:71]
s_waitcnt lgkmcnt(4)
v_mfma_f32_16x16x32_bf16 v[60:63], v[12:15], a[64:67], v[60:63]
ds_read_b128 v[36:39], v7 offset:22528
v_mfma_f32_16x16x32_bf16 v[64:67], v[16:19], a[64:67], v[64:67]
ds_read_b128 v[40:43], v7 offset:22784
v_mfma_f32_16x16x32_bf16 v[72:75], v[16:19], a[68:71], v[72:75]
v_mfma_f32_16x16x32_bf16 v[68:71], v[12:15], a[68:71], v[68:71]
s_waitcnt lgkmcnt(4)
v_mfma_f32_16x16x32_bf16 v[60:63], v[20:23], a[72:75], v[60:63]
ds_read_b128 v[12:15], v7 offset:24576
v_mfma_f32_16x16x32_bf16 v[64:67], v[24:27], a[72:75], v[64:67]
ds_read_b128 v[16:19], v7 offset:24832
v_mfma_f32_16x16x32_bf16 v[72:75], v[24:27], a[76:79], v[72:75]
buffer_load_dwordx4 v202, s[12:15], s68 offen offset:2048 nt lds
v_mfma_f32_16x16x32_bf16 v[68:71], v[20:23], a[76:79], v[68:71]
s_waitcnt lgkmcnt(4)
v_mfma_f32_16x16x32_bf16 v[60:63], v[28:31], a[80:83], v[60:63]
ds_read_b128 v[20:23], v7 offset:26624
v_mfma_f32_16x16x32_bf16 v[64:67], v[32:35], a[80:83], v[64:67]
ds_read_b128 v[24:27], v7 offset:26880
v_mfma_f32_16x16x32_bf16 v[72:75], v[32:35], a[84:87], v[72:75]
v_mfma_f32_16x16x32_bf16 v[68:71], v[28:31], a[84:87], v[68:71]
s_waitcnt lgkmcnt(4)
v_mfma_f32_16x16x32_bf16 v[60:63], v[36:39], a[88:91], v[60:63]
ds_read_b128 v[28:31], v7 offset:28672
v_mfma_f32_16x16x32_bf16 v[64:67], v[40:43], a[88:91], v[64:67]
ds_read_b128 v[32:35], v7 offset:28928
v_mfma_f32_16x16x32_bf16 v[72:75], v[40:43], a[92:95], v[72:75]
buffer_load_dwordx4 v203, s[12:15], s68 offen offset:3072 nt lds
v_mfma_f32_16x16x32_bf16 v[68:71], v[36:39], a[92:95], v[68:71]
s_waitcnt lgkmcnt(4)
s_add_u32 s68, s68, s75
s_add_u32 m0, s22, 49152
v_mfma_f32_16x16x32_bf16 v[60:63], v[12:15], a[96:99], v[60:63]
ds_read_b128 v[36:39], v7 offset:30720
v_mfma_f32_16x16x32_bf16 v[64:67], v[16:19], a[96:99], v[64:67]
ds_read_b128 v[40:43], v7 offset:30976
v_mfma_f32_16x16x32_bf16 v[72:75], v[16:19], a[100:103], v[72:75]
v_mfma_f32_16x16x32_bf16 v[68:71], v[12:15], a[100:103], v[68:71]
s_waitcnt lgkmcnt(4)
v_mfma_f32_16x16x32_bf16 v[60:63], v[20:23], a[104:107], v[60:63]
s_waitcnt vmcnt(15)
s_barrier
ds_read_b128 v[12:15], v7 offset:32768
v_mfma_f32_16x16x32_bf16 v[64:67], v[24:27], a[104:107], v[64:67]
ds_read_b128 v[16:19], v7 offset:33024
v_mfma_f32_16x16x32_bf16 v[72:75], v[24:27], a[108:111], v[72:75]
buffer_load_dwordx4 v200, s[12:15], s68 offen nt lds
v_mfma_f32_16x16x32_bf16 v[68:71], v[20:23], a[108:111], v[68:71]
s_waitcnt lgkmcnt(4)
v_mfma_f32_16x16x32_bf16 v[60:63], v[28:31], a[112:115], v[60:63]
ds_read_b128 v[20:23], v7 offset:34816
v_mfma_f32_16x16x32_bf16 v[64:67], v[32:35], a[112:115], v[64:67]
ds_read_b128 v[24:27], v7 offset:35072
v_mfma_f32_16x16x32_bf16 v[72:75], v[32:35], a[116:119], v[72:75]
v_mfma_f32_16x16x32_bf16 v[68:71], v[28:31], a[116:119], v[68:71]
s_waitcnt lgkmcnt(4)
v_mfma_f32_16x16x32_bf16 v[60:63], v[36:39], a[120:123], v[60:63]
ds_read_b128 v[28:31], v7 offset:36864
v_mfma_f32_16x16x32_bf16 v[64:67], v[40:43], a[120:123], v[64:67]
ds_read_b128 v[32:35], v7 offset:37120
v_mfma_f32_16x16x32_bf16 v[72:75], v[40:43], a[124:127], v[72:75]
buffer_load_dwordx4 v201, s[12:15], s68 offen offset:1024 nt lds
v_mfma_f32_16x16x32_bf16 v[68:71], v[36:39], a[124:127], v[68:71]
s_waitcnt lgkmcnt(4)
v_mfma_f32_16x16x32_bf16 v[60:63], v[12:15], a[128:131], v[60:63]
ds_read_b128 v[36:39], v7 offset:38912
v_mfma_f32_16x16x32_bf16 v[64:67], v[16:19], a[128:131], v[64:67]
ds_read_b128 v[40:43], v7 offset:39168
v_mfma_f32_16x16x32_bf16 v[72:75], v[16:19], a[132:135], v[72:75]
v_mfma_f32_16x16x32_bf16 v[68:71], v[12:15], a[132:135], v[68:71]
s_waitcnt lgkmcnt(4)
v_mfma_f32_16x16x32_bf16 v[60:63], v[20:23], a[136:139], v[60:63]
ds_read_b128 v[12:15], v7 offset:40960
v_mfma_f32_16x16x32_bf16 v[64:67], v[24:27], a[136:139], v[64:67]
ds_read_b128 v[16:19], v7 offset:41216
v_mfma_f32_16x16x32_bf16 v[72:75], v[24:27], a[140:143], v[72:75]
buffer_load_dwordx4 v202, s[12:15], s68 offen offset:2048 nt lds
v_mfma_f32_16x16x32_bf16 v[68:71], v[20:23], a[140:143], v[68:71]
s_waitcnt lgkmcnt(4)
v_mfma_f32_16x16x32_bf16 v[60:63], v[28:31], a[144:147], v[60:63]
ds_read_b128 v[20:23], v7 offset:43008
v_mfma_f32_16x16x32_bf16 v[64:67], v[32:35], a[144:147], v[64:67]
ds_read_b128 v[24:27], v7 offset:43264
v_mfma_f32_16x16x32_bf16 v[72:75], v[32:35], a[148:151], v[72:75]
v_mfma_f32_16x16x32_bf16 v[68:71], v[28:31], a[148:151], v[68:71]
s_waitcnt lgkmcnt(4)
v_mfma_f32_16x16x32_bf16 v[60:63], v[36:39], a[152:155], v[60:63]
ds_read_b128 v[28:31], v7 offset:45056
v_mfma_f32_16x16x32_bf16 v[64:67], v[40:43], a[152:155], v[64:67]
ds_read_b128 v[32:35], v7 offset:45312
v_mfma_f32_16x16x32_bf16 v[72:75], v[40:43], a[156:159], v[72:75]
buffer_load_dwordx4 v203, s[12:15], s68 offen offset:3072 nt lds
v_mfma_f32_16x16x32_bf16 v[68:71], v[36:39], a[156:159], v[68:71]
s_waitcnt lgkmcnt(4)
s_add_u32 s68, s68, s75
s_add_u32 m0, s22, 65536
v_mfma_f32_16x16x32_bf16 v[60:63], v[12:15], a[160:163], v[60:63]
s_cmp_lt_u32 s36, s37
ds_read_b128 v[36:39], v7 offset:47104
s_cselect_b32 s20, s20, 0x40000000
v_mfma_f32_16x16x32_bf16 v[64:67], v[16:19], a[160:163], v[64:67]
s_waitcnt vmcnt(8)
ds_read_b128 v[40:43], v7 offset:47360
s_max_i32 s27, s39, 0
v_mfma_f32_16x16x32_bf16 v[72:75], v[16:19], a[164:167], v[72:75]
s_add_u32 s39, s39, 1
v_mov_b32 v112, s27
v_mfma_f32_16x16x32_bf16 v[68:71], v[12:15], a[164:167], v[68:71]
s_waitcnt lgkmcnt(4)
v_mfma_f32_16x16x32_bf16 v[60:63], v[20:23], a[168:171], v[60:63]
buffer_store_dword v112, v108, s[8:11], 0 offen sc1
ds_read_b128 v[12:15], v7 offset:49152
v_mfma_f32_16x16x32_bf16 v[64:67], v[24:27], a[168:171], v[64:67]
ds_read_b128 v[16:19], v7 offset:49408
v_mfma_f32_16x16x32_bf16 v[72:75], v[24:27], a[172:175], v[72:75]
buffer_load_dwordx4 v200, s[12:15], s68 offen nt lds
v_mfma_f32_16x16x32_bf16 v[68:71], v[20:23], a[172:175], v[68:71]
s_waitcnt lgkmcnt(4)
s_add_u32 s36, s36, 1
v_mfma_f32_16x16x32_bf16 v[60:63], v[28:31], a[176:179], v[60:63]
ds_read_b128 v[20:23], v7 offset:51200
v_mfma_f32_16x16x32_bf16 v[64:67], v[32:35], a[176:179], v[64:67]
ds_read_b128 v[24:27], v7 offset:51456
v_mfma_f32_16x16x32_bf16 v[72:75], v[32:35], a[180:183], v[72:75]
v_mfma_f32_16x16x32_bf16 v[68:71], v[28:31], a[180:183], v[68:71]
s_waitcnt lgkmcnt(4)
v_mfma_f32_16x16x32_bf16 v[60:63], v[36:39], a[184:187], v[60:63]
ds_read_b128 v[28:31], v7 offset:53248
v_mfma_f32_16x16x32_bf16 v[64:67], v[40:43], a[184:187], v[64:67]
ds_read_b128 v[32:35], v7 offset:53504
v_mfma_f32_16x16x32_bf16 v[72:75], v[40:43], a[188:191], v[72:75]
buffer_load_dwordx4 v201, s[12:15], s68 offen offset:1024 nt lds
v_mfma_f32_16x16x32_bf16 v[68:71], v[36:39], a[188:191], v[68:71]
s_waitcnt lgkmcnt(4)
v_mfma_f32_16x16x32_bf16 v[60:63], v[12:15], a[192:195], v[60:63]
ds_read_b128 v[36:39], v7 offset:55296
v_mfma_f32_16x16x32_bf16 v[64:67], v[16:19], a[192:195], v[64:67]
ds_read_b128 v[40:43], v7 offset:55552
v_mfma_f32_16x16x32_bf16 v[72:75], v[16:19], a[196:199], v[72:75]
v_mfma_f32_16x16x32_bf16 v[68:71], v[12:15], a[196:199], v[68:71]
s_waitcnt lgkmcnt(4)
v_mfma_f32_16x16x32_bf16 v[60:63], v[20:23], a[200:203], v[60:63]
ds_read_b128 v[12:15], v7 offset:57344
v_mfma_f32_16x16x32_bf16 v[64:67], v[24:27], a[200:203], v[64:67]
ds_read_b128 v[16:19], v7 offset:57600
v_mfma_f32_16x16x32_bf16 v[72:75], v[24:27], a[204:207], v[72:75]
buffer_load_dwordx4 v202, s[12:15], s68 offen offset:2048 nt lds
v_mfma_f32_16x16x32_bf16 v[68:71], v[20:23], a[204:207], v[68:71]
s_waitcnt lgkmcnt(4)
v_mfma_f32_16x16x32_bf16 v[60:63], v[28:31], a[208:211], v[60:63]
ds_read_b128 v[20:23], v7 offset:59392
v_mfma_f32_16x16x32_bf16 v[64:67], v[32:35], a[208:211], v[64:67]
ds_read_b128 v[24:27], v7 offset:59648
v_mfma_f32_16x16x32_bf16 v[72:75], v[32:35], a[212:215], v[72:75]
v_mfma_f32_16x16x32_bf16 v[68:71], v[28:31], a[212:215], v[68:71]
s_waitcnt lgkmcnt(4)
v_mfma_f32_16x16x32_bf16 v[60:63], v[36:39], a[216:219], v[60:63]
ds_read_b128 v[28:31], v7 offset:61440
v_mfma_f32_16x16x32_bf16 v[64:67], v[40:43], a[216:219], v[64:67]
ds_read_b128 v[32:35], v7 offset:61696
v_mfma_f32_16x16x32_bf16 v[72:75], v[40:43], a[220:223], v[72:75]
buffer_load_dwordx4 v203, s[12:15], s68 offen offset:3072 nt lds
v_mfma_f32_16x16x32_bf16 v[68:71], v[36:39], a[220:223], v[68:71]
s_waitcnt lgkmcnt(4)
s_add_u32 s68, s68, s75
s_add_u32 m0, s22, 81920
v_mfma_f32_16x16x32_bf16 v[60:63], v[12:15], a[224:227], v[60:63]
ds_read_b128 v[36:39], v7 offset:63488
v_mfma_f32_16x16x32_bf16 v[64:67], v[16:19], a[224:227], v[64:67]
ds_read_b128 v[40:43], v7 offset:63744
v_mfma_f32_16x16x32_bf16 v[72:75], v[16:19], a[228:231], v[72:75]
v_mfma_f32_16x16x32_bf16 v[68:71], v[12:15], a[228:231], v[68:71]
s_waitcnt lgkmcnt(4)
v_mfma_f32_16x16x32_bf16 v[60:63], v[20:23], a[232:235], v[60:63]
s_waitcnt vmcnt(24)
s_barrier
ds_read_b128 v[12:15], v6 offset:0
v_mfma_f32_16x16x32_bf16 v[64:67], v[24:27], a[232:235], v[64:67]
ds_read_b128 v[16:19], v6 offset:256
v_mfma_f32_16x16x32_bf16 v[72:75], v[24:27], a[236:239], v[72:75]
buffer_load_dwordx4 v200, s[12:15], s68 offen nt lds
v_mfma_f32_16x16x32_bf16 v[68:71], v[20:23], a[236:239], v[68:71]
s_waitcnt lgkmcnt(4)
v_mfma_f32_16x16x32_bf16 v[60:63], v[28:31], a[240:243], v[60:63]
ds_read_b128 v[20:23], v6 offset:2048
v_mfma_f32_16x16x32_bf16 v[64:67], v[32:35], a[240:243], v[64:67]
ds_read_b128 v[24:27], v6 offset:2304
v_mfma_f32_16x16x32_bf16 v[72:75], v[32:35], a[244:247], v[72:75]
v_mfma_f32_16x16x32_bf16 v[68:71], v[28:31], a[244:247], v[68:71]
s_waitcnt lgkmcnt(4)
v_mfma_f32_16x16x32_bf16 v[60:63], v[36:39], a[248:251], v[60:63]
ds_read_b128 v[28:31], v6 offset:4096
v_mfma_f32_16x16x32_bf16 v[64:67], v[40:43], a[248:251], v[64:67]
ds_read_b128 v[32:35], v6 offset:4352
v_mfma_f32_16x16x32_bf16 v[72:75], v[40:43], a[252:255], v[72:75]
s_sub_u32 s24, s24, 1
buffer_load_dwordx4 v201, s[12:15], s68 offen offset:1024 nt lds
v_mfma_f32_16x16x32_bf16 v[68:71], v[36:39], a[252:255], v[68:71]
s_waitcnt lgkmcnt(4)
s_barrier
s_add_u32 m0, s22, 81920
s_nop 0
buffer_load_dwordx4 v202, s[12:15], s68 offen offset:2048 nt lds
buffer_load_dwordx4 v203, s[12:15], s68 offen offset:3072 nt lds
s_add_u32 s68, s68, s75
s_add_u32 m0, s22, 98304
s_nop 0
buffer_load_dwordx4 v200, s[12:15], s68 offen nt lds
buffer_load_dwordx4 v201, s[12:15], s68 offen offset:1024 nt lds
buffer_load_dwordx4 v202, s[12:15], s68 offen offset:2048 nt lds
buffer_load_dwordx4 v203, s[12:15], s68 offen offset:3072 nt lds
s_add_u32 s68, s68, s75
s_add_u32 m0, s22, 114688
s_nop 0
buffer_load_dwordx4 v200, s[12:15], s68 offen nt lds
buffer_load_dwordx4 v201, s[12:15], s68 offen offset:1024 nt lds
buffer_load_dwordx4 v202, s[12:15], s68 offen offset:2048 nt lds
buffer_load_dwordx4 v203, s[12:15], s68 offen offset:3072 nt lds
v_cvt_pk_bf16_f32 v84, v60, v61
v_cvt_pk_bf16_f32 v85, v62, v63
v_cvt_pk_bf16_f32 v86, v64, v65
v_cvt_pk_bf16_f32 v87, v66, v67
v_cvt_pk_bf16_f32 v88, v68, v69
v_cvt_pk_bf16_f32 v89, v70, v71
v_cvt_pk_bf16_f32 v90, v72, v73
v_cvt_pk_bf16_f32 v91, v74, v75
buffer_store_dwordx4 v[84:87], v9, s[8:11], s21 offen sc1
buffer_store_dwordx4 v[88:91], v9, s[8:11], s21 offen offset:256 sc1
s_mov_b32 s21, s31
s_add_u32 s31, s31, s29
s_waitcnt vmcnt(0)
s_mov_b32 s39, s37
s_max_i32 s27, s39, 0
v_mov_b32 v112, s27
buffer_store_dword v112, v108, s[8:11], 0 offen sc1
main_kernel_qa:
s_barrier
s_lshl_b32 s75, s98, 5
s_add_u32 s75, s75, s73
s_lshl_b32 s75, s75, 7
s_add_u32 s75, s75, 0x6a02e00
s_lshl_b32 s26, s25, 2
s_add_u32 s26, s26, s75
v_mov_b32 v108, 0x40000000
v_writelane_b32 v108, s26, 0
v_lshl_add_u32 v8, v1, 4, s22
s_add_u32 s12, s76, s74
s_addc_u32 s13, s77, 0
s_sub_u32 s14, 0x800000, s74
s_mov_b32 s15, 0x00020000
s_lshl_b32 s52, s98, 16
s_mov_b32 s53, 131072
s_mov_b32 s28, 81920
s_mov_b32 s37, 32
v_lshrrev_b32 v2, 4, v1
v_lshlrev_b32 v3, 2, v2
v_and_b32 v4, 15, v1
v_xor_b32 v4, v4, v3
v_lshlrev_b32 v4, 4, v4
s_lshl_b32 s26, s25, 6
v_add_u32 v2, s26, v2
v_mul_lo_u32 v2, v2, s30
v_add_u32 v92, v2, v4
v_xor_b32 v93, 16, v92
s_lshl_b32 s49, s30, 2
v_lshrrev_b32 v2, 5, v1
v_lshlrev_b32 v2, 12, v2
v_bfe_u32 v3, v1, 4, 1
v_lshl_add_u32 v2, v3, 10, v2
v_and_b32 v4, 1, v1
v_lshl_add_u32 v2, v4, 3, v2
v_bfe_u32 v4, v1, 2, 2
v_lshl_add_u32 v2, v4, 8, v2
v_xor_b32 v4, s25, v4
v_lshl_add_u32 v3, v4, 2, v3
v_and_b32 v4, 2, v1
v_xor_b32 v3, v3, v4
v_lshl_add_u32 v94, v3, 4, v2
v_xor_b32 v95, 16, v94
v_add_u32 v96, 0x10000, v94
v_add_u32 v97, 0x10000, v95
v_and_b32 v2, 8, v1
v_lshl_add_u32 v209, v2, 4, v9
v_and_b32 v3, 15, v1
v_lshrrev_b32 v4, 4, v1
v_and_b32 v5, 7, v1
s_lshl_b32 s26, s25, 9
v_lshl_add_u32 v210, v4, 3, v5
v_lshl_add_u32 v210, v210, 4, s26
v_cmp_gt_u32 vcc, 8, v3
s_nop 1
v_cndmask_b32 v210, v11, v210, vcc
v_lshl_add_u32 v211, v2, 1, v5
v_lshl_add_u32 v211, v4, 5, v211
s_add_u32 s26, s26, 4194304
v_lshl_add_u32 v211, v211, 3, s26
v_cmp_gt_u32 vcc, 2, v4
s_nop 1
v_cndmask_b32 v211, v11, v211, vcc
s_lshl_b32 s26, s25, 12
s_add_u32 s26, s26, 131328
v_xor_b32 v2, v4, v5
v_lshl_add_u32 v2, v2, 4, s26
v_lshl_add_u32 v212, v3, 7, v2
v_xor_b32 v219, 64, v212
s_mul_i32 s26, s25, 2560
s_add_u32 s26, s26, 147712
v_mul_u32_u24 v2, 80, v3
v_lshl_add_u32 v2, v4, 4, v2
v_add_u32 v220, s26, v2
v_mul_u32_u24 v217, 96, v3
v_add_u32 v217, 157952, v217
v_and_b32 v2, 1, v4
v_lshl_add_u32 v218, v2, 3, v217
v_lshl_add_u32 v217, v4, 4, v217
v_lshrrev_b32 v3, 3, v1
v_xor_b32 v2, v3, v5
v_mov_b32 v4, v5
s_lshl_b32 s26, s25, 3
v_add_u32 v5, s26, v3
v_lshlrev_b32 v2, 4, v2
v_lshl_add_u32 v2, v5, 7, v2
v_add_u32 v213, 131328, v2
v_mul_u32_u24 v2, 80, v5
v_add_u32 v2, 147712, v2
v_lshl_add_u32 v214, v4, 2, v2
v_mul_u32_u24 v2, 96, v5
v_add_u32 v2, 157952, v2
v_lshl_add_u32 v216, v4, 1, v2
v_bfe_u32 v3, v1, 2, 1
v_lshl_add_u32 v2, v3, 5, v2
v_and_b32 v3, 1, v1
v_lshl_add_u32 v2, v3, 4, v2
v_bfe_u32 v3, v1, 1, 1
v_lshl_add_u32 v215, v3, 3, v2
v_lshlrev_b32 v4, 2, v4
v_sub_u32 v5, v5, v4
v_cmp_le_i32 s[64:65], 0, v5
v_cmp_le_i32 s[66:67], 1, v5
v_cmp_le_i32 s[68:69], 2, v5
v_cmp_le_i32 s[70:71], 3, v5
v_mov_b32 v208, 0xd028965f
v_mov_b32 v146, 0
v_mov_b32 v147, 0
v_mov_b32 v150, 0
v_mov_b32 v151, 0
v_mov_b32 v182, 0
v_mov_b32 v183, 0
v_mov_b32 v186, 0
v_mov_b32 v187, 0
s_mov_b32 s40, 0x3e0293ee
s_lshl_b32 s26, s73, 7
s_lshl_b32 s27, s25, 2
s_add_u32 s26, s26, s27
v_mov_b32 v109, 0x40000000
s_add_u32 s27, s26, 0x6a00000
v_writelane_b32 v109, s27, 0
s_add_u32 s27, s26, 0x6a01000
v_writelane_b32 v109, s27, 1
s_add_u32 s27, s26, 0x6a04e00
v_writelane_b32 v109, s27, 2
s_mov_b64 s[50:51], 7
s_mov_b32 s56, s98
s_lshl_b32 s26, s73, 13
s_lshl_b32 s27, s98, 18
s_add_u32 s26, s26, s27
s_add_u32 s62, s26, 0x1400000
s_add_u32 s31, s26, 0x4c00000
s_lshr_b32 s26, s26, 2
s_add_u32 s59, s26, 0x5c00000
s_mov_b32 s29, 524288
s_mov_b32 s21, 0x40000000
s_mov_b32 s43, 0x40000000
s_mov_b32 s41, 0x40000000
s_mov_b32 s42, 0x40000000
s_mov_b32 s39, -1
s_mov_b32 s36, 0
s_mov_b32 s55, 0
s_waitcnt vmcnt(16)
s_barrier
ds_read_b64_tr_b16 a[0:1], v94 offset:0
ds_read_b64_tr_b16 a[2:3], v94 offset:2048
ds_read_b64_tr_b16 a[4:5], v95 offset:0
ds_read_b64_tr_b16 a[6:7], v95 offset:2048
ds_read_b64_tr_b16 a[8:9], v94 offset:8192
ds_read_b64_tr_b16 a[10:11], v94 offset:10240
ds_read_b64_tr_b16 a[12:13], v95 offset:8192
ds_read_b64_tr_b16 a[14:15], v95 offset:10240
ds_read_b64_tr_b16 a[16:17], v94 offset:16384
ds_read_b64_tr_b16 a[18:19], v94 offset:18432
ds_read_b64_tr_b16 a[20:21], v95 offset:16384
ds_read_b64_tr_b16 a[22:23], v95 offset:18432
ds_read_b64_tr_b16 a[24:25], v94 offset:24576
ds_read_b64_tr_b16 a[26:27], v94 offset:26624
ds_read_b64_tr_b16 a[28:29], v95 offset:24576
ds_read_b64_tr_b16 a[30:31], v95 offset:26624
ds_read_b64_tr_b16 a[32:33], v94 offset:32768
ds_read_b64_tr_b16 a[34:35], v94 offset:34816
ds_read_b64_tr_b16 a[36:37], v95 offset:32768
ds_read_b64_tr_b16 a[38:39], v95 offset:34816
ds_read_b64_tr_b16 a[40:41], v94 offset:40960
ds_read_b64_tr_b16 a[42:43], v94 offset:43008
ds_read_b64_tr_b16 a[44:45], v95 offset:40960
ds_read_b64_tr_b16 a[46:47], v95 offset:43008
ds_read_b64_tr_b16 a[48:49], v94 offset:49152
ds_read_b64_tr_b16 a[50:51], v94 offset:51200
ds_read_b64_tr_b16 a[52:53], v95 offset:49152
ds_read_b64_tr_b16 a[54:55], v95 offset:51200
ds_read_b64_tr_b16 a[56:57], v94 offset:57344
ds_read_b64_tr_b16 a[58:59], v94 offset:59392
ds_read_b64_tr_b16 a[60:61], v95 offset:57344
ds_read_b64_tr_b16 a[62:63], v95 offset:59392
s_waitcnt lgkmcnt(0)
s_barrier
s_lshl_b32 m0, s25, 14
s_mul_i32 s26, s30, 512
buffer_load_dwordx4 v92, s[12:15], s26 offen nt lds
s_add_u32 m0, m0, 1024
s_add_u32 s26, s26, s49
buffer_load_dwordx4 v93, s[12:15], s26 offen nt lds
s_add_u32 m0, m0, 1024
s_add_u32 s26, s26, s49
buffer_load_dwordx4 v92, s[12:15], s26 offen nt lds
s_add_u32 m0, m0, 1024
s_add_u32 s26, s26, s49
buffer_load_dwordx4 v93, s[12:15], s26 offen nt lds
s_add_u32 m0, m0, 1024
s_add_u32 s26, s26, s49
buffer_load_dwordx4 v92, s[12:15], s26 offen nt lds
s_add_u32 m0, m0, 1024
s_add_u32 s26, s26, s49
buffer_load_dwordx4 v93, s[12:15], s26 offen nt lds
s_add_u32 m0, m0, 1024
s_add_u32 s26, s26, s49
buffer_load_dwordx4 v92, s[12:15], s26 offen nt lds
s_add_u32 m0, m0, 1024
s_add_u32 s26, s26, s49
buffer_load_dwordx4 v93, s[12:15], s26 offen nt lds
s_add_u32 m0, m0, 1024
s_add_u32 s26, s26, s49
buffer_load_dwordx4 v92, s[12:15], s26 offen nt lds
s_add_u32 m0, m0, 1024
s_add_u32 s26, s26, s49
buffer_load_dwordx4 v93, s[12:15], s26 offen nt lds
s_add_u32 m0, m0, 1024
s_add_u32 s26, s26, s49
buffer_load_dwordx4 v92, s[12:15], s26 offen nt lds
s_add_u32 m0, m0, 1024
s_add_u32 s26, s26, s49
buffer_load_dwordx4 v93, s[12:15], s26 offen nt lds
s_add_u32 m0, m0, 1024
s_add_u32 s26, s26, s49
buffer_load_dwordx4 v92, s[12:15], s26 offen nt lds
s_add_u32 m0, m0, 1024
s_add_u32 s26, s26, s49
buffer_load_dwordx4 v93, s[12:15], s26 offen nt lds
s_add_u32 m0, m0, 1024
s_add_u32 s26, s26, s49
buffer_load_dwordx4 v92, s[12:15], s26 offen nt lds
s_add_u32 m0, m0, 1024
s_add_u32 s26, s26, s49
buffer_load_dwordx4 v93, s[12:15], s26 offen nt lds
s_waitcnt vmcnt(16)
s_barrier
ds_read_b64_tr_b16 a[64:65], v96 offset:0
ds_read_b64_tr_b16 a[66:67], v96 offset:2048
ds_read_b64_tr_b16 a[68:69], v97 offset:0
ds_read_b64_tr_b16 a[70:71], v97 offset:2048
ds_read_b64_tr_b16 a[72:73], v96 offset:8192
ds_read_b64_tr_b16 a[74:75], v96 offset:10240
ds_read_b64_tr_b16 a[76:77], v97 offset:8192
ds_read_b64_tr_b16 a[78:79], v97 offset:10240
ds_read_b64_tr_b16 a[80:81], v96 offset:16384
ds_read_b64_tr_b16 a[82:83], v96 offset:18432
ds_read_b64_tr_b16 a[84:85], v97 offset:16384
ds_read_b64_tr_b16 a[86:87], v97 offset:18432
ds_read_b64_tr_b16 a[88:89], v96 offset:24576
ds_read_b64_tr_b16 a[90:91], v96 offset:26624
ds_read_b64_tr_b16 a[92:93], v97 offset:24576
ds_read_b64_tr_b16 a[94:95], v97 offset:26624
ds_read_b64_tr_b16 a[96:97], v96 offset:32768
ds_read_b64_tr_b16 a[98:99], v96 offset:34816
ds_read_b64_tr_b16 a[100:101], v97 offset:32768
ds_read_b64_tr_b16 a[102:103], v97 offset:34816
ds_read_b64_tr_b16 a[104:105], v96 offset:40960
ds_read_b64_tr_b16 a[106:107], v96 offset:43008
ds_read_b64_tr_b16 a[108:109], v97 offset:40960
ds_read_b64_tr_b16 a[110:111], v97 offset:43008
ds_read_b64_tr_b16 a[112:113], v96 offset:49152
ds_read_b64_tr_b16 a[114:115], v96 offset:51200
ds_read_b64_tr_b16 a[116:117], v97 offset:49152
ds_read_b64_tr_b16 a[118:119], v97 offset:51200
ds_read_b64_tr_b16 a[120:121], v96 offset:57344
ds_read_b64_tr_b16 a[122:123], v96 offset:59392
ds_read_b64_tr_b16 a[124:125], v97 offset:57344
ds_read_b64_tr_b16 a[126:127], v97 offset:59392
s_waitcnt lgkmcnt(0)
s_barrier
s_lshl_b32 m0, s25, 14
s_add_u32 m0, m0, 0x10000
s_mul_i32 s26, s30, 768
buffer_load_dwordx4 v92, s[12:15], s26 offen nt lds
s_add_u32 m0, m0, 1024
s_add_u32 s26, s26, s49
buffer_load_dwordx4 v93, s[12:15], s26 offen nt lds
s_add_u32 m0, m0, 1024
s_add_u32 s26, s26, s49
buffer_load_dwordx4 v92, s[12:15], s26 offen nt lds
s_add_u32 m0, m0, 1024
s_add_u32 s26, s26, s49
buffer_load_dwordx4 v93, s[12:15], s26 offen nt lds
s_add_u32 m0, m0, 1024
s_add_u32 s26, s26, s49
buffer_load_dwordx4 v92, s[12:15], s26 offen nt lds
s_add_u32 m0, m0, 1024
s_add_u32 s26, s26, s49
buffer_load_dwordx4 v93, s[12:15], s26 offen nt lds
s_add_u32 m0, m0, 1024
s_add_u32 s26, s26, s49
buffer_load_dwordx4 v92, s[12:15], s26 offen nt lds
s_add_u32 m0, m0, 1024
s_add_u32 s26, s26, s49
buffer_load_dwordx4 v93, s[12:15], s26 offen nt lds
s_add_u32 m0, m0, 1024
s_add_u32 s26, s26, s49
buffer_load_dwordx4 v92, s[12:15], s26 offen nt lds
s_add_u32 m0, m0, 1024
s_add_u32 s26, s26, s49
buffer_load_dwordx4 v93, s[12:15], s26 offen nt lds
s_add_u32 m0, m0, 1024
s_add_u32 s26, s26, s49
buffer_load_dwordx4 v92, s[12:15], s26 offen nt lds
s_add_u32 m0, m0, 1024
s_add_u32 s26, s26, s49
buffer_load_dwordx4 v93, s[12:15], s26 offen nt lds
s_add_u32 m0, m0, 1024
s_add_u32 s26, s26, s49
buffer_load_dwordx4 v92, s[12:15], s26 offen nt lds
s_add_u32 m0, m0, 1024
s_add_u32 s26, s26, s49
buffer_load_dwordx4 v93, s[12:15], s26 offen nt lds
s_add_u32 m0, m0, 1024
s_add_u32 s26, s26, s49
buffer_load_dwordx4 v92, s[12:15], s26 offen nt lds
s_add_u32 m0, m0, 1024
s_add_u32 s26, s26, s49
buffer_load_dwordx4 v93, s[12:15], s26 offen nt lds
s_waitcnt vmcnt(16)
s_barrier
ds_read_b64_tr_b16 a[128:129], v94 offset:0
ds_read_b64_tr_b16 a[130:131], v94 offset:2048
ds_read_b64_tr_b16 a[132:133], v95 offset:0
ds_read_b64_tr_b16 a[134:135], v95 offset:2048
ds_read_b64_tr_b16 a[136:137], v94 offset:8192
ds_read_b64_tr_b16 a[138:139], v94 offset:10240
ds_read_b64_tr_b16 a[140:141], v95 offset:8192
ds_read_b64_tr_b16 a[142:143], v95 offset:10240
ds_read_b64_tr_b16 a[144:145], v94 offset:16384
ds_read_b64_tr_b16 a[146:147], v94 offset:18432
ds_read_b64_tr_b16 a[148:149], v95 offset:16384
ds_read_b64_tr_b16 a[150:151], v95 offset:18432
ds_read_b64_tr_b16 a[152:153], v94 offset:24576
ds_read_b64_tr_b16 a[154:155], v94 offset:26624
ds_read_b64_tr_b16 a[156:157], v95 offset:24576
ds_read_b64_tr_b16 a[158:159], v95 offset:26624
ds_read_b64_tr_b16 a[160:161], v94 offset:32768
ds_read_b64_tr_b16 a[162:163], v94 offset:34816
ds_read_b64_tr_b16 a[164:165], v95 offset:32768
ds_read_b64_tr_b16 a[166:167], v95 offset:34816
ds_read_b64_tr_b16 a[168:169], v94 offset:40960
ds_read_b64_tr_b16 a[170:171], v94 offset:43008
ds_read_b64_tr_b16 a[172:173], v95 offset:40960
ds_read_b64_tr_b16 a[174:175], v95 offset:43008
ds_read_b64_tr_b16 a[176:177], v94 offset:49152
ds_read_b64_tr_b16 a[178:179], v94 offset:51200
ds_read_b64_tr_b16 a[180:181], v95 offset:49152
ds_read_b64_tr_b16 a[182:183], v95 offset:51200
ds_read_b64_tr_b16 a[184:185], v94 offset:57344
ds_read_b64_tr_b16 a[186:187], v94 offset:59392
ds_read_b64_tr_b16 a[188:189], v95 offset:57344
ds_read_b64_tr_b16 a[190:191], v95 offset:59392
s_waitcnt lgkmcnt(0)
s_barrier
s_waitcnt vmcnt(0)
s_barrier
ds_read_b64_tr_b16 a[192:193], v96 offset:0
ds_read_b64_tr_b16 a[194:195], v96 offset:2048
ds_read_b64_tr_b16 a[196:197], v97 offset:0
ds_read_b64_tr_b16 a[198:199], v97 offset:2048
ds_read_b64_tr_b16 a[200:201], v96 offset:8192
ds_read_b64_tr_b16 a[202:203], v96 offset:10240
ds_read_b64_tr_b16 a[204:205], v97 offset:8192
ds_read_b64_tr_b16 a[206:207], v97 offset:10240
ds_read_b64_tr_b16 a[208:209], v96 offset:16384
ds_read_b64_tr_b16 a[210:211], v96 offset:18432
ds_read_b64_tr_b16 a[212:213], v97 offset:16384
ds_read_b64_tr_b16 a[214:215], v97 offset:18432
ds_read_b64_tr_b16 a[216:217], v96 offset:24576
ds_read_b64_tr_b16 a[218:219], v96 offset:26624
ds_read_b64_tr_b16 a[220:221], v97 offset:24576
ds_read_b64_tr_b16 a[222:223], v97 offset:26624
ds_read_b64_tr_b16 a[224:225], v96 offset:32768
ds_read_b64_tr_b16 a[226:227], v96 offset:34816
ds_read_b64_tr_b16 a[228:229], v97 offset:32768
ds_read_b64_tr_b16 a[230:231], v97 offset:34816
ds_read_b64_tr_b16 a[232:233], v96 offset:40960
ds_read_b64_tr_b16 a[234:235], v96 offset:43008
ds_read_b64_tr_b16 a[236:237], v97 offset:40960
ds_read_b64_tr_b16 a[238:239], v97 offset:43008
ds_read_b64_tr_b16 a[240:241], v96 offset:49152
ds_read_b64_tr_b16 a[242:243], v96 offset:51200
ds_read_b64_tr_b16 a[244:245], v97 offset:49152
ds_read_b64_tr_b16 a[246:247], v97 offset:51200
ds_read_b64_tr_b16 a[248:249], v96 offset:57344
ds_read_b64_tr_b16 a[250:251], v96 offset:59392
ds_read_b64_tr_b16 a[252:253], v97 offset:57344
ds_read_b64_tr_b16 a[254:255], v97 offset:59392
s_waitcnt lgkmcnt(0)
s_barrier
s_mov_b32 s20, s52
s_mov_b32 s36, 0
s_lshr_b32 s24, s37, 1
s_sub_u32 s24, s24, 1
s_mov_b32 m0, s22
s_nop 0
buffer_load_dwordx4 v8, s[8:11], s20 offen sc1 lds
s_add_u32 s36, s36, 1
buffer_load_dwordx4 v8, s[8:11], s20 offen offset:1024 sc1 lds
buffer_load_dword v2, v11, s[8:11], 0 offen
buffer_load_dwordx4 v8, s[8:11], s20 offen offset:2048 sc1 lds
buffer_load_dwordx4 v8, s[8:11], s20 offen offset:3072 sc1 lds
s_add_u32 s20, s20, s23
s_add_u32 m0, s22, 16384
s_nop 0
buffer_load_dwordx4 v8, s[8:11], s20 offen sc1 lds
buffer_load_dwordx4 v8, s[8:11], s20 offen offset:1024 sc1 lds
buffer_load_dwordx4 v8, s[8:11], s20 offen offset:2048 sc1 lds
buffer_load_dword v2, v11, s[8:11], 0 offen
buffer_load_dword v2, v11, s[8:11], 0 offen
buffer_load_dwordx4 v8, s[8:11], s20 offen offset:3072 sc1 lds
s_add_u32 s20, s20, s23
s_add_u32 m0, s22, 32768
buffer_load_dword v2, v11, s[8:11], 0 offen
buffer_load_dword v2, v11, s[8:11], 0 offen
buffer_load_dword v2, v11, s[8:11], 0 offen
buffer_load_dwordx4 v8, s[8:11], s20 offen sc1 lds
buffer_load_dword v2, v11, s[8:11], 0 offen
buffer_load_dword v2, v11, s[8:11], 0 offen
buffer_load_dword v2, v11, s[8:11], 0 offen
buffer_load_dwordx4 v8, s[8:11], s20 offen offset:1024 sc1 lds
buffer_load_dword v2, v11, s[8:11], 0 offen
buffer_load_dwordx4 v8, s[8:11], s20 offen offset:2048 sc1 lds
buffer_load_dwordx4 v8, s[8:11], s20 offen offset:3072 sc1 lds
s_add_u32 s20, s20, s23
s_add_u32 m0, s22, 49152
s_nop 0
buffer_load_dwordx4 v8, s[8:11], s20 offen sc1 lds
buffer_load_dwordx4 v8, s[8:11], s20 offen offset:1024 sc1 lds
buffer_load_dwordx4 v8, s[8:11], s20 offen offset:2048 sc1 lds
buffer_load_dword v2, v11, s[8:11], 0 offen
buffer_load_dwordx4 v8, s[8:11], s20 offen offset:3072 sc1 lds
s_add_u32 s20, s20, s28
s_add_u32 m0, s22, 65536
s_cmp_lt_u32 s36, s37
s_cselect_b32 s20, s20, 0x40000000
buffer_load_dwordx4 v8, s[8:11], s20 offen sc1 lds
s_add_u32 s36, s36, 1
buffer_load_dwordx4 v8, s[8:11], s20 offen offset:1024 sc1 lds
buffer_load_dword v2, v11, s[8:11], 0 offen
buffer_load_dwordx4 v8, s[8:11], s20 offen offset:2048 sc1 lds
buffer_load_dwordx4 v8, s[8:11], s20 offen offset:3072 sc1 lds
s_add_u32 s20, s20, s23
s_add_u32 m0, s22, 81920
s_nop 0
buffer_load_dwordx4 v8, s[8:11], s20 offen sc1 lds
buffer_load_dwordx4 v8, s[8:11], s20 offen offset:1024 sc1 lds
buffer_load_dword v111, v109, s[8:11], 0 offen sc1
s_waitcnt vmcnt(0)
s_waitcnt vmcnt(24)
s_barrier
ds_read_b128 v[12:15], v6 offset:0
ds_read_b128 v[16:19], v6 offset:256
ds_read_b128 v[20:23], v6 offset:2048
ds_read_b128 v[24:27], v6 offset:2304
ds_read_b128 v[28:31], v6 offset:4096
ds_read_b128 v[32:35], v6 offset:4352
s_waitcnt lgkmcnt(0)
.p2align 3
main_kernel_qj_lp:
v_mfma_f32_16x16x32_bf16 v[44:47], a[0:3], v[12:15], 0
ds_read_b128 v[36:39], v6 offset:6144
ds_read_b128 v[172:175], v217 offset:0
v_mfma_f32_16x16x32_bf16 v[52:55], a[0:3], v[16:19], 0
ds_read_b128 v[40:43], v6 offset:6400
ds_read_b64 v[180:181], v218 offset:64
v_mfma_f32_16x16x32_bf16 v[56:59], a[4:7], v[16:19], 0
ds_read_b128 v[176:179], v217 offset:1536
ds_read_b64 v[184:185], v218 offset:1600
v_mfma_f32_16x16x32_bf16 v[48:51], a[4:7], v[12:15], 0
s_waitcnt lgkmcnt(8)
v_cvt_pk_bf16_f32 v116, v60, v61
v_cvt_pk_bf16_f32 v117, v62, v63
v_mfma_f32_16x16x32_bf16 v[44:47], a[8:11], v[20:23], v[44:47]
s_waitcnt vmcnt(14)
ds_read_b128 v[12:15], v6 offset:8192
s_waitcnt lgkmcnt(3)
v_mfma_f32_16x16x32_bf16 v[188:191], v[136:139], v[172:175], 0
v_cvt_pk_bf16_f32 v118, v64, v65
v_mfma_f32_16x16x32_bf16 v[52:55], a[8:11], v[24:27], v[52:55]
ds_read_b128 v[16:19], v6 offset:8448
v_cvt_pk_bf16_f32 v119, v66, v67
v_mfma_f32_16x16x32_bf16 v[192:195], v[140:143], v[172:175], 0
v_mfma_f32_16x16x32_bf16 v[56:59], a[12:15], v[24:27], v[56:59]
buffer_load_dwordx4 v8, s[8:11], s20 offen offset:2048 sc1 lds
v_mfma_f32_16x16x32_bf16 v[188:191], v[144:147], v[180:183], v[188:191]
v_mfma_f32_16x16x32_bf16 v[48:51], a[12:15], v[20:23], v[48:51]
s_waitcnt lgkmcnt(8)
v_mfma_f32_16x16x32_bf16 v[192:195], v[148:151], v[180:183], v[192:195]
s_waitcnt lgkmcnt(2)
v_mfma_f32_16x16x32_bf16 v[44:47], a[16:19], v[28:31], v[44:47]
ds_read_b128 v[20:23], v6 offset:10240
v_mfma_f32_16x16x32_bf16 v[196:199], v[136:139], v[176:179], 0
v_mfma_f32_16x16x32_bf16 v[52:55], a[16:19], v[32:35], v[52:55]
ds_read_b128 v[24:27], v6 offset:10496
v_mfma_f32_16x16x32_bf16 v[200:203], v[140:143], v[176:179], 0
buffer_load_dwordx4 v[136:139], v209, s[8:11], s41 offen offset:0 sc1
v_cvt_pk_bf16_f32 v84, v188, v189
v_mfma_f32_16x16x32_bf16 v[56:59], a[20:23], v[32:35], v[56:59]
v_cvt_pk_bf16_f32 v85, v190, v191
v_cvt_pk_bf16_f32 v86, v192, v193
v_mfma_f32_16x16x32_bf16 v[48:51], a[20:23], v[28:31], v[48:51]
s_waitcnt lgkmcnt(7)
buffer_load_dwordx4 v[140:143], v209, s[8:11], s41 offen offset:128 sc1
v_mfma_f32_16x16x32_bf16 v[44:47], a[24:27], v[36:39], v[44:47]
s_waitcnt vmcnt(19)
ds_read_b128 v[28:31], v6 offset:12288
v_cvt_pk_bf16_f32 v87, v194, v195
v_mfma_f32_16x16x32_bf16 v[196:199], v[144:147], v[184:187], v[196:199]
s_waitcnt vmcnt(11)
v_readlane_b32 s55, v111, 0
v_mfma_f32_16x16x32_bf16 v[152:155], v[124:127], v[116:119], 0
v_cvt_pk_bf16_f32 v120, v68, v69
v_cvt_pk_bf16_f32 v121, v70, v71
v_mfma_f32_16x16x32_bf16 v[52:55], a[24:27], v[40:43], v[52:55]
ds_read_b128 v[32:35], v6 offset:12544
v_cvt_pk_bf16_f32 v122, v72, v73
v_mfma_f32_16x16x32_bf16 v[56:59], a[28:31], v[40:43], v[56:59]
buffer_load_dwordx4 v8, s[8:11], s20 offen offset:3072 sc1 lds
v_cvt_pk_bf16_f32 v123, v74, v75
v_mfma_f32_16x16x32_bf16 v[164:167], v[132:135], v[116:119], 0
v_readlane_b32 s60, v111, 1
v_mfma_f32_16x16x32_bf16 v[48:51], a[28:31], v[36:39], v[48:51]
s_waitcnt lgkmcnt(4)
v_readlane_b32 s61, v111, 2
s_add_u32 s20, s20, s23
v_mfma_f32_16x16x32_bf16 v[156:159], v[124:127], v[120:123], 0
s_add_u32 m0, s22, 98304
v_mfma_f32_16x16x32_bf16 v[44:47], a[32:35], v[12:15], v[44:47]
s_min_u32 s55, s55, s60
ds_read_b128 v[36:39], v6 offset:14336
v_mfma_f32_16x16x32_bf16 v[160:163], v[128:131], v[120:123], 0
buffer_store_dwordx4 v[84:87], v9, s[8:11], s21 offen sc1
v_mfma_f32_16x16x32_bf16 v[52:55], a[32:35], v[16:19], v[52:55]
s_min_u32 s55, s55, s61
ds_read_b128 v[40:43], v6 offset:14592
s_cmp_gt_u32 s55, s56
v_mfma_f32_16x16x32_bf16 v[200:203], v[148:151], v[184:187], v[200:203]
s_cselect_b32 s60, 0, 1
v_cvt_pk_bf16_f32 v88, v196, v197
v_cvt_pk_bf16_f32 v89, v198, v199
v_mfma_f32_16x16x32_bf16 v[168:171], v[132:135], v[120:123], 0
ds_write_b128 v212, v[152:155] offset:0
v_mfma_f32_16x16x32_bf16 v[56:59], a[36:39], v[16:19], v[56:59]
s_cselect_b32 s57, s62, 0x40000000
buffer_load_dwordx2 v[144:145], v211, s[8:11], s42 offen offset:0 sc1
v_mfma_f32_16x16x32_bf16 v[48:51], a[36:39], v[12:15], v[48:51]
s_waitcnt lgkmcnt(5)
v_cvt_pk_bf16_f32 v90, v200, v201
s_cselect_b32 s58, s59, 0x40000000
v_mfma_f32_16x16x32_bf16 v[44:47], a[40:43], v[20:23], v[44:47]
buffer_load_dwordx4 v[124:127], v9, s[8:11], s57 offen offset:0 sc1
ds_read_b128 v[12:15], v6 offset:16384
v_mfma_f32_16x16x32_bf16 v[52:55], a[40:43], v[24:27], v[52:55]
ds_read_b128 v[16:19], v6 offset:16640
v_cvt_pk_bf16_f32 v91, v202, v203
v_mfma_f32_16x16x32_bf16 v[56:59], a[44:47], v[24:27], v[56:59]
buffer_load_dwordx4 v8, s[8:11], s20 offen sc1 lds
v_mfma_f32_16x16x32_bf16 v[48:51], a[44:47], v[20:23], v[48:51]
s_waitcnt lgkmcnt(5)
ds_write_b128 v220, v[164:167] offset:0
v_mfma_f32_16x16x32_bf16 v[44:47], a[48:51], v[28:31], v[44:47]
buffer_load_dwordx4 v[128:131], v9, s[8:11], s57 offen offset:256 sc1
ds_read_b128 v[20:23], v6 offset:18432
v_mfma_f32_16x16x32_bf16 v[52:55], a[48:51], v[32:35], v[52:55]
ds_read_b128 v[24:27], v6 offset:18688
v_mfma_f32_16x16x32_bf16 v[56:59], a[52:55], v[32:35], v[56:59]
buffer_store_dwordx4 v[88:91], v9, s[8:11], s21 offen offset:256 sc1
s_mov_b32 s21, s43
v_mfma_f32_16x16x32_bf16 v[48:51], a[52:55], v[28:31], v[48:51]
s_waitcnt lgkmcnt(6)
s_mov_b32 s43, s31
s_add_u32 s31, s31, s29
v_mfma_f32_16x16x32_bf16 v[44:47], a[56:59], v[36:39], v[44:47]
buffer_load_dwordx4 v[132:135], v210, s[8:11], s58 offen sc1
ds_read_b128 v[28:31], v6 offset:20480
v_mfma_f32_16x16x32_bf16 v[52:55], a[56:59], v[40:43], v[52:55]
ds_read_b128 v[32:35], v6 offset:20736
v_mfma_f32_16x16x32_bf16 v[56:59], a[60:63], v[40:43], v[56:59]
buffer_load_dwordx4 v8, s[8:11], s20 offen offset:1024 sc1 lds
v_mfma_f32_16x16x32_bf16 v[48:51], a[60:63], v[36:39], v[48:51]
s_waitcnt lgkmcnt(5)
ds_write_b128 v212, v[156:159] offset:2048
v_mfma_f32_16x16x32_bf16 v[44:47], a[64:67], v[12:15], v[44:47]
buffer_load_dwordx2 v[148:149], v211, s[8:11], s42 offen offset:64 sc1
ds_read_b128 v[36:39], v6 offset:22528
v_mfma_f32_16x16x32_bf16 v[52:55], a[64:67], v[16:19], v[52:55]
ds_read_b128 v[40:43], v6 offset:22784
v_mfma_f32_16x16x32_bf16 v[56:59], a[68:71], v[16:19], v[56:59]
ds_write_b128 v219, v[160:163] offset:2048
v_mfma_f32_16x16x32_bf16 v[48:51], a[68:71], v[12:15], v[48:51]
s_waitcnt lgkmcnt(6)
v_mfma_f32_16x16x32_bf16 v[44:47], a[72:75], v[20:23], v[44:47]
ds_read_b128 v[12:15], v6 offset:24576
v_mfma_f32_16x16x32_bf16 v[52:55], a[72:75], v[24:27], v[52:55]
ds_read_b128 v[16:19], v6 offset:24832
v_mfma_f32_16x16x32_bf16 v[56:59], a[76:79], v[24:27], v[56:59]
buffer_load_dwordx4 v8, s[8:11], s20 offen offset:2048 sc1 lds
v_mfma_f32_16x16x32_bf16 v[48:51], a[76:79], v[20:23], v[48:51]
s_waitcnt lgkmcnt(6)
v_mfma_f32_16x16x32_bf16 v[44:47], a[80:83], v[28:31], v[44:47]
ds_read_b128 v[20:23], v6 offset:26624
v_mfma_f32_16x16x32_bf16 v[52:55], a[80:83], v[32:35], v[52:55]
ds_read_b128 v[24:27], v6 offset:26880
v_mfma_f32_16x16x32_bf16 v[56:59], a[84:87], v[32:35], v[56:59]
ds_write_b128 v220, v[168:171] offset:1280
v_mfma_f32_16x16x32_bf16 v[48:51], a[84:87], v[28:31], v[48:51]
s_waitcnt lgkmcnt(6)
v_mfma_f32_16x16x32_bf16 v[44:47], a[88:91], v[36:39], v[44:47]
ds_read_b128 v[28:31], v6 offset:28672
v_mfma_f32_16x16x32_bf16 v[52:55], a[88:91], v[40:43], v[52:55]
ds_read_b128 v[32:35], v6 offset:28928
v_mfma_f32_16x16x32_bf16 v[56:59], a[92:95], v[40:43], v[56:59]
buffer_load_dwordx4 v8, s[8:11], s20 offen offset:3072 sc1 lds
v_mfma_f32_16x16x32_bf16 v[48:51], a[92:95], v[36:39], v[48:51]
s_waitcnt lgkmcnt(5)
s_add_u32 s20, s20, s23
s_add_u32 m0, s22, 114688
v_mfma_f32_16x16x32_bf16 v[44:47], a[96:99], v[12:15], v[44:47]
ds_read_b128 v[36:39], v6 offset:30720
v_mfma_f32_16x16x32_bf16 v[52:55], a[96:99], v[16:19], v[52:55]
ds_read_b128 v[40:43], v6 offset:30976
v_mfma_f32_16x16x32_bf16 v[56:59], a[100:103], v[16:19], v[56:59]
v_mfma_f32_16x16x32_bf16 v[48:51], a[100:103], v[12:15], v[48:51]
s_waitcnt lgkmcnt(4)
v_mfma_f32_16x16x32_bf16 v[44:47], a[104:107], v[20:23], v[44:47]
s_waitcnt vmcnt(22)
s_barrier
ds_read_b128 v[12:15], v6 offset:32768
v_mfma_f32_16x16x32_bf16 v[52:55], a[104:107], v[24:27], v[52:55]
ds_read_b128 v[16:19], v6 offset:33024
ds_read_b128 v[152:155], v213 offset:0
v_mfma_f32_16x16x32_bf16 v[56:59], a[108:111], v[24:27], v[56:59]
buffer_load_dwordx4 v8, s[8:11], s20 offen sc1 lds
ds_read_b32 v168, v214 offset:0
v_mfma_f32_16x16x32_bf16 v[48:51], a[108:111], v[20:23], v[48:51]
s_waitcnt lgkmcnt(6)
ds_read_b128 v[156:159], v213 offset:4096
ds_read_b32 v169, v214 offset:2560
v_mfma_f32_16x16x32_bf16 v[44:47], a[112:115], v[28:31], v[44:47]
ds_read_b128 v[20:23], v6 offset:34816
ds_read_b128 v[160:163], v213 offset:8192
v_mfma_f32_16x16x32_bf16 v[52:55], a[112:115], v[32:35], v[52:55]
ds_read_b128 v[24:27], v6 offset:35072
ds_read_b32 v170, v214 offset:5120
v_mfma_f32_16x16x32_bf16 v[56:59], a[116:119], v[32:35], v[56:59]
ds_read_b128 v[164:167], v213 offset:12288
ds_read_b32 v171, v214 offset:7680
v_mfma_f32_16x16x32_bf16 v[48:51], a[116:119], v[28:31], v[48:51]
s_waitcnt lgkmcnt(12)
s_waitcnt lgkmcnt(6)
v_add_f32 v152, v152, v156
v_mfma_f32_16x16x32_bf16 v[44:47], a[120:123], v[36:39], v[44:47]
ds_read_b128 v[28:31], v6 offset:36864
v_add_f32 v153, v153, v157
v_mfma_f32_16x16x32_bf16 v[52:55], a[120:123], v[40:43], v[52:55]
ds_read_b128 v[32:35], v6 offset:37120
v_add_f32 v154, v154, v158
v_mfma_f32_16x16x32_bf16 v[56:59], a[124:127], v[40:43], v[56:59]
buffer_load_dwordx4 v8, s[8:11], s20 offen offset:1024 sc1 lds
v_add_f32 v155, v155, v159
v_mfma_f32_16x16x32_bf16 v[48:51], a[124:127], v[36:39], v[48:51]
s_waitcnt lgkmcnt(12)
v_add_f32 v168, v168, v169
s_waitcnt lgkmcnt(2)
v_mfma_f32_16x16x32_bf16 v[44:47], a[128:131], v[12:15], v[44:47]
ds_read_b128 v[36:39], v6 offset:38912
v_add_f32 v160, v160, v164
v_mfma_f32_16x16x32_bf16 v[52:55], a[128:131], v[16:19], v[52:55]
ds_read_b128 v[40:43], v6 offset:39168
v_add_f32 v161, v161, v165
v_mfma_f32_16x16x32_bf16 v[56:59], a[132:135], v[16:19], v[56:59]
v_add_f32 v162, v162, v166
v_add_f32 v163, v163, v167
v_mfma_f32_16x16x32_bf16 v[48:51], a[132:135], v[12:15], v[48:51]
s_waitcnt lgkmcnt(7)
v_add_f32 v170, v170, v171
v_mfma_f32_16x16x32_bf16 v[44:47], a[136:139], v[20:23], v[44:47]
ds_read_b128 v[12:15], v6 offset:40960
v_add_f32 v152, v152, v160
v_mfma_f32_16x16x32_bf16 v[52:55], a[136:139], v[24:27], v[52:55]
ds_read_b128 v[16:19], v6 offset:41216
v_add_f32 v153, v153, v161
v_mfma_f32_16x16x32_bf16 v[56:59], a[140:143], v[24:27], v[56:59]
buffer_load_dwordx4 v8, s[8:11], s20 offen offset:2048 sc1 lds
v_add_f32 v154, v154, v162
v_mfma_f32_16x16x32_bf16 v[48:51], a[140:143], v[20:23], v[48:51]
s_waitcnt lgkmcnt(4)
v_add_f32 v155, v155, v163
v_add_f32 v156, v168, v170
v_mfma_f32_16x16x32_bf16 v[44:47], a[144:147], v[28:31], v[44:47]
ds_read_b128 v[20:23], v6 offset:43008
v_cndmask_b32 v152, v208, v152, s[64:65]
v_mfma_f32_16x16x32_bf16 v[52:55], a[144:147], v[32:35], v[52:55]
ds_read_b128 v[24:27], v6 offset:43264
v_cndmask_b32 v153, v208, v153, s[66:67]
v_mfma_f32_16x16x32_bf16 v[56:59], a[148:151], v[32:35], v[56:59]
v_cndmask_b32 v154, v208, v154, s[68:69]
v_mfma_f32_16x16x32_bf16 v[48:51], a[148:151], v[28:31], v[48:51]
s_waitcnt lgkmcnt(4)
v_cndmask_b32 v155, v208, v155, s[70:71]
v_max3_f32 v204, v152, v153, v156
v_mfma_f32_16x16x32_bf16 v[44:47], a[152:155], v[36:39], v[44:47]
buffer_load_dword v111, v109, s[8:11], 0 offen sc1
ds_read_b128 v[28:31], v6 offset:45056
v_mfma_f32_16x16x32_bf16 v[52:55], a[152:155], v[40:43], v[52:55]
ds_read_b128 v[32:35], v6 offset:45312
v_max3_f32 v204, v204, v154, v155
v_mfma_f32_16x16x32_bf16 v[56:59], a[156:159], v[40:43], v[56:59]
buffer_load_dwordx4 v8, s[8:11], s20 offen offset:3072 sc1 lds
v_max_f32_dpp v204, v204, v204 quad_perm:[1,0,3,2] row_mask:0xf bank_mask:0xf
v_mfma_f32_16x16x32_bf16 v[48:51], a[156:159], v[36:39], v[48:51]
s_waitcnt lgkmcnt(4)
s_add_u32 s20, s20, s28
v_max_f32_dpp v204, v204, v204 quad_perm:[2,3,0,1] row_mask:0xf bank_mask:0xf
v_mfma_f32_16x16x32_bf16 v[44:47], a[160:163], v[12:15], v[44:47]
s_add_u32 m0, s22, 0
ds_read_b128 v[36:39], v6 offset:47104
v_max_f32_dpp v204, v204, v204 row_half_mirror row_mask:0xf bank_mask:0xf
v_mfma_f32_16x16x32_bf16 v[52:55], a[160:163], v[16:19], v[52:55]
s_cmp_lt_u32 s36, s37
ds_read_b128 v[40:43], v6 offset:47360
s_cselect_b32 s20, s20, 0x40000000
v_mfma_f32_16x16x32_bf16 v[56:59], a[164:167], v[16:19], v[56:59]
v_mul_f32 v204, s40, v204
v_fma_f32 v152, v152, s40, -v204
v_mfma_f32_16x16x32_bf16 v[48:51], a[164:167], v[12:15], v[48:51]
s_waitcnt lgkmcnt(4)
v_exp_f32 v152, v152
v_mfma_f32_16x16x32_bf16 v[44:47], a[168:171], v[20:23], v[44:47]
ds_read_b128 v[12:15], v6 offset:49152
v_fma_f32 v153, v153, s40, -v204
v_mfma_f32_16x16x32_bf16 v[52:55], a[168:171], v[24:27], v[52:55]
ds_read_b128 v[16:19], v6 offset:49408
v_fma_f32 v154, v154, s40, -v204
v_mfma_f32_16x16x32_bf16 v[56:59], a[172:175], v[24:27], v[56:59]
buffer_load_dwordx4 v8, s[8:11], s20 offen sc1 lds
v_fma_f32 v155, v155, s40, -v204
v_mfma_f32_16x16x32_bf16 v[48:51], a[172:175], v[20:23], v[48:51]
s_waitcnt lgkmcnt(4)
v_exp_f32 v153, v153
v_mfma_f32_16x16x32_bf16 v[44:47], a[176:179], v[28:31], v[44:47]
s_add_u32 s36, s36, 1
ds_read_b128 v[20:23], v6 offset:51200
v_fma_f32 v156, v156, s40, -v204
v_mfma_f32_16x16x32_bf16 v[52:55], a[176:179], v[32:35], v[52:55]
ds_read_b128 v[24:27], v6 offset:51456
v_add_f32 v204, v152, v153
v_mfma_f32_16x16x32_bf16 v[56:59], a[180:183], v[32:35], v[56:59]
v_exp_f32 v154, v154
v_mfma_f32_16x16x32_bf16 v[48:51], a[180:183], v[28:31], v[48:51]
s_waitcnt lgkmcnt(4)
v_exp_f32 v155, v155
v_mfma_f32_16x16x32_bf16 v[44:47], a[184:187], v[36:39], v[44:47]
ds_read_b128 v[28:31], v6 offset:53248
v_add_f32 v205, v154, v155
v_mfma_f32_16x16x32_bf16 v[52:55], a[184:187], v[40:43], v[52:55]
ds_read_b128 v[32:35], v6 offset:53504
v_exp_f32 v156, v156
v_mfma_f32_16x16x32_bf16 v[56:59], a[188:191], v[40:43], v[56:59]
buffer_load_dwordx4 v8, s[8:11], s20 offen offset:1024 sc1 lds
v_add_f32 v204, v204, v156
v_mfma_f32_16x16x32_bf16 v[48:51], a[188:191], v[36:39], v[48:51]
s_waitcnt lgkmcnt(4)
v_add_f32 v204, v204, v205
v_mfma_f32_16x16x32_bf16 v[44:47], a[192:195], v[12:15], v[44:47]
s_waitcnt vmcnt(12)
ds_read_b128 v[36:39], v6 offset:55296
v_add_f32_dpp v204, v204, v204 quad_perm:[1,0,3,2] row_mask:0xf bank_mask:0xf
v_mfma_f32_16x16x32_bf16 v[52:55], a[192:195], v[16:19], v[52:55]
s_max_i32 s27, s39, 0
ds_read_b128 v[40:43], v6 offset:55552
v_add_f32_dpp v204, v204, v204 quad_perm:[2,3,0,1] row_mask:0xf bank_mask:0xf
v_mfma_f32_16x16x32_bf16 v[56:59], a[196:199], v[16:19], v[56:59]
v_mov_b32 v112, s27
v_add_f32_dpp v204, v204, v204 row_half_mirror row_mask:0xf bank_mask:0xf
v_mfma_f32_16x16x32_bf16 v[48:51], a[196:199], v[12:15], v[48:51]
s_waitcnt lgkmcnt(4)
v_rcp_f32 v204, v204
v_mfma_f32_16x16x32_bf16 v[44:47], a[200:203], v[20:23], v[44:47]
buffer_store_dword v112, v108, s[8:11], 0 offen sc1
ds_read_b128 v[12:15], v6 offset:57344
v_mfma_f32_16x16x32_bf16 v[52:55], a[200:203], v[24:27], v[52:55]
ds_read_b128 v[16:19], v6 offset:57600
v_mul_f32 v152, v152, v204
v_mfma_f32_16x16x32_bf16 v[56:59], a[204:207], v[24:27], v[56:59]
buffer_load_dwordx4 v8, s[8:11], s20 offen offset:2048 sc1 lds
v_mul_f32 v153, v153, v204
v_mfma_f32_16x16x32_bf16 v[48:51], a[204:207], v[20:23], v[48:51]
s_waitcnt lgkmcnt(4)
v_mul_f32 v154, v154, v204
v_mul_f32 v155, v155, v204
v_mfma_f32_16x16x32_bf16 v[44:47], a[208:211], v[28:31], v[44:47]
ds_read_b128 v[20:23], v6 offset:59392
v_mul_f32 v156, v156, v204
v_mfma_f32_16x16x32_bf16 v[52:55], a[208:211], v[32:35], v[52:55]
ds_read_b128 v[24:27], v6 offset:59648
v_cvt_pk_bf16_f32 v158, v152, v153
v_mfma_f32_16x16x32_bf16 v[56:59], a[212:215], v[32:35], v[56:59]
v_cvt_pk_bf16_f32 v159, v154, v155
v_mfma_f32_16x16x32_bf16 v[48:51], a[212:215], v[28:31], v[48:51]
s_waitcnt lgkmcnt(4)
v_cvt_pk_bf16_f32 v160, v156, v156
v_mfma_f32_16x16x32_bf16 v[44:47], a[216:219], v[36:39], v[44:47]
ds_read_b128 v[28:31], v6 offset:61440
ds_write_b64 v215, v[158:159]
v_mfma_f32_16x16x32_bf16 v[52:55], a[216:219], v[40:43], v[52:55]
ds_read_b128 v[32:35], v6 offset:61696
ds_write_b16 v216, v160 offset:64
v_mfma_f32_16x16x32_bf16 v[56:59], a[220:223], v[40:43], v[56:59]
buffer_load_dwordx4 v8, s[8:11], s20 offen offset:3072 sc1 lds
v_mfma_f32_16x16x32_bf16 v[48:51], a[220:223], v[36:39], v[48:51]
s_waitcnt lgkmcnt(6)
s_add_u32 s20, s20, s23
s_add_u32 m0, s22, 16384
v_mfma_f32_16x16x32_bf16 v[44:47], a[224:227], v[12:15], v[44:47]
ds_read_b128 v[36:39], v6 offset:63488
v_mfma_f32_16x16x32_bf16 v[52:55], a[224:227], v[16:19], v[52:55]
ds_read_b128 v[40:43], v6 offset:63744
v_mfma_f32_16x16x32_bf16 v[56:59], a[228:231], v[16:19], v[56:59]
v_mfma_f32_16x16x32_bf16 v[48:51], a[228:231], v[12:15], v[48:51]
s_waitcnt lgkmcnt(2)
v_mfma_f32_16x16x32_bf16 v[44:47], a[232:235], v[20:23], v[44:47]
s_waitcnt vmcnt(21)
s_barrier
ds_read_b128 v[12:15], v7 offset:0
v_mfma_f32_16x16x32_bf16 v[52:55], a[232:235], v[24:27], v[52:55]
s_cmp_lg_u32 s60, 0
ds_read_b128 v[16:19], v7 offset:256
v_mfma_f32_16x16x32_bf16 v[56:59], a[236:239], v[24:27], v[56:59]
buffer_load_dwordx4 v8, s[8:11], s20 offen sc1 lds
v_mfma_f32_16x16x32_bf16 v[48:51], a[236:239], v[20:23], v[48:51]
s_waitcnt lgkmcnt(5)
v_mfma_f32_16x16x32_bf16 v[44:47], a[240:243], v[28:31], v[44:47]
ds_read_b128 v[20:23], v7 offset:2048
v_mfma_f32_16x16x32_bf16 v[52:55], a[240:243], v[32:35], v[52:55]
ds_read_b128 v[24:27], v7 offset:2304
v_mfma_f32_16x16x32_bf16 v[56:59], a[244:247], v[32:35], v[56:59]
s_cbranch_scc1 main_kernel_qj_c0
main_kernel_qj_k0:
s_add_u32 s39, s39, 1
v_mfma_f32_16x16x32_bf16 v[48:51], a[244:247], v[28:31], v[48:51]
s_waitcnt lgkmcnt(4)
s_add_u32 s56, s56, 2
s_add_u32 s41, s62, 0x1000000
v_mfma_f32_16x16x32_bf16 v[44:47], a[248:251], v[36:39], v[44:47]
s_mov_b32 s42, s59
ds_read_b128 v[28:31], v7 offset:4096
s_add_u32 s62, s62, 524288
v_mfma_f32_16x16x32_bf16 v[52:55], a[248:251], v[40:43], v[52:55]
s_add_u32 s59, s59, 131072
ds_read_b128 v[32:35], v7 offset:4352
v_mfma_f32_16x16x32_bf16 v[56:59], a[252:255], v[40:43], v[56:59]
buffer_load_dwordx4 v8, s[8:11], s20 offen offset:1024 sc1 lds
v_mfma_f32_16x16x32_bf16 v[48:51], a[252:255], v[36:39], v[48:51]
s_waitcnt lgkmcnt(4)
v_mfma_f32_16x16x32_bf16 v[60:63], a[0:3], v[12:15], 0
ds_read_b128 v[36:39], v7 offset:6144
ds_read_b128 v[172:175], v217 offset:0
v_mfma_f32_16x16x32_bf16 v[68:71], a[0:3], v[16:19], 0
ds_read_b128 v[40:43], v7 offset:6400
ds_read_b64 v[180:181], v218 offset:64
v_mfma_f32_16x16x32_bf16 v[72:75], a[4:7], v[16:19], 0
ds_read_b128 v[176:179], v217 offset:1536
ds_read_b64 v[184:185], v218 offset:1600
v_mfma_f32_16x16x32_bf16 v[64:67], a[4:7], v[12:15], 0
s_waitcnt lgkmcnt(8)
v_cvt_pk_bf16_f32 v116, v44, v45
v_cvt_pk_bf16_f32 v117, v46, v47
v_mfma_f32_16x16x32_bf16 v[60:63], a[8:11], v[20:23], v[60:63]
s_waitcnt vmcnt(14)
ds_read_b128 v[12:15], v7 offset:8192
s_waitcnt lgkmcnt(3)
v_mfma_f32_16x16x32_bf16 v[188:191], v[136:139], v[172:175], 0
v_cvt_pk_bf16_f32 v118, v48, v49
v_mfma_f32_16x16x32_bf16 v[68:71], a[8:11], v[24:27], v[68:71]
ds_read_b128 v[16:19], v7 offset:8448
v_cvt_pk_bf16_f32 v119, v50, v51
v_mfma_f32_16x16x32_bf16 v[192:195], v[140:143], v[172:175], 0
v_mfma_f32_16x16x32_bf16 v[72:75], a[12:15], v[24:27], v[72:75]
buffer_load_dwordx4 v8, s[8:11], s20 offen offset:2048 sc1 lds
v_mfma_f32_16x16x32_bf16 v[188:191], v[144:147], v[180:183], v[188:191]
v_mfma_f32_16x16x32_bf16 v[64:67], a[12:15], v[20:23], v[64:67]
s_waitcnt lgkmcnt(8)
v_mfma_f32_16x16x32_bf16 v[192:195], v[148:151], v[180:183], v[192:195]
s_waitcnt lgkmcnt(2)
v_mfma_f32_16x16x32_bf16 v[60:63], a[16:19], v[28:31], v[60:63]
ds_read_b128 v[20:23], v7 offset:10240
v_mfma_f32_16x16x32_bf16 v[196:199], v[136:139], v[176:179], 0
v_mfma_f32_16x16x32_bf16 v[68:71], a[16:19], v[32:35], v[68:71]
ds_read_b128 v[24:27], v7 offset:10496
v_mfma_f32_16x16x32_bf16 v[200:203], v[140:143], v[176:179], 0
buffer_load_dwordx4 v[136:139], v209, s[8:11], s41 offen offset:0 sc1
v_cvt_pk_bf16_f32 v84, v188, v189
v_mfma_f32_16x16x32_bf16 v[72:75], a[20:23], v[32:35], v[72:75]
v_cvt_pk_bf16_f32 v85, v190, v191
v_cvt_pk_bf16_f32 v86, v192, v193
v_mfma_f32_16x16x32_bf16 v[64:67], a[20:23], v[28:31], v[64:67]
s_waitcnt lgkmcnt(7)
buffer_load_dwordx4 v[140:143], v209, s[8:11], s41 offen offset:128 sc1
v_mfma_f32_16x16x32_bf16 v[60:63], a[24:27], v[36:39], v[60:63]
s_waitcnt vmcnt(19)
ds_read_b128 v[28:31], v7 offset:12288
v_cvt_pk_bf16_f32 v87, v194, v195
v_mfma_f32_16x16x32_bf16 v[196:199], v[144:147], v[184:187], v[196:199]
s_waitcnt vmcnt(11)
v_readlane_b32 s55, v111, 0
v_mfma_f32_16x16x32_bf16 v[152:155], v[124:127], v[116:119], 0
v_cvt_pk_bf16_f32 v120, v52, v53
v_cvt_pk_bf16_f32 v121, v54, v55
v_mfma_f32_16x16x32_bf16 v[68:71], a[24:27], v[40:43], v[68:71]
ds_read_b128 v[32:35], v7 offset:12544
v_cvt_pk_bf16_f32 v122, v56, v57
v_mfma_f32_16x16x32_bf16 v[72:75], a[28:31], v[40:43], v[72:75]
buffer_load_dwordx4 v8, s[8:11], s20 offen offset:3072 sc1 lds
v_cvt_pk_bf16_f32 v123, v58, v59
v_mfma_f32_16x16x32_bf16 v[164:167], v[132:135], v[116:119], 0
v_readlane_b32 s60, v111, 1
v_mfma_f32_16x16x32_bf16 v[64:67], a[28:31], v[36:39], v[64:67]
s_waitcnt lgkmcnt(4)
v_readlane_b32 s61, v111, 2
s_add_u32 s20, s20, s23
v_mfma_f32_16x16x32_bf16 v[156:159], v[124:127], v[120:123], 0
s_add_u32 m0, s22, 32768
v_mfma_f32_16x16x32_bf16 v[60:63], a[32:35], v[12:15], v[60:63]
s_min_u32 s55, s55, s60
ds_read_b128 v[36:39], v7 offset:14336
v_mfma_f32_16x16x32_bf16 v[160:163], v[128:131], v[120:123], 0
buffer_store_dwordx4 v[84:87], v9, s[8:11], s21 offen sc1
v_mfma_f32_16x16x32_bf16 v[68:71], a[32:35], v[16:19], v[68:71]
s_min_u32 s55, s55, s61
ds_read_b128 v[40:43], v7 offset:14592
s_cmp_gt_u32 s55, s56
v_mfma_f32_16x16x32_bf16 v[200:203], v[148:151], v[184:187], v[200:203]
s_cselect_b32 s60, 0, 1
v_cvt_pk_bf16_f32 v88, v196, v197
v_cvt_pk_bf16_f32 v89, v198, v199
v_mfma_f32_16x16x32_bf16 v[168:171], v[132:135], v[120:123], 0
ds_write_b128 v212, v[152:155] offset:0
v_mfma_f32_16x16x32_bf16 v[72:75], a[36:39], v[16:19], v[72:75]
s_cselect_b32 s57, s62, 0x40000000
buffer_load_dwordx2 v[144:145], v211, s[8:11], s42 offen offset:0 sc1
v_mfma_f32_16x16x32_bf16 v[64:67], a[36:39], v[12:15], v[64:67]
s_waitcnt lgkmcnt(5)
v_cvt_pk_bf16_f32 v90, v200, v201
s_cselect_b32 s58, s59, 0x40000000
v_mfma_f32_16x16x32_bf16 v[60:63], a[40:43], v[20:23], v[60:63]
buffer_load_dwordx4 v[124:127], v9, s[8:11], s57 offen offset:0 sc1
ds_read_b128 v[12:15], v7 offset:16384
v_mfma_f32_16x16x32_bf16 v[68:71], a[40:43], v[24:27], v[68:71]
ds_read_b128 v[16:19], v7 offset:16640
v_cvt_pk_bf16_f32 v91, v202, v203
v_mfma_f32_16x16x32_bf16 v[72:75], a[44:47], v[24:27], v[72:75]
buffer_load_dwordx4 v8, s[8:11], s20 offen sc1 lds
v_mfma_f32_16x16x32_bf16 v[64:67], a[44:47], v[20:23], v[64:67]
s_waitcnt lgkmcnt(5)
ds_write_b128 v220, v[164:167] offset:0
v_mfma_f32_16x16x32_bf16 v[60:63], a[48:51], v[28:31], v[60:63]
buffer_load_dwordx4 v[128:131], v9, s[8:11], s57 offen offset:256 sc1
ds_read_b128 v[20:23], v7 offset:18432
v_mfma_f32_16x16x32_bf16 v[68:71], a[48:51], v[32:35], v[68:71]
ds_read_b128 v[24:27], v7 offset:18688
v_mfma_f32_16x16x32_bf16 v[72:75], a[52:55], v[32:35], v[72:75]
buffer_store_dwordx4 v[88:91], v9, s[8:11], s21 offen offset:256 sc1
s_mov_b32 s21, s43
v_mfma_f32_16x16x32_bf16 v[64:67], a[52:55], v[28:31], v[64:67]
s_waitcnt lgkmcnt(6)
s_mov_b32 s43, s31
s_add_u32 s31, s31, s29
v_mfma_f32_16x16x32_bf16 v[60:63], a[56:59], v[36:39], v[60:63]
buffer_load_dwordx4 v[132:135], v210, s[8:11], s58 offen sc1
ds_read_b128 v[28:31], v7 offset:20480
v_mfma_f32_16x16x32_bf16 v[68:71], a[56:59], v[40:43], v[68:71]
ds_read_b128 v[32:35], v7 offset:20736
v_mfma_f32_16x16x32_bf16 v[72:75], a[60:63], v[40:43], v[72:75]
buffer_load_dwordx4 v8, s[8:11], s20 offen offset:1024 sc1 lds
v_mfma_f32_16x16x32_bf16 v[64:67], a[60:63], v[36:39], v[64:67]
s_waitcnt lgkmcnt(5)
ds_write_b128 v212, v[156:159] offset:2048
v_mfma_f32_16x16x32_bf16 v[60:63], a[64:67], v[12:15], v[60:63]
buffer_load_dwordx2 v[148:149], v211, s[8:11], s42 offen offset:64 sc1
ds_read_b128 v[36:39], v7 offset:22528
v_mfma_f32_16x16x32_bf16 v[68:71], a[64:67], v[16:19], v[68:71]
ds_read_b128 v[40:43], v7 offset:22784
v_mfma_f32_16x16x32_bf16 v[72:75], a[68:71], v[16:19], v[72:75]
ds_write_b128 v219, v[160:163] offset:2048
v_mfma_f32_16x16x32_bf16 v[64:67], a[68:71], v[12:15], v[64:67]
s_waitcnt lgkmcnt(6)
v_mfma_f32_16x16x32_bf16 v[60:63], a[72:75], v[20:23], v[60:63]
ds_read_b128 v[12:15], v7 offset:24576
v_mfma_f32_16x16x32_bf16 v[68:71], a[72:75], v[24:27], v[68:71]
ds_read_b128 v[16:19], v7 offset:24832
v_mfma_f32_16x16x32_bf16 v[72:75], a[76:79], v[24:27], v[72:75]
buffer_load_dwordx4 v8, s[8:11], s20 offen offset:2048 sc1 lds
v_mfma_f32_16x16x32_bf16 v[64:67], a[76:79], v[20:23], v[64:67]
s_waitcnt lgkmcnt(6)
v_mfma_f32_16x16x32_bf16 v[60:63], a[80:83], v[28:31], v[60:63]
ds_read_b128 v[20:23], v7 offset:26624
v_mfma_f32_16x16x32_bf16 v[68:71], a[80:83], v[32:35], v[68:71]
ds_read_b128 v[24:27], v7 offset:26880
v_mfma_f32_16x16x32_bf16 v[72:75], a[84:87], v[32:35], v[72:75]
ds_write_b128 v220, v[168:171] offset:1280
v_mfma_f32_16x16x32_bf16 v[64:67], a[84:87], v[28:31], v[64:67]
s_waitcnt lgkmcnt(6)
v_mfma_f32_16x16x32_bf16 v[60:63], a[88:91], v[36:39], v[60:63]
ds_read_b128 v[28:31], v7 offset:28672
v_mfma_f32_16x16x32_bf16 v[68:71], a[88:91], v[40:43], v[68:71]
ds_read_b128 v[32:35], v7 offset:28928
v_mfma_f32_16x16x32_bf16 v[72:75], a[92:95], v[40:43], v[72:75]
buffer_load_dwordx4 v8, s[8:11], s20 offen offset:3072 sc1 lds
v_mfma_f32_16x16x32_bf16 v[64:67], a[92:95], v[36:39], v[64:67]
s_waitcnt lgkmcnt(5)
s_add_u32 s20, s20, s23
s_add_u32 m0, s22, 49152
v_mfma_f32_16x16x32_bf16 v[60:63], a[96:99], v[12:15], v[60:63]
ds_read_b128 v[36:39], v7 offset:30720
v_mfma_f32_16x16x32_bf16 v[68:71], a[96:99], v[16:19], v[68:71]
ds_read_b128 v[40:43], v7 offset:30976
v_mfma_f32_16x16x32_bf16 v[72:75], a[100:103], v[16:19], v[72:75]
v_mfma_f32_16x16x32_bf16 v[64:67], a[100:103], v[12:15], v[64:67]
s_waitcnt lgkmcnt(4)
v_mfma_f32_16x16x32_bf16 v[60:63], a[104:107], v[20:23], v[60:63]
s_waitcnt vmcnt(22)
s_barrier
ds_read_b128 v[12:15], v7 offset:32768
v_mfma_f32_16x16x32_bf16 v[68:71], a[104:107], v[24:27], v[68:71]
ds_read_b128 v[16:19], v7 offset:33024
ds_read_b128 v[152:155], v213 offset:0
v_mfma_f32_16x16x32_bf16 v[72:75], a[108:111], v[24:27], v[72:75]
buffer_load_dwordx4 v8, s[8:11], s20 offen sc1 lds
ds_read_b32 v168, v214 offset:0
v_mfma_f32_16x16x32_bf16 v[64:67], a[108:111], v[20:23], v[64:67]
s_waitcnt lgkmcnt(6)
ds_read_b128 v[156:159], v213 offset:4096
ds_read_b32 v169, v214 offset:2560
v_mfma_f32_16x16x32_bf16 v[60:63], a[112:115], v[28:31], v[60:63]
ds_read_b128 v[20:23], v7 offset:34816
ds_read_b128 v[160:163], v213 offset:8192
v_mfma_f32_16x16x32_bf16 v[68:71], a[112:115], v[32:35], v[68:71]
ds_read_b128 v[24:27], v7 offset:35072
ds_read_b32 v170, v214 offset:5120
v_mfma_f32_16x16x32_bf16 v[72:75], a[116:119], v[32:35], v[72:75]
ds_read_b128 v[164:167], v213 offset:12288
ds_read_b32 v171, v214 offset:7680
v_mfma_f32_16x16x32_bf16 v[64:67], a[116:119], v[28:31], v[64:67]
s_waitcnt lgkmcnt(12)
s_waitcnt lgkmcnt(6)
v_add_f32 v152, v152, v156
v_mfma_f32_16x16x32_bf16 v[60:63], a[120:123], v[36:39], v[60:63]
ds_read_b128 v[28:31], v7 offset:36864
v_add_f32 v153, v153, v157
v_mfma_f32_16x16x32_bf16 v[68:71], a[120:123], v[40:43], v[68:71]
ds_read_b128 v[32:35], v7 offset:37120
v_add_f32 v154, v154, v158
v_mfma_f32_16x16x32_bf16 v[72:75], a[124:127], v[40:43], v[72:75]
buffer_load_dwordx4 v8, s[8:11], s20 offen offset:1024 sc1 lds
v_add_f32 v155, v155, v159
v_mfma_f32_16x16x32_bf16 v[64:67], a[124:127], v[36:39], v[64:67]
s_waitcnt lgkmcnt(12)
v_add_f32 v168, v168, v169
s_waitcnt lgkmcnt(2)
v_mfma_f32_16x16x32_bf16 v[60:63], a[128:131], v[12:15], v[60:63]
ds_read_b128 v[36:39], v7 offset:38912
v_add_f32 v160, v160, v164
v_mfma_f32_16x16x32_bf16 v[68:71], a[128:131], v[16:19], v[68:71]
ds_read_b128 v[40:43], v7 offset:39168
v_add_f32 v161, v161, v165
v_mfma_f32_16x16x32_bf16 v[72:75], a[132:135], v[16:19], v[72:75]
v_add_f32 v162, v162, v166
v_add_f32 v163, v163, v167
v_mfma_f32_16x16x32_bf16 v[64:67], a[132:135], v[12:15], v[64:67]
s_waitcnt lgkmcnt(7)
v_add_f32 v170, v170, v171
v_mfma_f32_16x16x32_bf16 v[60:63], a[136:139], v[20:23], v[60:63]
ds_read_b128 v[12:15], v7 offset:40960
v_add_f32 v152, v152, v160
v_mfma_f32_16x16x32_bf16 v[68:71], a[136:139], v[24:27], v[68:71]
ds_read_b128 v[16:19], v7 offset:41216
v_add_f32 v153, v153, v161
v_mfma_f32_16x16x32_bf16 v[72:75], a[140:143], v[24:27], v[72:75]
buffer_load_dwordx4 v8, s[8:11], s20 offen offset:2048 sc1 lds
v_add_f32 v154, v154, v162
v_mfma_f32_16x16x32_bf16 v[64:67], a[140:143], v[20:23], v[64:67]
s_waitcnt lgkmcnt(4)
v_add_f32 v155, v155, v163
v_add_f32 v156, v168, v170
v_mfma_f32_16x16x32_bf16 v[60:63], a[144:147], v[28:31], v[60:63]
ds_read_b128 v[20:23], v7 offset:43008
v_cndmask_b32 v152, v208, v152, s[64:65]
v_mfma_f32_16x16x32_bf16 v[68:71], a[144:147], v[32:35], v[68:71]
ds_read_b128 v[24:27], v7 offset:43264
v_cndmask_b32 v153, v208, v153, s[66:67]
v_mfma_f32_16x16x32_bf16 v[72:75], a[148:151], v[32:35], v[72:75]
v_cndmask_b32 v154, v208, v154, s[68:69]
v_mfma_f32_16x16x32_bf16 v[64:67], a[148:151], v[28:31], v[64:67]
s_waitcnt lgkmcnt(4)
v_cndmask_b32 v155, v208, v155, s[70:71]
v_max3_f32 v204, v152, v153, v156
v_mfma_f32_16x16x32_bf16 v[60:63], a[152:155], v[36:39], v[60:63]
buffer_load_dword v111, v109, s[8:11], 0 offen sc1
ds_read_b128 v[28:31], v7 offset:45056
v_mfma_f32_16x16x32_bf16 v[68:71], a[152:155], v[40:43], v[68:71]
ds_read_b128 v[32:35], v7 offset:45312
v_max3_f32 v204, v204, v154, v155
v_mfma_f32_16x16x32_bf16 v[72:75], a[156:159], v[40:43], v[72:75]
buffer_load_dwordx4 v8, s[8:11], s20 offen offset:3072 sc1 lds
v_max_f32_dpp v204, v204, v204 quad_perm:[1,0,3,2] row_mask:0xf bank_mask:0xf
v_mfma_f32_16x16x32_bf16 v[64:67], a[156:159], v[36:39], v[64:67]
s_waitcnt lgkmcnt(4)
s_add_u32 s20, s20, s28
v_max_f32_dpp v204, v204, v204 quad_perm:[2,3,0,1] row_mask:0xf bank_mask:0xf
v_mfma_f32_16x16x32_bf16 v[60:63], a[160:163], v[12:15], v[60:63]
s_add_u32 m0, s22, 65536
ds_read_b128 v[36:39], v7 offset:47104
v_max_f32_dpp v204, v204, v204 row_half_mirror row_mask:0xf bank_mask:0xf
v_mfma_f32_16x16x32_bf16 v[68:71], a[160:163], v[16:19], v[68:71]
s_cmp_lt_u32 s36, s37
ds_read_b128 v[40:43], v7 offset:47360
s_cselect_b32 s20, s20, 0x40000000
v_mfma_f32_16x16x32_bf16 v[72:75], a[164:167], v[16:19], v[72:75]
v_mul_f32 v204, s40, v204
v_fma_f32 v152, v152, s40, -v204
v_mfma_f32_16x16x32_bf16 v[64:67], a[164:167], v[12:15], v[64:67]
s_waitcnt lgkmcnt(4)
v_exp_f32 v152, v152
v_mfma_f32_16x16x32_bf16 v[60:63], a[168:171], v[20:23], v[60:63]
ds_read_b128 v[12:15], v7 offset:49152
v_fma_f32 v153, v153, s40, -v204
v_mfma_f32_16x16x32_bf16 v[68:71], a[168:171], v[24:27], v[68:71]
ds_read_b128 v[16:19], v7 offset:49408
v_fma_f32 v154, v154, s40, -v204
v_mfma_f32_16x16x32_bf16 v[72:75], a[172:175], v[24:27], v[72:75]
buffer_load_dwordx4 v8, s[8:11], s20 offen sc1 lds
v_fma_f32 v155, v155, s40, -v204
v_mfma_f32_16x16x32_bf16 v[64:67], a[172:175], v[20:23], v[64:67]
s_waitcnt lgkmcnt(4)
v_exp_f32 v153, v153
v_mfma_f32_16x16x32_bf16 v[60:63], a[176:179], v[28:31], v[60:63]
s_add_u32 s36, s36, 1
ds_read_b128 v[20:23], v7 offset:51200
v_fma_f32 v156, v156, s40, -v204
v_mfma_f32_16x16x32_bf16 v[68:71], a[176:179], v[32:35], v[68:71]
ds_read_b128 v[24:27], v7 offset:51456
v_add_f32 v204, v152, v153
v_mfma_f32_16x16x32_bf16 v[72:75], a[180:183], v[32:35], v[72:75]
v_exp_f32 v154, v154
v_mfma_f32_16x16x32_bf16 v[64:67], a[180:183], v[28:31], v[64:67]
s_waitcnt lgkmcnt(4)
v_exp_f32 v155, v155
v_mfma_f32_16x16x32_bf16 v[60:63], a[184:187], v[36:39], v[60:63]
ds_read_b128 v[28:31], v7 offset:53248
v_add_f32 v205, v154, v155
v_mfma_f32_16x16x32_bf16 v[68:71], a[184:187], v[40:43], v[68:71]
ds_read_b128 v[32:35], v7 offset:53504
v_exp_f32 v156, v156
v_mfma_f32_16x16x32_bf16 v[72:75], a[188:191], v[40:43], v[72:75]
buffer_load_dwordx4 v8, s[8:11], s20 offen offset:1024 sc1 lds
v_add_f32 v204, v204, v156
v_mfma_f32_16x16x32_bf16 v[64:67], a[188:191], v[36:39], v[64:67]
s_waitcnt lgkmcnt(4)
v_add_f32 v204, v204, v205
v_mfma_f32_16x16x32_bf16 v[60:63], a[192:195], v[12:15], v[60:63]
s_waitcnt vmcnt(12)
ds_read_b128 v[36:39], v7 offset:55296
v_add_f32_dpp v204, v204, v204 quad_perm:[1,0,3,2] row_mask:0xf bank_mask:0xf
v_mfma_f32_16x16x32_bf16 v[68:71], a[192:195], v[16:19], v[68:71]
s_max_i32 s27, s39, 0
ds_read_b128 v[40:43], v7 offset:55552
v_add_f32_dpp v204, v204, v204 quad_perm:[2,3,0,1] row_mask:0xf bank_mask:0xf
v_mfma_f32_16x16x32_bf16 v[72:75], a[196:199], v[16:19], v[72:75]
v_mov_b32 v112, s27
v_add_f32_dpp v204, v204, v204 row_half_mirror row_mask:0xf bank_mask:0xf
v_mfma_f32_16x16x32_bf16 v[64:67], a[196:199], v[12:15], v[64:67]
s_waitcnt lgkmcnt(4)
v_rcp_f32 v204, v204
v_mfma_f32_16x16x32_bf16 v[60:63], a[200:203], v[20:23], v[60:63]
buffer_store_dword v112, v108, s[8:11], 0 offen sc1
ds_read_b128 v[12:15], v7 offset:57344
v_mfma_f32_16x16x32_bf16 v[68:71], a[200:203], v[24:27], v[68:71]
ds_read_b128 v[16:19], v7 offset:57600
v_mul_f32 v152, v152, v204
v_mfma_f32_16x16x32_bf16 v[72:75], a[204:207], v[24:27], v[72:75]
buffer_load_dwordx4 v8, s[8:11], s20 offen offset:2048 sc1 lds
v_mul_f32 v153, v153, v204
v_mfma_f32_16x16x32_bf16 v[64:67], a[204:207], v[20:23], v[64:67]
s_waitcnt lgkmcnt(4)
v_mul_f32 v154, v154, v204
v_mul_f32 v155, v155, v204
v_mfma_f32_16x16x32_bf16 v[60:63], a[208:211], v[28:31], v[60:63]
ds_read_b128 v[20:23], v7 offset:59392
v_mul_f32 v156, v156, v204
v_mfma_f32_16x16x32_bf16 v[68:71], a[208:211], v[32:35], v[68:71]
ds_read_b128 v[24:27], v7 offset:59648
v_cvt_pk_bf16_f32 v158, v152, v153
v_mfma_f32_16x16x32_bf16 v[72:75], a[212:215], v[32:35], v[72:75]
v_cvt_pk_bf16_f32 v159, v154, v155
v_mfma_f32_16x16x32_bf16 v[64:67], a[212:215], v[28:31], v[64:67]
s_waitcnt lgkmcnt(4)
v_cvt_pk_bf16_f32 v160, v156, v156
v_mfma_f32_16x16x32_bf16 v[60:63], a[216:219], v[36:39], v[60:63]
ds_read_b128 v[28:31], v7 offset:61440
ds_write_b64 v215, v[158:159]
v_mfma_f32_16x16x32_bf16 v[68:71], a[216:219], v[40:43], v[68:71]
ds_read_b128 v[32:35], v7 offset:61696
ds_write_b16 v216, v160 offset:64
v_mfma_f32_16x16x32_bf16 v[72:75], a[220:223], v[40:43], v[72:75]
buffer_load_dwordx4 v8, s[8:11], s20 offen offset:3072 sc1 lds
v_mfma_f32_16x16x32_bf16 v[64:67], a[220:223], v[36:39], v[64:67]
s_waitcnt lgkmcnt(6)
s_add_u32 s20, s20, s23
s_add_u32 m0, s22, 81920
v_mfma_f32_16x16x32_bf16 v[60:63], a[224:227], v[12:15], v[60:63]
ds_read_b128 v[36:39], v7 offset:63488
v_mfma_f32_16x16x32_bf16 v[68:71], a[224:227], v[16:19], v[68:71]
ds_read_b128 v[40:43], v7 offset:63744
v_mfma_f32_16x16x32_bf16 v[72:75], a[228:231], v[16:19], v[72:75]
v_mfma_f32_16x16x32_bf16 v[64:67], a[228:231], v[12:15], v[64:67]
s_waitcnt lgkmcnt(2)
v_mfma_f32_16x16x32_bf16 v[60:63], a[232:235], v[20:23], v[60:63]
s_waitcnt vmcnt(21)
s_barrier
ds_read_b128 v[12:15], v6 offset:0
v_mfma_f32_16x16x32_bf16 v[68:71], a[232:235], v[24:27], v[68:71]
s_cmp_lg_u32 s60, 0
ds_read_b128 v[16:19], v6 offset:256
v_mfma_f32_16x16x32_bf16 v[72:75], a[236:239], v[24:27], v[72:75]
buffer_load_dwordx4 v8, s[8:11], s20 offen sc1 lds
v_mfma_f32_16x16x32_bf16 v[64:67], a[236:239], v[20:23], v[64:67]
s_waitcnt lgkmcnt(5)
v_mfma_f32_16x16x32_bf16 v[60:63], a[240:243], v[28:31], v[60:63]
ds_read_b128 v[20:23], v6 offset:2048
v_mfma_f32_16x16x32_bf16 v[68:71], a[240:243], v[32:35], v[68:71]
ds_read_b128 v[24:27], v6 offset:2304
v_mfma_f32_16x16x32_bf16 v[72:75], a[244:247], v[32:35], v[72:75]
s_cbranch_scc1 main_kernel_qj_c1
main_kernel_qj_k1:
s_add_u32 s39, s39, 1
v_mfma_f32_16x16x32_bf16 v[64:67], a[244:247], v[28:31], v[64:67]
s_waitcnt lgkmcnt(4)
s_add_u32 s56, s56, 2
s_add_u32 s41, s62, 0x1000000
v_mfma_f32_16x16x32_bf16 v[60:63], a[248:251], v[36:39], v[60:63]
s_mov_b32 s42, s59
ds_read_b128 v[28:31], v6 offset:4096
s_add_u32 s62, s62, 524288
v_mfma_f32_16x16x32_bf16 v[68:71], a[248:251], v[40:43], v[68:71]
s_add_u32 s59, s59, 131072
ds_read_b128 v[32:35], v6 offset:4352
v_mfma_f32_16x16x32_bf16 v[72:75], a[252:255], v[40:43], v[72:75]
s_sub_u32 s24, s24, 1
buffer_load_dwordx4 v8, s[8:11], s20 offen offset:1024 sc1 lds
v_mfma_f32_16x16x32_bf16 v[64:67], a[252:255], v[36:39], v[64:67]
s_waitcnt lgkmcnt(4)
s_cbranch_scc0 main_kernel_qj_lp
v_cvt_pk_bf16_f32 v116, v60, v61
v_cvt_pk_bf16_f32 v117, v62, v63
s_nop 3
v_cvt_pk_bf16_f32 v118, v64, v65
v_cvt_pk_bf16_f32 v119, v66, v67
v_cvt_pk_bf16_f32 v120, v68, v69
v_cvt_pk_bf16_f32 v121, v70, v71
v_cvt_pk_bf16_f32 v122, v72, v73
v_cvt_pk_bf16_f32 v123, v74, v75
ds_read_b128 v[172:175], v217 offset:0
ds_read_b64 v[180:181], v218 offset:64
ds_read_b128 v[176:179], v217 offset:1536
ds_read_b64 v[184:185], v218 offset:1600
s_waitcnt vmcnt(0)
v_mfma_f32_16x16x32_bf16 v[152:155], v[124:127], v[116:119], 0
v_mfma_f32_16x16x32_bf16 v[156:159], v[124:127], v[120:123], 0
v_mfma_f32_16x16x32_bf16 v[160:163], v[128:131], v[120:123], 0
v_mfma_f32_16x16x32_bf16 v[164:167], v[132:135], v[116:119], 0
v_mfma_f32_16x16x32_bf16 v[168:171], v[132:135], v[120:123], 0
s_waitcnt lgkmcnt(0)
s_nop 2
ds_write_b128 v212, v[152:155] offset:0
ds_write_b128 v212, v[156:159] offset:2048
ds_write_b128 v219, v[160:163] offset:2048
ds_write_b128 v220, v[164:167] offset:0
ds_write_b128 v220, v[168:171] offset:1280
v_mfma_f32_16x16x32_bf16 v[188:191], v[136:139], v[172:175], 0
v_mfma_f32_16x16x32_bf16 v[192:195], v[140:143], v[172:175], 0
v_mfma_f32_16x16x32_bf16 v[196:199], v[136:139], v[176:179], 0
v_mfma_f32_16x16x32_bf16 v[200:203], v[140:143], v[176:179], 0
v_mfma_f32_16x16x32_bf16 v[188:191], v[144:147], v[180:183], v[188:191]
v_mfma_f32_16x16x32_bf16 v[192:195], v[148:151], v[180:183], v[192:195]
v_mfma_f32_16x16x32_bf16 v[196:199], v[144:147], v[184:187], v[196:199]
v_mfma_f32_16x16x32_bf16 v[200:203], v[148:151], v[184:187], v[200:203]
buffer_load_dwordx4 v[136:139], v209, s[8:11], s41 offen offset:0 sc1
buffer_load_dwordx4 v[140:143], v209, s[8:11], s41 offen offset:128 sc1
buffer_load_dwordx2 v[144:145], v211, s[8:11], s42 offen offset:0 sc1
buffer_load_dwordx2 v[148:149], v211, s[8:11], s42 offen offset:64 sc1
s_nop 0
v_cvt_pk_bf16_f32 v84, v188, v189
v_cvt_pk_bf16_f32 v85, v190, v191
v_cvt_pk_bf16_f32 v86, v192, v193
v_cvt_pk_bf16_f32 v87, v194, v195
v_cvt_pk_bf16_f32 v88, v196, v197
v_cvt_pk_bf16_f32 v89, v198, v199
v_cvt_pk_bf16_f32 v90, v200, v201
v_cvt_pk_bf16_f32 v91, v202, v203
buffer_store_dwordx4 v[84:87], v9, s[8:11], s21 offen sc1
buffer_store_dwordx4 v[88:91], v9, s[8:11], s21 offen offset:256 sc1
s_mov_b32 s21, s43
s_mov_b32 s43, s31
s_add_u32 s31, s31, s29
s_waitcnt lgkmcnt(0)
s_barrier
ds_read_b128 v[152:155], v213 offset:0
ds_read_b32 v168, v214 offset:0
ds_read_b128 v[156:159], v213 offset:4096
ds_read_b32 v169, v214 offset:2560
ds_read_b128 v[160:163], v213 offset:8192
ds_read_b32 v170, v214 offset:5120
ds_read_b128 v[164:167], v213 offset:12288
ds_read_b32 v171, v214 offset:7680
s_waitcnt lgkmcnt(4)
v_add_f32 v152, v152, v156
v_add_f32 v153, v153, v157
v_add_f32 v154, v154, v158
v_add_f32 v155, v155, v159
v_add_f32 v168, v168, v169
s_waitcnt lgkmcnt(0)
v_add_f32 v160, v160, v164
v_add_f32 v161, v161, v165
v_add_f32 v162, v162, v166
v_add_f32 v163, v163, v167
v_add_f32 v170, v170, v171
v_add_f32 v152, v152, v160
v_add_f32 v153, v153, v161
v_add_f32 v154, v154, v162
v_add_f32 v155, v155, v163
v_add_f32 v156, v168, v170
v_cndmask_b32 v152, v208, v152, s[64:65]
v_cndmask_b32 v153, v208, v153, s[66:67]
v_cndmask_b32 v154, v208, v154, s[68:69]
v_cndmask_b32 v155, v208, v155, s[70:71]
v_max3_f32 v204, v152, v153, v156
v_max3_f32 v204, v204, v154, v155
s_nop 1
v_max_f32_dpp v204, v204, v204 quad_perm:[1,0,3,2] row_mask:0xf bank_mask:0xf
s_nop 1
v_max_f32_dpp v204, v204, v204 quad_perm:[2,3,0,1] row_mask:0xf bank_mask:0xf
s_nop 1
v_max_f32_dpp v204, v204, v204 row_half_mirror row_mask:0xf bank_mask:0xf
v_mul_f32 v204, s40, v204
v_fma_f32 v152, v152, s40, -v204
v_fma_f32 v153, v153, s40, -v204
v_fma_f32 v154, v154, s40, -v204
v_fma_f32 v155, v155, s40, -v204
v_fma_f32 v156, v156, s40, -v204
v_exp_f32 v152, v152
v_exp_f32 v153, v153
v_exp_f32 v154, v154
v_exp_f32 v155, v155
v_exp_f32 v156, v156
v_add_f32 v204, v152, v153
v_add_f32 v205, v154, v155
v_add_f32 v204, v204, v156
v_add_f32 v204, v204, v205
s_nop 1
v_add_f32_dpp v204, v204, v204 quad_perm:[1,0,3,2] row_mask:0xf bank_mask:0xf
s_nop 1
v_add_f32_dpp v204, v204, v204 quad_perm:[2,3,0,1] row_mask:0xf bank_mask:0xf
s_nop 1
v_add_f32_dpp v204, v204, v204 row_half_mirror row_mask:0xf bank_mask:0xf
v_rcp_f32 v204, v204
s_nop 0
v_mul_f32 v152, v152, v204
v_mul_f32 v153, v153, v204
v_mul_f32 v154, v154, v204
v_mul_f32 v155, v155, v204
v_mul_f32 v156, v156, v204
v_cvt_pk_bf16_f32 v158, v152, v153
v_cvt_pk_bf16_f32 v159, v154, v155
v_cvt_pk_bf16_f32 v160, v156, v156
ds_write_b64 v215, v[158:159]
ds_write_b16 v216, v160 offset:64
s_waitcnt lgkmcnt(0)
s_barrier
ds_read_b128 v[172:175], v217 offset:0
ds_read_b64 v[180:181], v218 offset:64
ds_read_b128 v[176:179], v217 offset:1536
ds_read_b64 v[184:185], v218 offset:1600
s_waitcnt vmcnt(0)
s_max_i32 s27, s39, 0
v_mov_b32 v112, s27
buffer_store_dword v112, v108, s[8:11], 0 offen sc1
s_waitcnt lgkmcnt(0)
v_mfma_f32_16x16x32_bf16 v[188:191], v[136:139], v[172:175], 0
v_mfma_f32_16x16x32_bf16 v[192:195], v[140:143], v[172:175], 0
v_mfma_f32_16x16x32_bf16 v[196:199], v[136:139], v[176:179], 0
v_mfma_f32_16x16x32_bf16 v[200:203], v[140:143], v[176:179], 0
v_mfma_f32_16x16x32_bf16 v[188:191], v[144:147], v[180:183], v[188:191]
v_mfma_f32_16x16x32_bf16 v[192:195], v[148:151], v[180:183], v[192:195]
v_mfma_f32_16x16x32_bf16 v[196:199], v[144:147], v[184:187], v[196:199]
v_mfma_f32_16x16x32_bf16 v[200:203], v[148:151], v[184:187], v[200:203]
s_nop 4
v_cvt_pk_bf16_f32 v84, v188, v189
v_cvt_pk_bf16_f32 v85, v190, v191
v_cvt_pk_bf16_f32 v86, v192, v193
v_cvt_pk_bf16_f32 v87, v194, v195
v_cvt_pk_bf16_f32 v88, v196, v197
v_cvt_pk_bf16_f32 v89, v198, v199
v_cvt_pk_bf16_f32 v90, v200, v201
v_cvt_pk_bf16_f32 v91, v202, v203
buffer_store_dwordx4 v[84:87], v9, s[8:11], s21 offen sc1
buffer_store_dwordx4 v[88:91], v9, s[8:11], s21 offen offset:256 sc1
s_mov_b32 s21, s43
s_mov_b32 s43, s31
s_add_u32 s31, s31, s29
s_waitcnt vmcnt(0)
s_mov_b32 s39, s37
s_max_i32 s27, s39, 0
v_mov_b32 v112, s27
buffer_store_dword v112, v108, s[8:11], 0 offen sc1
s_branch main_kernel_qj_dn
main_kernel_qj_c0:
s_mov_b32 s38, 0
s_branch main_kernel_qj_cc
main_kernel_qj_c1:
s_mov_b32 s38, 1
main_kernel_qj_cc:
ds_read_b128 v[172:175], v217 offset:0
ds_read_b64 v[180:181], v218 offset:64
ds_read_b128 v[176:179], v217 offset:1536
ds_read_b64 v[184:185], v218 offset:1600
s_waitcnt vmcnt(0) lgkmcnt(0)
v_mfma_f32_16x16x32_bf16 v[188:191], v[136:139], v[172:175], 0
v_mfma_f32_16x16x32_bf16 v[192:195], v[140:143], v[172:175], 0
v_mfma_f32_16x16x32_bf16 v[196:199], v[136:139], v[176:179], 0
v_mfma_f32_16x16x32_bf16 v[200:203], v[140:143], v[176:179], 0
v_mfma_f32_16x16x32_bf16 v[188:191], v[144:147], v[180:183], v[188:191]
v_mfma_f32_16x16x32_bf16 v[192:195], v[148:151], v[180:183], v[192:195]
v_mfma_f32_16x16x32_bf16 v[196:199], v[144:147], v[184:187], v[196:199]
v_mfma_f32_16x16x32_bf16 v[200:203], v[148:151], v[184:187], v[200:203]
s_nop 4
v_cvt_pk_bf16_f32 v84, v188, v189
v_cvt_pk_bf16_f32 v85, v190, v191
v_cvt_pk_bf16_f32 v86, v192, v193
v_cvt_pk_bf16_f32 v87, v194, v195
v_cvt_pk_bf16_f32 v88, v196, v197
v_cvt_pk_bf16_f32 v89, v198, v199
v_cvt_pk_bf16_f32 v90, v200, v201
v_cvt_pk_bf16_f32 v91, v202, v203
buffer_store_dwordx4 v[84:87], v9, s[8:11], s21 offen sc1
buffer_store_dwordx4 v[88:91], v9, s[8:11], s21 offen offset:256 sc1
s_waitcnt vmcnt(0)
s_add_u32 s27, s39, 1
v_mov_b32 v112, s27
buffer_store_dword v112, v108, s[8:11], 0 offen sc1
s_add_u32 s55, s56, 1
s_cmp_ge_u32 s56, 58
s_cbranch_scc1 main_kernel_qj_dp
main_kernel_qj_cw:
buffer_load_dword v111, v109, s[8:11], 0 offen sc1
s_waitcnt vmcnt(0)
v_cmp_gt_u32 vcc, s55, v111
s_and_b64 vcc, vcc, s[50:51]
s_cbranch_scc0 main_kernel_qj_cw_ok
s_add_u32 s54, s54, 1
s_cmp_ge_u32 s54, 131072
s_cbranch_scc1 main_kernel_qj_cw_ok
s_sleep 1
s_branch main_kernel_qj_cw
main_kernel_qj_cw_ok:
s_cmp_gt_u32 s55, s56
s_cselect_b32 s60, 0, 1
s_cselect_b32 s57, s62, 0x40000000
s_cselect_b32 s58, s59, 0x40000000
buffer_load_dwordx4 v[124:127], v9, s[8:11], s57 offen offset:0 sc1
buffer_load_dwordx4 v[128:131], v9, s[8:11], s57 offen offset:256 sc1
buffer_load_dwordx4 v[132:135], v210, s[8:11], s58 offen sc1
s_waitcnt vmcnt(0)
s_branch main_kernel_qj_dq
main_kernel_qj_dp:
s_mov_b64 s[50:51], 3
main_kernel_qj_cv:
buffer_load_dword v111, v109, s[8:11], 0 offen sc1
s_waitcnt vmcnt(0)
v_cmp_gt_u32 vcc, s55, v111
s_and_b64 vcc, vcc, s[50:51]
s_cbranch_scc0 main_kernel_qj_cv_ok
s_add_u32 s54, s54, 1
s_cmp_ge_u32 s54, 131072
s_cbranch_scc1 main_kernel_qj_cv_ok
s_sleep 1
s_branch main_kernel_qj_cv
main_kernel_qj_cv_ok:
s_mov_b64 s[50:51], 7
s_cmp_gt_u32 s55, s56
s_cselect_b32 s60, 0, 1
s_cselect_b32 s57, s62, 0x40000000
s_cselect_b32 s58, s59, 0x40000000
buffer_load_dwordx4 v[124:127], v9, s[8:11], s57 offen offset:0 sc1
buffer_load_dwordx4 v[128:131], v9, s[8:11], s57 offen offset:256 sc1
main_kernel_qj_dl:
buffer_load_dwordx4 v[132:135], v210, s[8:11], s58 offen sc1
buffer_load_dwordx2 v[224:225], v211, s[8:11], s58 offen offset:0 sc1
buffer_load_dwordx2 v[226:227], v211, s[8:11], s58 offen offset:64 sc1
s_waitcnt vmcnt(0)
v_max3_u32 v224, v224, v225, v226
v_max3_u32 v225, v227, v132, v133
v_max3_u32 v224, v224, v134, v135
v_max_u32 v224, v224, v225
v_cmp_eq_u32 vcc, -1, v224
s_nop 3
s_cbranch_vccz main_kernel_qj_dq
s_add_u32 s54, s54, 1
s_cmp_ge_u32 s54, 131072
s_cbranch_scc1 main_kernel_qj_dq
s_branch main_kernel_qj_dl
main_kernel_qj_dq:
s_cmp_eq_u32 s38, 0
s_cbranch_scc1 main_kernel_qj_k0
s_branch main_kernel_qj_k1
main_kernel_qj_dn:
s_endpgm
main_kernel_f1:
s_cmp_ge_u32 s73, 28
s_cbranch_scc1 main_kernel_sp
s_lshl_b32 s75, s73, 7
s_add_u32 s75, s75, 0x6a02000
s_lshl_b32 s26, s25, 2
s_add_u32 s26, s26, s75
v_mov_b32 v108, 0x40000000
v_writelane_b32 v108, s26, 0
s_mov_b32 s16, s86
s_mov_b32 s17, s87
s_mov_b32 s18, 0x1c00
s_mov_b32 s19, 0x00020000
s_lshl_b32 s27, s25, 6
v_lshrrev_b32 v2, 5, v1
v_lshl_add_u32 v2, v2, 5, s27
v_bfe_u32 v3, v1, 4, 1
v_lshl_add_u32 v2, v3, 3, v2
buffer_load_dwordx2 v[84:85], v2, s[16:19], s74 offen offset:0
buffer_load_dwordx2 v[86:87], v2, s[16:19], s74 offen offset:16
v_lshl_add_u32 v8, v1, 4, s22
s_lshl_b32 s75, s73, 13
s_add_u32 s31, s75, 0x3400000
s_mov_b32 s29, 229376
v_lshrrev_b32 v2, 5, v1
v_lshlrev_b32 v2, 12, v2
v_bfe_u32 v3, v1, 4, 1
v_lshl_add_u32 v2, v3, 10, v2
v_and_b32 v4, 1, v1
v_lshl_add_u32 v2, v4, 3, v2
v_bfe_u32 v4, v1, 2, 2
v_lshl_add_u32 v2, v4, 8, v2
v_xor_b32 v4, s25, v4
v_lshl_add_u32 v3, v4, 2, v3
v_and_b32 v4, 2, v1
v_xor_b32 v3, v3, v4
v_lshl_add_u32 v94, v3, 4, v2
v_xor_b32 v95, 16, v94
v_add_u32 v96, 0x10000, v94
v_add_u32 v97, 0x10000, v95
s_waitcnt vmcnt(16)
s_barrier
ds_read_b64_tr_b16 a[0:1], v94 offset:0
ds_read_b64_tr_b16 a[2:3], v94 offset:2048
ds_read_b64_tr_b16 a[4:5], v95 offset:0
ds_read_b64_tr_b16 a[6:7], v95 offset:2048
ds_read_b64_tr_b16 a[8:9], v94 offset:8192
ds_read_b64_tr_b16 a[10:11], v94 offset:10240
ds_read_b64_tr_b16 a[12:13], v95 offset:8192
ds_read_b64_tr_b16 a[14:15], v95 offset:10240
ds_read_b64_tr_b16 a[16:17], v94 offset:16384
ds_read_b64_tr_b16 a[18:19], v94 offset:18432
ds_read_b64_tr_b16 a[20:21], v95 offset:16384
ds_read_b64_tr_b16 a[22:23], v95 offset:18432
ds_read_b64_tr_b16 a[24:25], v94 offset:24576
ds_read_b64_tr_b16 a[26:27], v94 offset:26624
ds_read_b64_tr_b16 a[28:29], v95 offset:24576
ds_read_b64_tr_b16 a[30:31], v95 offset:26624
ds_read_b64_tr_b16 a[32:33], v94 offset:32768
ds_read_b64_tr_b16 a[34:35], v94 offset:34816
ds_read_b64_tr_b16 a[36:37], v95 offset:32768
ds_read_b64_tr_b16 a[38:39], v95 offset:34816
ds_read_b64_tr_b16 a[40:41], v94 offset:40960
ds_read_b64_tr_b16 a[42:43], v94 offset:43008
ds_read_b64_tr_b16 a[44:45], v95 offset:40960
ds_read_b64_tr_b16 a[46:47], v95 offset:43008
ds_read_b64_tr_b16 a[48:49], v94 offset:49152
ds_read_b64_tr_b16 a[50:51], v94 offset:51200
ds_read_b64_tr_b16 a[52:53], v95 offset:49152
ds_read_b64_tr_b16 a[54:55], v95 offset:51200
ds_read_b64_tr_b16 a[56:57], v94 offset:57344
ds_read_b64_tr_b16 a[58:59], v94 offset:59392
ds_read_b64_tr_b16 a[60:61], v95 offset:57344
ds_read_b64_tr_b16 a[62:63], v95 offset:59392
s_waitcnt lgkmcnt(0)
s_barrier
s_lshl_b32 m0, s25, 14
s_mul_i32 s26, s30, 512
buffer_load_dwordx4 v92, s[12:15], s26 offen nt lds
s_add_u32 m0, m0, 1024
s_add_u32 s26, s26, s49
buffer_load_dwordx4 v93, s[12:15], s26 offen nt lds
s_add_u32 m0, m0, 1024
s_add_u32 s26, s26, s49
buffer_load_dwordx4 v92, s[12:15], s26 offen nt lds
s_add_u32 m0, m0, 1024
s_add_u32 s26, s26, s49
buffer_load_dwordx4 v93, s[12:15], s26 offen nt lds
s_add_u32 m0, m0, 1024
s_add_u32 s26, s26, s49
buffer_load_dwordx4 v92, s[12:15], s26 offen nt lds
s_add_u32 m0, m0, 1024
s_add_u32 s26, s26, s49
buffer_load_dwordx4 v93, s[12:15], s26 offen nt lds
s_add_u32 m0, m0, 1024
s_add_u32 s26, s26, s49
buffer_load_dwordx4 v92, s[12:15], s26 offen nt lds
s_add_u32 m0, m0, 1024
s_add_u32 s26, s26, s49
buffer_load_dwordx4 v93, s[12:15], s26 offen nt lds
s_add_u32 m0, m0, 1024
s_add_u32 s26, s26, s49
buffer_load_dwordx4 v92, s[12:15], s26 offen nt lds
s_add_u32 m0, m0, 1024
s_add_u32 s26, s26, s49
buffer_load_dwordx4 v93, s[12:15], s26 offen nt lds
s_add_u32 m0, m0, 1024
s_add_u32 s26, s26, s49
buffer_load_dwordx4 v92, s[12:15], s26 offen nt lds
s_add_u32 m0, m0, 1024
s_add_u32 s26, s26, s49
buffer_load_dwordx4 v93, s[12:15], s26 offen nt lds
s_add_u32 m0, m0, 1024
s_add_u32 s26, s26, s49
buffer_load_dwordx4 v92, s[12:15], s26 offen nt lds
s_add_u32 m0, m0, 1024
s_add_u32 s26, s26, s49
buffer_load_dwordx4 v93, s[12:15], s26 offen nt lds
s_add_u32 m0, m0, 1024
s_add_u32 s26, s26, s49
buffer_load_dwordx4 v92, s[12:15], s26 offen nt lds
s_add_u32 m0, m0, 1024
s_add_u32 s26, s26, s49
buffer_load_dwordx4 v93, s[12:15], s26 offen nt lds
s_waitcnt vmcnt(16)
s_barrier
ds_read_b64_tr_b16 a[64:65], v96 offset:0
ds_read_b64_tr_b16 a[66:67], v96 offset:2048
ds_read_b64_tr_b16 a[68:69], v97 offset:0
ds_read_b64_tr_b16 a[70:71], v97 offset:2048
ds_read_b64_tr_b16 a[72:73], v96 offset:8192
ds_read_b64_tr_b16 a[74:75], v96 offset:10240
ds_read_b64_tr_b16 a[76:77], v97 offset:8192
ds_read_b64_tr_b16 a[78:79], v97 offset:10240
ds_read_b64_tr_b16 a[80:81], v96 offset:16384
ds_read_b64_tr_b16 a[82:83], v96 offset:18432
ds_read_b64_tr_b16 a[84:85], v97 offset:16384
ds_read_b64_tr_b16 a[86:87], v97 offset:18432
ds_read_b64_tr_b16 a[88:89], v96 offset:24576
ds_read_b64_tr_b16 a[90:91], v96 offset:26624
ds_read_b64_tr_b16 a[92:93], v97 offset:24576
ds_read_b64_tr_b16 a[94:95], v97 offset:26624
ds_read_b64_tr_b16 a[96:97], v96 offset:32768
ds_read_b64_tr_b16 a[98:99], v96 offset:34816
ds_read_b64_tr_b16 a[100:101], v97 offset:32768
ds_read_b64_tr_b16 a[102:103], v97 offset:34816
ds_read_b64_tr_b16 a[104:105], v96 offset:40960
ds_read_b64_tr_b16 a[106:107], v96 offset:43008
ds_read_b64_tr_b16 a[108:109], v97 offset:40960
ds_read_b64_tr_b16 a[110:111], v97 offset:43008
ds_read_b64_tr_b16 a[112:113], v96 offset:49152
ds_read_b64_tr_b16 a[114:115], v96 offset:51200
ds_read_b64_tr_b16 a[116:117], v97 offset:49152
ds_read_b64_tr_b16 a[118:119], v97 offset:51200
ds_read_b64_tr_b16 a[120:121], v96 offset:57344
ds_read_b64_tr_b16 a[122:123], v96 offset:59392
ds_read_b64_tr_b16 a[124:125], v97 offset:57344
ds_read_b64_tr_b16 a[126:127], v97 offset:59392
s_waitcnt lgkmcnt(0)
s_barrier
s_lshl_b32 m0, s25, 14
s_add_u32 m0, m0, 0x10000
s_mul_i32 s26, s30, 768
buffer_load_dwordx4 v92, s[12:15], s26 offen nt lds
s_add_u32 m0, m0, 1024
s_add_u32 s26, s26, s49
buffer_load_dwordx4 v93, s[12:15], s26 offen nt lds
s_add_u32 m0, m0, 1024
s_add_u32 s26, s26, s49
buffer_load_dwordx4 v92, s[12:15], s26 offen nt lds
s_add_u32 m0, m0, 1024
s_add_u32 s26, s26, s49
buffer_load_dwordx4 v93, s[12:15], s26 offen nt lds
s_add_u32 m0, m0, 1024
s_add_u32 s26, s26, s49
buffer_load_dwordx4 v92, s[12:15], s26 offen nt lds
s_add_u32 m0, m0, 1024
s_add_u32 s26, s26, s49
buffer_load_dwordx4 v93, s[12:15], s26 offen nt lds
s_add_u32 m0, m0, 1024
s_add_u32 s26, s26, s49
buffer_load_dwordx4 v92, s[12:15], s26 offen nt lds
s_add_u32 m0, m0, 1024
s_add_u32 s26, s26, s49
buffer_load_dwordx4 v93, s[12:15], s26 offen nt lds
s_add_u32 m0, m0, 1024
s_add_u32 s26, s26, s49
buffer_load_dwordx4 v92, s[12:15], s26 offen nt lds
s_add_u32 m0, m0, 1024
s_add_u32 s26, s26, s49
buffer_load_dwordx4 v93, s[12:15], s26 offen nt lds
s_add_u32 m0, m0, 1024
s_add_u32 s26, s26, s49
buffer_load_dwordx4 v92, s[12:15], s26 offen nt lds
s_add_u32 m0, m0, 1024
s_add_u32 s26, s26, s49
buffer_load_dwordx4 v93, s[12:15], s26 offen nt lds
s_add_u32 m0, m0, 1024
s_add_u32 s26, s26, s49
buffer_load_dwordx4 v92, s[12:15], s26 offen nt lds
s_add_u32 m0, m0, 1024
s_add_u32 s26, s26, s49
buffer_load_dwordx4 v93, s[12:15], s26 offen nt lds
s_add_u32 m0, m0, 1024
s_add_u32 s26, s26, s49
buffer_load_dwordx4 v92, s[12:15], s26 offen nt lds
s_add_u32 m0, m0, 1024
s_add_u32 s26, s26, s49
buffer_load_dwordx4 v93, s[12:15], s26 offen nt lds
s_waitcnt vmcnt(16)
s_barrier
buffer_load_dwordx2 v[210:211], v209, s[64:67], 0 offen offset:128
ds_read_b64_tr_b16 a[128:129], v94 offset:0
ds_read_b64_tr_b16 a[130:131], v94 offset:2048
ds_read_b64_tr_b16 a[132:133], v95 offset:0
ds_read_b64_tr_b16 a[134:135], v95 offset:2048
ds_read_b64_tr_b16 a[136:137], v94 offset:8192
ds_read_b64_tr_b16 a[138:139], v94 offset:10240
ds_read_b64_tr_b16 a[140:141], v95 offset:8192
ds_read_b64_tr_b16 a[142:143], v95 offset:10240
ds_read_b64_tr_b16 a[144:145], v94 offset:16384
ds_read_b64_tr_b16 a[146:147], v94 offset:18432
ds_read_b64_tr_b16 a[148:149], v95 offset:16384
ds_read_b64_tr_b16 a[150:151], v95 offset:18432
ds_read_b64_tr_b16 a[152:153], v94 offset:24576
ds_read_b64_tr_b16 a[154:155], v94 offset:26624
ds_read_b64_tr_b16 a[156:157], v95 offset:24576
ds_read_b64_tr_b16 a[158:159], v95 offset:26624
ds_read_b64_tr_b16 a[160:161], v94 offset:32768
ds_read_b64_tr_b16 a[162:163], v94 offset:34816
ds_read_b64_tr_b16 a[164:165], v95 offset:32768
ds_read_b64_tr_b16 a[166:167], v95 offset:34816
ds_read_b64_tr_b16 a[168:169], v94 offset:40960
ds_read_b64_tr_b16 a[170:171], v94 offset:43008
ds_read_b64_tr_b16 a[172:173], v95 offset:40960
ds_read_b64_tr_b16 a[174:175], v95 offset:43008
ds_read_b64_tr_b16 a[176:177], v94 offset:49152
ds_read_b64_tr_b16 a[178:179], v94 offset:51200
ds_read_b64_tr_b16 a[180:181], v95 offset:49152
ds_read_b64_tr_b16 a[182:183], v95 offset:51200
ds_read_b64_tr_b16 a[184:185], v94 offset:57344
ds_read_b64_tr_b16 a[186:187], v94 offset:59392
ds_read_b64_tr_b16 a[188:189], v95 offset:57344
ds_read_b64_tr_b16 a[190:191], v95 offset:59392
s_waitcnt lgkmcnt(0)
s_barrier
s_waitcnt vmcnt(0)
s_cmp_lg_u32 s25, 0
s_cbranch_scc1 main_kernel_f1_ysk
s_mov_b32 s56, 2
s_cmp_lg_u32 s3, 0
s_cbranch_scc1 main_kernel_f1_yok
main_kernel_f1_ylp:
v_cmp_eq_u32 vcc, -1, v210
s_mov_b32 s57, 0x2000
v_cmp_eq_u32 s[58:59], s57, v211
s_and_b32 s58, s58, vcc_lo
s_and_b32 s58, s58, 0xff
v_readlane_b32 s56, v210, 8
s_cmp_eq_u32 s58, 0xff
s_cbranch_scc1 main_kernel_f1_yfa
s_mov_b32 s57, 0
v_readlane_b32 s58, v211, 0
s_lshr_b32 s58, s58, 8
s_add_u32 s57, s57, s58
v_readlane_b32 s58, v211, 1
s_lshr_b32 s58, s58, 8
s_add_u32 s57, s57, s58
v_readlane_b32 s58, v211, 2
s_lshr_b32 s58, s58, 8
s_add_u32 s57, s57, s58
v_readlane_b32 s58, v211, 3
s_lshr_b32 s58, s58, 8
s_add_u32 s57, s57, s58
v_readlane_b32 s58, v211, 4
s_lshr_b32 s58, s58, 8
s_add_u32 s57, s57, s58
v_readlane_b32 s58, v211, 5
s_lshr_b32 s58, s58, 8
s_add_u32 s57, s57, s58
v_readlane_b32 s58, v211, 6
s_lshr_b32 s58, s58, 8
s_add_u32 s57, s57, s58
v_readlane_b32 s58, v211, 7
s_lshr_b32 s58, s58, 8
s_add_u32 s57, s57, s58
s_mov_b32 s56, 2
s_cmp_eq_u32 s57, 256
s_cbranch_scc1 main_kernel_f1_yok
main_kernel_f1_ylpr:
s_add_u32 s54, s54, 1
s_cmp_ge_u32 s54, 131072
s_cbranch_scc1 main_kernel_f1_yok
s_sleep 4
buffer_load_dwordx2 v[210:211], v209, s[64:67], 0 offen offset:128 sc1
s_waitcnt vmcnt(0)
s_branch main_kernel_f1_ylp
main_kernel_f1_yfa:
s_mov_b32 s56, 1
main_kernel_f1_yok:
v_mov_b32 v210, s56
v_mov_b32 v211, 131136
ds_write_b32 v211, v210
s_waitcnt lgkmcnt(0)
main_kernel_f1_ysk:
s_barrier
v_mov_b32 v211, 131136
ds_read_b32 v210, v211
ds_read_b64_tr_b16 a[192:193], v96 offset:0
ds_read_b64_tr_b16 a[194:195], v96 offset:2048
ds_read_b64_tr_b16 a[196:197], v97 offset:0
ds_read_b64_tr_b16 a[198:199], v97 offset:2048
ds_read_b64_tr_b16 a[200:201], v96 offset:8192
ds_read_b64_tr_b16 a[202:203], v96 offset:10240
ds_read_b64_tr_b16 a[204:205], v97 offset:8192
ds_read_b64_tr_b16 a[206:207], v97 offset:10240
ds_read_b64_tr_b16 a[208:209], v96 offset:16384
ds_read_b64_tr_b16 a[210:211], v96 offset:18432
ds_read_b64_tr_b16 a[212:213], v97 offset:16384
ds_read_b64_tr_b16 a[214:215], v97 offset:18432
ds_read_b64_tr_b16 a[216:217], v96 offset:24576
ds_read_b64_tr_b16 a[218:219], v96 offset:26624
ds_read_b64_tr_b16 a[220:221], v97 offset:24576
ds_read_b64_tr_b16 a[222:223], v97 offset:26624
ds_read_b64_tr_b16 a[224:225], v96 offset:32768
ds_read_b64_tr_b16 a[226:227], v96 offset:34816
ds_read_b64_tr_b16 a[228:229], v97 offset:32768
ds_read_b64_tr_b16 a[230:231], v97 offset:34816
ds_read_b64_tr_b16 a[232:233], v96 offset:40960
ds_read_b64_tr_b16 a[234:235], v96 offset:43008
ds_read_b64_tr_b16 a[236:237], v97 offset:40960
ds_read_b64_tr_b16 a[238:239], v97 offset:43008
ds_read_b64_tr_b16 a[240:241], v96 offset:49152
ds_read_b64_tr_b16 a[242:243], v96 offset:51200
ds_read_b64_tr_b16 a[244:245], v97 offset:49152
ds_read_b64_tr_b16 a[246:247], v97 offset:51200
ds_read_b64_tr_b16 a[248:249], v96 offset:57344
ds_read_b64_tr_b16 a[250:251], v96 offset:59392
ds_read_b64_tr_b16 a[252:253], v97 offset:57344
ds_read_b64_tr_b16 a[254:255], v97 offset:59392
s_waitcnt lgkmcnt(0)
s_barrier
v_readfirstlane_b32 s6, v210
s_and_b32 s56, s6, 3
s_sub_u32 s56, s56, s3
s_cmp_eq_u32 s56, 2
s_cbranch_scc1 main_kernel_again
v_lshlrev_b32 v76, 16, v84
v_and_b32 v77, 0xffff0000, v84
v_lshlrev_b32 v78, 16, v85
v_and_b32 v79, 0xffff0000, v85
v_lshlrev_b32 v80, 16, v86
v_and_b32 v81, 0xffff0000, v86
v_lshlrev_b32 v82, 16, v87
v_and_b32 v83, 0xffff0000, v87
s_mov_b32 s40, 0xbdd2d3e8
v_mov_b32 v10, 0xc0135761
s_mov_b32 s21, 0x40000000
s_mov_b32 s39, -1
s_mov_b32 s36, 0
s_lshl_b32 s74, s94, 21
s_lshl_b32 s75, s95, 8
s_add_u32 s74, s74, s75
s_add_u32 s12, s82, s74
s_addc_u32 s13, s83, 0
s_sub_u32 s14, 0x800000, s74
s_mov_b32 s15, 0x00020000
s_mov_b32 s68, 0
s_mov_b32 s75, 131072
v_lshrrev_b32 v2, 4, v1
v_lshlrev_b32 v3, 2, v2
v_and_b32 v4, 15, v1
v_xor_b32 v4, v4, v3
s_lshl_b32 s26, s25, 4
v_add_u32 v2, s26, v2
v_mul_u32_u24 v2, 2048, v2
v_lshl_add_u32 v200, v4, 4, v2
v_xor_b32 v2, 16, v200
v_add_u32 v201, 7168, v2
v_add_u32 v202, 14336, v200
v_add_u32 v203, 21504, v2
s_mov_b32 s20, s52
s_mov_b32 s36, 0
s_lshr_b32 s24, s37, 1
s_sub_u32 s24, s24, 2
s_mov_b32 m0, s22
s_nop 0
buffer_load_dwordx4 v8, s[8:11], s20 offen sc1 lds
s_add_u32 s36, s36, 1
buffer_load_dwordx4 v8, s[8:11], s20 offen offset:1024 sc1 lds
buffer_load_dword v2, v11, s[8:11], 0 offen
buffer_load_dwordx4 v8, s[8:11], s20 offen offset:2048 sc1 lds
buffer_load_dwordx4 v8, s[8:11], s20 offen offset:3072 sc1 lds
s_add_u32 s20, s20, s23
s_add_u32 m0, s22, 16384
s_nop 0
buffer_load_dwordx4 v8, s[8:11], s20 offen sc1 lds
buffer_load_dword v2, v11, s[8:11], 0 offen
buffer_load_dwordx4 v8, s[8:11], s20 offen offset:1024 sc1 lds
buffer_load_dwordx4 v8, s[8:11], s20 offen offset:2048 sc1 lds
buffer_load_dwordx4 v8, s[8:11], s20 offen offset:3072 sc1 lds
s_add_u32 s20, s20, s23
s_add_u32 m0, s22, 32768
s_nop 0
buffer_load_dwordx4 v8, s[8:11], s20 offen sc1 lds
buffer_load_dwordx4 v8, s[8:11], s20 offen offset:1024 sc1 lds
buffer_load_dwordx4 v8, s[8:11], s20 offen offset:2048 sc1 lds
buffer_load_dwordx4 v8, s[8:11], s20 offen offset:3072 sc1 lds
s_add_u32 s20, s20, s23
s_add_u32 m0, s22, 49152
s_nop 0
buffer_load_dwordx4 v8, s[8:11], s20 offen sc1 lds
buffer_load_dwordx4 v8, s[8:11], s20 offen offset:1024 sc1 lds
buffer_load_dword v2, v11, s[8:11], 0 offen
buffer_load_dwordx4 v8, s[8:11], s20 offen offset:2048 sc1 lds
buffer_load_dwordx4 v8, s[8:11], s20 offen offset:3072 sc1 lds
s_add_u32 s20, s20, s28
s_add_u32 m0, s22, 65536
s_cmp_lt_u32 s36, s37
s_cselect_b32 s20, s20, 0x40000000
buffer_load_dwordx4 v8, s[8:11], s20 offen sc1 lds
s_add_u32 s36, s36, 1
buffer_load_dwordx4 v8, s[8:11], s20 offen offset:1024 sc1 lds
buffer_load_dword v2, v11, s[8:11], 0 offen
buffer_load_dwordx4 v8, s[8:11], s20 offen offset:2048 sc1 lds
buffer_load_dwordx4 v8, s[8:11], s20 offen offset:3072 sc1 lds
s_add_u32 s20, s20, s23
s_add_u32 m0, s22, 81920
s_nop 0
buffer_load_dwordx4 v8, s[8:11], s20 offen sc1 lds
buffer_load_dword v2, v11, s[8:11], 0 offen
buffer_load_dwordx4 v8, s[8:11], s20 offen offset:1024 sc1 lds
s_waitcnt vmcnt(17)
s_barrier
ds_read_b128 v[12:15], v6 offset:0
ds_read_b128 v[16:19], v6 offset:256
ds_read_b128 v[20:23], v6 offset:2048
ds_read_b128 v[24:27], v6 offset:2304
ds_read_b128 v[28:31], v6 offset:4096
ds_read_b128 v[32:35], v6 offset:4352
s_waitcnt lgkmcnt(0)
.p2align 3
main_kernel_f1j_lp:
v_mfma_f32_16x16x32_bf16 v[44:47], a[0:3], v[12:15], v[76:79]
ds_read_b128 v[36:39], v6 offset:6144
v_mfma_f32_16x16x32_bf16 v[52:55], a[0:3], v[16:19], v[76:79]
ds_read_b128 v[40:43], v6 offset:6400
v_mul_f32 v92, v60, v60
v_mfma_f32_16x16x32_bf16 v[56:59], a[4:7], v[16:19], v[80:83]
v_mul_f32 v93, v61, v61
v_mfma_f32_16x16x32_bf16 v[48:51], a[4:7], v[12:15], v[80:83]
s_waitcnt lgkmcnt(4)
v_fma_f32 v92, v92, s40, v10
v_mfma_f32_16x16x32_bf16 v[44:47], a[8:11], v[20:23], v[44:47]
ds_read_b128 v[12:15], v6 offset:8192
v_mul_f32 v94, v62, v62
v_mfma_f32_16x16x32_bf16 v[52:55], a[8:11], v[24:27], v[52:55]
ds_read_b128 v[16:19], v6 offset:8448
v_fma_f32 v93, v93, s40, v10
v_mfma_f32_16x16x32_bf16 v[56:59], a[12:15], v[24:27], v[56:59]
buffer_load_dwordx4 v8, s[8:11], s20 offen offset:2048 sc1 lds
v_mul_f32 v95, v63, v63
v_mfma_f32_16x16x32_bf16 v[48:51], a[12:15], v[20:23], v[48:51]
s_waitcnt lgkmcnt(4)
v_mul_f32 v92, v92, v60
v_mfma_f32_16x16x32_bf16 v[44:47], a[16:19], v[28:31], v[44:47]
ds_read_b128 v[20:23], v6 offset:10240
v_fma_f32 v94, v94, s40, v10
v_mfma_f32_16x16x32_bf16 v[52:55], a[16:19], v[32:35], v[52:55]
ds_read_b128 v[24:27], v6 offset:10496
v_mul_f32 v96, v64, v64
v_mfma_f32_16x16x32_bf16 v[56:59], a[20:23], v[32:35], v[56:59]
v_exp_f32 v92, v92
v_mfma_f32_16x16x32_bf16 v[48:51], a[20:23], v[28:31], v[48:51]
s_waitcnt lgkmcnt(4)
v_mul_f32 v93, v93, v61
v_mfma_f32_16x16x32_bf16 v[44:47], a[24:27], v[36:39], v[44:47]
ds_read_b128 v[28:31], v6 offset:12288
v_fma_f32 v95, v95, s40, v10
v_mfma_f32_16x16x32_bf16 v[52:55], a[24:27], v[40:43], v[52:55]
ds_read_b128 v[32:35], v6 offset:12544
v_mul_f32 v97, v65, v65
v_mfma_f32_16x16x32_bf16 v[56:59], a[28:31], v[40:43], v[56:59]
buffer_load_dwordx4 v8, s[8:11], s20 offen offset:3072 sc1 lds
v_mul_f32 v94, v94, v62
v_mfma_f32_16x16x32_bf16 v[48:51], a[28:31], v[36:39], v[48:51]
s_waitcnt lgkmcnt(4)
v_exp_f32 v93, v93
v_mfma_f32_16x16x32_bf16 v[44:47], a[32:35], v[12:15], v[44:47]
s_add_u32 s20, s20, s23
ds_read_b128 v[36:39], v6 offset:14336
v_fma_f32 v96, v96, s40, v10
v_mfma_f32_16x16x32_bf16 v[52:55], a[32:35], v[16:19], v[52:55]
s_add_u32 m0, s22, 98304
ds_read_b128 v[40:43], v6 offset:14592
v_mul_f32 v98, v66, v66
v_mfma_f32_16x16x32_bf16 v[56:59], a[36:39], v[16:19], v[56:59]
v_exp_f32 v94, v94
v_mfma_f32_16x16x32_bf16 v[48:51], a[36:39], v[12:15], v[48:51]
s_waitcnt lgkmcnt(4)
v_mul_f32 v95, v95, v63
v_fma_f32 v97, v97, s40, v10
v_mfma_f32_16x16x32_bf16 v[44:47], a[40:43], v[20:23], v[44:47]
ds_read_b128 v[12:15], v6 offset:16384
v_mul_f32 v99, v67, v67
v_mfma_f32_16x16x32_bf16 v[52:55], a[40:43], v[24:27], v[52:55]
ds_read_b128 v[16:19], v6 offset:16640
v_add_f32 v92, 1.0, v92
v_mfma_f32_16x16x32_bf16 v[56:59], a[44:47], v[24:27], v[56:59]
buffer_load_dwordx4 v8, s[8:11], s20 offen sc1 lds
v_mul_f32 v96, v96, v64
v_mfma_f32_16x16x32_bf16 v[48:51], a[44:47], v[20:23], v[48:51]
s_waitcnt lgkmcnt(4)
v_exp_f32 v95, v95
v_mfma_f32_16x16x32_bf16 v[44:47], a[48:51], v[28:31], v[44:47]
ds_read_b128 v[20:23], v6 offset:18432
v_fma_f32 v98, v98, s40, v10
v_mfma_f32_16x16x32_bf16 v[52:55], a[48:51], v[32:35], v[52:55]
ds_read_b128 v[24:27], v6 offset:18688
v_mul_f32 v100, v68, v68
v_mfma_f32_16x16x32_bf16 v[56:59], a[52:55], v[32:35], v[56:59]
v_rcp_f32 v92, v92
v_mfma_f32_16x16x32_bf16 v[48:51], a[52:55], v[28:31], v[48:51]
s_waitcnt lgkmcnt(4)
v_exp_f32 v96, v96
v_mfma_f32_16x16x32_bf16 v[44:47], a[56:59], v[36:39], v[44:47]
ds_read_b128 v[28:31], v6 offset:20480
v_add_f32 v93, 1.0, v93
v_mfma_f32_16x16x32_bf16 v[52:55], a[56:59], v[40:43], v[52:55]
ds_read_b128 v[32:35], v6 offset:20736
v_mul_f32 v97, v97, v65
v_mfma_f32_16x16x32_bf16 v[56:59], a[60:63], v[40:43], v[56:59]
buffer_load_dwordx4 v8, s[8:11], s20 offen offset:1024 sc1 lds
v_fma_f32 v99, v99, s40, v10
v_mfma_f32_16x16x32_bf16 v[48:51], a[60:63], v[36:39], v[48:51]
s_waitcnt lgkmcnt(4)
v_rcp_f32 v93, v93
v_mfma_f32_16x16x32_bf16 v[44:47], a[64:67], v[12:15], v[44:47]
ds_read_b128 v[36:39], v6 offset:22528
v_mul_f32 v101, v69, v69
v_mfma_f32_16x16x32_bf16 v[52:55], a[64:67], v[16:19], v[52:55]
ds_read_b128 v[40:43], v6 offset:22784
v_add_f32 v94, 1.0, v94
v_mfma_f32_16x16x32_bf16 v[56:59], a[68:71], v[16:19], v[56:59]
v_exp_f32 v97, v97
v_mfma_f32_16x16x32_bf16 v[48:51], a[68:71], v[12:15], v[48:51]
s_waitcnt lgkmcnt(4)
v_rcp_f32 v94, v94
v_mfma_f32_16x16x32_bf16 v[44:47], a[72:75], v[20:23], v[44:47]
ds_read_b128 v[12:15], v6 offset:24576
v_mul_f32 v98, v98, v66
v_mfma_f32_16x16x32_bf16 v[52:55], a[72:75], v[24:27], v[52:55]
ds_read_b128 v[16:19], v6 offset:24832
v_fma_f32 v100, v100, s40, v10
v_mfma_f32_16x16x32_bf16 v[56:59], a[76:79], v[24:27], v[56:59]
buffer_load_dwordx4 v8, s[8:11], s20 offen offset:2048 sc1 lds
v_mul_f32 v102, v70, v70
v_mfma_f32_16x16x32_bf16 v[48:51], a[76:79], v[20:23], v[48:51]
s_waitcnt lgkmcnt(4)
v_exp_f32 v98, v98
v_mfma_f32_16x16x32_bf16 v[44:47], a[80:83], v[28:31], v[44:47]
ds_read_b128 v[20:23], v6 offset:26624
v_add_f32 v95, 1.0, v95
v_mfma_f32_16x16x32_bf16 v[52:55], a[80:83], v[32:35], v[52:55]
ds_read_b128 v[24:27], v6 offset:26880
v_mul_f32 v99, v99, v67
v_mfma_f32_16x16x32_bf16 v[56:59], a[84:87], v[32:35], v[56:59]
v_rcp_f32 v95, v95
v_mfma_f32_16x16x32_bf16 v[48:51], a[84:87], v[28:31], v[48:51]
s_waitcnt lgkmcnt(4)
v_fma_f32 v101, v101, s40, v10
v_mul_f32 v103, v71, v71
v_mfma_f32_16x16x32_bf16 v[44:47], a[88:91], v[36:39], v[44:47]
ds_read_b128 v[28:31], v6 offset:28672
v_mul_f32 v92, v92, v60
v_mfma_f32_16x16x32_bf16 v[52:55], a[88:91], v[40:43], v[52:55]
ds_read_b128 v[32:35], v6 offset:28928
v_add_f32 v96, 1.0, v96
v_mfma_f32_16x16x32_bf16 v[56:59], a[92:95], v[40:43], v[56:59]
buffer_load_dwordx4 v8, s[8:11], s20 offen offset:3072 sc1 lds
v_mul_f32 v100, v100, v68
v_mfma_f32_16x16x32_bf16 v[48:51], a[92:95], v[36:39], v[48:51]
s_waitcnt lgkmcnt(4)
v_exp_f32 v99, v99
v_mfma_f32_16x16x32_bf16 v[44:47], a[96:99], v[12:15], v[44:47]
s_add_u32 s20, s20, s23
ds_read_b128 v[36:39], v6 offset:30720
v_fma_f32 v102, v102, s40, v10
v_mfma_f32_16x16x32_bf16 v[52:55], a[96:99], v[16:19], v[52:55]
s_add_u32 m0, s22, 114688
ds_read_b128 v[40:43], v6 offset:30976
v_mul_f32 v104, v72, v72
v_mfma_f32_16x16x32_bf16 v[56:59], a[100:103], v[16:19], v[56:59]
v_rcp_f32 v96, v96
v_mfma_f32_16x16x32_bf16 v[48:51], a[100:103], v[12:15], v[48:51]
s_waitcnt lgkmcnt(4)
v_exp_f32 v100, v100
v_mfma_f32_16x16x32_bf16 v[44:47], a[104:107], v[20:23], v[44:47]
s_waitcnt vmcnt(14)
s_barrier
ds_read_b128 v[12:15], v6 offset:32768
v_mfma_f32_16x16x32_bf16 v[52:55], a[104:107], v[24:27], v[52:55]
ds_read_b128 v[16:19], v6 offset:33024
v_mul_f32 v93, v93, v61
v_mfma_f32_16x16x32_bf16 v[56:59], a[108:111], v[24:27], v[56:59]
buffer_load_dwordx4 v8, s[8:11], s20 offen sc1 lds
v_cvt_pk_bf16_f32 v84, v92, v93
v_mfma_f32_16x16x32_bf16 v[48:51], a[108:111], v[20:23], v[48:51]
s_waitcnt lgkmcnt(4)
v_add_f32 v97, 1.0, v97
v_mfma_f32_16x16x32_bf16 v[44:47], a[112:115], v[28:31], v[44:47]
ds_read_b128 v[20:23], v6 offset:34816
v_mul_f32 v101, v101, v69
v_mfma_f32_16x16x32_bf16 v[52:55], a[112:115], v[32:35], v[52:55]
ds_read_b128 v[24:27], v6 offset:35072
v_fma_f32 v103, v103, s40, v10
v_mfma_f32_16x16x32_bf16 v[56:59], a[116:119], v[32:35], v[56:59]
v_rcp_f32 v97, v97
v_mfma_f32_16x16x32_bf16 v[48:51], a[116:119], v[28:31], v[48:51]
s_waitcnt lgkmcnt(4)
v_exp_f32 v101, v101
v_mfma_f32_16x16x32_bf16 v[44:47], a[120:123], v[36:39], v[44:47]
s_waitcnt vmcnt(8)
ds_read_b128 v[28:31], v6 offset:36864
v_mul_f32 v105, v73, v73
v_mfma_f32_16x16x32_bf16 v[52:55], a[120:123], v[40:43], v[52:55]
s_max_i32 s27, s39, 0
ds_read_b128 v[32:35], v6 offset:37120
v_mov_b32 v112, s27
v_mfma_f32_16x16x32_bf16 v[56:59], a[124:127], v[40:43], v[56:59]
buffer_load_dwordx4 v8, s[8:11], s20 offen offset:1024 sc1 lds
v_mul_f32 v94, v94, v62
v_mfma_f32_16x16x32_bf16 v[48:51], a[124:127], v[36:39], v[48:51]
s_waitcnt lgkmcnt(4)
v_add_f32 v98, 1.0, v98
v_mul_f32 v102, v102, v70
v_mfma_f32_16x16x32_bf16 v[44:47], a[128:131], v[12:15], v[44:47]
buffer_store_dword v112, v108, s[8:11], 0 offen sc1
ds_read_b128 v[36:39], v6 offset:38912
v_mfma_f32_16x16x32_bf16 v[52:55], a[128:131], v[16:19], v[52:55]
s_add_u32 s39, s39, 1
ds_read_b128 v[40:43], v6 offset:39168
v_fma_f32 v104, v104, s40, v10
v_mfma_f32_16x16x32_bf16 v[56:59], a[132:135], v[16:19], v[56:59]
v_rcp_f32 v98, v98
v_mfma_f32_16x16x32_bf16 v[48:51], a[132:135], v[12:15], v[48:51]
s_waitcnt lgkmcnt(4)
v_exp_f32 v102, v102
v_mfma_f32_16x16x32_bf16 v[44:47], a[136:139], v[20:23], v[44:47]
ds_read_b128 v[12:15], v6 offset:40960
v_mul_f32 v106, v74, v74
v_mfma_f32_16x16x32_bf16 v[52:55], a[136:139], v[24:27], v[52:55]
ds_read_b128 v[16:19], v6 offset:41216
v_mul_f32 v95, v95, v63
v_mfma_f32_16x16x32_bf16 v[56:59], a[140:143], v[24:27], v[56:59]
buffer_load_dwordx4 v8, s[8:11], s20 offen offset:2048 sc1 lds
v_cvt_pk_bf16_f32 v85, v94, v95
v_mfma_f32_16x16x32_bf16 v[48:51], a[140:143], v[20:23], v[48:51]
s_waitcnt lgkmcnt(4)
v_add_f32 v99, 1.0, v99
v_mfma_f32_16x16x32_bf16 v[44:47], a[144:147], v[28:31], v[44:47]
ds_read_b128 v[20:23], v6 offset:43008
v_mul_f32 v103, v103, v71
v_mfma_f32_16x16x32_bf16 v[52:55], a[144:147], v[32:35], v[52:55]
ds_read_b128 v[24:27], v6 offset:43264
v_fma_f32 v105, v105, s40, v10
v_mfma_f32_16x16x32_bf16 v[56:59], a[148:151], v[32:35], v[56:59]
v_rcp_f32 v99, v99
v_mfma_f32_16x16x32_bf16 v[48:51], a[148:151], v[28:31], v[48:51]
s_waitcnt lgkmcnt(4)
v_exp_f32 v103, v103
v_mfma_f32_16x16x32_bf16 v[44:47], a[152:155], v[36:39], v[44:47]
ds_read_b128 v[28:31], v6 offset:45056
v_mul_f32 v107, v75, v75
v_mfma_f32_16x16x32_bf16 v[52:55], a[152:155], v[40:43], v[52:55]
ds_read_b128 v[32:35], v6 offset:45312
v_mul_f32 v96, v96, v64
v_mfma_f32_16x16x32_bf16 v[56:59], a[156:159], v[40:43], v[56:59]
buffer_load_dwordx4 v8, s[8:11], s20 offen offset:3072 sc1 lds
v_add_f32 v100, 1.0, v100
v_mfma_f32_16x16x32_bf16 v[48:51], a[156:159], v[36:39], v[48:51]
s_waitcnt lgkmcnt(4)
s_add_u32 s20, s20, s28
v_mul_f32 v104, v104, v72
v_mfma_f32_16x16x32_bf16 v[44:47], a[160:163], v[12:15], v[44:47]
s_add_u32 m0, s22, 0
ds_read_b128 v[36:39], v6 offset:47104
v_fma_f32 v106, v106, s40, v10
v_mfma_f32_16x16x32_bf16 v[52:55], a[160:163], v[16:19], v[52:55]
s_cmp_lt_u32 s36, s37
ds_read_b128 v[40:43], v6 offset:47360
s_cselect_b32 s20, s20, 0x40000000
v_mfma_f32_16x16x32_bf16 v[56:59], a[164:167], v[16:19], v[56:59]
v_rcp_f32 v100, v100
v_mfma_f32_16x16x32_bf16 v[48:51], a[164:167], v[12:15], v[48:51]
s_waitcnt lgkmcnt(4)
v_exp_f32 v104, v104
v_mfma_f32_16x16x32_bf16 v[44:47], a[168:171], v[20:23], v[44:47]
ds_read_b128 v[12:15], v6 offset:49152
v_mul_f32 v97, v97, v65
v_mfma_f32_16x16x32_bf16 v[52:55], a[168:171], v[24:27], v[52:55]
ds_read_b128 v[16:19], v6 offset:49408
v_cvt_pk_bf16_f32 v86, v96, v97
v_mfma_f32_16x16x32_bf16 v[56:59], a[172:175], v[24:27], v[56:59]
buffer_load_dwordx4 v8, s[8:11], s20 offen sc1 lds
v_add_f32 v101, 1.0, v101
v_mfma_f32_16x16x32_bf16 v[48:51], a[172:175], v[20:23], v[48:51]
s_waitcnt lgkmcnt(4)
v_rcp_f32 v101, v101
v_mfma_f32_16x16x32_bf16 v[44:47], a[176:179], v[28:31], v[44:47]
s_add_u32 s36, s36, 1
ds_read_b128 v[20:23], v6 offset:51200
v_mul_f32 v105, v105, v73
v_mfma_f32_16x16x32_bf16 v[52:55], a[176:179], v[32:35], v[52:55]
ds_read_b128 v[24:27], v6 offset:51456
v_fma_f32 v107, v107, s40, v10
v_mfma_f32_16x16x32_bf16 v[56:59], a[180:183], v[32:35], v[56:59]
v_exp_f32 v105, v105
v_mfma_f32_16x16x32_bf16 v[48:51], a[180:183], v[28:31], v[48:51]
s_waitcnt lgkmcnt(4)
v_mul_f32 v98, v98, v66
v_add_f32 v102, 1.0, v102
v_mfma_f32_16x16x32_bf16 v[44:47], a[184:187], v[36:39], v[44:47]
ds_read_b128 v[28:31], v6 offset:53248
v_mul_f32 v106, v106, v74
v_mfma_f32_16x16x32_bf16 v[52:55], a[184:187], v[40:43], v[52:55]
ds_read_b128 v[32:35], v6 offset:53504
v_mul_f32 v99, v99, v67
v_mfma_f32_16x16x32_bf16 v[56:59], a[188:191], v[40:43], v[56:59]
buffer_load_dwordx4 v8, s[8:11], s20 offen offset:1024 sc1 lds
v_cvt_pk_bf16_f32 v87, v98, v99
v_mfma_f32_16x16x32_bf16 v[48:51], a[188:191], v[36:39], v[48:51]
s_waitcnt lgkmcnt(4)
v_rcp_f32 v102, v102
v_mfma_f32_16x16x32_bf16 v[44:47], a[192:195], v[12:15], v[44:47]
ds_read_b128 v[36:39], v6 offset:55296
v_add_f32 v103, 1.0, v103
v_mfma_f32_16x16x32_bf16 v[52:55], a[192:195], v[16:19], v[52:55]
ds_read_b128 v[40:43], v6 offset:55552
v_mul_f32 v107, v107, v75
v_mfma_f32_16x16x32_bf16 v[56:59], a[196:199], v[16:19], v[56:59]
buffer_store_dwordx4 v[84:87], v9, s[8:11], s21 offen sc1
v_mul_f32 v100, v100, v68
v_mfma_f32_16x16x32_bf16 v[48:51], a[196:199], v[12:15], v[48:51]
s_waitcnt lgkmcnt(4)
v_exp_f32 v106, v106
v_mfma_f32_16x16x32_bf16 v[44:47], a[200:203], v[20:23], v[44:47]
ds_read_b128 v[12:15], v6 offset:57344
v_add_f32 v104, 1.0, v104
v_mfma_f32_16x16x32_bf16 v[52:55], a[200:203], v[24:27], v[52:55]
ds_read_b128 v[16:19], v6 offset:57600
v_mul_f32 v101, v101, v69
v_mfma_f32_16x16x32_bf16 v[56:59], a[204:207], v[24:27], v[56:59]
buffer_load_dwordx4 v8, s[8:11], s20 offen offset:2048 sc1 lds
v_cvt_pk_bf16_f32 v88, v100, v101
v_mfma_f32_16x16x32_bf16 v[48:51], a[204:207], v[20:23], v[48:51]
s_waitcnt lgkmcnt(4)
v_rcp_f32 v103, v103
v_mfma_f32_16x16x32_bf16 v[44:47], a[208:211], v[28:31], v[44:47]
ds_read_b128 v[20:23], v6 offset:59392
v_add_f32 v105, 1.0, v105
v_mfma_f32_16x16x32_bf16 v[52:55], a[208:211], v[32:35], v[52:55]
ds_read_b128 v[24:27], v6 offset:59648
v_mul_f32 v102, v102, v70
v_mfma_f32_16x16x32_bf16 v[56:59], a[212:215], v[32:35], v[56:59]
v_exp_f32 v107, v107
v_mfma_f32_16x16x32_bf16 v[48:51], a[212:215], v[28:31], v[48:51]
s_waitcnt lgkmcnt(4)
v_rcp_f32 v104, v104
v_mfma_f32_16x16x32_bf16 v[44:47], a[216:219], v[36:39], v[44:47]
ds_read_b128 v[28:31], v6 offset:61440
v_add_f32 v106, 1.0, v106
v_mfma_f32_16x16x32_bf16 v[52:55], a[216:219], v[40:43], v[52:55]
ds_read_b128 v[32:35], v6 offset:61696
v_mul_f32 v103, v103, v71
v_mfma_f32_16x16x32_bf16 v[56:59], a[220:223], v[40:43], v[56:59]
buffer_load_dwordx4 v8, s[8:11], s20 offen offset:3072 sc1 lds
v_cvt_pk_bf16_f32 v89, v102, v103
v_mfma_f32_16x16x32_bf16 v[48:51], a[220:223], v[36:39], v[48:51]
s_waitcnt lgkmcnt(4)
v_rcp_f32 v105, v105
v_mfma_f32_16x16x32_bf16 v[44:47], a[224:227], v[12:15], v[44:47]
s_add_u32 s20, s20, s23
ds_read_b128 v[36:39], v6 offset:63488
v_add_f32 v107, 1.0, v107
v_mfma_f32_16x16x32_bf16 v[52:55], a[224:227], v[16:19], v[52:55]
s_add_u32 m0, s22, 16384
ds_read_b128 v[40:43], v6 offset:63744
v_mul_f32 v104, v104, v72
v_mfma_f32_16x16x32_bf16 v[56:59], a[228:231], v[16:19], v[56:59]
v_rcp_f32 v106, v106
v_mfma_f32_16x16x32_bf16 v[48:51], a[228:231], v[12:15], v[48:51]
s_waitcnt lgkmcnt(4)
v_rcp_f32 v107, v107
v_mfma_f32_16x16x32_bf16 v[44:47], a[232:235], v[20:23], v[44:47]
s_waitcnt vmcnt(14)
s_barrier
ds_read_b128 v[12:15], v7 offset:0
v_mfma_f32_16x16x32_bf16 v[52:55], a[232:235], v[24:27], v[52:55]
ds_read_b128 v[16:19], v7 offset:256
v_mul_f32 v105, v105, v73
v_mfma_f32_16x16x32_bf16 v[56:59], a[236:239], v[24:27], v[56:59]
buffer_load_dwordx4 v8, s[8:11], s20 offen sc1 lds
v_cvt_pk_bf16_f32 v90, v104, v105
v_mfma_f32_16x16x32_bf16 v[48:51], a[236:239], v[20:23], v[48:51]
s_waitcnt lgkmcnt(4)
v_mul_f32 v106, v106, v74
v_mul_f32 v107, v107, v75
v_mfma_f32_16x16x32_bf16 v[44:47], a[240:243], v[28:31], v[44:47]
ds_read_b128 v[20:23], v7 offset:2048
v_cvt_pk_bf16_f32 v91, v106, v107
v_mfma_f32_16x16x32_bf16 v[52:55], a[240:243], v[32:35], v[52:55]
ds_read_b128 v[24:27], v7 offset:2304
v_mfma_f32_16x16x32_bf16 v[56:59], a[244:247], v[32:35], v[56:59]
buffer_store_dwordx4 v[88:91], v9, s[8:11], s21 offen offset:256 sc1
s_mov_b32 s21, s31
v_mfma_f32_16x16x32_bf16 v[48:51], a[244:247], v[28:31], v[48:51]
s_waitcnt lgkmcnt(4)
s_add_u32 s31, s31, s29
v_mfma_f32_16x16x32_bf16 v[44:47], a[248:251], v[36:39], v[44:47]
ds_read_b128 v[28:31], v7 offset:4096
v_mfma_f32_16x16x32_bf16 v[52:55], a[248:251], v[40:43], v[52:55]
ds_read_b128 v[32:35], v7 offset:4352
v_mfma_f32_16x16x32_bf16 v[56:59], a[252:255], v[40:43], v[56:59]
buffer_load_dwordx4 v8, s[8:11], s20 offen offset:1024 sc1 lds
v_mfma_f32_16x16x32_bf16 v[48:51], a[252:255], v[36:39], v[48:51]
s_waitcnt lgkmcnt(4)
v_mfma_f32_16x16x32_bf16 v[60:63], a[0:3], v[12:15], v[76:79]
ds_read_b128 v[36:39], v7 offset:6144
v_mfma_f32_16x16x32_bf16 v[68:71], a[0:3], v[16:19], v[76:79]
ds_read_b128 v[40:43], v7 offset:6400
v_mul_f32 v92, v44, v44
v_mfma_f32_16x16x32_bf16 v[72:75], a[4:7], v[16:19], v[80:83]
v_mul_f32 v93, v45, v45
v_mfma_f32_16x16x32_bf16 v[64:67], a[4:7], v[12:15], v[80:83]
s_waitcnt lgkmcnt(4)
v_fma_f32 v92, v92, s40, v10
v_mfma_f32_16x16x32_bf16 v[60:63], a[8:11], v[20:23], v[60:63]
ds_read_b128 v[12:15], v7 offset:8192
v_mul_f32 v94, v46, v46
v_mfma_f32_16x16x32_bf16 v[68:71], a[8:11], v[24:27], v[68:71]
ds_read_b128 v[16:19], v7 offset:8448
v_fma_f32 v93, v93, s40, v10
v_mfma_f32_16x16x32_bf16 v[72:75], a[12:15], v[24:27], v[72:75]
buffer_load_dwordx4 v8, s[8:11], s20 offen offset:2048 sc1 lds
v_mul_f32 v95, v47, v47
v_mfma_f32_16x16x32_bf16 v[64:67], a[12:15], v[20:23], v[64:67]
s_waitcnt lgkmcnt(4)
v_mul_f32 v92, v92, v44
v_mfma_f32_16x16x32_bf16 v[60:63], a[16:19], v[28:31], v[60:63]
ds_read_b128 v[20:23], v7 offset:10240
v_fma_f32 v94, v94, s40, v10
v_mfma_f32_16x16x32_bf16 v[68:71], a[16:19], v[32:35], v[68:71]
ds_read_b128 v[24:27], v7 offset:10496
v_mul_f32 v96, v48, v48
v_mfma_f32_16x16x32_bf16 v[72:75], a[20:23], v[32:35], v[72:75]
v_exp_f32 v92, v92
v_mfma_f32_16x16x32_bf16 v[64:67], a[20:23], v[28:31], v[64:67]
s_waitcnt lgkmcnt(4)
v_mul_f32 v93, v93, v45
v_mfma_f32_16x16x32_bf16 v[60:63], a[24:27], v[36:39], v[60:63]
ds_read_b128 v[28:31], v7 offset:12288
v_fma_f32 v95, v95, s40, v10
v_mfma_f32_16x16x32_bf16 v[68:71], a[24:27], v[40:43], v[68:71]
ds_read_b128 v[32:35], v7 offset:12544
v_mul_f32 v97, v49, v49
v_mfma_f32_16x16x32_bf16 v[72:75], a[28:31], v[40:43], v[72:75]
buffer_load_dwordx4 v8, s[8:11], s20 offen offset:3072 sc1 lds
v_mul_f32 v94, v94, v46
v_mfma_f32_16x16x32_bf16 v[64:67], a[28:31], v[36:39], v[64:67]
s_waitcnt lgkmcnt(4)
v_exp_f32 v93, v93
v_mfma_f32_16x16x32_bf16 v[60:63], a[32:35], v[12:15], v[60:63]
s_add_u32 s20, s20, s23
ds_read_b128 v[36:39], v7 offset:14336
v_fma_f32 v96, v96, s40, v10
v_mfma_f32_16x16x32_bf16 v[68:71], a[32:35], v[16:19], v[68:71]
s_add_u32 m0, s22, 32768
ds_read_b128 v[40:43], v7 offset:14592
v_mul_f32 v98, v50, v50
v_mfma_f32_16x16x32_bf16 v[72:75], a[36:39], v[16:19], v[72:75]
v_exp_f32 v94, v94
v_mfma_f32_16x16x32_bf16 v[64:67], a[36:39], v[12:15], v[64:67]
s_waitcnt lgkmcnt(4)
v_mul_f32 v95, v95, v47
v_fma_f32 v97, v97, s40, v10
v_mfma_f32_16x16x32_bf16 v[60:63], a[40:43], v[20:23], v[60:63]
ds_read_b128 v[12:15], v7 offset:16384
v_mul_f32 v99, v51, v51
v_mfma_f32_16x16x32_bf16 v[68:71], a[40:43], v[24:27], v[68:71]
ds_read_b128 v[16:19], v7 offset:16640
v_add_f32 v92, 1.0, v92
v_mfma_f32_16x16x32_bf16 v[72:75], a[44:47], v[24:27], v[72:75]
buffer_load_dwordx4 v8, s[8:11], s20 offen sc1 lds
v_mul_f32 v96, v96, v48
v_mfma_f32_16x16x32_bf16 v[64:67], a[44:47], v[20:23], v[64:67]
s_waitcnt lgkmcnt(4)
v_exp_f32 v95, v95
v_mfma_f32_16x16x32_bf16 v[60:63], a[48:51], v[28:31], v[60:63]
ds_read_b128 v[20:23], v7 offset:18432
v_fma_f32 v98, v98, s40, v10
v_mfma_f32_16x16x32_bf16 v[68:71], a[48:51], v[32:35], v[68:71]
ds_read_b128 v[24:27], v7 offset:18688
v_mul_f32 v100, v52, v52
v_mfma_f32_16x16x32_bf16 v[72:75], a[52:55], v[32:35], v[72:75]
v_rcp_f32 v92, v92
v_mfma_f32_16x16x32_bf16 v[64:67], a[52:55], v[28:31], v[64:67]
s_waitcnt lgkmcnt(4)
v_exp_f32 v96, v96
v_mfma_f32_16x16x32_bf16 v[60:63], a[56:59], v[36:39], v[60:63]
ds_read_b128 v[28:31], v7 offset:20480
v_add_f32 v93, 1.0, v93
v_mfma_f32_16x16x32_bf16 v[68:71], a[56:59], v[40:43], v[68:71]
ds_read_b128 v[32:35], v7 offset:20736
v_mul_f32 v97, v97, v49
v_mfma_f32_16x16x32_bf16 v[72:75], a[60:63], v[40:43], v[72:75]
buffer_load_dwordx4 v8, s[8:11], s20 offen offset:1024 sc1 lds
v_fma_f32 v99, v99, s40, v10
v_mfma_f32_16x16x32_bf16 v[64:67], a[60:63], v[36:39], v[64:67]
s_waitcnt lgkmcnt(4)
v_rcp_f32 v93, v93
v_mfma_f32_16x16x32_bf16 v[60:63], a[64:67], v[12:15], v[60:63]
ds_read_b128 v[36:39], v7 offset:22528
v_mul_f32 v101, v53, v53
v_mfma_f32_16x16x32_bf16 v[68:71], a[64:67], v[16:19], v[68:71]
ds_read_b128 v[40:43], v7 offset:22784
v_add_f32 v94, 1.0, v94
v_mfma_f32_16x16x32_bf16 v[72:75], a[68:71], v[16:19], v[72:75]
v_exp_f32 v97, v97
v_mfma_f32_16x16x32_bf16 v[64:67], a[68:71], v[12:15], v[64:67]
s_waitcnt lgkmcnt(4)
v_rcp_f32 v94, v94
v_mfma_f32_16x16x32_bf16 v[60:63], a[72:75], v[20:23], v[60:63]
ds_read_b128 v[12:15], v7 offset:24576
v_mul_f32 v98, v98, v50
v_mfma_f32_16x16x32_bf16 v[68:71], a[72:75], v[24:27], v[68:71]
ds_read_b128 v[16:19], v7 offset:24832
v_fma_f32 v100, v100, s40, v10
v_mfma_f32_16x16x32_bf16 v[72:75], a[76:79], v[24:27], v[72:75]
buffer_load_dwordx4 v8, s[8:11], s20 offen offset:2048 sc1 lds
v_mul_f32 v102, v54, v54
v_mfma_f32_16x16x32_bf16 v[64:67], a[76:79], v[20:23], v[64:67]
s_waitcnt lgkmcnt(4)
v_exp_f32 v98, v98
v_mfma_f32_16x16x32_bf16 v[60:63], a[80:83], v[28:31], v[60:63]
ds_read_b128 v[20:23], v7 offset:26624
v_add_f32 v95, 1.0, v95
v_mfma_f32_16x16x32_bf16 v[68:71], a[80:83], v[32:35], v[68:71]
ds_read_b128 v[24:27], v7 offset:26880
v_mul_f32 v99, v99, v51
v_mfma_f32_16x16x32_bf16 v[72:75], a[84:87], v[32:35], v[72:75]
v_rcp_f32 v95, v95
v_mfma_f32_16x16x32_bf16 v[64:67], a[84:87], v[28:31], v[64:67]
s_waitcnt lgkmcnt(4)
v_fma_f32 v101, v101, s40, v10
v_mul_f32 v103, v55, v55
v_mfma_f32_16x16x32_bf16 v[60:63], a[88:91], v[36:39], v[60:63]
ds_read_b128 v[28:31], v7 offset:28672
v_mul_f32 v92, v92, v44
v_mfma_f32_16x16x32_bf16 v[68:71], a[88:91], v[40:43], v[68:71]
ds_read_b128 v[32:35], v7 offset:28928
v_add_f32 v96, 1.0, v96
v_mfma_f32_16x16x32_bf16 v[72:75], a[92:95], v[40:43], v[72:75]
buffer_load_dwordx4 v8, s[8:11], s20 offen offset:3072 sc1 lds
v_mul_f32 v100, v100, v52
v_mfma_f32_16x16x32_bf16 v[64:67], a[92:95], v[36:39], v[64:67]
s_waitcnt lgkmcnt(4)
v_exp_f32 v99, v99
v_mfma_f32_16x16x32_bf16 v[60:63], a[96:99], v[12:15], v[60:63]
s_add_u32 s20, s20, s23
ds_read_b128 v[36:39], v7 offset:30720
v_fma_f32 v102, v102, s40, v10
v_mfma_f32_16x16x32_bf16 v[68:71], a[96:99], v[16:19], v[68:71]
s_add_u32 m0, s22, 49152
ds_read_b128 v[40:43], v7 offset:30976
v_mul_f32 v104, v56, v56
v_mfma_f32_16x16x32_bf16 v[72:75], a[100:103], v[16:19], v[72:75]
v_rcp_f32 v96, v96
v_mfma_f32_16x16x32_bf16 v[64:67], a[100:103], v[12:15], v[64:67]
s_waitcnt lgkmcnt(4)
v_exp_f32 v100, v100
v_mfma_f32_16x16x32_bf16 v[60:63], a[104:107], v[20:23], v[60:63]
s_waitcnt vmcnt(14)
s_barrier
ds_read_b128 v[12:15], v7 offset:32768
v_mfma_f32_16x16x32_bf16 v[68:71], a[104:107], v[24:27], v[68:71]
ds_read_b128 v[16:19], v7 offset:33024
v_mul_f32 v93, v93, v45
v_mfma_f32_16x16x32_bf16 v[72:75], a[108:111], v[24:27], v[72:75]
buffer_load_dwordx4 v8, s[8:11], s20 offen sc1 lds
v_cvt_pk_bf16_f32 v84, v92, v93
v_mfma_f32_16x16x32_bf16 v[64:67], a[108:111], v[20:23], v[64:67]
s_waitcnt lgkmcnt(4)
v_add_f32 v97, 1.0, v97
v_mfma_f32_16x16x32_bf16 v[60:63], a[112:115], v[28:31], v[60:63]
ds_read_b128 v[20:23], v7 offset:34816
v_mul_f32 v101, v101, v53
v_mfma_f32_16x16x32_bf16 v[68:71], a[112:115], v[32:35], v[68:71]
ds_read_b128 v[24:27], v7 offset:35072
v_fma_f32 v103, v103, s40, v10
v_mfma_f32_16x16x32_bf16 v[72:75], a[116:119], v[32:35], v[72:75]
v_rcp_f32 v97, v97
v_mfma_f32_16x16x32_bf16 v[64:67], a[116:119], v[28:31], v[64:67]
s_waitcnt lgkmcnt(4)
v_exp_f32 v101, v101
v_mfma_f32_16x16x32_bf16 v[60:63], a[120:123], v[36:39], v[60:63]
s_waitcnt vmcnt(8)
ds_read_b128 v[28:31], v7 offset:36864
v_mul_f32 v105, v57, v57
v_mfma_f32_16x16x32_bf16 v[68:71], a[120:123], v[40:43], v[68:71]
s_max_i32 s27, s39, 0
ds_read_b128 v[32:35], v7 offset:37120
v_mov_b32 v112, s27
v_mfma_f32_16x16x32_bf16 v[72:75], a[124:127], v[40:43], v[72:75]
buffer_load_dwordx4 v8, s[8:11], s20 offen offset:1024 sc1 lds
v_mul_f32 v94, v94, v46
v_mfma_f32_16x16x32_bf16 v[64:67], a[124:127], v[36:39], v[64:67]
s_waitcnt lgkmcnt(4)
v_add_f32 v98, 1.0, v98
v_mul_f32 v102, v102, v54
v_mfma_f32_16x16x32_bf16 v[60:63], a[128:131], v[12:15], v[60:63]
buffer_store_dword v112, v108, s[8:11], 0 offen sc1
ds_read_b128 v[36:39], v7 offset:38912
v_mfma_f32_16x16x32_bf16 v[68:71], a[128:131], v[16:19], v[68:71]
s_add_u32 s39, s39, 1
ds_read_b128 v[40:43], v7 offset:39168
v_fma_f32 v104, v104, s40, v10
v_mfma_f32_16x16x32_bf16 v[72:75], a[132:135], v[16:19], v[72:75]
v_rcp_f32 v98, v98
v_mfma_f32_16x16x32_bf16 v[64:67], a[132:135], v[12:15], v[64:67]
s_waitcnt lgkmcnt(4)
v_exp_f32 v102, v102
v_mfma_f32_16x16x32_bf16 v[60:63], a[136:139], v[20:23], v[60:63]
ds_read_b128 v[12:15], v7 offset:40960
v_mul_f32 v106, v58, v58
v_mfma_f32_16x16x32_bf16 v[68:71], a[136:139], v[24:27], v[68:71]
ds_read_b128 v[16:19], v7 offset:41216
v_mul_f32 v95, v95, v47
v_mfma_f32_16x16x32_bf16 v[72:75], a[140:143], v[24:27], v[72:75]
buffer_load_dwordx4 v8, s[8:11], s20 offen offset:2048 sc1 lds
v_cvt_pk_bf16_f32 v85, v94, v95
v_mfma_f32_16x16x32_bf16 v[64:67], a[140:143], v[20:23], v[64:67]
s_waitcnt lgkmcnt(4)
v_add_f32 v99, 1.0, v99
v_mfma_f32_16x16x32_bf16 v[60:63], a[144:147], v[28:31], v[60:63]
ds_read_b128 v[20:23], v7 offset:43008
v_mul_f32 v103, v103, v55
v_mfma_f32_16x16x32_bf16 v[68:71], a[144:147], v[32:35], v[68:71]
ds_read_b128 v[24:27], v7 offset:43264
v_fma_f32 v105, v105, s40, v10
v_mfma_f32_16x16x32_bf16 v[72:75], a[148:151], v[32:35], v[72:75]
v_rcp_f32 v99, v99
v_mfma_f32_16x16x32_bf16 v[64:67], a[148:151], v[28:31], v[64:67]
s_waitcnt lgkmcnt(4)
v_exp_f32 v103, v103
v_mfma_f32_16x16x32_bf16 v[60:63], a[152:155], v[36:39], v[60:63]
ds_read_b128 v[28:31], v7 offset:45056
v_mul_f32 v107, v59, v59
v_mfma_f32_16x16x32_bf16 v[68:71], a[152:155], v[40:43], v[68:71]
ds_read_b128 v[32:35], v7 offset:45312
v_mul_f32 v96, v96, v48
v_mfma_f32_16x16x32_bf16 v[72:75], a[156:159], v[40:43], v[72:75]
buffer_load_dwordx4 v8, s[8:11], s20 offen offset:3072 sc1 lds
v_add_f32 v100, 1.0, v100
v_mfma_f32_16x16x32_bf16 v[64:67], a[156:159], v[36:39], v[64:67]
s_waitcnt lgkmcnt(4)
s_add_u32 s20, s20, s28
v_mul_f32 v104, v104, v56
v_mfma_f32_16x16x32_bf16 v[60:63], a[160:163], v[12:15], v[60:63]
s_add_u32 m0, s22, 65536
ds_read_b128 v[36:39], v7 offset:47104
v_fma_f32 v106, v106, s40, v10
v_mfma_f32_16x16x32_bf16 v[68:71], a[160:163], v[16:19], v[68:71]
s_cmp_lt_u32 s36, s37
ds_read_b128 v[40:43], v7 offset:47360
s_cselect_b32 s20, s20, 0x40000000
v_mfma_f32_16x16x32_bf16 v[72:75], a[164:167], v[16:19], v[72:75]
v_rcp_f32 v100, v100
v_mfma_f32_16x16x32_bf16 v[64:67], a[164:167], v[12:15], v[64:67]
s_waitcnt lgkmcnt(4)
v_exp_f32 v104, v104
v_mfma_f32_16x16x32_bf16 v[60:63], a[168:171], v[20:23], v[60:63]
ds_read_b128 v[12:15], v7 offset:49152
v_mul_f32 v97, v97, v49
v_mfma_f32_16x16x32_bf16 v[68:71], a[168:171], v[24:27], v[68:71]
ds_read_b128 v[16:19], v7 offset:49408
v_cvt_pk_bf16_f32 v86, v96, v97
v_mfma_f32_16x16x32_bf16 v[72:75], a[172:175], v[24:27], v[72:75]
buffer_load_dwordx4 v8, s[8:11], s20 offen sc1 lds
v_add_f32 v101, 1.0, v101
v_mfma_f32_16x16x32_bf16 v[64:67], a[172:175], v[20:23], v[64:67]
s_waitcnt lgkmcnt(4)
v_rcp_f32 v101, v101
v_mfma_f32_16x16x32_bf16 v[60:63], a[176:179], v[28:31], v[60:63]
s_add_u32 s36, s36, 1
ds_read_b128 v[20:23], v7 offset:51200
v_mul_f32 v105, v105, v57
v_mfma_f32_16x16x32_bf16 v[68:71], a[176:179], v[32:35], v[68:71]
ds_read_b128 v[24:27], v7 offset:51456
v_fma_f32 v107, v107, s40, v10
v_mfma_f32_16x16x32_bf16 v[72:75], a[180:183], v[32:35], v[72:75]
v_exp_f32 v105, v105
v_mfma_f32_16x16x32_bf16 v[64:67], a[180:183], v[28:31], v[64:67]
s_waitcnt lgkmcnt(4)
v_mul_f32 v98, v98, v50
v_add_f32 v102, 1.0, v102
v_mfma_f32_16x16x32_bf16 v[60:63], a[184:187], v[36:39], v[60:63]
ds_read_b128 v[28:31], v7 offset:53248
v_mul_f32 v106, v106, v58
v_mfma_f32_16x16x32_bf16 v[68:71], a[184:187], v[40:43], v[68:71]
ds_read_b128 v[32:35], v7 offset:53504
v_mul_f32 v99, v99, v51
v_mfma_f32_16x16x32_bf16 v[72:75], a[188:191], v[40:43], v[72:75]
buffer_load_dwordx4 v8, s[8:11], s20 offen offset:1024 sc1 lds
v_cvt_pk_bf16_f32 v87, v98, v99
v_mfma_f32_16x16x32_bf16 v[64:67], a[188:191], v[36:39], v[64:67]
s_waitcnt lgkmcnt(4)
v_rcp_f32 v102, v102
v_mfma_f32_16x16x32_bf16 v[60:63], a[192:195], v[12:15], v[60:63]
ds_read_b128 v[36:39], v7 offset:55296
v_add_f32 v103, 1.0, v103
v_mfma_f32_16x16x32_bf16 v[68:71], a[192:195], v[16:19], v[68:71]
ds_read_b128 v[40:43], v7 offset:55552
v_mul_f32 v107, v107, v59
v_mfma_f32_16x16x32_bf16 v[72:75], a[196:199], v[16:19], v[72:75]
buffer_store_dwordx4 v[84:87], v9, s[8:11], s21 offen sc1
v_mul_f32 v100, v100, v52
v_mfma_f32_16x16x32_bf16 v[64:67], a[196:199], v[12:15], v[64:67]
s_waitcnt lgkmcnt(4)
v_exp_f32 v106, v106
v_mfma_f32_16x16x32_bf16 v[60:63], a[200:203], v[20:23], v[60:63]
ds_read_b128 v[12:15], v7 offset:57344
v_add_f32 v104, 1.0, v104
v_mfma_f32_16x16x32_bf16 v[68:71], a[200:203], v[24:27], v[68:71]
ds_read_b128 v[16:19], v7 offset:57600
v_mul_f32 v101, v101, v53
v_mfma_f32_16x16x32_bf16 v[72:75], a[204:207], v[24:27], v[72:75]
buffer_load_dwordx4 v8, s[8:11], s20 offen offset:2048 sc1 lds
v_cvt_pk_bf16_f32 v88, v100, v101
v_mfma_f32_16x16x32_bf16 v[64:67], a[204:207], v[20:23], v[64:67]
s_waitcnt lgkmcnt(4)
v_rcp_f32 v103, v103
v_mfma_f32_16x16x32_bf16 v[60:63], a[208:211], v[28:31], v[60:63]
ds_read_b128 v[20:23], v7 offset:59392
v_add_f32 v105, 1.0, v105
v_mfma_f32_16x16x32_bf16 v[68:71], a[208:211], v[32:35], v[68:71]
ds_read_b128 v[24:27], v7 offset:59648
v_mul_f32 v102, v102, v54
v_mfma_f32_16x16x32_bf16 v[72:75], a[212:215], v[32:35], v[72:75]
v_exp_f32 v107, v107
v_mfma_f32_16x16x32_bf16 v[64:67], a[212:215], v[28:31], v[64:67]
s_waitcnt lgkmcnt(4)
v_rcp_f32 v104, v104
v_mfma_f32_16x16x32_bf16 v[60:63], a[216:219], v[36:39], v[60:63]
ds_read_b128 v[28:31], v7 offset:61440
v_add_f32 v106, 1.0, v106
v_mfma_f32_16x16x32_bf16 v[68:71], a[216:219], v[40:43], v[68:71]
ds_read_b128 v[32:35], v7 offset:61696
v_mul_f32 v103, v103, v55
v_mfma_f32_16x16x32_bf16 v[72:75], a[220:223], v[40:43], v[72:75]
buffer_load_dwordx4 v8, s[8:11], s20 offen offset:3072 sc1 lds
v_cvt_pk_bf16_f32 v89, v102, v103
v_mfma_f32_16x16x32_bf16 v[64:67], a[220:223], v[36:39], v[64:67]
s_waitcnt lgkmcnt(4)
v_rcp_f32 v105, v105
v_mfma_f32_16x16x32_bf16 v[60:63], a[224:227], v[12:15], v[60:63]
s_add_u32 s20, s20, s23
ds_read_b128 v[36:39], v7 offset:63488
v_add_f32 v107, 1.0, v107
v_mfma_f32_16x16x32_bf16 v[68:71], a[224:227], v[16:19], v[68:71]
s_add_u32 m0, s22, 81920
ds_read_b128 v[40:43], v7 offset:63744
v_mul_f32 v104, v104, v56
v_mfma_f32_16x16x32_bf16 v[72:75], a[228:231], v[16:19], v[72:75]
v_rcp_f32 v106, v106
v_mfma_f32_16x16x32_bf16 v[64:67], a[228:231], v[12:15], v[64:67]
s_waitcnt lgkmcnt(4)
v_rcp_f32 v107, v107
v_mfma_f32_16x16x32_bf16 v[60:63], a[232:235], v[20:23], v[60:63]
s_waitcnt vmcnt(14)
s_barrier
ds_read_b128 v[12:15], v6 offset:0
v_mfma_f32_16x16x32_bf16 v[68:71], a[232:235], v[24:27], v[68:71]
ds_read_b128 v[16:19], v6 offset:256
v_mul_f32 v105, v105, v57
v_mfma_f32_16x16x32_bf16 v[72:75], a[236:239], v[24:27], v[72:75]
buffer_load_dwordx4 v8, s[8:11], s20 offen sc1 lds
v_cvt_pk_bf16_f32 v90, v104, v105
v_mfma_f32_16x16x32_bf16 v[64:67], a[236:239], v[20:23], v[64:67]
s_waitcnt lgkmcnt(4)
v_mul_f32 v106, v106, v58
v_mul_f32 v107, v107, v59
v_mfma_f32_16x16x32_bf16 v[60:63], a[240:243], v[28:31], v[60:63]
ds_read_b128 v[20:23], v6 offset:2048
v_cvt_pk_bf16_f32 v91, v106, v107
v_mfma_f32_16x16x32_bf16 v[68:71], a[240:243], v[32:35], v[68:71]
ds_read_b128 v[24:27], v6 offset:2304
v_mfma_f32_16x16x32_bf16 v[72:75], a[244:247], v[32:35], v[72:75]
buffer_store_dwordx4 v[88:91], v9, s[8:11], s21 offen offset:256 sc1
s_mov_b32 s21, s31
v_mfma_f32_16x16x32_bf16 v[64:67], a[244:247], v[28:31], v[64:67]
s_waitcnt lgkmcnt(4)
s_add_u32 s31, s31, s29
v_mfma_f32_16x16x32_bf16 v[60:63], a[248:251], v[36:39], v[60:63]
ds_read_b128 v[28:31], v6 offset:4096
v_mfma_f32_16x16x32_bf16 v[68:71], a[248:251], v[40:43], v[68:71]
ds_read_b128 v[32:35], v6 offset:4352
v_mfma_f32_16x16x32_bf16 v[72:75], a[252:255], v[40:43], v[72:75]
s_sub_u32 s24, s24, 1
buffer_load_dwordx4 v8, s[8:11], s20 offen offset:1024 sc1 lds
v_mfma_f32_16x16x32_bf16 v[64:67], a[252:255], v[36:39], v[64:67]
s_waitcnt lgkmcnt(4)
s_cbranch_scc0 main_kernel_f1j_lp
v_mfma_f32_16x16x32_bf16 v[44:47], a[0:3], v[12:15], v[76:79]
ds_read_b128 v[36:39], v6 offset:6144
v_mfma_f32_16x16x32_bf16 v[52:55], a[0:3], v[16:19], v[76:79]
ds_read_b128 v[40:43], v6 offset:6400
v_mul_f32 v92, v60, v60
v_mfma_f32_16x16x32_bf16 v[56:59], a[4:7], v[16:19], v[80:83]
v_mul_f32 v93, v61, v61
v_mfma_f32_16x16x32_bf16 v[48:51], a[4:7], v[12:15], v[80:83]
s_waitcnt lgkmcnt(4)
v_fma_f32 v92, v92, s40, v10
v_mfma_f32_16x16x32_bf16 v[44:47], a[8:11], v[20:23], v[44:47]
ds_read_b128 v[12:15], v6 offset:8192
v_mul_f32 v94, v62, v62
v_mfma_f32_16x16x32_bf16 v[52:55], a[8:11], v[24:27], v[52:55]
ds_read_b128 v[16:19], v6 offset:8448
v_fma_f32 v93, v93, s40, v10
v_mfma_f32_16x16x32_bf16 v[56:59], a[12:15], v[24:27], v[56:59]
buffer_load_dwordx4 v8, s[8:11], s20 offen offset:2048 sc1 lds
v_mul_f32 v95, v63, v63
v_mfma_f32_16x16x32_bf16 v[48:51], a[12:15], v[20:23], v[48:51]
s_waitcnt lgkmcnt(4)
v_mul_f32 v92, v92, v60
v_mfma_f32_16x16x32_bf16 v[44:47], a[16:19], v[28:31], v[44:47]
ds_read_b128 v[20:23], v6 offset:10240
v_fma_f32 v94, v94, s40, v10
v_mfma_f32_16x16x32_bf16 v[52:55], a[16:19], v[32:35], v[52:55]
ds_read_b128 v[24:27], v6 offset:10496
v_mul_f32 v96, v64, v64
v_mfma_f32_16x16x32_bf16 v[56:59], a[20:23], v[32:35], v[56:59]
v_exp_f32 v92, v92
v_mfma_f32_16x16x32_bf16 v[48:51], a[20:23], v[28:31], v[48:51]
s_waitcnt lgkmcnt(4)
v_mul_f32 v93, v93, v61
v_mfma_f32_16x16x32_bf16 v[44:47], a[24:27], v[36:39], v[44:47]
ds_read_b128 v[28:31], v6 offset:12288
v_fma_f32 v95, v95, s40, v10
v_mfma_f32_16x16x32_bf16 v[52:55], a[24:27], v[40:43], v[52:55]
ds_read_b128 v[32:35], v6 offset:12544
v_mul_f32 v97, v65, v65
v_mfma_f32_16x16x32_bf16 v[56:59], a[28:31], v[40:43], v[56:59]
buffer_load_dwordx4 v8, s[8:11], s20 offen offset:3072 sc1 lds
v_mul_f32 v94, v94, v62
v_mfma_f32_16x16x32_bf16 v[48:51], a[28:31], v[36:39], v[48:51]
s_waitcnt lgkmcnt(4)
v_exp_f32 v93, v93
v_mfma_f32_16x16x32_bf16 v[44:47], a[32:35], v[12:15], v[44:47]
s_add_u32 s20, s20, s23
ds_read_b128 v[36:39], v6 offset:14336
v_fma_f32 v96, v96, s40, v10
v_mfma_f32_16x16x32_bf16 v[52:55], a[32:35], v[16:19], v[52:55]
s_add_u32 m0, s22, 98304
ds_read_b128 v[40:43], v6 offset:14592
v_mul_f32 v98, v66, v66
v_mfma_f32_16x16x32_bf16 v[56:59], a[36:39], v[16:19], v[56:59]
v_exp_f32 v94, v94
v_mfma_f32_16x16x32_bf16 v[48:51], a[36:39], v[12:15], v[48:51]
s_waitcnt lgkmcnt(4)
v_mul_f32 v95, v95, v63
v_fma_f32 v97, v97, s40, v10
v_mfma_f32_16x16x32_bf16 v[44:47], a[40:43], v[20:23], v[44:47]
ds_read_b128 v[12:15], v6 offset:16384
v_mul_f32 v99, v67, v67
v_mfma_f32_16x16x32_bf16 v[52:55], a[40:43], v[24:27], v[52:55]
ds_read_b128 v[16:19], v6 offset:16640
v_add_f32 v92, 1.0, v92
v_mfma_f32_16x16x32_bf16 v[56:59], a[44:47], v[24:27], v[56:59]
buffer_load_dwordx4 v8, s[8:11], s20 offen sc1 lds
v_mul_f32 v96, v96, v64
v_mfma_f32_16x16x32_bf16 v[48:51], a[44:47], v[20:23], v[48:51]
s_waitcnt lgkmcnt(4)
v_exp_f32 v95, v95
v_mfma_f32_16x16x32_bf16 v[44:47], a[48:51], v[28:31], v[44:47]
ds_read_b128 v[20:23], v6 offset:18432
v_fma_f32 v98, v98, s40, v10
v_mfma_f32_16x16x32_bf16 v[52:55], a[48:51], v[32:35], v[52:55]
ds_read_b128 v[24:27], v6 offset:18688
v_mul_f32 v100, v68, v68
v_mfma_f32_16x16x32_bf16 v[56:59], a[52:55], v[32:35], v[56:59]
v_rcp_f32 v92, v92
v_mfma_f32_16x16x32_bf16 v[48:51], a[52:55], v[28:31], v[48:51]
s_waitcnt lgkmcnt(4)
v_exp_f32 v96, v96
v_mfma_f32_16x16x32_bf16 v[44:47], a[56:59], v[36:39], v[44:47]
ds_read_b128 v[28:31], v6 offset:20480
v_add_f32 v93, 1.0, v93
v_mfma_f32_16x16x32_bf16 v[52:55], a[56:59], v[40:43], v[52:55]
ds_read_b128 v[32:35], v6 offset:20736
v_mul_f32 v97, v97, v65
v_mfma_f32_16x16x32_bf16 v[56:59], a[60:63], v[40:43], v[56:59]
buffer_load_dwordx4 v8, s[8:11], s20 offen offset:1024 sc1 lds
v_fma_f32 v99, v99, s40, v10
v_mfma_f32_16x16x32_bf16 v[48:51], a[60:63], v[36:39], v[48:51]
s_waitcnt lgkmcnt(4)
v_rcp_f32 v93, v93
v_mfma_f32_16x16x32_bf16 v[44:47], a[64:67], v[12:15], v[44:47]
ds_read_b128 v[36:39], v6 offset:22528
v_mul_f32 v101, v69, v69
v_mfma_f32_16x16x32_bf16 v[52:55], a[64:67], v[16:19], v[52:55]
ds_read_b128 v[40:43], v6 offset:22784
v_add_f32 v94, 1.0, v94
v_mfma_f32_16x16x32_bf16 v[56:59], a[68:71], v[16:19], v[56:59]
v_exp_f32 v97, v97
v_mfma_f32_16x16x32_bf16 v[48:51], a[68:71], v[12:15], v[48:51]
s_waitcnt lgkmcnt(4)
v_rcp_f32 v94, v94
v_mfma_f32_16x16x32_bf16 v[44:47], a[72:75], v[20:23], v[44:47]
ds_read_b128 v[12:15], v6 offset:24576
v_mul_f32 v98, v98, v66
v_mfma_f32_16x16x32_bf16 v[52:55], a[72:75], v[24:27], v[52:55]
ds_read_b128 v[16:19], v6 offset:24832
v_fma_f32 v100, v100, s40, v10
v_mfma_f32_16x16x32_bf16 v[56:59], a[76:79], v[24:27], v[56:59]
buffer_load_dwordx4 v8, s[8:11], s20 offen offset:2048 sc1 lds
v_mul_f32 v102, v70, v70
v_mfma_f32_16x16x32_bf16 v[48:51], a[76:79], v[20:23], v[48:51]
s_waitcnt lgkmcnt(4)
v_exp_f32 v98, v98
v_mfma_f32_16x16x32_bf16 v[44:47], a[80:83], v[28:31], v[44:47]
ds_read_b128 v[20:23], v6 offset:26624
v_add_f32 v95, 1.0, v95
v_mfma_f32_16x16x32_bf16 v[52:55], a[80:83], v[32:35], v[52:55]
ds_read_b128 v[24:27], v6 offset:26880
v_mul_f32 v99, v99, v67
v_mfma_f32_16x16x32_bf16 v[56:59], a[84:87], v[32:35], v[56:59]
v_rcp_f32 v95, v95
v_mfma_f32_16x16x32_bf16 v[48:51], a[84:87], v[28:31], v[48:51]
s_waitcnt lgkmcnt(4)
v_fma_f32 v101, v101, s40, v10
v_mul_f32 v103, v71, v71
v_mfma_f32_16x16x32_bf16 v[44:47], a[88:91], v[36:39], v[44:47]
ds_read_b128 v[28:31], v6 offset:28672
v_mul_f32 v92, v92, v60
v_mfma_f32_16x16x32_bf16 v[52:55], a[88:91], v[40:43], v[52:55]
ds_read_b128 v[32:35], v6 offset:28928
v_add_f32 v96, 1.0, v96
v_mfma_f32_16x16x32_bf16 v[56:59], a[92:95], v[40:43], v[56:59]
buffer_load_dwordx4 v8, s[8:11], s20 offen offset:3072 sc1 lds
v_mul_f32 v100, v100, v68
v_mfma_f32_16x16x32_bf16 v[48:51], a[92:95], v[36:39], v[48:51]
s_waitcnt lgkmcnt(4)
v_exp_f32 v99, v99
v_mfma_f32_16x16x32_bf16 v[44:47], a[96:99], v[12:15], v[44:47]
s_add_u32 s20, s20, s23
ds_read_b128 v[36:39], v6 offset:30720
v_fma_f32 v102, v102, s40, v10
v_mfma_f32_16x16x32_bf16 v[52:55], a[96:99], v[16:19], v[52:55]
s_add_u32 m0, s22, 114688
ds_read_b128 v[40:43], v6 offset:30976
v_mul_f32 v104, v72, v72
v_mfma_f32_16x16x32_bf16 v[56:59], a[100:103], v[16:19], v[56:59]
v_rcp_f32 v96, v96
v_mfma_f32_16x16x32_bf16 v[48:51], a[100:103], v[12:15], v[48:51]
s_waitcnt lgkmcnt(4)
v_exp_f32 v100, v100
v_mfma_f32_16x16x32_bf16 v[44:47], a[104:107], v[20:23], v[44:47]
s_waitcnt vmcnt(14)
s_barrier
ds_read_b128 v[12:15], v6 offset:32768
v_mfma_f32_16x16x32_bf16 v[52:55], a[104:107], v[24:27], v[52:55]
ds_read_b128 v[16:19], v6 offset:33024
v_mul_f32 v93, v93, v61
v_mfma_f32_16x16x32_bf16 v[56:59], a[108:111], v[24:27], v[56:59]
buffer_load_dwordx4 v8, s[8:11], s20 offen sc1 lds
v_cvt_pk_bf16_f32 v84, v92, v93
v_mfma_f32_16x16x32_bf16 v[48:51], a[108:111], v[20:23], v[48:51]
s_waitcnt lgkmcnt(4)
v_add_f32 v97, 1.0, v97
v_mfma_f32_16x16x32_bf16 v[44:47], a[112:115], v[28:31], v[44:47]
ds_read_b128 v[20:23], v6 offset:34816
v_mul_f32 v101, v101, v69
v_mfma_f32_16x16x32_bf16 v[52:55], a[112:115], v[32:35], v[52:55]
ds_read_b128 v[24:27], v6 offset:35072
v_fma_f32 v103, v103, s40, v10
v_mfma_f32_16x16x32_bf16 v[56:59], a[116:119], v[32:35], v[56:59]
v_rcp_f32 v97, v97
v_mfma_f32_16x16x32_bf16 v[48:51], a[116:119], v[28:31], v[48:51]
s_waitcnt lgkmcnt(4)
v_exp_f32 v101, v101
v_mfma_f32_16x16x32_bf16 v[44:47], a[120:123], v[36:39], v[44:47]
s_waitcnt vmcnt(8)
ds_read_b128 v[28:31], v6 offset:36864
v_mul_f32 v105, v73, v73
v_mfma_f32_16x16x32_bf16 v[52:55], a[120:123], v[40:43], v[52:55]
s_max_i32 s27, s39, 0
ds_read_b128 v[32:35], v6 offset:37120
v_mov_b32 v112, s27
v_mfma_f32_16x16x32_bf16 v[56:59], a[124:127], v[40:43], v[56:59]
buffer_load_dwordx4 v8, s[8:11], s20 offen offset:1024 sc1 lds
v_mul_f32 v94, v94, v62
v_mfma_f32_16x16x32_bf16 v[48:51], a[124:127], v[36:39], v[48:51]
s_waitcnt lgkmcnt(4)
v_add_f32 v98, 1.0, v98
v_mul_f32 v102, v102, v70
v_mfma_f32_16x16x32_bf16 v[44:47], a[128:131], v[12:15], v[44:47]
buffer_store_dword v112, v108, s[8:11], 0 offen sc1
ds_read_b128 v[36:39], v6 offset:38912
v_mfma_f32_16x16x32_bf16 v[52:55], a[128:131], v[16:19], v[52:55]
s_add_u32 s39, s39, 1
ds_read_b128 v[40:43], v6 offset:39168
v_fma_f32 v104, v104, s40, v10
v_mfma_f32_16x16x32_bf16 v[56:59], a[132:135], v[16:19], v[56:59]
v_rcp_f32 v98, v98
v_mfma_f32_16x16x32_bf16 v[48:51], a[132:135], v[12:15], v[48:51]
s_waitcnt lgkmcnt(4)
v_exp_f32 v102, v102
v_mfma_f32_16x16x32_bf16 v[44:47], a[136:139], v[20:23], v[44:47]
ds_read_b128 v[12:15], v6 offset:40960
v_mul_f32 v106, v74, v74
v_mfma_f32_16x16x32_bf16 v[52:55], a[136:139], v[24:27], v[52:55]
ds_read_b128 v[16:19], v6 offset:41216
v_mul_f32 v95, v95, v63
v_mfma_f32_16x16x32_bf16 v[56:59], a[140:143], v[24:27], v[56:59]
buffer_load_dwordx4 v8, s[8:11], s20 offen offset:2048 sc1 lds
v_cvt_pk_bf16_f32 v85, v94, v95
v_mfma_f32_16x16x32_bf16 v[48:51], a[140:143], v[20:23], v[48:51]
s_waitcnt lgkmcnt(4)
v_add_f32 v99, 1.0, v99
v_mfma_f32_16x16x32_bf16 v[44:47], a[144:147], v[28:31], v[44:47]
ds_read_b128 v[20:23], v6 offset:43008
v_mul_f32 v103, v103, v71
v_mfma_f32_16x16x32_bf16 v[52:55], a[144:147], v[32:35], v[52:55]
ds_read_b128 v[24:27], v6 offset:43264
v_fma_f32 v105, v105, s40, v10
v_mfma_f32_16x16x32_bf16 v[56:59], a[148:151], v[32:35], v[56:59]
v_rcp_f32 v99, v99
v_mfma_f32_16x16x32_bf16 v[48:51], a[148:151], v[28:31], v[48:51]
s_waitcnt lgkmcnt(4)
v_exp_f32 v103, v103
v_mfma_f32_16x16x32_bf16 v[44:47], a[152:155], v[36:39], v[44:47]
ds_read_b128 v[28:31], v6 offset:45056
v_mul_f32 v107, v75, v75
v_mfma_f32_16x16x32_bf16 v[52:55], a[152:155], v[40:43], v[52:55]
ds_read_b128 v[32:35], v6 offset:45312
v_mul_f32 v96, v96, v64
v_mfma_f32_16x16x32_bf16 v[56:59], a[156:159], v[40:43], v[56:59]
buffer_load_dwordx4 v8, s[8:11], s20 offen offset:3072 sc1 lds
v_add_f32 v100, 1.0, v100
v_mfma_f32_16x16x32_bf16 v[48:51], a[156:159], v[36:39], v[48:51]
s_waitcnt lgkmcnt(4)
s_add_u32 s20, s20, s28
v_mul_f32 v104, v104, v72
v_mfma_f32_16x16x32_bf16 v[44:47], a[160:163], v[12:15], v[44:47]
s_add_u32 m0, s22, 0
ds_read_b128 v[36:39], v6 offset:47104
v_fma_f32 v106, v106, s40, v10
v_mfma_f32_16x16x32_bf16 v[52:55], a[160:163], v[16:19], v[52:55]
s_cmp_lt_u32 s36, s37
ds_read_b128 v[40:43], v6 offset:47360
s_cselect_b32 s20, s20, 0x40000000
v_mfma_f32_16x16x32_bf16 v[56:59], a[164:167], v[16:19], v[56:59]
v_rcp_f32 v100, v100
v_mfma_f32_16x16x32_bf16 v[48:51], a[164:167], v[12:15], v[48:51]
s_waitcnt lgkmcnt(4)
v_exp_f32 v104, v104
v_mfma_f32_16x16x32_bf16 v[44:47], a[168:171], v[20:23], v[44:47]
ds_read_b128 v[12:15], v6 offset:49152
v_mul_f32 v97, v97, v65
v_mfma_f32_16x16x32_bf16 v[52:55], a[168:171], v[24:27], v[52:55]
ds_read_b128 v[16:19], v6 offset:49408
v_cvt_pk_bf16_f32 v86, v96, v97
v_mfma_f32_16x16x32_bf16 v[56:59], a[172:175], v[24:27], v[56:59]
buffer_load_dwordx4 v200, s[12:15], s68 offen nt lds
v_add_f32 v101, 1.0, v101
v_mfma_f32_16x16x32_bf16 v[48:51], a[172:175], v[20:23], v[48:51]
s_waitcnt lgkmcnt(4)
v_rcp_f32 v101, v101
v_mfma_f32_16x16x32_bf16 v[44:47], a[176:179], v[28:31], v[44:47]
s_add_u32 s36, s36, 1
ds_read_b128 v[20:23], v6 offset:51200
v_mul_f32 v105, v105, v73
v_mfma_f32_16x16x32_bf16 v[52:55], a[176:179], v[32:35], v[52:55]
ds_read_b128 v[24:27], v6 offset:51456
v_fma_f32 v107, v107, s40, v10
v_mfma_f32_16x16x32_bf16 v[56:59], a[180:183], v[32:35], v[56:59]
v_exp_f32 v105, v105
v_mfma_f32_16x16x32_bf16 v[48:51], a[180:183], v[28:31], v[48:51]
s_waitcnt lgkmcnt(4)
v_mul_f32 v98, v98, v66
v_add_f32 v102, 1.0, v102
v_mfma_f32_16x16x32_bf16 v[44:47], a[184:187], v[36:39], v[44:47]
ds_read_b128 v[28:31], v6 offset:53248
v_mul_f32 v106, v106, v74
v_mfma_f32_16x16x32_bf16 v[52:55], a[184:187], v[40:43], v[52:55]
ds_read_b128 v[32:35], v6 offset:53504
v_mul_f32 v99, v99, v67
v_mfma_f32_16x16x32_bf16 v[56:59], a[188:191], v[40:43], v[56:59]
buffer_load_dwordx4 v201, s[12:15], s68 offen offset:1024 nt lds
v_cvt_pk_bf16_f32 v87, v98, v99
v_mfma_f32_16x16x32_bf16 v[48:51], a[188:191], v[36:39], v[48:51]
s_waitcnt lgkmcnt(4)
v_rcp_f32 v102, v102
v_mfma_f32_16x16x32_bf16 v[44:47], a[192:195], v[12:15], v[44:47]
ds_read_b128 v[36:39], v6 offset:55296
v_add_f32 v103, 1.0, v103
v_mfma_f32_16x16x32_bf16 v[52:55], a[192:195], v[16:19], v[52:55]
ds_read_b128 v[40:43], v6 offset:55552
v_mul_f32 v107, v107, v75
v_mfma_f32_16x16x32_bf16 v[56:59], a[196:199], v[16:19], v[56:59]
buffer_store_dwordx4 v[84:87], v9, s[8:11], s21 offen sc1
v_mul_f32 v100, v100, v68
v_mfma_f32_16x16x32_bf16 v[48:51], a[196:199], v[12:15], v[48:51]
s_waitcnt lgkmcnt(4)
v_exp_f32 v106, v106
v_mfma_f32_16x16x32_bf16 v[44:47], a[200:203], v[20:23], v[44:47]
ds_read_b128 v[12:15], v6 offset:57344
v_add_f32 v104, 1.0, v104
v_mfma_f32_16x16x32_bf16 v[52:55], a[200:203], v[24:27], v[52:55]
ds_read_b128 v[16:19], v6 offset:57600
v_mul_f32 v101, v101, v69
v_mfma_f32_16x16x32_bf16 v[56:59], a[204:207], v[24:27], v[56:59]
buffer_load_dwordx4 v202, s[12:15], s68 offen offset:2048 nt lds
v_cvt_pk_bf16_f32 v88, v100, v101
v_mfma_f32_16x16x32_bf16 v[48:51], a[204:207], v[20:23], v[48:51]
s_waitcnt lgkmcnt(4)
v_rcp_f32 v103, v103
v_mfma_f32_16x16x32_bf16 v[44:47], a[208:211], v[28:31], v[44:47]
ds_read_b128 v[20:23], v6 offset:59392
v_add_f32 v105, 1.0, v105
v_mfma_f32_16x16x32_bf16 v[52:55], a[208:211], v[32:35], v[52:55]
ds_read_b128 v[24:27], v6 offset:59648
v_mul_f32 v102, v102, v70
v_mfma_f32_16x16x32_bf16 v[56:59], a[212:215], v[32:35], v[56:59]
v_exp_f32 v107, v107
v_mfma_f32_16x16x32_bf16 v[48:51], a[212:215], v[28:31], v[48:51]
s_waitcnt lgkmcnt(4)
v_rcp_f32 v104, v104
v_mfma_f32_16x16x32_bf16 v[44:47], a[216:219], v[36:39], v[44:47]
ds_read_b128 v[28:31], v6 offset:61440
v_add_f32 v106, 1.0, v106
v_mfma_f32_16x16x32_bf16 v[52:55], a[216:219], v[40:43], v[52:55]
ds_read_b128 v[32:35], v6 offset:61696
v_mul_f32 v103, v103, v71
v_mfma_f32_16x16x32_bf16 v[56:59], a[220:223], v[40:43], v[56:59]
buffer_load_dwordx4 v203, s[12:15], s68 offen offset:3072 nt lds
v_cvt_pk_bf16_f32 v89, v102, v103
v_mfma_f32_16x16x32_bf16 v[48:51], a[220:223], v[36:39], v[48:51]
s_waitcnt lgkmcnt(4)
v_rcp_f32 v105, v105
v_mfma_f32_16x16x32_bf16 v[44:47], a[224:227], v[12:15], v[44:47]
s_add_u32 s68, s68, s75
ds_read_b128 v[36:39], v6 offset:63488
v_add_f32 v107, 1.0, v107
v_mfma_f32_16x16x32_bf16 v[52:55], a[224:227], v[16:19], v[52:55]
s_add_u32 m0, s22, 16384
ds_read_b128 v[40:43], v6 offset:63744
v_mul_f32 v104, v104, v72
v_mfma_f32_16x16x32_bf16 v[56:59], a[228:231], v[16:19], v[56:59]
v_rcp_f32 v106, v106
v_mfma_f32_16x16x32_bf16 v[48:51], a[228:231], v[12:15], v[48:51]
s_waitcnt lgkmcnt(4)
v_rcp_f32 v107, v107
v_mfma_f32_16x16x32_bf16 v[44:47], a[232:235], v[20:23], v[44:47]
s_waitcnt vmcnt(14)
s_barrier
ds_read_b128 v[12:15], v7 offset:0
v_mfma_f32_16x16x32_bf16 v[52:55], a[232:235], v[24:27], v[52:55]
ds_read_b128 v[16:19], v7 offset:256
v_mul_f32 v105, v105, v73
v_mfma_f32_16x16x32_bf16 v[56:59], a[236:239], v[24:27], v[56:59]
buffer_load_dwordx4 v200, s[12:15], s68 offen nt lds
v_cvt_pk_bf16_f32 v90, v104, v105
v_mfma_f32_16x16x32_bf16 v[48:51], a[236:239], v[20:23], v[48:51]
s_waitcnt lgkmcnt(4)
v_mul_f32 v106, v106, v74
v_mul_f32 v107, v107, v75
v_mfma_f32_16x16x32_bf16 v[44:47], a[240:243], v[28:31], v[44:47]
ds_read_b128 v[20:23], v7 offset:2048
v_cvt_pk_bf16_f32 v91, v106, v107
v_mfma_f32_16x16x32_bf16 v[52:55], a[240:243], v[32:35], v[52:55]
ds_read_b128 v[24:27], v7 offset:2304
v_mfma_f32_16x16x32_bf16 v[56:59], a[244:247], v[32:35], v[56:59]
buffer_store_dwordx4 v[88:91], v9, s[8:11], s21 offen offset:256 sc1
s_mov_b32 s21, s31
v_mfma_f32_16x16x32_bf16 v[48:51], a[244:247], v[28:31], v[48:51]
s_waitcnt lgkmcnt(4)
s_add_u32 s31, s31, s29
v_mfma_f32_16x16x32_bf16 v[44:47], a[248:251], v[36:39], v[44:47]
ds_read_b128 v[28:31], v7 offset:4096
v_mfma_f32_16x16x32_bf16 v[52:55], a[248:251], v[40:43], v[52:55]
ds_read_b128 v[32:35], v7 offset:4352
v_mfma_f32_16x16x32_bf16 v[56:59], a[252:255], v[40:43], v[56:59]
buffer_load_dwordx4 v201, s[12:15], s68 offen offset:1024 nt lds
v_mfma_f32_16x16x32_bf16 v[48:51], a[252:255], v[36:39], v[48:51]
s_waitcnt lgkmcnt(4)
v_mfma_f32_16x16x32_bf16 v[60:63], a[0:3], v[12:15], v[76:79]
ds_read_b128 v[36:39], v7 offset:6144
v_mfma_f32_16x16x32_bf16 v[68:71], a[0:3], v[16:19], v[76:79]
ds_read_b128 v[40:43], v7 offset:6400
v_mul_f32 v92, v44, v44
v_mfma_f32_16x16x32_bf16 v[72:75], a[4:7], v[16:19], v[80:83]
v_mul_f32 v93, v45, v45
v_mfma_f32_16x16x32_bf16 v[64:67], a[4:7], v[12:15], v[80:83]
s_waitcnt lgkmcnt(4)
v_fma_f32 v92, v92, s40, v10
v_mfma_f32_16x16x32_bf16 v[60:63], a[8:11], v[20:23], v[60:63]
ds_read_b128 v[12:15], v7 offset:8192
v_mul_f32 v94, v46, v46
v_mfma_f32_16x16x32_bf16 v[68:71], a[8:11], v[24:27], v[68:71]
ds_read_b128 v[16:19], v7 offset:8448
v_fma_f32 v93, v93, s40, v10
v_mfma_f32_16x16x32_bf16 v[72:75], a[12:15], v[24:27], v[72:75]
buffer_load_dwordx4 v202, s[12:15], s68 offen offset:2048 nt lds
v_mul_f32 v95, v47, v47
v_mfma_f32_16x16x32_bf16 v[64:67], a[12:15], v[20:23], v[64:67]
s_waitcnt lgkmcnt(4)
v_mul_f32 v92, v92, v44
v_mfma_f32_16x16x32_bf16 v[60:63], a[16:19], v[28:31], v[60:63]
ds_read_b128 v[20:23], v7 offset:10240
v_fma_f32 v94, v94, s40, v10
v_mfma_f32_16x16x32_bf16 v[68:71], a[16:19], v[32:35], v[68:71]
ds_read_b128 v[24:27], v7 offset:10496
v_mul_f32 v96, v48, v48
v_mfma_f32_16x16x32_bf16 v[72:75], a[20:23], v[32:35], v[72:75]
v_exp_f32 v92, v92
v_mfma_f32_16x16x32_bf16 v[64:67], a[20:23], v[28:31], v[64:67]
s_waitcnt lgkmcnt(4)
v_mul_f32 v93, v93, v45
v_mfma_f32_16x16x32_bf16 v[60:63], a[24:27], v[36:39], v[60:63]
ds_read_b128 v[28:31], v7 offset:12288
v_fma_f32 v95, v95, s40, v10
v_mfma_f32_16x16x32_bf16 v[68:71], a[24:27], v[40:43], v[68:71]
ds_read_b128 v[32:35], v7 offset:12544
v_mul_f32 v97, v49, v49
v_mfma_f32_16x16x32_bf16 v[72:75], a[28:31], v[40:43], v[72:75]
buffer_load_dwordx4 v203, s[12:15], s68 offen offset:3072 nt lds
v_mul_f32 v94, v94, v46
v_mfma_f32_16x16x32_bf16 v[64:67], a[28:31], v[36:39], v[64:67]
s_waitcnt lgkmcnt(4)
v_exp_f32 v93, v93
v_mfma_f32_16x16x32_bf16 v[60:63], a[32:35], v[12:15], v[60:63]
s_add_u32 s68, s68, s75
ds_read_b128 v[36:39], v7 offset:14336
v_fma_f32 v96, v96, s40, v10
v_mfma_f32_16x16x32_bf16 v[68:71], a[32:35], v[16:19], v[68:71]
s_add_u32 m0, s22, 32768
ds_read_b128 v[40:43], v7 offset:14592
v_mul_f32 v98, v50, v50
v_mfma_f32_16x16x32_bf16 v[72:75], a[36:39], v[16:19], v[72:75]
v_exp_f32 v94, v94
v_mfma_f32_16x16x32_bf16 v[64:67], a[36:39], v[12:15], v[64:67]
s_waitcnt lgkmcnt(4)
v_mul_f32 v95, v95, v47
v_fma_f32 v97, v97, s40, v10
v_mfma_f32_16x16x32_bf16 v[60:63], a[40:43], v[20:23], v[60:63]
ds_read_b128 v[12:15], v7 offset:16384
v_mul_f32 v99, v51, v51
v_mfma_f32_16x16x32_bf16 v[68:71], a[40:43], v[24:27], v[68:71]
ds_read_b128 v[16:19], v7 offset:16640
v_add_f32 v92, 1.0, v92
v_mfma_f32_16x16x32_bf16 v[72:75], a[44:47], v[24:27], v[72:75]
buffer_load_dwordx4 v200, s[12:15], s68 offen nt lds
v_mul_f32 v96, v96, v48
v_mfma_f32_16x16x32_bf16 v[64:67], a[44:47], v[20:23], v[64:67]
s_waitcnt lgkmcnt(4)
v_exp_f32 v95, v95
v_mfma_f32_16x16x32_bf16 v[60:63], a[48:51], v[28:31], v[60:63]
ds_read_b128 v[20:23], v7 offset:18432
v_fma_f32 v98, v98, s40, v10
v_mfma_f32_16x16x32_bf16 v[68:71], a[48:51], v[32:35], v[68:71]
ds_read_b128 v[24:27], v7 offset:18688
v_mul_f32 v100, v52, v52
v_mfma_f32_16x16x32_bf16 v[72:75], a[52:55], v[32:35], v[72:75]
v_rcp_f32 v92, v92
v_mfma_f32_16x16x32_bf16 v[64:67], a[52:55], v[28:31], v[64:67]
s_waitcnt lgkmcnt(4)
v_exp_f32 v96, v96
v_mfma_f32_16x16x32_bf16 v[60:63], a[56:59], v[36:39], v[60:63]
ds_read_b128 v[28:31], v7 offset:20480
v_add_f32 v93, 1.0, v93
v_mfma_f32_16x16x32_bf16 v[68:71], a[56:59], v[40:43], v[68:71]
ds_read_b128 v[32:35], v7 offset:20736
v_mul_f32 v97, v97, v49
v_mfma_f32_16x16x32_bf16 v[72:75], a[60:63], v[40:43], v[72:75]
buffer_load_dwordx4 v201, s[12:15], s68 offen offset:1024 nt lds
v_fma_f32 v99, v99, s40, v10
v_mfma_f32_16x16x32_bf16 v[64:67], a[60:63], v[36:39], v[64:67]
s_waitcnt lgkmcnt(4)
v_rcp_f32 v93, v93
v_mfma_f32_16x16x32_bf16 v[60:63], a[64:67], v[12:15], v[60:63]
ds_read_b128 v[36:39], v7 offset:22528
v_mul_f32 v101, v53, v53
v_mfma_f32_16x16x32_bf16 v[68:71], a[64:67], v[16:19], v[68:71]
ds_read_b128 v[40:43], v7 offset:22784
v_add_f32 v94, 1.0, v94
v_mfma_f32_16x16x32_bf16 v[72:75], a[68:71], v[16:19], v[72:75]
v_exp_f32 v97, v97
v_mfma_f32_16x16x32_bf16 v[64:67], a[68:71], v[12:15], v[64:67]
s_waitcnt lgkmcnt(4)
v_rcp_f32 v94, v94
v_mfma_f32_16x16x32_bf16 v[60:63], a[72:75], v[20:23], v[60:63]
ds_read_b128 v[12:15], v7 offset:24576
v_mul_f32 v98, v98, v50
v_mfma_f32_16x16x32_bf16 v[68:71], a[72:75], v[24:27], v[68:71]
ds_read_b128 v[16:19], v7 offset:24832
v_fma_f32 v100, v100, s40, v10
v_mfma_f32_16x16x32_bf16 v[72:75], a[76:79], v[24:27], v[72:75]
buffer_load_dwordx4 v202, s[12:15], s68 offen offset:2048 nt lds
v_mul_f32 v102, v54, v54
v_mfma_f32_16x16x32_bf16 v[64:67], a[76:79], v[20:23], v[64:67]
s_waitcnt lgkmcnt(4)
v_exp_f32 v98, v98
v_mfma_f32_16x16x32_bf16 v[60:63], a[80:83], v[28:31], v[60:63]
ds_read_b128 v[20:23], v7 offset:26624
v_add_f32 v95, 1.0, v95
v_mfma_f32_16x16x32_bf16 v[68:71], a[80:83], v[32:35], v[68:71]
ds_read_b128 v[24:27], v7 offset:26880
v_mul_f32 v99, v99, v51
v_mfma_f32_16x16x32_bf16 v[72:75], a[84:87], v[32:35], v[72:75]
v_rcp_f32 v95, v95
v_mfma_f32_16x16x32_bf16 v[64:67], a[84:87], v[28:31], v[64:67]
s_waitcnt lgkmcnt(4)
v_fma_f32 v101, v101, s40, v10
v_mul_f32 v103, v55, v55
v_mfma_f32_16x16x32_bf16 v[60:63], a[88:91], v[36:39], v[60:63]
ds_read_b128 v[28:31], v7 offset:28672
v_mul_f32 v92, v92, v44
v_mfma_f32_16x16x32_bf16 v[68:71], a[88:91], v[40:43], v[68:71]
ds_read_b128 v[32:35], v7 offset:28928
v_add_f32 v96, 1.0, v96
v_mfma_f32_16x16x32_bf16 v[72:75], a[92:95], v[40:43], v[72:75]
buffer_load_dwordx4 v203, s[12:15], s68 offen offset:3072 nt lds
v_mul_f32 v100, v100, v52
v_mfma_f32_16x16x32_bf16 v[64:67], a[92:95], v[36:39], v[64:67]
s_waitcnt lgkmcnt(4)
v_exp_f32 v99, v99
v_mfma_f32_16x16x32_bf16 v[60:63], a[96:99], v[12:15], v[60:63]
s_add_u32 s68, s68, s75
ds_read_b128 v[36:39], v7 offset:30720
v_fma_f32 v102, v102, s40, v10
v_mfma_f32_16x16x32_bf16 v[68:71], a[96:99], v[16:19], v[68:71]
s_add_u32 m0, s22, 49152
ds_read_b128 v[40:43], v7 offset:30976
v_mul_f32 v104, v56, v56
v_mfma_f32_16x16x32_bf16 v[72:75], a[100:103], v[16:19], v[72:75]
v_rcp_f32 v96, v96
v_mfma_f32_16x16x32_bf16 v[64:67], a[100:103], v[12:15], v[64:67]
s_waitcnt lgkmcnt(4)
v_exp_f32 v100, v100
v_mfma_f32_16x16x32_bf16 v[60:63], a[104:107], v[20:23], v[60:63]
s_waitcnt vmcnt(14)
s_barrier
ds_read_b128 v[12:15], v7 offset:32768
v_mfma_f32_16x16x32_bf16 v[68:71], a[104:107], v[24:27], v[68:71]
ds_read_b128 v[16:19], v7 offset:33024
v_mul_f32 v93, v93, v45
v_mfma_f32_16x16x32_bf16 v[72:75], a[108:111], v[24:27], v[72:75]
buffer_load_dwordx4 v200, s[12:15], s68 offen nt lds
v_cvt_pk_bf16_f32 v84, v92, v93
v_mfma_f32_16x16x32_bf16 v[64:67], a[108:111], v[20:23], v[64:67]
s_waitcnt lgkmcnt(4)
v_add_f32 v97, 1.0, v97
v_mfma_f32_16x16x32_bf16 v[60:63], a[112:115], v[28:31], v[60:63]
ds_read_b128 v[20:23], v7 offset:34816
v_mul_f32 v101, v101, v53
v_mfma_f32_16x16x32_bf16 v[68:71], a[112:115], v[32:35], v[68:71]
ds_read_b128 v[24:27], v7 offset:35072
v_fma_f32 v103, v103, s40, v10
v_mfma_f32_16x16x32_bf16 v[72:75], a[116:119], v[32:35], v[72:75]
v_rcp_f32 v97, v97
v_mfma_f32_16x16x32_bf16 v[64:67], a[116:119], v[28:31], v[64:67]
s_waitcnt lgkmcnt(4)
v_exp_f32 v101, v101
v_mfma_f32_16x16x32_bf16 v[60:63], a[120:123], v[36:39], v[60:63]
s_waitcnt vmcnt(8)
ds_read_b128 v[28:31], v7 offset:36864
v_mul_f32 v105, v57, v57
v_mfma_f32_16x16x32_bf16 v[68:71], a[120:123], v[40:43], v[68:71]
s_max_i32 s27, s39, 0
ds_read_b128 v[32:35], v7 offset:37120
v_mov_b32 v112, s27
v_mfma_f32_16x16x32_bf16 v[72:75], a[124:127], v[40:43], v[72:75]
buffer_load_dwordx4 v201, s[12:15], s68 offen offset:1024 nt lds
v_mul_f32 v94, v94, v46
v_mfma_f32_16x16x32_bf16 v[64:67], a[124:127], v[36:39], v[64:67]
s_waitcnt lgkmcnt(4)
v_add_f32 v98, 1.0, v98
v_mul_f32 v102, v102, v54
v_mfma_f32_16x16x32_bf16 v[60:63], a[128:131], v[12:15], v[60:63]
buffer_store_dword v112, v108, s[8:11], 0 offen sc1
ds_read_b128 v[36:39], v7 offset:38912
v_mfma_f32_16x16x32_bf16 v[68:71], a[128:131], v[16:19], v[68:71]
s_add_u32 s39, s39, 1
ds_read_b128 v[40:43], v7 offset:39168
v_fma_f32 v104, v104, s40, v10
v_mfma_f32_16x16x32_bf16 v[72:75], a[132:135], v[16:19], v[72:75]
v_rcp_f32 v98, v98
v_mfma_f32_16x16x32_bf16 v[64:67], a[132:135], v[12:15], v[64:67]
s_waitcnt lgkmcnt(4)
v_exp_f32 v102, v102
v_mfma_f32_16x16x32_bf16 v[60:63], a[136:139], v[20:23], v[60:63]
ds_read_b128 v[12:15], v7 offset:40960
v_mul_f32 v106, v58, v58
v_mfma_f32_16x16x32_bf16 v[68:71], a[136:139], v[24:27], v[68:71]
ds_read_b128 v[16:19], v7 offset:41216
v_mul_f32 v95, v95, v47
v_mfma_f32_16x16x32_bf16 v[72:75], a[140:143], v[24:27], v[72:75]
buffer_load_dwordx4 v202, s[12:15], s68 offen offset:2048 nt lds
v_cvt_pk_bf16_f32 v85, v94, v95
v_mfma_f32_16x16x32_bf16 v[64:67], a[140:143], v[20:23], v[64:67]
s_waitcnt lgkmcnt(4)
v_add_f32 v99, 1.0, v99
v_mfma_f32_16x16x32_bf16 v[60:63], a[144:147], v[28:31], v[60:63]
ds_read_b128 v[20:23], v7 offset:43008
v_mul_f32 v103, v103, v55
v_mfma_f32_16x16x32_bf16 v[68:71], a[144:147], v[32:35], v[68:71]
ds_read_b128 v[24:27], v7 offset:43264
v_fma_f32 v105, v105, s40, v10
v_mfma_f32_16x16x32_bf16 v[72:75], a[148:151], v[32:35], v[72:75]
v_rcp_f32 v99, v99
v_mfma_f32_16x16x32_bf16 v[64:67], a[148:151], v[28:31], v[64:67]
s_waitcnt lgkmcnt(4)
v_exp_f32 v103, v103
v_mfma_f32_16x16x32_bf16 v[60:63], a[152:155], v[36:39], v[60:63]
ds_read_b128 v[28:31], v7 offset:45056
v_mul_f32 v107, v59, v59
v_mfma_f32_16x16x32_bf16 v[68:71], a[152:155], v[40:43], v[68:71]
ds_read_b128 v[32:35], v7 offset:45312
v_mul_f32 v96, v96, v48
v_mfma_f32_16x16x32_bf16 v[72:75], a[156:159], v[40:43], v[72:75]
buffer_load_dwordx4 v203, s[12:15], s68 offen offset:3072 nt lds
v_add_f32 v100, 1.0, v100
v_mfma_f32_16x16x32_bf16 v[64:67], a[156:159], v[36:39], v[64:67]
s_waitcnt lgkmcnt(4)
s_add_u32 s68, s68, s75
v_mul_f32 v104, v104, v56
v_mfma_f32_16x16x32_bf16 v[60:63], a[160:163], v[12:15], v[60:63]
s_add_u32 m0, s22, 65536
ds_read_b128 v[36:39], v7 offset:47104
v_fma_f32 v106, v106, s40, v10
v_mfma_f32_16x16x32_bf16 v[68:71], a[160:163], v[16:19], v[68:71]
s_cmp_lt_u32 s36, s37
ds_read_b128 v[40:43], v7 offset:47360
s_cselect_b32 s20, s20, 0x40000000
v_mfma_f32_16x16x32_bf16 v[72:75], a[164:167], v[16:19], v[72:75]
v_rcp_f32 v100, v100
v_mfma_f32_16x16x32_bf16 v[64:67], a[164:167], v[12:15], v[64:67]
s_waitcnt lgkmcnt(4)
v_exp_f32 v104, v104
v_mfma_f32_16x16x32_bf16 v[60:63], a[168:171], v[20:23], v[60:63]
ds_read_b128 v[12:15], v7 offset:49152
v_mul_f32 v97, v97, v49
v_mfma_f32_16x16x32_bf16 v[68:71], a[168:171], v[24:27], v[68:71]
ds_read_b128 v[16:19], v7 offset:49408
v_cvt_pk_bf16_f32 v86, v96, v97
v_mfma_f32_16x16x32_bf16 v[72:75], a[172:175], v[24:27], v[72:75]
buffer_load_dwordx4 v200, s[12:15], s68 offen nt lds
v_add_f32 v101, 1.0, v101
v_mfma_f32_16x16x32_bf16 v[64:67], a[172:175], v[20:23], v[64:67]
s_waitcnt lgkmcnt(4)
v_rcp_f32 v101, v101
v_mfma_f32_16x16x32_bf16 v[60:63], a[176:179], v[28:31], v[60:63]
s_add_u32 s36, s36, 1
ds_read_b128 v[20:23], v7 offset:51200
v_mul_f32 v105, v105, v57
v_mfma_f32_16x16x32_bf16 v[68:71], a[176:179], v[32:35], v[68:71]
ds_read_b128 v[24:27], v7 offset:51456
v_fma_f32 v107, v107, s40, v10
v_mfma_f32_16x16x32_bf16 v[72:75], a[180:183], v[32:35], v[72:75]
v_exp_f32 v105, v105
v_mfma_f32_16x16x32_bf16 v[64:67], a[180:183], v[28:31], v[64:67]
s_waitcnt lgkmcnt(4)
v_mul_f32 v98, v98, v50
v_add_f32 v102, 1.0, v102
v_mfma_f32_16x16x32_bf16 v[60:63], a[184:187], v[36:39], v[60:63]
ds_read_b128 v[28:31], v7 offset:53248
v_mul_f32 v106, v106, v58
v_mfma_f32_16x16x32_bf16 v[68:71], a[184:187], v[40:43], v[68:71]
ds_read_b128 v[32:35], v7 offset:53504
v_mul_f32 v99, v99, v51
v_mfma_f32_16x16x32_bf16 v[72:75], a[188:191], v[40:43], v[72:75]
buffer_load_dwordx4 v201, s[12:15], s68 offen offset:1024 nt lds
v_cvt_pk_bf16_f32 v87, v98, v99
v_mfma_f32_16x16x32_bf16 v[64:67], a[188:191], v[36:39], v[64:67]
s_waitcnt lgkmcnt(4)
v_rcp_f32 v102, v102
v_mfma_f32_16x16x32_bf16 v[60:63], a[192:195], v[12:15], v[60:63]
ds_read_b128 v[36:39], v7 offset:55296
v_add_f32 v103, 1.0, v103
v_mfma_f32_16x16x32_bf16 v[68:71], a[192:195], v[16:19], v[68:71]
ds_read_b128 v[40:43], v7 offset:55552
v_mul_f32 v107, v107, v59
v_mfma_f32_16x16x32_bf16 v[72:75], a[196:199], v[16:19], v[72:75]
buffer_store_dwordx4 v[84:87], v9, s[8:11], s21 offen sc1
v_mul_f32 v100, v100, v52
v_mfma_f32_16x16x32_bf16 v[64:67], a[196:199], v[12:15], v[64:67]
s_waitcnt lgkmcnt(4)
v_exp_f32 v106, v106
v_mfma_f32_16x16x32_bf16 v[60:63], a[200:203], v[20:23], v[60:63]
ds_read_b128 v[12:15], v7 offset:57344
v_add_f32 v104, 1.0, v104
v_mfma_f32_16x16x32_bf16 v[68:71], a[200:203], v[24:27], v[68:71]
ds_read_b128 v[16:19], v7 offset:57600
v_mul_f32 v101, v101, v53
v_mfma_f32_16x16x32_bf16 v[72:75], a[204:207], v[24:27], v[72:75]
buffer_load_dwordx4 v202, s[12:15], s68 offen offset:2048 nt lds
v_cvt_pk_bf16_f32 v88, v100, v101
v_mfma_f32_16x16x32_bf16 v[64:67], a[204:207], v[20:23], v[64:67]
s_waitcnt lgkmcnt(4)
v_rcp_f32 v103, v103
v_mfma_f32_16x16x32_bf16 v[60:63], a[208:211], v[28:31], v[60:63]
ds_read_b128 v[20:23], v7 offset:59392
v_add_f32 v105, 1.0, v105
v_mfma_f32_16x16x32_bf16 v[68:71], a[208:211], v[32:35], v[68:71]
ds_read_b128 v[24:27], v7 offset:59648
v_mul_f32 v102, v102, v54
v_mfma_f32_16x16x32_bf16 v[72:75], a[212:215], v[32:35], v[72:75]
v_exp_f32 v107, v107
v_mfma_f32_16x16x32_bf16 v[64:67], a[212:215], v[28:31], v[64:67]
s_waitcnt lgkmcnt(4)
v_rcp_f32 v104, v104
v_mfma_f32_16x16x32_bf16 v[60:63], a[216:219], v[36:39], v[60:63]
ds_read_b128 v[28:31], v7 offset:61440
v_add_f32 v106, 1.0, v106
v_mfma_f32_16x16x32_bf16 v[68:71], a[216:219], v[40:43], v[68:71]
ds_read_b128 v[32:35], v7 offset:61696
v_mul_f32 v103, v103, v55
v_mfma_f32_16x16x32_bf16 v[72:75], a[220:223], v[40:43], v[72:75]
buffer_load_dwordx4 v203, s[12:15], s68 offen offset:3072 nt lds
v_cvt_pk_bf16_f32 v89, v102, v103
v_mfma_f32_16x16x32_bf16 v[64:67], a[220:223], v[36:39], v[64:67]
s_waitcnt lgkmcnt(4)
v_rcp_f32 v105, v105
v_mfma_f32_16x16x32_bf16 v[60:63], a[224:227], v[12:15], v[60:63]
s_add_u32 s68, s68, s75
ds_read_b128 v[36:39], v7 offset:63488
v_add_f32 v107, 1.0, v107
v_mfma_f32_16x16x32_bf16 v[68:71], a[224:227], v[16:19], v[68:71]
s_add_u32 m0, s22, 81920
ds_read_b128 v[40:43], v7 offset:63744
v_mul_f32 v104, v104, v56
v_mfma_f32_16x16x32_bf16 v[72:75], a[228:231], v[16:19], v[72:75]
v_rcp_f32 v106, v106
v_mfma_f32_16x16x32_bf16 v[64:67], a[228:231], v[12:15], v[64:67]
s_waitcnt lgkmcnt(4)
v_rcp_f32 v107, v107
v_mfma_f32_16x16x32_bf16 v[60:63], a[232:235], v[20:23], v[60:63]
s_waitcnt vmcnt(24)
s_barrier
ds_read_b128 v[12:15], v6 offset:0
v_mfma_f32_16x16x32_bf16 v[68:71], a[232:235], v[24:27], v[68:71]
ds_read_b128 v[16:19], v6 offset:256
v_mul_f32 v105, v105, v57
v_mfma_f32_16x16x32_bf16 v[72:75], a[236:239], v[24:27], v[72:75]
buffer_load_dwordx4 v200, s[12:15], s68 offen nt lds
v_cvt_pk_bf16_f32 v90, v104, v105
v_mfma_f32_16x16x32_bf16 v[64:67], a[236:239], v[20:23], v[64:67]
s_waitcnt lgkmcnt(4)
v_mul_f32 v106, v106, v58
v_mul_f32 v107, v107, v59
v_mfma_f32_16x16x32_bf16 v[60:63], a[240:243], v[28:31], v[60:63]
ds_read_b128 v[20:23], v6 offset:2048
v_cvt_pk_bf16_f32 v91, v106, v107
v_mfma_f32_16x16x32_bf16 v[68:71], a[240:243], v[32:35], v[68:71]
ds_read_b128 v[24:27], v6 offset:2304
v_mfma_f32_16x16x32_bf16 v[72:75], a[244:247], v[32:35], v[72:75]
buffer_store_dwordx4 v[88:91], v9, s[8:11], s21 offen offset:256 sc1
s_mov_b32 s21, s31
v_mfma_f32_16x16x32_bf16 v[64:67], a[244:247], v[28:31], v[64:67]
s_waitcnt lgkmcnt(4)
s_add_u32 s31, s31, s29
v_mfma_f32_16x16x32_bf16 v[60:63], a[248:251], v[36:39], v[60:63]
ds_read_b128 v[28:31], v6 offset:4096
v_mfma_f32_16x16x32_bf16 v[68:71], a[248:251], v[40:43], v[68:71]
ds_read_b128 v[32:35], v6 offset:4352
v_mfma_f32_16x16x32_bf16 v[72:75], a[252:255], v[40:43], v[72:75]
s_sub_u32 s24, s24, 1
buffer_load_dwordx4 v201, s[12:15], s68 offen offset:1024 nt lds
v_mfma_f32_16x16x32_bf16 v[64:67], a[252:255], v[36:39], v[64:67]
s_waitcnt lgkmcnt(4)
s_barrier
s_add_u32 m0, s22, 81920
s_nop 0
buffer_load_dwordx4 v202, s[12:15], s68 offen offset:2048 nt lds
buffer_load_dwordx4 v203, s[12:15], s68 offen offset:3072 nt lds
s_add_u32 s68, s68, s75
s_add_u32 m0, s22, 98304
s_nop 0
buffer_load_dwordx4 v200, s[12:15], s68 offen nt lds
buffer_load_dwordx4 v201, s[12:15], s68 offen offset:1024 nt lds
buffer_load_dwordx4 v202, s[12:15], s68 offen offset:2048 nt lds
buffer_load_dwordx4 v203, s[12:15], s68 offen offset:3072 nt lds
s_add_u32 s68, s68, s75
s_add_u32 m0, s22, 114688
s_nop 0
buffer_load_dwordx4 v200, s[12:15], s68 offen nt lds
buffer_load_dwordx4 v201, s[12:15], s68 offen offset:1024 nt lds
buffer_load_dwordx4 v202, s[12:15], s68 offen offset:2048 nt lds
buffer_load_dwordx4 v203, s[12:15], s68 offen offset:3072 nt lds
v_mul_f32 v92, v60, v60
v_mul_f32 v93, v61, v61
v_fma_f32 v92, v92, s40, v10
v_mul_f32 v94, v62, v62
v_fma_f32 v93, v93, s40, v10
v_mul_f32 v95, v63, v63
v_mul_f32 v92, v92, v60
v_fma_f32 v94, v94, s40, v10
v_mul_f32 v96, v64, v64
v_mul_f32 v93, v93, v61
v_fma_f32 v95, v95, s40, v10
v_mul_f32 v97, v65, v65
v_exp_f32 v92, v92
v_mul_f32 v94, v94, v62
v_fma_f32 v96, v96, s40, v10
v_mul_f32 v98, v66, v66
v_exp_f32 v93, v93
v_mul_f32 v95, v95, v63
v_fma_f32 v97, v97, s40, v10
v_mul_f32 v99, v67, v67
v_add_f32 v92, 1.0, v92
v_exp_f32 v94, v94
v_mul_f32 v96, v96, v64
v_fma_f32 v98, v98, s40, v10
v_mul_f32 v100, v68, v68
v_add_f32 v93, 1.0, v93
v_exp_f32 v95, v95
v_mul_f32 v97, v97, v65
v_fma_f32 v99, v99, s40, v10
v_mul_f32 v101, v69, v69
v_rcp_f32 v92, v92
v_add_f32 v94, 1.0, v94
v_exp_f32 v96, v96
v_mul_f32 v98, v98, v66
v_fma_f32 v100, v100, s40, v10
v_mul_f32 v102, v70, v70
v_rcp_f32 v93, v93
v_add_f32 v95, 1.0, v95
v_exp_f32 v97, v97
v_mul_f32 v99, v99, v67
v_fma_f32 v101, v101, s40, v10
v_mul_f32 v103, v71, v71
v_mul_f32 v92, v92, v60
v_rcp_f32 v94, v94
v_add_f32 v96, 1.0, v96
v_exp_f32 v98, v98
v_mul_f32 v100, v100, v68
v_fma_f32 v102, v102, s40, v10
v_mul_f32 v104, v72, v72
v_mul_f32 v93, v93, v61
v_rcp_f32 v95, v95
v_add_f32 v97, 1.0, v97
v_exp_f32 v99, v99
v_mul_f32 v101, v101, v69
v_fma_f32 v103, v103, s40, v10
v_mul_f32 v105, v73, v73
v_mul_f32 v94, v94, v62
v_rcp_f32 v96, v96
v_add_f32 v98, 1.0, v98
v_exp_f32 v100, v100
v_mul_f32 v102, v102, v70
v_fma_f32 v104, v104, s40, v10
v_mul_f32 v106, v74, v74
v_mul_f32 v95, v95, v63
v_rcp_f32 v97, v97
v_add_f32 v99, 1.0, v99
v_exp_f32 v101, v101
v_mul_f32 v103, v103, v71
v_fma_f32 v105, v105, s40, v10
v_mul_f32 v107, v75, v75
v_mul_f32 v96, v96, v64
v_rcp_f32 v98, v98
v_add_f32 v100, 1.0, v100
v_exp_f32 v102, v102
v_mul_f32 v104, v104, v72
v_fma_f32 v106, v106, s40, v10
v_mul_f32 v97, v97, v65
v_rcp_f32 v99, v99
v_add_f32 v101, 1.0, v101
v_exp_f32 v103, v103
v_mul_f32 v105, v105, v73
v_fma_f32 v107, v107, s40, v10
v_mul_f32 v98, v98, v66
v_rcp_f32 v100, v100
v_add_f32 v102, 1.0, v102
v_exp_f32 v104, v104
v_mul_f32 v106, v106, v74
v_mul_f32 v99, v99, v67
v_rcp_f32 v101, v101
v_add_f32 v103, 1.0, v103
v_exp_f32 v105, v105
v_mul_f32 v107, v107, v75
v_mul_f32 v100, v100, v68
v_rcp_f32 v102, v102
v_add_f32 v104, 1.0, v104
v_exp_f32 v106, v106
v_mul_f32 v101, v101, v69
v_rcp_f32 v103, v103
v_add_f32 v105, 1.0, v105
v_exp_f32 v107, v107
v_mul_f32 v102, v102, v70
v_rcp_f32 v104, v104
v_add_f32 v106, 1.0, v106
v_mul_f32 v103, v103, v71
v_rcp_f32 v105, v105
v_add_f32 v107, 1.0, v107
v_mul_f32 v104, v104, v72
v_rcp_f32 v106, v106
v_mul_f32 v105, v105, v73
v_rcp_f32 v107, v107
v_mul_f32 v106, v106, v74
v_mul_f32 v107, v107, v75
v_cvt_pk_bf16_f32 v84, v92, v93
v_cvt_pk_bf16_f32 v85, v94, v95
v_cvt_pk_bf16_f32 v86, v96, v97
v_cvt_pk_bf16_f32 v87, v98, v99
v_cvt_pk_bf16_f32 v88, v100, v101
v_cvt_pk_bf16_f32 v89, v102, v103
v_cvt_pk_bf16_f32 v90, v104, v105
v_cvt_pk_bf16_f32 v91, v106, v107
buffer_store_dwordx4 v[84:87], v9, s[8:11], s21 offen sc1
buffer_store_dwordx4 v[88:91], v9, s[8:11], s21 offen offset:256 sc1
s_mov_b32 s21, s31
s_add_u32 s31, s31, s29
s_waitcnt vmcnt(0)
s_mov_b32 s39, s37
s_max_i32 s27, s39, 0
v_mov_b32 v112, s27
buffer_store_dword v112, v108, s[8:11], 0 offen sc1
s_branch main_kernel_wo
main_kernel_sp:
s_waitcnt vmcnt(0)
s_or_b32 s56, s3, s25
s_cbranch_scc1 main_kernel_nocal
s_and_b32 s57, s73, 3
s_lshl_b32 s56, s57, 11
s_add_u32 s56, s56, 0x6400000
s_add_u32 s48, s56, 8192
v_mov_b32 v16, -1
v_mov_b32 v17, -1
v_mov_b32 v18, -1
v_mov_b32 v19, -1
v_lshlrev_b32 v20, 4, v1
s_mov_b64 s[44:45], -1
buffer_store_dwordx4 v[16:19], v20, s[8:11], s56 offen sc1
buffer_store_dwordx4 v[16:19], v20, s[8:11], s48 offen sc1
s_waitcnt vmcnt(0)
s_memtime s[46:47]
s_waitcnt lgkmcnt(0)
buffer_load_dword v2, off, s[8:11], s56 offset:0 sc1
s_waitcnt vmcnt(0)
s_memtime s[58:59]
s_waitcnt lgkmcnt(0)
s_sub_u32 s46, s58, s46
s_min_u32 s44, s44, s46
s_memtime s[46:47]
s_waitcnt lgkmcnt(0)
buffer_load_dword v2, off, s[8:11], s48 offset:0 sc1
s_waitcnt vmcnt(0)
s_memtime s[58:59]
s_waitcnt lgkmcnt(0)
s_sub_u32 s46, s58, s46
s_min_u32 s45, s45, s46
s_memtime s[46:47]
s_waitcnt lgkmcnt(0)
buffer_load_dword v2, off, s[8:11], s56 offset:128 sc1
s_waitcnt vmcnt(0)
s_memtime s[58:59]
s_waitcnt lgkmcnt(0)
s_sub_u32 s46, s58, s46
s_min_u32 s44, s44, s46
s_memtime s[46:47]
s_waitcnt lgkmcnt(0)
buffer_load_dword v2, off, s[8:11], s48 offset:128 sc1
s_waitcnt vmcnt(0)
s_memtime s[58:59]
s_waitcnt lgkmcnt(0)
s_sub_u32 s46, s58, s46
s_min_u32 s45, s45, s46
s_memtime s[46:47]
s_waitcnt lgkmcnt(0)
buffer_load_dword v2, off, s[8:11], s56 offset:512 sc1
s_waitcnt vmcnt(0)
s_memtime s[58:59]
s_waitcnt lgkmcnt(0)
s_sub_u32 s46, s58, s46
s_min_u32 s44, s44, s46
s_memtime s[46:47]
s_waitcnt lgkmcnt(0)
buffer_load_dword v2, off, s[8:11], s48 offset:512 sc1
s_waitcnt vmcnt(0)
s_memtime s[58:59]
s_waitcnt lgkmcnt(0)
s_sub_u32 s46, s58, s46
s_min_u32 s45, s45, s46
s_memtime s[46:47]
s_waitcnt lgkmcnt(0)
buffer_load_dword v2, off, s[8:11], s56 offset:768 sc1
s_waitcnt vmcnt(0)
s_memtime s[58:59]
s_waitcnt lgkmcnt(0)
s_sub_u32 s46, s58, s46
s_min_u32 s44, s44, s46
s_memtime s[46:47]
s_waitcnt lgkmcnt(0)
buffer_load_dword v2, off, s[8:11], s48 offset:768 sc1
s_waitcnt vmcnt(0)
s_memtime s[58:59]
s_waitcnt lgkmcnt(0)
s_sub_u32 s46, s58, s46
s_min_u32 s45, s45, s46
s_sub_u32 s46, s44, s45
s_sub_u32 s47, 0, s46
s_cmp_ge_u32 s7, 4
s_cselect_b32 s46, s47, s46
s_min_i32 s46, s46, 255
s_max_i32 s46, s46, -255
s_add_u32 s46, s46, 0x1000100
v_mov_b32 v2, s46
v_cmp_eq_u32 vcc, 0, v1
s_nop 1
v_cndmask_b32 v5, v11, v1, vcc
buffer_atomic_add v2, v5, s[64:67], 0 offen offset:192 sc1
main_kernel_nocal:
buffer_load_dwordx2 v[210:211], v209, s[64:67], 0 offen offset:128
s_waitcnt vmcnt(0)
s_cmp_lg_u32 s25, 0
s_cbranch_scc1 main_kernel_sp_ysk
s_mov_b32 s56, 2
s_cmp_lg_u32 s3, 0
s_cbranch_scc1 main_kernel_sp_yok
main_kernel_sp_ylp:
v_cmp_eq_u32 vcc, -1, v210
s_mov_b32 s57, 0x2000
v_cmp_eq_u32 s[58:59], s57, v211
s_and_b32 s58, s58, vcc_lo
s_and_b32 s58, s58, 0xff
v_readlane_b32 s56, v210, 8
s_cmp_eq_u32 s58, 0xff
s_cbranch_scc1 main_kernel_sp_yfa
s_mov_b32 s57, 0
v_readlane_b32 s58, v211, 0
s_lshr_b32 s58, s58, 8
s_add_u32 s57, s57, s58
v_readlane_b32 s58, v211, 1
s_lshr_b32 s58, s58, 8
s_add_u32 s57, s57, s58
v_readlane_b32 s58, v211, 2
s_lshr_b32 s58, s58, 8
s_add_u32 s57, s57, s58
v_readlane_b32 s58, v211, 3
s_lshr_b32 s58, s58, 8
s_add_u32 s57, s57, s58
v_readlane_b32 s58, v211, 4
s_lshr_b32 s58, s58, 8
s_add_u32 s57, s57, s58
v_readlane_b32 s58, v211, 5
s_lshr_b32 s58, s58, 8
s_add_u32 s57, s57, s58
v_readlane_b32 s58, v211, 6
s_lshr_b32 s58, s58, 8
s_add_u32 s57, s57, s58
v_readlane_b32 s58, v211, 7
s_lshr_b32 s58, s58, 8
s_add_u32 s57, s57, s58
s_mov_b32 s56, 2
s_cmp_eq_u32 s57, 256
s_cbranch_scc1 main_kernel_sp_yok
main_kernel_sp_ylpr:
s_add_u32 s54, s54, 1
s_cmp_ge_u32 s54, 131072
s_cbranch_scc1 main_kernel_sp_yok
s_sleep 4
buffer_load_dwordx2 v[210:211], v209, s[64:67], 0 offen offset:128 sc1
s_waitcnt vmcnt(0)
s_branch main_kernel_sp_ylp
main_kernel_sp_yfa:
s_mov_b32 s56, 1
main_kernel_sp_yok:
v_mov_b32 v210, s56
v_mov_b32 v211, 131136
ds_write_b32 v211, v210
s_waitcnt lgkmcnt(0)
main_kernel_sp_ysk:
s_barrier
v_mov_b32 v211, 131136
ds_read_b32 v210, v211
s_waitcnt lgkmcnt(0)
v_readfirstlane_b32 s6, v210
s_and_b32 s56, s6, 3
s_sub_u32 s56, s56, s3
s_cmp_eq_u32 s56, 2
s_cbranch_scc1 main_kernel_again
s_branch main_kernel_wo
main_kernel_f2:
v_lshl_add_u32 v8, v1, 4, s22
s_mov_b32 s16, s90
s_mov_b32 s17, s91
s_mov_b32 s18, 0x800
s_mov_b32 s19, 0x00020000
s_mul_i32 s52, s94, 57344
s_add_u32 s52, s52, 0x3400000
s_mov_b32 s53, 229376
s_mov_b32 s23, 14336
s_mov_b32 s28, 186368
s_mov_b32 s37, 64
s_mov_b32 s45, 0
s_mov_b32 s48, 65536
s_mov_b32 s36, 0
s_lshl_b32 s26, s98, 3
s_add_u32 s26, s26, s95
s_mul_i32 s44, s26, 229376
s_add_u32 s44, s44, 107085824
v_bfe_u32 v2, v1, 3, 1
v_lshlrev_b32 v2, 13, v2
v_and_b32 v3, 7, v1
v_lshl_add_u32 v2, v3, 4, v2
v_lshrrev_b32 v4, 4, v1
v_lshl_add_u32 v2, v4, 7, v2
s_lshl_b32 s26, s94, 11
s_lshl_b32 s27, s25, 9
s_add_u32 s26, s26, s27
v_add_u32 v116, s26, v2
v_add_u32 v117, 16384, v116
s_lshl_b32 s26, s94, 13
s_add_u32 s26, s26, s27
v_lshl_add_u32 v118, v1, 3, s26
v_add_u32 v119, 4096, v118
s_lshl_b32 s26, s94, 14
s_add_u32 s27, s27, s26
s_lshl_b32 s26, s95, 11
s_add_u32 s27, s27, s26
s_add_u32 s27, s27, 0x4400000
v_lshl_add_u32 v121, v1, 3, s27
s_lshl_b32 s26, s95, 8
s_lshl_b32 s27, s25, 6
s_add_u32 s26, s26, s27
v_lshl_add_u32 v4, v4, 4, s26
v_and_b32 v3, 1, v1
v_lshl_add_u32 v3, v3, 3, v4
v_bfe_u32 v2, v1, 1, 3
v_lshl_add_u32 v120, v2, 11, v3
s_lshl_b32 s26, s94, 14
v_add_u32 v120, s26, v120
buffer_load_dwordx2 v[124:125], v3, s[16:19], 0 offen
s_mov_b32 s40, 0xbfb8aa3b
s_mov_b32 s43, s44
s_mul_i32 s75, s94, 896
s_add_u32 s75, s75, 0x6a02000
v_lshrrev_b32 v2, 2, v1
v_and_b32 v3, 3, v1
v_lshlrev_b32 v3, 2, v3
v_lshl_add_u32 v2, v2, 7, v3
v_add_u32 v2, s75, v2
s_cmp_eq_u32 s25, 0
s_cselect_b32 s50, 0xfffffff, 0
s_mov_b32 s51, 0
v_cndmask_b32 v109, v11, v2, s[50:51]
s_lshl_b32 s75, s73, 7
s_add_u32 s75, s75, 0x6a05e00
s_lshl_b32 s26, s25, 2
s_add_u32 s26, s26, s75
v_mov_b32 v108, 0x40000000
v_writelane_b32 v108, s26, 0
s_add_u32 s26, s26, 4096
v_writelane_b32 v108, s26, 1
v_lshrrev_b32 v2, 5, v1
v_lshlrev_b32 v2, 12, v2
v_bfe_u32 v3, v1, 4, 1
v_lshl_add_u32 v2, v3, 10, v2
v_bfe_u32 v4, v1, 2, 2
v_lshl_add_u32 v2, v4, 8, v2
v_xor_b32 v4, s25, v4
v_lshl_add_u32 v3, v4, 2, v3
v_and_b32 v4, 3, v1
v_xor_b32 v3, v3, v4
v_lshl_add_u32 v94, v3, 4, v2
v_xor_b32 v95, 8, v94
v_add_u32 v96, 0x10000, v94
v_add_u32 v97, 0x10000, v95
s_waitcnt vmcnt(16)
s_barrier
ds_read_b64_tr_b16 a[0:1], v94 offset:0
ds_read_b64_tr_b16 a[2:3], v94 offset:2048
ds_read_b64_tr_b16 a[4:5], v95 offset:0
ds_read_b64_tr_b16 a[6:7], v95 offset:2048
ds_read_b64_tr_b16 a[8:9], v94 offset:8192
ds_read_b64_tr_b16 a[10:11], v94 offset:10240
ds_read_b64_tr_b16 a[12:13], v95 offset:8192
ds_read_b64_tr_b16 a[14:15], v95 offset:10240
ds_read_b64_tr_b16 a[16:17], v94 offset:16384
ds_read_b64_tr_b16 a[18:19], v94 offset:18432
ds_read_b64_tr_b16 a[20:21], v95 offset:16384
ds_read_b64_tr_b16 a[22:23], v95 offset:18432
ds_read_b64_tr_b16 a[24:25], v94 offset:24576
ds_read_b64_tr_b16 a[26:27], v94 offset:26624
ds_read_b64_tr_b16 a[28:29], v95 offset:24576
ds_read_b64_tr_b16 a[30:31], v95 offset:26624
ds_read_b64_tr_b16 a[32:33], v94 offset:32768
ds_read_b64_tr_b16 a[34:35], v94 offset:34816
ds_read_b64_tr_b16 a[36:37], v95 offset:32768
ds_read_b64_tr_b16 a[38:39], v95 offset:34816
ds_read_b64_tr_b16 a[40:41], v94 offset:40960
ds_read_b64_tr_b16 a[42:43], v94 offset:43008
ds_read_b64_tr_b16 a[44:45], v95 offset:40960
ds_read_b64_tr_b16 a[46:47], v95 offset:43008
ds_read_b64_tr_b16 a[48:49], v94 offset:49152
ds_read_b64_tr_b16 a[50:51], v94 offset:51200
ds_read_b64_tr_b16 a[52:53], v95 offset:49152
ds_read_b64_tr_b16 a[54:55], v95 offset:51200
ds_read_b64_tr_b16 a[56:57], v94 offset:57344
ds_read_b64_tr_b16 a[58:59], v94 offset:59392
ds_read_b64_tr_b16 a[60:61], v95 offset:57344
ds_read_b64_tr_b16 a[62:63], v95 offset:59392
s_waitcnt lgkmcnt(0)
s_barrier
s_lshl_b32 m0, s25, 14
s_mul_i32 s26, s30, 512
buffer_load_dwordx4 v92, s[12:15], s26 offen nt lds
s_add_u32 m0, m0, 1024
s_add_u32 s26, s26, s49
buffer_load_dwordx4 v93, s[12:15], s26 offen nt lds
s_add_u32 m0, m0, 1024
s_add_u32 s26, s26, s49
buffer_load_dwordx4 v92, s[12:15], s26 offen nt lds
s_add_u32 m0, m0, 1024
s_add_u32 s26, s26, s49
buffer_load_dwordx4 v93, s[12:15], s26 offen nt lds
s_add_u32 m0, m0, 1024
s_add_u32 s26, s26, s49
buffer_load_dwordx4 v92, s[12:15], s26 offen nt lds
s_add_u32 m0, m0, 1024
s_add_u32 s26, s26, s49
buffer_load_dwordx4 v93, s[12:15], s26 offen nt lds
s_add_u32 m0, m0, 1024
s_add_u32 s26, s26, s49
buffer_load_dwordx4 v92, s[12:15], s26 offen nt lds
s_add_u32 m0, m0, 1024
s_add_u32 s26, s26, s49
buffer_load_dwordx4 v93, s[12:15], s26 offen nt lds
s_add_u32 m0, m0, 1024
s_add_u32 s26, s26, s49
buffer_load_dwordx4 v92, s[12:15], s26 offen nt lds
s_add_u32 m0, m0, 1024
s_add_u32 s26, s26, s49
buffer_load_dwordx4 v93, s[12:15], s26 offen nt lds
s_add_u32 m0, m0, 1024
s_add_u32 s26, s26, s49
buffer_load_dwordx4 v92, s[12:15], s26 offen nt lds
s_add_u32 m0, m0, 1024
s_add_u32 s26, s26, s49
buffer_load_dwordx4 v93, s[12:15], s26 offen nt lds
s_add_u32 m0, m0, 1024
s_add_u32 s26, s26, s49
buffer_load_dwordx4 v92, s[12:15], s26 offen nt lds
s_add_u32 m0, m0, 1024
s_add_u32 s26, s26, s49
buffer_load_dwordx4 v93, s[12:15], s26 offen nt lds
s_add_u32 m0, m0, 1024
s_add_u32 s26, s26, s49
buffer_load_dwordx4 v92, s[12:15], s26 offen nt lds
s_add_u32 m0, m0, 1024
s_add_u32 s26, s26, s49
buffer_load_dwordx4 v93, s[12:15], s26 offen nt lds
s_waitcnt vmcnt(16)
s_barrier
ds_read_b64_tr_b16 a[64:65], v96 offset:0
ds_read_b64_tr_b16 a[66:67], v96 offset:2048
ds_read_b64_tr_b16 a[68:69], v97 offset:0
ds_read_b64_tr_b16 a[70:71], v97 offset:2048
ds_read_b64_tr_b16 a[72:73], v96 offset:8192
ds_read_b64_tr_b16 a[74:75], v96 offset:10240
ds_read_b64_tr_b16 a[76:77], v97 offset:8192
ds_read_b64_tr_b16 a[78:79], v97 offset:10240
ds_read_b64_tr_b16 a[80:81], v96 offset:16384
ds_read_b64_tr_b16 a[82:83], v96 offset:18432
ds_read_b64_tr_b16 a[84:85], v97 offset:16384
ds_read_b64_tr_b16 a[86:87], v97 offset:18432
ds_read_b64_tr_b16 a[88:89], v96 offset:24576
ds_read_b64_tr_b16 a[90:91], v96 offset:26624
ds_read_b64_tr_b16 a[92:93], v97 offset:24576
ds_read_b64_tr_b16 a[94:95], v97 offset:26624
ds_read_b64_tr_b16 a[96:97], v96 offset:32768
ds_read_b64_tr_b16 a[98:99], v96 offset:34816
ds_read_b64_tr_b16 a[100:101], v97 offset:32768
ds_read_b64_tr_b16 a[102:103], v97 offset:34816
ds_read_b64_tr_b16 a[104:105], v96 offset:40960
ds_read_b64_tr_b16 a[106:107], v96 offset:43008
ds_read_b64_tr_b16 a[108:109], v97 offset:40960
ds_read_b64_tr_b16 a[110:111], v97 offset:43008
ds_read_b64_tr_b16 a[112:113], v96 offset:49152
ds_read_b64_tr_b16 a[114:115], v96 offset:51200
ds_read_b64_tr_b16 a[116:117], v97 offset:49152
ds_read_b64_tr_b16 a[118:119], v97 offset:51200
ds_read_b64_tr_b16 a[120:121], v96 offset:57344
ds_read_b64_tr_b16 a[122:123], v96 offset:59392
ds_read_b64_tr_b16 a[124:125], v97 offset:57344
ds_read_b64_tr_b16 a[126:127], v97 offset:59392
s_waitcnt lgkmcnt(0)
s_barrier
s_lshl_b32 m0, s25, 13
s_add_u32 m0, m0, 0x10000
s_lshl_b32 s26, s25, 5
s_sub_u32 s26, 768, s26
s_mul_i32 s26, s26, s30
buffer_load_dwordx4 v92, s[12:15], s26 offen nt lds
s_add_u32 m0, m0, 1024
s_add_u32 s26, s26, s49
buffer_load_dwordx4 v93, s[12:15], s26 offen nt lds
s_add_u32 m0, m0, 1024
s_add_u32 s26, s26, s49
buffer_load_dwordx4 v92, s[12:15], s26 offen nt lds
s_add_u32 m0, m0, 1024
s_add_u32 s26, s26, s49
buffer_load_dwordx4 v93, s[12:15], s26 offen nt lds
s_add_u32 m0, m0, 1024
s_add_u32 s26, s26, s49
buffer_load_dwordx4 v92, s[12:15], s26 offen nt lds
s_add_u32 m0, m0, 1024
s_add_u32 s26, s26, s49
buffer_load_dwordx4 v93, s[12:15], s26 offen nt lds
s_add_u32 m0, m0, 1024
s_add_u32 s26, s26, s49
buffer_load_dwordx4 v92, s[12:15], s26 offen nt lds
s_add_u32 m0, m0, 1024
s_add_u32 s26, s26, s49
buffer_load_dwordx4 v93, s[12:15], s26 offen nt lds
s_waitcnt vmcnt(8)
s_barrier
buffer_load_dwordx2 v[210:211], v209, s[64:67], 0 offen offset:128
ds_read_b64_tr_b16 a[128:129], v94 offset:0
ds_read_b64_tr_b16 a[130:131], v94 offset:2048
ds_read_b64_tr_b16 a[132:133], v95 offset:0
ds_read_b64_tr_b16 a[134:135], v95 offset:2048
ds_read_b64_tr_b16 a[136:137], v94 offset:8192
ds_read_b64_tr_b16 a[138:139], v94 offset:10240
ds_read_b64_tr_b16 a[140:141], v95 offset:8192
ds_read_b64_tr_b16 a[142:143], v95 offset:10240
ds_read_b64_tr_b16 a[144:145], v94 offset:16384
ds_read_b64_tr_b16 a[146:147], v94 offset:18432
ds_read_b64_tr_b16 a[148:149], v95 offset:16384
ds_read_b64_tr_b16 a[150:151], v95 offset:18432
ds_read_b64_tr_b16 a[152:153], v94 offset:24576
ds_read_b64_tr_b16 a[154:155], v94 offset:26624
ds_read_b64_tr_b16 a[156:157], v95 offset:24576
ds_read_b64_tr_b16 a[158:159], v95 offset:26624
ds_read_b64_tr_b16 a[160:161], v94 offset:32768
ds_read_b64_tr_b16 a[162:163], v94 offset:34816
ds_read_b64_tr_b16 a[164:165], v95 offset:32768
ds_read_b64_tr_b16 a[166:167], v95 offset:34816
ds_read_b64_tr_b16 a[168:169], v94 offset:40960
ds_read_b64_tr_b16 a[170:171], v94 offset:43008
ds_read_b64_tr_b16 a[172:173], v95 offset:40960
ds_read_b64_tr_b16 a[174:175], v95 offset:43008
ds_read_b64_tr_b16 a[176:177], v94 offset:49152
ds_read_b64_tr_b16 a[178:179], v94 offset:51200
ds_read_b64_tr_b16 a[180:181], v95 offset:49152
ds_read_b64_tr_b16 a[182:183], v95 offset:51200
ds_read_b64_tr_b16 a[184:185], v94 offset:57344
ds_read_b64_tr_b16 a[186:187], v94 offset:59392
ds_read_b64_tr_b16 a[188:189], v95 offset:57344
ds_read_b64_tr_b16 a[190:191], v95 offset:59392
s_waitcnt lgkmcnt(0)
s_barrier
s_waitcnt vmcnt(0)
s_cmp_lg_u32 s25, 0
s_cbranch_scc1 main_kernel_f2_ysk
s_mov_b32 s56, 2
s_cmp_lg_u32 s3, 0
s_cbranch_scc1 main_kernel_f2_yok
main_kernel_f2_ylp:
v_cmp_eq_u32 vcc, -1, v210
s_mov_b32 s57, 0x2000
v_cmp_eq_u32 s[58:59], s57, v211
s_and_b32 s58, s58, vcc_lo
s_and_b32 s58, s58, 0xff
v_readlane_b32 s56, v210, 8
s_cmp_eq_u32 s58, 0xff
s_cbranch_scc1 main_kernel_f2_yfa
s_mov_b32 s57, 0
v_readlane_b32 s58, v211, 0
s_lshr_b32 s58, s58, 8
s_add_u32 s57, s57, s58
v_readlane_b32 s58, v211, 1
s_lshr_b32 s58, s58, 8
s_add_u32 s57, s57, s58
v_readlane_b32 s58, v211, 2
s_lshr_b32 s58, s58, 8
s_add_u32 s57, s57, s58
v_readlane_b32 s58, v211, 3
s_lshr_b32 s58, s58, 8
s_add_u32 s57, s57, s58
v_readlane_b32 s58, v211, 4
s_lshr_b32 s58, s58, 8
s_add_u32 s57, s57, s58
v_readlane_b32 s58, v211, 5
s_lshr_b32 s58, s58, 8
s_add_u32 s57, s57, s58
v_readlane_b32 s58, v211, 6
s_lshr_b32 s58, s58, 8
s_add_u32 s57, s57, s58
v_readlane_b32 s58, v211, 7
s_lshr_b32 s58, s58, 8
s_add_u32 s57, s57, s58
s_mov_b32 s56, 2
s_cmp_eq_u32 s57, 256
s_cbranch_scc1 main_kernel_f2_yok
main_kernel_f2_ylpr:
s_add_u32 s54, s54, 1
s_cmp_ge_u32 s54, 131072
s_cbranch_scc1 main_kernel_f2_yok
s_sleep 4
buffer_load_dwordx2 v[210:211], v209, s[64:67], 0 offen offset:128 sc1
s_waitcnt vmcnt(0)
s_branch main_kernel_f2_ylp
main_kernel_f2_yfa:
s_mov_b32 s56, 1
main_kernel_f2_yok:
v_mov_b32 v210, s56
v_mov_b32 v211, 131136
ds_write_b32 v211, v210
s_waitcnt lgkmcnt(0)
main_kernel_f2_ysk:
s_barrier
v_mov_b32 v211, 131136
ds_read_b32 v210, v211
ds_read_b64_tr_b16 a[192:193], v96 offset:0
ds_read_b64_tr_b16 a[194:195], v96 offset:2048
ds_read_b64_tr_b16 a[196:197], v97 offset:0
ds_read_b64_tr_b16 a[198:199], v97 offset:2048
ds_read_b64_tr_b16 a[200:201], v96 offset:8192
ds_read_b64_tr_b16 a[202:203], v96 offset:10240
ds_read_b64_tr_b16 a[204:205], v97 offset:8192
ds_read_b64_tr_b16 a[206:207], v97 offset:10240
ds_read_b64_tr_b16 a[208:209], v96 offset:16384
ds_read_b64_tr_b16 a[210:211], v96 offset:18432
ds_read_b64_tr_b16 a[212:213], v97 offset:16384
ds_read_b64_tr_b16 a[214:215], v97 offset:18432
ds_read_b64_tr_b16 a[216:217], v96 offset:24576
ds_read_b64_tr_b16 a[218:219], v96 offset:26624
ds_read_b64_tr_b16 a[220:221], v97 offset:24576
ds_read_b64_tr_b16 a[222:223], v97 offset:26624
s_waitcnt lgkmcnt(0)
s_barrier
v_readfirstlane_b32 s6, v210
s_and_b32 s56, s6, 3
s_sub_u32 s56, s56, s3
s_cmp_eq_u32 s56, 2
s_cbranch_scc1 main_kernel_again
s_mov_b32 s60, 0
v_lshlrev_b32 v148, 16, v124
v_and_b32 v149, 0xffff0000, v124
v_lshlrev_b32 v150, 16, v125
v_and_b32 v151, 0xffff0000, v125
s_lshl_b32 s74, s94, 21
s_lshl_b32 s75, s95, 8
s_add_u32 s74, s74, s75
s_add_u32 s12, s82, s74
s_addc_u32 s13, s83, 0
s_sub_u32 s14, 0x800000, s74
s_mov_b32 s15, 0x00020000
s_mov_b32 s68, 0
s_mov_b32 s75, 131072
v_lshrrev_b32 v2, 4, v1
v_lshlrev_b32 v3, 2, v2
v_and_b32 v4, 15, v1
v_xor_b32 v4, v4, v3
s_lshl_b32 s26, s25, 4
v_add_u32 v2, s26, v2
v_mul_u32_u24 v2, 2048, v2
v_lshl_add_u32 v200, v4, 4, v2
v_xor_b32 v2, 16, v200
v_add_u32 v201, 7168, v2
v_add_u32 v202, 14336, v200
v_add_u32 v203, 21504, v2
s_cmp_lg_u32 s3, 0
s_cbranch_scc1 main_kernel_fs
main_kernel_fj0_wa:
buffer_load_dword v111, v109, s[8:11], 0 offen sc1
s_waitcnt vmcnt(0)
v_cmp_gt_u32 vcc, 2, v111
s_and_b64 vcc, vcc, s[50:51]
s_cbranch_scc0 main_kernel_fj0_wa_ok
s_add_u32 s54, s54, 1
s_cmp_ge_u32 s54, 131072
s_cbranch_scc1 main_kernel_fj0_wa_ok
s_sleep 1
s_branch main_kernel_fj0_wa
main_kernel_fj0_wa_ok:
s_mov_b32 s39, -4
s_barrier
s_mov_b32 s26, 0
s_mov_b32 s41, 0x40000000
s_mov_b32 s42, 0x40000000
s_mov_b32 s55, 0x40000000
s_mov_b32 s46, 0x40000000
s_mov_b32 s47, 0x40000000
s_mov_b32 s56, 0x40000000
s_mov_b32 s57, 0
s_mov_b32 s58, 0
s_mov_b32 s59, 0
s_mov_b32 s64, 0
s_mov_b32 s65, 0
s_mov_b32 s66, 0xfffe0000
v_mov_b32 v132, 0
v_mov_b32 v133, 0
v_mov_b32 v134, 0
v_mov_b32 v135, 0
v_mov_b32 v136, 0
v_mov_b32 v137, 0
v_mov_b32 v138, 0
v_mov_b32 v139, 0
s_mov_b32 s20, s52
s_mov_b32 s36, 0
s_lshr_b32 s24, s37, 1
s_sub_u32 s24, s24, 2
s_mov_b32 m0, s22
s_nop 0
buffer_load_dwordx4 v8, s[8:11], s20 offen sc1 lds
buffer_load_dword v2, v11, s[8:11], 0 offen
buffer_load_dword v2, v11, s[8:11], 0 offen
s_add_u32 s36, s36, 1
buffer_load_dwordx4 v8, s[8:11], s20 offen offset:1024 sc1 lds
buffer_load_dwordx4 v8, s[8:11], s20 offen offset:2048 sc1 lds
buffer_load_dwordx4 v8, s[8:11], s20 offen offset:3072 sc1 lds
s_add_u32 s20, s20, s23
s_add_u32 m0, s22, 16384
buffer_load_dword v2, v11, s[8:11], 0 offen
buffer_load_dwordx4 v8, s[8:11], s20 offen sc1 lds
buffer_load_dwordx4 v8, s[8:11], s20 offen offset:1024 sc1 lds
buffer_load_dwordx4 v8, s[8:11], s20 offen offset:2048 sc1 lds
buffer_load_dword v2, v11, s[8:11], 0 offen
buffer_load_dword v2, v11, s[8:11], 0 offen
buffer_load_dword v2, v11, s[8:11], 0 offen
buffer_load_dwordx4 v8, s[8:11], s20 offen offset:3072 sc1 lds
s_add_u32 s20, s20, s23
s_add_u32 m0, s22, 32768
s_nop 0
buffer_load_dwordx4 v8, s[8:11], s20 offen sc1 lds
buffer_load_dword v2, v11, s[8:11], 0 offen
buffer_load_dword v2, v11, s[8:11], 0 offen
buffer_load_dword v2, v11, s[8:11], 0 offen
buffer_load_dwordx4 v8, s[8:11], s20 offen offset:1024 sc1 lds
buffer_load_dwordx4 v8, s[8:11], s20 offen offset:2048 sc1 lds
buffer_load_dwordx4 v8, s[8:11], s20 offen offset:3072 sc1 lds
s_add_u32 s20, s20, s23
s_add_u32 m0, s22, 49152
s_nop 0
buffer_load_dwordx4 v8, s[8:11], s20 offen sc1 lds
buffer_load_dwordx4 v8, s[8:11], s20 offen offset:1024 sc1 lds
buffer_load_dwordx4 v8, s[8:11], s20 offen offset:2048 sc1 lds
buffer_load_dwordx4 v8, s[8:11], s20 offen offset:3072 sc1 lds
s_add_u32 s20, s20, s28
s_add_u32 m0, s22, 65536
s_cmp_lt_u32 s36, s37
s_cselect_b32 s20, s20, 0x40000000
buffer_load_dwordx4 v8, s[8:11], s20 offen sc1 lds
buffer_load_dword v2, v11, s[8:11], 0 offen
buffer_load_dword v2, v11, s[8:11], 0 offen
s_add_u32 s36, s36, 1
buffer_load_dwordx4 v8, s[8:11], s20 offen offset:1024 sc1 lds
buffer_load_dwordx4 v8, s[8:11], s20 offen offset:2048 sc1 lds
buffer_load_dwordx4 v8, s[8:11], s20 offen offset:3072 sc1 lds
s_add_u32 s20, s20, s23
s_add_u32 m0, s22, 81920
buffer_load_dword v2, v11, s[8:11], 0 offen
buffer_load_dwordx4 v8, s[8:11], s20 offen sc1 lds
buffer_load_dwordx4 v8, s[8:11], s20 offen offset:1024 sc1 lds
s_waitcnt vmcnt(28)
s_barrier
ds_read_b128 v[12:15], v6 offset:0
ds_read_b128 v[16:19], v6 offset:256
ds_read_b128 v[20:23], v6 offset:2048
ds_read_b128 v[24:27], v6 offset:2304
ds_read_b128 v[28:31], v6 offset:4096
ds_read_b128 v[32:35], v6 offset:4352
s_waitcnt lgkmcnt(0)
.p2align 3
main_kernel_fj0_lp:
v_mfma_f32_16x16x32_bf16 v[44:47], a[0:3], v[12:15], 0
ds_read_b128 v[36:39], v6 offset:6144
v_mfma_f32_16x16x32_bf16 v[52:55], a[0:3], v[16:19], 0
ds_read_b128 v[40:43], v6 offset:6400
v_cvt_pk_bf16_f32 v84, v60, v61
v_mfma_f32_16x16x32_bf16 v[56:59], a[4:7], v[16:19], 0
v_add_u32 v63, s64, v63
v_mfma_f32_16x16x32_bf16 v[48:51], a[4:7], v[12:15], 0
s_waitcnt lgkmcnt(4)
v_cvt_pk_bf16_f32 v85, v62, s65
v_mfma_f32_16x16x32_bf16 v[44:47], a[8:11], v[20:23], v[44:47]
ds_read_b128 v[12:15], v6 offset:8192
v_bfi_b32 v85, s66, v63, v85
v_mfma_f32_16x16x32_bf16 v[52:55], a[8:11], v[24:27], v[52:55]
ds_read_b128 v[16:19], v6 offset:8448
v_cvt_pk_bf16_f32 v86, v64, v65
v_mfma_f32_16x16x32_bf16 v[56:59], a[12:15], v[24:27], v[56:59]
buffer_load_dwordx4 v8, s[8:11], s20 offen offset:2048 sc1 lds
v_add_u32 v67, s64, v67
v_mfma_f32_16x16x32_bf16 v[48:51], a[12:15], v[20:23], v[48:51]
s_waitcnt lgkmcnt(4)
v_cvt_pk_bf16_f32 v87, v66, s65
v_mfma_f32_16x16x32_bf16 v[44:47], a[16:19], v[28:31], v[44:47]
buffer_load_dwordx2 v[124:125], v118, s[8:11], s42 offen offset:0 sc1
ds_read_b128 v[20:23], v6 offset:10240
v_mfma_f32_16x16x32_bf16 v[52:55], a[16:19], v[32:35], v[52:55]
ds_read_b128 v[24:27], v6 offset:10496
v_bfi_b32 v87, s66, v67, v87
v_mfma_f32_16x16x32_bf16 v[56:59], a[20:23], v[32:35], v[56:59]
buffer_store_dwordx4 v[84:87], v116, s[8:11], s41 offen
v_cvt_pk_bf16_f32 v88, v68, v69
v_mfma_f32_16x16x32_bf16 v[48:51], a[20:23], v[28:31], v[48:51]
s_waitcnt lgkmcnt(4)
v_add_u32 v71, s64, v71
v_mfma_f32_16x16x32_bf16 v[44:47], a[24:27], v[36:39], v[44:47]
buffer_load_dwordx2 v[126:127], v118, s[8:11], s42 offen offset:2048 sc1
ds_read_b128 v[28:31], v6 offset:12288
v_mfma_f32_16x16x32_bf16 v[52:55], a[24:27], v[40:43], v[52:55]
ds_read_b128 v[32:35], v6 offset:12544
v_cvt_pk_bf16_f32 v89, v70, s65
v_mfma_f32_16x16x32_bf16 v[56:59], a[28:31], v[40:43], v[56:59]
buffer_load_dwordx4 v8, s[8:11], s20 offen offset:3072 sc1 lds
v_bfi_b32 v89, s66, v71, v89
v_mfma_f32_16x16x32_bf16 v[48:51], a[28:31], v[36:39], v[48:51]
s_waitcnt lgkmcnt(4)
s_add_u32 s20, s20, s23
s_add_u32 m0, s22, 98304
v_mfma_f32_16x16x32_bf16 v[44:47], a[32:35], v[12:15], v[44:47]
s_waitcnt vmcnt(18)
s_barrier
ds_read_b128 v[36:39], v6 offset:16384
v_mfma_f32_16x16x32_bf16 v[52:55], a[32:35], v[16:19], v[52:55]
s_waitcnt vmcnt(21)
ds_read_b128 v[40:43], v6 offset:16640
v_cvt_pk_bf16_f32 v90, v72, v73
v_mfma_f32_16x16x32_bf16 v[56:59], a[36:39], v[16:19], v[56:59]
buffer_load_dwordx4 v8, s[8:11], s20 offen sc1 lds
v_add_u32 v75, s64, v75
v_mfma_f32_16x16x32_bf16 v[48:51], a[36:39], v[12:15], v[48:51]
s_waitcnt lgkmcnt(4)
v_cvt_pk_bf16_f32 v91, v74, s65
v_mfma_f32_16x16x32_bf16 v[44:47], a[40:43], v[20:23], v[44:47]
buffer_load_dwordx2 v[128:129], v119, s[8:11], s42 offen offset:0 sc1
ds_read_b128 v[12:15], v6 offset:18432
v_mfma_f32_16x16x32_bf16 v[52:55], a[40:43], v[24:27], v[52:55]
ds_read_b128 v[16:19], v6 offset:18688
v_bfi_b32 v91, s66, v75, v91
v_mfma_f32_16x16x32_bf16 v[56:59], a[44:47], v[24:27], v[56:59]
buffer_store_dwordx4 v[88:91], v117, s[8:11], s41 offen
v_bitop3_b32 v162, v133, v135, s59 bitop3:0x7e
v_mfma_f32_16x16x32_bf16 v[48:51], a[44:47], v[20:23], v[48:51]
s_waitcnt lgkmcnt(4)
v_bitop3_b32 v163, v137, v139, s59 bitop3:0x7e
v_mfma_f32_16x16x32_bf16 v[44:47], a[48:51], v[28:31], v[44:47]
buffer_load_dwordx2 v[130:131], v119, s[8:11], s42 offen offset:2048 sc1
ds_read_b128 v[20:23], v6 offset:20480
v_mfma_f32_16x16x32_bf16 v[52:55], a[48:51], v[32:35], v[52:55]
ds_read_b128 v[24:27], v6 offset:20736
v_or_b32 v162, v162, v163
v_mfma_f32_16x16x32_bf16 v[56:59], a[52:55], v[32:35], v[56:59]
buffer_load_dwordx4 v8, s[8:11], s20 offen offset:1024 sc1 lds
v_and_b32 v162, 0x10000, v162
v_mfma_f32_16x16x32_bf16 v[48:51], a[52:55], v[28:31], v[48:51]
s_waitcnt lgkmcnt(4)
v_cmp_ne_u32 vcc, 0, v162
v_mfma_f32_16x16x32_bf16 v[44:47], a[56:59], v[36:39], v[44:47]
ds_read_b128 v[28:31], v6 offset:22528
v_mfma_f32_16x16x32_bf16 v[52:55], a[56:59], v[40:43], v[52:55]
ds_read_b128 v[32:35], v6 offset:22784
v_mfma_f32_16x16x32_bf16 v[56:59], a[60:63], v[40:43], v[56:59]
s_cbranch_vccnz main_kernel_fj0_c0
main_kernel_fj0_k0:
v_mfma_f32_16x16x32_bf16 v[48:51], a[60:63], v[36:39], v[48:51]
s_waitcnt lgkmcnt(4)
v_lshlrev_b32 v144, 16, v132
v_mfma_f32_16x16x32_bf16 v[44:47], a[64:67], v[12:15], v[44:47]
ds_read_b128 v[36:39], v6 offset:24576
v_and_b32 v145, 0xffff0000, v132
v_mfma_f32_16x16x32_bf16 v[52:55], a[64:67], v[16:19], v[52:55]
ds_read_b128 v[40:43], v6 offset:24832
v_lshlrev_b32 v146, 16, v133
v_mfma_f32_16x16x32_bf16 v[56:59], a[68:71], v[16:19], v[56:59]
buffer_load_dwordx4 v8, s[8:11], s20 offen offset:2048 sc1 lds
v_and_b32 v147, 0xffff0000, v133
v_mfma_f32_16x16x32_bf16 v[48:51], a[68:71], v[12:15], v[48:51]
s_waitcnt lgkmcnt(4)
v_add_f32 v140, v148, v144
v_mfma_f32_16x16x32_bf16 v[44:47], a[72:75], v[20:23], v[44:47]
ds_read_b128 v[12:15], v6 offset:26624
v_add_f32 v141, v149, v145
v_mfma_f32_16x16x32_bf16 v[52:55], a[72:75], v[24:27], v[52:55]
ds_read_b128 v[16:19], v6 offset:26880
v_add_f32 v142, v150, v146
v_mfma_f32_16x16x32_bf16 v[56:59], a[76:79], v[24:27], v[56:59]
v_add_f32 v143, v151, v147
v_mfma_f32_16x16x32_bf16 v[48:51], a[76:79], v[20:23], v[48:51]
s_waitcnt lgkmcnt(4)
v_lshlrev_b32 v144, 16, v134
v_mfma_f32_16x16x32_bf16 v[44:47], a[80:83], v[28:31], v[44:47]
ds_read_b128 v[20:23], v6 offset:28672
v_and_b32 v145, 0xffff0000, v134
v_mfma_f32_16x16x32_bf16 v[52:55], a[80:83], v[32:35], v[52:55]
ds_read_b128 v[24:27], v6 offset:28928
v_lshlrev_b32 v146, 16, v135
v_mfma_f32_16x16x32_bf16 v[56:59], a[84:87], v[32:35], v[56:59]
buffer_load_dwordx4 v8, s[8:11], s20 offen offset:3072 sc1 lds
v_and_b32 v147, 0xffff0000, v135
v_mfma_f32_16x16x32_bf16 v[48:51], a[84:87], v[28:31], v[48:51]
s_waitcnt lgkmcnt(4)
s_add_u32 s20, s20, s23
s_add_u32 m0, s22, 114688
v_mfma_f32_16x16x32_bf16 v[44:47], a[88:91], v[36:39], v[44:47]
ds_read_b128 v[28:31], v6 offset:32768
v_add_f32 v140, v140, v144
v_mfma_f32_16x16x32_bf16 v[52:55], a[88:91], v[40:43], v[52:55]
ds_read_b128 v[32:35], v6 offset:33024
v_add_f32 v141, v141, v145
v_mfma_f32_16x16x32_bf16 v[56:59], a[92:95], v[40:43], v[56:59]
buffer_load_dwordx4 v8, s[8:11], s20 offen sc1 lds
v_add_f32 v142, v142, v146
v_mfma_f32_16x16x32_bf16 v[48:51], a[92:95], v[36:39], v[48:51]
s_waitcnt lgkmcnt(4)
v_add_f32 v143, v143, v147
s_add_u32 s38, s36, 1
v_mfma_f32_16x16x32_bf16 v[44:47], a[96:99], v[12:15], v[44:47]
s_min_u32 s38, s38, s37
ds_read_b128 v[36:39], v6 offset:34816
v_lshlrev_b32 v144, 16, v136
v_mfma_f32_16x16x32_bf16 v[52:55], a[96:99], v[16:19], v[52:55]
ds_read_b128 v[40:43], v6 offset:35072
v_and_b32 v145, 0xffff0000, v136
v_mfma_f32_16x16x32_bf16 v[56:59], a[100:103], v[16:19], v[56:59]
v_lshlrev_b32 v146, 16, v137
v_mfma_f32_16x16x32_bf16 v[48:51], a[100:103], v[12:15], v[48:51]
s_waitcnt lgkmcnt(4)
v_and_b32 v147, 0xffff0000, v137
v_mfma_f32_16x16x32_bf16 v[44:47], a[104:107], v[20:23], v[44:47]
ds_read_b128 v[12:15], v6 offset:36864
v_add_f32 v140, v140, v144
v_mfma_f32_16x16x32_bf16 v[52:55], a[104:107], v[24:27], v[52:55]
ds_read_b128 v[16:19], v6 offset:37120
v_add_f32 v141, v141, v145
v_mfma_f32_16x16x32_bf16 v[56:59], a[108:111], v[24:27], v[56:59]
buffer_load_dwordx4 v8, s[8:11], s20 offen offset:1024 sc1 lds
v_add_f32 v142, v142, v146
v_mfma_f32_16x16x32_bf16 v[48:51], a[108:111], v[20:23], v[48:51]
s_waitcnt lgkmcnt(4)
v_add_f32 v143, v143, v147
v_mfma_f32_16x16x32_bf16 v[44:47], a[112:115], v[28:31], v[44:47]
ds_read_b128 v[20:23], v6 offset:38912
v_lshlrev_b32 v144, 16, v138
v_mfma_f32_16x16x32_bf16 v[52:55], a[112:115], v[32:35], v[52:55]
ds_read_b128 v[24:27], v6 offset:39168
v_and_b32 v145, 0xffff0000, v138
v_mfma_f32_16x16x32_bf16 v[56:59], a[116:119], v[32:35], v[56:59]
s_waitcnt vmcnt(21)
v_cmp_gt_u32 s[62:63], s38, v111
v_mfma_f32_16x16x32_bf16 v[48:51], a[116:119], v[28:31], v[48:51]
s_waitcnt lgkmcnt(4)
v_lshlrev_b32 v146, 16, v139
v_mfma_f32_16x16x32_bf16 v[44:47], a[120:123], v[36:39], v[44:47]
s_and_b64 s[62:63], s[62:63], s[50:51]
ds_read_b128 v[28:31], v6 offset:40960
v_and_b32 v147, 0xffff0000, v139
v_mfma_f32_16x16x32_bf16 v[52:55], a[120:123], v[40:43], v[52:55]
s_mov_b32 s55, s42
ds_read_b128 v[32:35], v6 offset:41216
v_add_f32 v140, v140, v144
v_mfma_f32_16x16x32_bf16 v[56:59], a[124:127], v[40:43], v[56:59]
buffer_load_dwordx4 v8, s[8:11], s20 offen offset:2048 sc1 lds
v_add_f32 v141, v141, v145
v_mfma_f32_16x16x32_bf16 v[48:51], a[124:127], v[36:39], v[48:51]
s_waitcnt lgkmcnt(4)
v_add_f32 v142, v142, v146
s_mov_b32 s42, s41
v_mfma_f32_16x16x32_bf16 v[44:47], a[128:131], v[12:15], v[44:47]
s_mov_b32 s41, s43
ds_read_b128 v[36:39], v6 offset:43008
v_add_f32 v143, v143, v147
v_mfma_f32_16x16x32_bf16 v[52:55], a[128:131], v[16:19], v[52:55]
s_mov_b32 s59, s58
ds_read_b128 v[40:43], v6 offset:43264
v_mul_f32 v144, s40, v140
v_mfma_f32_16x16x32_bf16 v[56:59], a[132:135], v[16:19], v[56:59]
s_cbranch_scc1 main_kernel_fj0_a0
main_kernel_fj0_b0:
s_mov_b32 s58, s57
v_mfma_f32_16x16x32_bf16 v[48:51], a[132:135], v[12:15], v[48:51]
s_waitcnt lgkmcnt(4)
v_exp_f32 v144, v144
v_mfma_f32_16x16x32_bf16 v[44:47], a[136:139], v[20:23], v[44:47]
s_mov_b32 s57, s60
ds_read_b128 v[12:15], v6 offset:45056
v_mul_f32 v145, s40, v141
v_mfma_f32_16x16x32_bf16 v[52:55], a[136:139], v[24:27], v[52:55]
s_add_u32 s43, s43, 32768
ds_read_b128 v[16:19], v6 offset:45312
v_mul_f32 v146, s40, v142
v_mfma_f32_16x16x32_bf16 v[56:59], a[140:143], v[24:27], v[56:59]
buffer_load_dwordx4 v8, s[8:11], s20 offen offset:3072 sc1 lds
v_mul_f32 v147, s40, v143
v_mfma_f32_16x16x32_bf16 v[48:51], a[140:143], v[20:23], v[48:51]
s_waitcnt lgkmcnt(4)
s_add_u32 s20, s20, s28
s_add_u32 m0, s22, 0
v_mfma_f32_16x16x32_bf16 v[44:47], a[144:147], v[28:31], v[44:47]
s_waitcnt vmcnt(19)
s_barrier
ds_read_b128 v[20:23], v6 offset:49152
v_mfma_f32_16x16x32_bf16 v[52:55], a[144:147], v[32:35], v[52:55]
s_cmp_lt_u32 s36, s37
ds_read_b128 v[24:27], v6 offset:49408
s_cselect_b32 s20, s20, 0x40000000
v_mfma_f32_16x16x32_bf16 v[56:59], a[148:151], v[32:35], v[56:59]
buffer_load_dwordx4 v8, s[8:11], s20 offen sc1 lds
v_add_f32 v144, 1.0, v144
v_mfma_f32_16x16x32_bf16 v[48:51], a[148:151], v[28:31], v[48:51]
s_waitcnt lgkmcnt(4)
v_exp_f32 v145, v145
v_mfma_f32_16x16x32_bf16 v[44:47], a[152:155], v[36:39], v[44:47]
buffer_load_dword v111, v109, s[8:11], 0 offen sc1
ds_read_b128 v[28:31], v6 offset:51200
v_mfma_f32_16x16x32_bf16 v[52:55], a[152:155], v[40:43], v[52:55]
s_waitcnt vmcnt(45)
ds_read_b128 v[32:35], v6 offset:51456
v_add_f32 v145, 1.0, v145
v_mfma_f32_16x16x32_bf16 v[56:59], a[156:159], v[40:43], v[56:59]
s_ashr_i32 s26, s39, 1
s_max_i32 s26, s26, 0
v_mov_b32 v112, s26
v_mfma_f32_16x16x32_bf16 v[48:51], a[156:159], v[36:39], v[48:51]
s_waitcnt lgkmcnt(4)
v_exp_f32 v146, v146
v_mfma_f32_16x16x32_bf16 v[44:47], a[160:163], v[12:15], v[44:47]
buffer_store_dword v112, v108, s[8:11], 0 offen sc1
ds_read_b128 v[36:39], v6 offset:53248
v_mfma_f32_16x16x32_bf16 v[52:55], a[160:163], v[16:19], v[52:55]
s_add_u32 s36, s36, 1
ds_read_b128 v[40:43], v6 offset:53504
v_add_f32 v146, 1.0, v146
v_mfma_f32_16x16x32_bf16 v[56:59], a[164:167], v[16:19], v[56:59]
buffer_load_dwordx4 v8, s[8:11], s20 offen offset:1024 sc1 lds
s_sub_u32 s27, s43, s44
v_mfma_f32_16x16x32_bf16 v[48:51], a[164:167], v[12:15], v[48:51]
s_waitcnt lgkmcnt(4)
v_exp_f32 v147, v147
v_mfma_f32_16x16x32_bf16 v[44:47], a[168:171], v[20:23], v[44:47]
s_cmp_eq_u32 s27, 229376
ds_read_b128 v[12:15], v6 offset:55296
v_add_f32 v147, 1.0, v147
v_mfma_f32_16x16x32_bf16 v[52:55], a[168:171], v[24:27], v[52:55]
s_cselect_b32 s43, s44, s43
ds_read_b128 v[16:19], v6 offset:55552
s_cselect_b32 s27, 0x10000, 0
v_mfma_f32_16x16x32_bf16 v[56:59], a[172:175], v[24:27], v[56:59]
s_xor_b32 s60, s60, s27
v_rcp_f32 v144, v144
v_mfma_f32_16x16x32_bf16 v[48:51], a[172:175], v[20:23], v[48:51]
s_waitcnt lgkmcnt(4)
v_rcp_f32 v145, v145
v_mfma_f32_16x16x32_bf16 v[44:47], a[176:179], v[28:31], v[44:47]
s_sub_u32 s64, 0x10000, s57
ds_read_b128 v[20:23], v6 offset:57344
v_mul_f32 v140, v140, v144
v_mfma_f32_16x16x32_bf16 v[52:55], a[176:179], v[32:35], v[52:55]
s_add_u32 s65, s57, 0x3f800000
ds_read_b128 v[24:27], v6 offset:57600
v_mul_f32 v141, v141, v145
v_mfma_f32_16x16x32_bf16 v[56:59], a[180:183], v[32:35], v[56:59]
buffer_load_dwordx4 v8, s[8:11], s20 offen offset:2048 sc1 lds
v_cvt_pk_bf16_f32 v160, v140, v141
v_mfma_f32_16x16x32_bf16 v[48:51], a[180:183], v[28:31], v[48:51]
s_waitcnt lgkmcnt(4)
v_rcp_f32 v146, v146
v_mfma_f32_16x16x32_bf16 v[44:47], a[184:187], v[36:39], v[44:47]
ds_read_b128 v[28:31], v6 offset:59392
v_mul_f32 v142, v142, v146
v_mfma_f32_16x16x32_bf16 v[52:55], a[184:187], v[40:43], v[52:55]
ds_read_b128 v[32:35], v6 offset:59648
v_mfma_f32_16x16x32_bf16 v[56:59], a[188:191], v[40:43], v[56:59]
v_rcp_f32 v147, v147
v_mfma_f32_16x16x32_bf16 v[48:51], a[188:191], v[36:39], v[48:51]
s_waitcnt lgkmcnt(4)
v_mul_f32 v143, v143, v147
v_mfma_f32_16x16x32_bf16 v[44:47], a[192:195], v[12:15], v[44:47]
ds_read_b128 v[36:39], v6 offset:61440
v_cvt_pk_bf16_f32 v161, v142, v143
v_mfma_f32_16x16x32_bf16 v[52:55], a[192:195], v[16:19], v[52:55]
ds_read_b128 v[40:43], v6 offset:61696
v_mfma_f32_16x16x32_bf16 v[56:59], a[196:199], v[16:19], v[56:59]
buffer_load_dwordx4 v8, s[8:11], s20 offen offset:3072 sc1 lds
v_mfma_f32_16x16x32_bf16 v[48:51], a[196:199], v[12:15], v[48:51]
s_waitcnt lgkmcnt(4)
s_add_u32 s20, s20, s23
s_add_u32 m0, s22, 16384
v_mfma_f32_16x16x32_bf16 v[44:47], a[200:203], v[20:23], v[44:47]
buffer_store_dwordx2 v[160:161], v121, s[8:11], s56 offen sc1
ds_read_b128 v[12:15], v7 offset:0
v_mfma_f32_16x16x32_bf16 v[52:55], a[200:203], v[24:27], v[52:55]
s_mov_b32 s56, s47
ds_read_b128 v[16:19], v7 offset:256
s_mov_b32 s47, s46
v_mfma_f32_16x16x32_bf16 v[56:59], a[204:207], v[24:27], v[56:59]
s_mov_b32 s46, s45
buffer_load_dwordx4 v8, s[8:11], s20 offen sc1 lds
v_mfma_f32_16x16x32_bf16 v[48:51], a[204:207], v[20:23], v[48:51]
s_waitcnt lgkmcnt(4)
s_add_u32 s45, s45, 65536
s_add_u32 s39, s39, 1
v_mfma_f32_16x16x32_bf16 v[44:47], a[208:211], v[28:31], v[44:47]
ds_read_b128 v[20:23], v7 offset:2048
v_mfma_f32_16x16x32_bf16 v[52:55], a[208:211], v[32:35], v[52:55]
ds_read_b128 v[24:27], v7 offset:2304
v_mfma_f32_16x16x32_bf16 v[56:59], a[212:215], v[32:35], v[56:59]
v_mfma_f32_16x16x32_bf16 v[48:51], a[212:215], v[28:31], v[48:51]
s_waitcnt lgkmcnt(4)
v_mfma_f32_16x16x32_bf16 v[44:47], a[216:219], v[36:39], v[44:47]
ds_read_b128 v[28:31], v7 offset:4096
v_mfma_f32_16x16x32_bf16 v[52:55], a[216:219], v[40:43], v[52:55]
ds_read_b128 v[32:35], v7 offset:4352
v_mfma_f32_16x16x32_bf16 v[56:59], a[220:223], v[40:43], v[56:59]
buffer_load_dwordx4 v8, s[8:11], s20 offen offset:1024 sc1 lds
v_mfma_f32_16x16x32_bf16 v[48:51], a[220:223], v[36:39], v[48:51]
s_waitcnt lgkmcnt(4)
v_mfma_f32_16x16x32_bf16 v[60:63], a[0:3], v[12:15], 0
ds_read_b128 v[36:39], v7 offset:6144
v_mfma_f32_16x16x32_bf16 v[68:71], a[0:3], v[16:19], 0
ds_read_b128 v[40:43], v7 offset:6400
v_cvt_pk_bf16_f32 v84, v44, v45
v_mfma_f32_16x16x32_bf16 v[72:75], a[4:7], v[16:19], 0
v_add_u32 v47, s64, v47
v_mfma_f32_16x16x32_bf16 v[64:67], a[4:7], v[12:15], 0
s_waitcnt lgkmcnt(4)
v_cvt_pk_bf16_f32 v85, v46, s65
v_mfma_f32_16x16x32_bf16 v[60:63], a[8:11], v[20:23], v[60:63]
ds_read_b128 v[12:15], v7 offset:8192
v_bfi_b32 v85, s66, v47, v85
v_mfma_f32_16x16x32_bf16 v[68:71], a[8:11], v[24:27], v[68:71]
ds_read_b128 v[16:19], v7 offset:8448
v_cvt_pk_bf16_f32 v86, v48, v49
v_mfma_f32_16x16x32_bf16 v[72:75], a[12:15], v[24:27], v[72:75]
buffer_load_dwordx4 v8, s[8:11], s20 offen offset:2048 sc1 lds
v_add_u32 v51, s64, v51
v_mfma_f32_16x16x32_bf16 v[64:67], a[12:15], v[20:23], v[64:67]
s_waitcnt lgkmcnt(4)
v_cvt_pk_bf16_f32 v87, v50, s65
v_mfma_f32_16x16x32_bf16 v[60:63], a[16:19], v[28:31], v[60:63]
buffer_load_dwordx2 v[132:133], v118, s[8:11], s42 offen offset:0 sc1
ds_read_b128 v[20:23], v7 offset:10240
v_mfma_f32_16x16x32_bf16 v[68:71], a[16:19], v[32:35], v[68:71]
ds_read_b128 v[24:27], v7 offset:10496
v_bfi_b32 v87, s66, v51, v87
v_mfma_f32_16x16x32_bf16 v[72:75], a[20:23], v[32:35], v[72:75]
buffer_store_dwordx4 v[84:87], v116, s[8:11], s41 offen
v_cvt_pk_bf16_f32 v88, v52, v53
v_mfma_f32_16x16x32_bf16 v[64:67], a[20:23], v[28:31], v[64:67]
s_waitcnt lgkmcnt(4)
v_add_u32 v55, s64, v55
v_mfma_f32_16x16x32_bf16 v[60:63], a[24:27], v[36:39], v[60:63]
buffer_load_dwordx2 v[134:135], v118, s[8:11], s42 offen offset:2048 sc1
ds_read_b128 v[28:31], v7 offset:12288
v_mfma_f32_16x16x32_bf16 v[68:71], a[24:27], v[40:43], v[68:71]
ds_read_b128 v[32:35], v7 offset:12544
v_cvt_pk_bf16_f32 v89, v54, s65
v_mfma_f32_16x16x32_bf16 v[72:75], a[28:31], v[40:43], v[72:75]
buffer_load_dwordx4 v8, s[8:11], s20 offen offset:3072 sc1 lds
v_bfi_b32 v89, s66, v55, v89
v_mfma_f32_16x16x32_bf16 v[64:67], a[28:31], v[36:39], v[64:67]
s_waitcnt lgkmcnt(4)
s_add_u32 s20, s20, s23
s_add_u32 m0, s22, 32768
v_mfma_f32_16x16x32_bf16 v[60:63], a[32:35], v[12:15], v[60:63]
s_waitcnt vmcnt(18)
s_barrier
ds_read_b128 v[36:39], v7 offset:16384
v_mfma_f32_16x16x32_bf16 v[68:71], a[32:35], v[16:19], v[68:71]
s_waitcnt vmcnt(21)
ds_read_b128 v[40:43], v7 offset:16640
v_cvt_pk_bf16_f32 v90, v56, v57
v_mfma_f32_16x16x32_bf16 v[72:75], a[36:39], v[16:19], v[72:75]
buffer_load_dwordx4 v8, s[8:11], s20 offen sc1 lds
v_add_u32 v59, s64, v59
v_mfma_f32_16x16x32_bf16 v[64:67], a[36:39], v[12:15], v[64:67]
s_waitcnt lgkmcnt(4)
v_cvt_pk_bf16_f32 v91, v58, s65
v_mfma_f32_16x16x32_bf16 v[60:63], a[40:43], v[20:23], v[60:63]
buffer_load_dwordx2 v[136:137], v119, s[8:11], s42 offen offset:0 sc1
ds_read_b128 v[12:15], v7 offset:18432
v_mfma_f32_16x16x32_bf16 v[68:71], a[40:43], v[24:27], v[68:71]
ds_read_b128 v[16:19], v7 offset:18688
v_bfi_b32 v91, s66, v59, v91
v_mfma_f32_16x16x32_bf16 v[72:75], a[44:47], v[24:27], v[72:75]
buffer_store_dwordx4 v[88:91], v117, s[8:11], s41 offen
v_bitop3_b32 v162, v125, v127, s59 bitop3:0x7e
v_mfma_f32_16x16x32_bf16 v[64:67], a[44:47], v[20:23], v[64:67]
s_waitcnt lgkmcnt(4)
v_bitop3_b32 v163, v129, v131, s59 bitop3:0x7e
v_mfma_f32_16x16x32_bf16 v[60:63], a[48:51], v[28:31], v[60:63]
buffer_load_dwordx2 v[138:139], v119, s[8:11], s42 offen offset:2048 sc1
ds_read_b128 v[20:23], v7 offset:20480
v_mfma_f32_16x16x32_bf16 v[68:71], a[48:51], v[32:35], v[68:71]
ds_read_b128 v[24:27], v7 offset:20736
v_or_b32 v162, v162, v163
v_mfma_f32_16x16x32_bf16 v[72:75], a[52:55], v[32:35], v[72:75]
buffer_load_dwordx4 v8, s[8:11], s20 offen offset:1024 sc1 lds
v_and_b32 v162, 0x10000, v162
v_mfma_f32_16x16x32_bf16 v[64:67], a[52:55], v[28:31], v[64:67]
s_waitcnt lgkmcnt(4)
v_cmp_ne_u32 vcc, 0, v162
v_mfma_f32_16x16x32_bf16 v[60:63], a[56:59], v[36:39], v[60:63]
ds_read_b128 v[28:31], v7 offset:22528
v_mfma_f32_16x16x32_bf16 v[68:71], a[56:59], v[40:43], v[68:71]
ds_read_b128 v[32:35], v7 offset:22784
v_mfma_f32_16x16x32_bf16 v[72:75], a[60:63], v[40:43], v[72:75]
s_cbranch_vccnz main_kernel_fj0_c1
main_kernel_fj0_k1:
v_mfma_f32_16x16x32_bf16 v[64:67], a[60:63], v[36:39], v[64:67]
s_waitcnt lgkmcnt(4)
v_lshlrev_b32 v144, 16, v124
v_mfma_f32_16x16x32_bf16 v[60:63], a[64:67], v[12:15], v[60:63]
ds_read_b128 v[36:39], v7 offset:24576
v_and_b32 v145, 0xffff0000, v124
v_mfma_f32_16x16x32_bf16 v[68:71], a[64:67], v[16:19], v[68:71]
ds_read_b128 v[40:43], v7 offset:24832
v_lshlrev_b32 v146, 16, v125
v_mfma_f32_16x16x32_bf16 v[72:75], a[68:71], v[16:19], v[72:75]
buffer_load_dwordx4 v8, s[8:11], s20 offen offset:2048 sc1 lds
v_and_b32 v147, 0xffff0000, v125
v_mfma_f32_16x16x32_bf16 v[64:67], a[68:71], v[12:15], v[64:67]
s_waitcnt lgkmcnt(4)
v_add_f32 v140, v148, v144
v_mfma_f32_16x16x32_bf16 v[60:63], a[72:75], v[20:23], v[60:63]
ds_read_b128 v[12:15], v7 offset:26624
v_add_f32 v141, v149, v145
v_mfma_f32_16x16x32_bf16 v[68:71], a[72:75], v[24:27], v[68:71]
ds_read_b128 v[16:19], v7 offset:26880
v_add_f32 v142, v150, v146
v_mfma_f32_16x16x32_bf16 v[72:75], a[76:79], v[24:27], v[72:75]
v_add_f32 v143, v151, v147
v_mfma_f32_16x16x32_bf16 v[64:67], a[76:79], v[20:23], v[64:67]
s_waitcnt lgkmcnt(4)
v_lshlrev_b32 v144, 16, v126
v_mfma_f32_16x16x32_bf16 v[60:63], a[80:83], v[28:31], v[60:63]
ds_read_b128 v[20:23], v7 offset:28672
v_and_b32 v145, 0xffff0000, v126
v_mfma_f32_16x16x32_bf16 v[68:71], a[80:83], v[32:35], v[68:71]
ds_read_b128 v[24:27], v7 offset:28928
v_lshlrev_b32 v146, 16, v127
v_mfma_f32_16x16x32_bf16 v[72:75], a[84:87], v[32:35], v[72:75]
buffer_load_dwordx4 v8, s[8:11], s20 offen offset:3072 sc1 lds
v_and_b32 v147, 0xffff0000, v127
v_mfma_f32_16x16x32_bf16 v[64:67], a[84:87], v[28:31], v[64:67]
s_waitcnt lgkmcnt(4)
s_add_u32 s20, s20, s23
s_add_u32 m0, s22, 49152
v_mfma_f32_16x16x32_bf16 v[60:63], a[88:91], v[36:39], v[60:63]
ds_read_b128 v[28:31], v7 offset:32768
v_add_f32 v140, v140, v144
v_mfma_f32_16x16x32_bf16 v[68:71], a[88:91], v[40:43], v[68:71]
ds_read_b128 v[32:35], v7 offset:33024
v_add_f32 v141, v141, v145
v_mfma_f32_16x16x32_bf16 v[72:75], a[92:95], v[40:43], v[72:75]
buffer_load_dwordx4 v8, s[8:11], s20 offen sc1 lds
v_add_f32 v142, v142, v146
v_mfma_f32_16x16x32_bf16 v[64:67], a[92:95], v[36:39], v[64:67]
s_waitcnt lgkmcnt(4)
v_add_f32 v143, v143, v147
s_add_u32 s38, s36, 1
v_mfma_f32_16x16x32_bf16 v[60:63], a[96:99], v[12:15], v[60:63]
s_min_u32 s38, s38, s37
ds_read_b128 v[36:39], v7 offset:34816
v_lshlrev_b32 v144, 16, v128
v_mfma_f32_16x16x32_bf16 v[68:71], a[96:99], v[16:19], v[68:71]
ds_read_b128 v[40:43], v7 offset:35072
v_and_b32 v145, 0xffff0000, v128
v_mfma_f32_16x16x32_bf16 v[72:75], a[100:103], v[16:19], v[72:75]
v_lshlrev_b32 v146, 16, v129
v_mfma_f32_16x16x32_bf16 v[64:67], a[100:103], v[12:15], v[64:67]
s_waitcnt lgkmcnt(4)
v_and_b32 v147, 0xffff0000, v129
v_mfma_f32_16x16x32_bf16 v[60:63], a[104:107], v[20:23], v[60:63]
ds_read_b128 v[12:15], v7 offset:36864
v_add_f32 v140, v140, v144
v_mfma_f32_16x16x32_bf16 v[68:71], a[104:107], v[24:27], v[68:71]
ds_read_b128 v[16:19], v7 offset:37120
v_add_f32 v141, v141, v145
v_mfma_f32_16x16x32_bf16 v[72:75], a[108:111], v[24:27], v[72:75]
buffer_load_dwordx4 v8, s[8:11], s20 offen offset:1024 sc1 lds
v_add_f32 v142, v142, v146
v_mfma_f32_16x16x32_bf16 v[64:67], a[108:111], v[20:23], v[64:67]
s_waitcnt lgkmcnt(4)
v_add_f32 v143, v143, v147
v_mfma_f32_16x16x32_bf16 v[60:63], a[112:115], v[28:31], v[60:63]
ds_read_b128 v[20:23], v7 offset:38912
v_lshlrev_b32 v144, 16, v130
v_mfma_f32_16x16x32_bf16 v[68:71], a[112:115], v[32:35], v[68:71]
ds_read_b128 v[24:27], v7 offset:39168
v_and_b32 v145, 0xffff0000, v130
v_mfma_f32_16x16x32_bf16 v[72:75], a[116:119], v[32:35], v[72:75]
s_waitcnt vmcnt(21)
v_cmp_gt_u32 s[62:63], s38, v111
v_mfma_f32_16x16x32_bf16 v[64:67], a[116:119], v[28:31], v[64:67]
s_waitcnt lgkmcnt(4)
v_lshlrev_b32 v146, 16, v131
v_mfma_f32_16x16x32_bf16 v[60:63], a[120:123], v[36:39], v[60:63]
s_and_b64 s[62:63], s[62:63], s[50:51]
ds_read_b128 v[28:31], v7 offset:40960
v_and_b32 v147, 0xffff0000, v131
v_mfma_f32_16x16x32_bf16 v[68:71], a[120:123], v[40:43], v[68:71]
s_mov_b32 s55, s42
ds_read_b128 v[32:35], v7 offset:41216
v_add_f32 v140, v140, v144
v_mfma_f32_16x16x32_bf16 v[72:75], a[124:127], v[40:43], v[72:75]
buffer_load_dwordx4 v8, s[8:11], s20 offen offset:2048 sc1 lds
v_add_f32 v141, v141, v145
v_mfma_f32_16x16x32_bf16 v[64:67], a[124:127], v[36:39], v[64:67]
s_waitcnt lgkmcnt(4)
v_add_f32 v142, v142, v146
s_mov_b32 s42, s41
v_mfma_f32_16x16x32_bf16 v[60:63], a[128:131], v[12:15], v[60:63]
s_mov_b32 s41, s43
ds_read_b128 v[36:39], v7 offset:43008
v_add_f32 v143, v143, v147
v_mfma_f32_16x16x32_bf16 v[68:71], a[128:131], v[16:19], v[68:71]
s_mov_b32 s59, s58
ds_read_b128 v[40:43], v7 offset:43264
v_mul_f32 v144, s40, v140
v_mfma_f32_16x16x32_bf16 v[72:75], a[132:135], v[16:19], v[72:75]
s_cbranch_scc1 main_kernel_fj0_a1
main_kernel_fj0_b1:
s_mov_b32 s58, s57
v_mfma_f32_16x16x32_bf16 v[64:67], a[132:135], v[12:15], v[64:67]
s_waitcnt lgkmcnt(4)
v_exp_f32 v144, v144
v_mfma_f32_16x16x32_bf16 v[60:63], a[136:139], v[20:23], v[60:63]
s_mov_b32 s57, s60
ds_read_b128 v[12:15], v7 offset:45056
v_mul_f32 v145, s40, v141
v_mfma_f32_16x16x32_bf16 v[68:71], a[136:139], v[24:27], v[68:71]
s_add_u32 s43, s43, 32768
ds_read_b128 v[16:19], v7 offset:45312
v_mul_f32 v146, s40, v142
v_mfma_f32_16x16x32_bf16 v[72:75], a[140:143], v[24:27], v[72:75]
buffer_load_dwordx4 v8, s[8:11], s20 offen offset:3072 sc1 lds
v_mul_f32 v147, s40, v143
v_mfma_f32_16x16x32_bf16 v[64:67], a[140:143], v[20:23], v[64:67]
s_waitcnt lgkmcnt(4)
s_add_u32 s20, s20, s28
s_add_u32 m0, s22, 65536
v_mfma_f32_16x16x32_bf16 v[60:63], a[144:147], v[28:31], v[60:63]
s_waitcnt vmcnt(19)
s_barrier
ds_read_b128 v[20:23], v7 offset:49152
v_mfma_f32_16x16x32_bf16 v[68:71], a[144:147], v[32:35], v[68:71]
s_cmp_lt_u32 s36, s37
ds_read_b128 v[24:27], v7 offset:49408
s_cselect_b32 s20, s20, 0x40000000
v_mfma_f32_16x16x32_bf16 v[72:75], a[148:151], v[32:35], v[72:75]
buffer_load_dwordx4 v8, s[8:11], s20 offen sc1 lds
v_add_f32 v144, 1.0, v144
v_mfma_f32_16x16x32_bf16 v[64:67], a[148:151], v[28:31], v[64:67]
s_waitcnt lgkmcnt(4)
v_exp_f32 v145, v145
v_mfma_f32_16x16x32_bf16 v[60:63], a[152:155], v[36:39], v[60:63]
buffer_load_dword v111, v109, s[8:11], 0 offen sc1
ds_read_b128 v[28:31], v7 offset:51200
v_mfma_f32_16x16x32_bf16 v[68:71], a[152:155], v[40:43], v[68:71]
s_waitcnt vmcnt(45)
ds_read_b128 v[32:35], v7 offset:51456
v_add_f32 v145, 1.0, v145
v_mfma_f32_16x16x32_bf16 v[72:75], a[156:159], v[40:43], v[72:75]
s_ashr_i32 s26, s39, 1
s_max_i32 s26, s26, 0
v_mov_b32 v112, s26
v_mfma_f32_16x16x32_bf16 v[64:67], a[156:159], v[36:39], v[64:67]
s_waitcnt lgkmcnt(4)
v_exp_f32 v146, v146
v_mfma_f32_16x16x32_bf16 v[60:63], a[160:163], v[12:15], v[60:63]
buffer_store_dword v112, v108, s[8:11], 0 offen sc1
ds_read_b128 v[36:39], v7 offset:53248
v_mfma_f32_16x16x32_bf16 v[68:71], a[160:163], v[16:19], v[68:71]
s_add_u32 s36, s36, 1
ds_read_b128 v[40:43], v7 offset:53504
v_add_f32 v146, 1.0, v146
v_mfma_f32_16x16x32_bf16 v[72:75], a[164:167], v[16:19], v[72:75]
buffer_load_dwordx4 v8, s[8:11], s20 offen offset:1024 sc1 lds
s_sub_u32 s27, s43, s44
v_mfma_f32_16x16x32_bf16 v[64:67], a[164:167], v[12:15], v[64:67]
s_waitcnt lgkmcnt(4)
v_exp_f32 v147, v147
v_mfma_f32_16x16x32_bf16 v[60:63], a[168:171], v[20:23], v[60:63]
s_cmp_eq_u32 s27, 229376
ds_read_b128 v[12:15], v7 offset:55296
v_add_f32 v147, 1.0, v147
v_mfma_f32_16x16x32_bf16 v[68:71], a[168:171], v[24:27], v[68:71]
s_cselect_b32 s43, s44, s43
ds_read_b128 v[16:19], v7 offset:55552
s_cselect_b32 s27, 0x10000, 0
v_mfma_f32_16x16x32_bf16 v[72:75], a[172:175], v[24:27], v[72:75]
s_xor_b32 s60, s60, s27
v_rcp_f32 v144, v144
v_mfma_f32_16x16x32_bf16 v[64:67], a[172:175], v[20:23], v[64:67]
s_waitcnt lgkmcnt(4)
v_rcp_f32 v145, v145
v_mfma_f32_16x16x32_bf16 v[60:63], a[176:179], v[28:31], v[60:63]
s_sub_u32 s64, 0x10000, s57
ds_read_b128 v[20:23], v7 offset:57344
v_mul_f32 v140, v140, v144
v_mfma_f32_16x16x32_bf16 v[68:71], a[176:179], v[32:35], v[68:71]
s_add_u32 s65, s57, 0x3f800000
ds_read_b128 v[24:27], v7 offset:57600
v_mul_f32 v141, v141, v145
v_mfma_f32_16x16x32_bf16 v[72:75], a[180:183], v[32:35], v[72:75]
buffer_load_dwordx4 v8, s[8:11], s20 offen offset:2048 sc1 lds
v_cvt_pk_bf16_f32 v160, v140, v141
v_mfma_f32_16x16x32_bf16 v[64:67], a[180:183], v[28:31], v[64:67]
s_waitcnt lgkmcnt(4)
v_rcp_f32 v146, v146
v_mfma_f32_16x16x32_bf16 v[60:63], a[184:187], v[36:39], v[60:63]
ds_read_b128 v[28:31], v7 offset:59392
v_mul_f32 v142, v142, v146
v_mfma_f32_16x16x32_bf16 v[68:71], a[184:187], v[40:43], v[68:71]
ds_read_b128 v[32:35], v7 offset:59648
v_mfma_f32_16x16x32_bf16 v[72:75], a[188:191], v[40:43], v[72:75]
v_rcp_f32 v147, v147
v_mfma_f32_16x16x32_bf16 v[64:67], a[188:191], v[36:39], v[64:67]
s_waitcnt lgkmcnt(4)
v_mul_f32 v143, v143, v147
v_mfma_f32_16x16x32_bf16 v[60:63], a[192:195], v[12:15], v[60:63]
ds_read_b128 v[36:39], v7 offset:61440
v_cvt_pk_bf16_f32 v161, v142, v143
v_mfma_f32_16x16x32_bf16 v[68:71], a[192:195], v[16:19], v[68:71]
ds_read_b128 v[40:43], v7 offset:61696
v_mfma_f32_16x16x32_bf16 v[72:75], a[196:199], v[16:19], v[72:75]
buffer_load_dwordx4 v8, s[8:11], s20 offen offset:3072 sc1 lds
v_mfma_f32_16x16x32_bf16 v[64:67], a[196:199], v[12:15], v[64:67]
s_waitcnt lgkmcnt(4)
s_add_u32 s20, s20, s23
s_add_u32 m0, s22, 81920
v_mfma_f32_16x16x32_bf16 v[60:63], a[200:203], v[20:23], v[60:63]
buffer_store_dwordx2 v[160:161], v121, s[8:11], s56 offen sc1
ds_read_b128 v[12:15], v6 offset:0
v_mfma_f32_16x16x32_bf16 v[68:71], a[200:203], v[24:27], v[68:71]
s_mov_b32 s56, s47
ds_read_b128 v[16:19], v6 offset:256
s_mov_b32 s47, s46
v_mfma_f32_16x16x32_bf16 v[72:75], a[204:207], v[24:27], v[72:75]
s_mov_b32 s46, s45
buffer_load_dwordx4 v8, s[8:11], s20 offen sc1 lds
v_mfma_f32_16x16x32_bf16 v[64:67], a[204:207], v[20:23], v[64:67]
s_waitcnt lgkmcnt(4)
s_add_u32 s45, s45, 65536
s_add_u32 s39, s39, 1
v_mfma_f32_16x16x32_bf16 v[60:63], a[208:211], v[28:31], v[60:63]
ds_read_b128 v[20:23], v6 offset:2048
v_mfma_f32_16x16x32_bf16 v[68:71], a[208:211], v[32:35], v[68:71]
ds_read_b128 v[24:27], v6 offset:2304
v_mfma_f32_16x16x32_bf16 v[72:75], a[212:215], v[32:35], v[72:75]
v_mfma_f32_16x16x32_bf16 v[64:67], a[212:215], v[28:31], v[64:67]
s_waitcnt lgkmcnt(4)
v_mfma_f32_16x16x32_bf16 v[60:63], a[216:219], v[36:39], v[60:63]
ds_read_b128 v[28:31], v6 offset:4096
v_mfma_f32_16x16x32_bf16 v[68:71], a[216:219], v[40:43], v[68:71]
ds_read_b128 v[32:35], v6 offset:4352
v_mfma_f32_16x16x32_bf16 v[72:75], a[220:223], v[40:43], v[72:75]
s_sub_u32 s24, s24, 1
buffer_load_dwordx4 v8, s[8:11], s20 offen offset:1024 sc1 lds
v_mfma_f32_16x16x32_bf16 v[64:67], a[220:223], v[36:39], v[64:67]
s_waitcnt lgkmcnt(4)
s_cbranch_scc0 main_kernel_fj0_lp
v_mfma_f32_16x16x32_bf16 v[44:47], a[0:3], v[12:15], 0
ds_read_b128 v[36:39], v6 offset:6144
v_mfma_f32_16x16x32_bf16 v[52:55], a[0:3], v[16:19], 0
ds_read_b128 v[40:43], v6 offset:6400
v_cvt_pk_bf16_f32 v84, v60, v61
v_mfma_f32_16x16x32_bf16 v[56:59], a[4:7], v[16:19], 0
v_add_u32 v63, s64, v63
v_mfma_f32_16x16x32_bf16 v[48:51], a[4:7], v[12:15], 0
s_waitcnt lgkmcnt(4)
v_cvt_pk_bf16_f32 v85, v62, s65
v_mfma_f32_16x16x32_bf16 v[44:47], a[8:11], v[20:23], v[44:47]
ds_read_b128 v[12:15], v6 offset:8192
v_bfi_b32 v85, s66, v63, v85
v_mfma_f32_16x16x32_bf16 v[52:55], a[8:11], v[24:27], v[52:55]
ds_read_b128 v[16:19], v6 offset:8448
v_cvt_pk_bf16_f32 v86, v64, v65
v_mfma_f32_16x16x32_bf16 v[56:59], a[12:15], v[24:27], v[56:59]
buffer_load_dwordx4 v8, s[8:11], s20 offen offset:2048 sc1 lds
v_add_u32 v67, s64, v67
v_mfma_f32_16x16x32_bf16 v[48:51], a[12:15], v[20:23], v[48:51]
s_waitcnt lgkmcnt(4)
v_cvt_pk_bf16_f32 v87, v66, s65
v_mfma_f32_16x16x32_bf16 v[44:47], a[16:19], v[28:31], v[44:47]
buffer_load_dwordx2 v[124:125], v118, s[8:11], s42 offen offset:0 sc1
ds_read_b128 v[20:23], v6 offset:10240
v_mfma_f32_16x16x32_bf16 v[52:55], a[16:19], v[32:35], v[52:55]
ds_read_b128 v[24:27], v6 offset:10496
v_bfi_b32 v87, s66, v67, v87
v_mfma_f32_16x16x32_bf16 v[56:59], a[20:23], v[32:35], v[56:59]
buffer_store_dwordx4 v[84:87], v116, s[8:11], s41 offen
v_cvt_pk_bf16_f32 v88, v68, v69
v_mfma_f32_16x16x32_bf16 v[48:51], a[20:23], v[28:31], v[48:51]
s_waitcnt lgkmcnt(4)
v_add_u32 v71, s64, v71
v_mfma_f32_16x16x32_bf16 v[44:47], a[24:27], v[36:39], v[44:47]
buffer_load_dwordx2 v[126:127], v118, s[8:11], s42 offen offset:2048 sc1
ds_read_b128 v[28:31], v6 offset:12288
v_mfma_f32_16x16x32_bf16 v[52:55], a[24:27], v[40:43], v[52:55]
ds_read_b128 v[32:35], v6 offset:12544
v_cvt_pk_bf16_f32 v89, v70, s65
v_mfma_f32_16x16x32_bf16 v[56:59], a[28:31], v[40:43], v[56:59]
buffer_load_dwordx4 v8, s[8:11], s20 offen offset:3072 sc1 lds
v_bfi_b32 v89, s66, v71, v89
v_mfma_f32_16x16x32_bf16 v[48:51], a[28:31], v[36:39], v[48:51]
s_waitcnt lgkmcnt(4)
s_add_u32 s20, s20, s23
s_add_u32 m0, s22, 98304
v_mfma_f32_16x16x32_bf16 v[44:47], a[32:35], v[12:15], v[44:47]
s_waitcnt vmcnt(18)
s_barrier
ds_read_b128 v[36:39], v6 offset:16384
v_mfma_f32_16x16x32_bf16 v[52:55], a[32:35], v[16:19], v[52:55]
s_waitcnt vmcnt(21)
ds_read_b128 v[40:43], v6 offset:16640
v_cvt_pk_bf16_f32 v90, v72, v73
v_mfma_f32_16x16x32_bf16 v[56:59], a[36:39], v[16:19], v[56:59]
buffer_load_dwordx4 v8, s[8:11], s20 offen sc1 lds
v_add_u32 v75, s64, v75
v_mfma_f32_16x16x32_bf16 v[48:51], a[36:39], v[12:15], v[48:51]
s_waitcnt lgkmcnt(4)
v_cvt_pk_bf16_f32 v91, v74, s65
v_mfma_f32_16x16x32_bf16 v[44:47], a[40:43], v[20:23], v[44:47]
buffer_load_dwordx2 v[128:129], v119, s[8:11], s42 offen offset:0 sc1
ds_read_b128 v[12:15], v6 offset:18432
v_mfma_f32_16x16x32_bf16 v[52:55], a[40:43], v[24:27], v[52:55]
ds_read_b128 v[16:19], v6 offset:18688
v_bfi_b32 v91, s66, v75, v91
v_mfma_f32_16x16x32_bf16 v[56:59], a[44:47], v[24:27], v[56:59]
buffer_store_dwordx4 v[88:91], v117, s[8:11], s41 offen
v_bitop3_b32 v162, v133, v135, s59 bitop3:0x7e
v_mfma_f32_16x16x32_bf16 v[48:51], a[44:47], v[20:23], v[48:51]
s_waitcnt lgkmcnt(4)
v_bitop3_b32 v163, v137, v139, s59 bitop3:0x7e
v_mfma_f32_16x16x32_bf16 v[44:47], a[48:51], v[28:31], v[44:47]
buffer_load_dwordx2 v[130:131], v119, s[8:11], s42 offen offset:2048 sc1
ds_read_b128 v[20:23], v6 offset:20480
v_mfma_f32_16x16x32_bf16 v[52:55], a[48:51], v[32:35], v[52:55]
ds_read_b128 v[24:27], v6 offset:20736
v_or_b32 v162, v162, v163
v_mfma_f32_16x16x32_bf16 v[56:59], a[52:55], v[32:35], v[56:59]
buffer_load_dwordx4 v8, s[8:11], s20 offen offset:1024 sc1 lds
v_and_b32 v162, 0x10000, v162
v_mfma_f32_16x16x32_bf16 v[48:51], a[52:55], v[28:31], v[48:51]
s_waitcnt lgkmcnt(4)
v_cmp_ne_u32 vcc, 0, v162
v_mfma_f32_16x16x32_bf16 v[44:47], a[56:59], v[36:39], v[44:47]
ds_read_b128 v[28:31], v6 offset:22528
v_mfma_f32_16x16x32_bf16 v[52:55], a[56:59], v[40:43], v[52:55]
ds_read_b128 v[32:35], v6 offset:22784
v_mfma_f32_16x16x32_bf16 v[56:59], a[60:63], v[40:43], v[56:59]
s_cbranch_vccnz main_kernel_fj0_zc0
main_kernel_fj0_zk0:
v_mfma_f32_16x16x32_bf16 v[48:51], a[60:63], v[36:39], v[48:51]
s_waitcnt lgkmcnt(4)
v_lshlrev_b32 v144, 16, v132
v_mfma_f32_16x16x32_bf16 v[44:47], a[64:67], v[12:15], v[44:47]
ds_read_b128 v[36:39], v6 offset:24576
v_and_b32 v145, 0xffff0000, v132
v_mfma_f32_16x16x32_bf16 v[52:55], a[64:67], v[16:19], v[52:55]
ds_read_b128 v[40:43], v6 offset:24832
v_lshlrev_b32 v146, 16, v133
v_mfma_f32_16x16x32_bf16 v[56:59], a[68:71], v[16:19], v[56:59]
buffer_load_dwordx4 v8, s[8:11], s20 offen offset:2048 sc1 lds
v_and_b32 v147, 0xffff0000, v133
v_mfma_f32_16x16x32_bf16 v[48:51], a[68:71], v[12:15], v[48:51]
s_waitcnt lgkmcnt(4)
v_add_f32 v140, v148, v144
v_mfma_f32_16x16x32_bf16 v[44:47], a[72:75], v[20:23], v[44:47]
ds_read_b128 v[12:15], v6 offset:26624
v_add_f32 v141, v149, v145
v_mfma_f32_16x16x32_bf16 v[52:55], a[72:75], v[24:27], v[52:55]
ds_read_b128 v[16:19], v6 offset:26880
v_add_f32 v142, v150, v146
v_mfma_f32_16x16x32_bf16 v[56:59], a[76:79], v[24:27], v[56:59]
v_add_f32 v143, v151, v147
v_mfma_f32_16x16x32_bf16 v[48:51], a[76:79], v[20:23], v[48:51]
s_waitcnt lgkmcnt(4)
v_lshlrev_b32 v144, 16, v134
v_mfma_f32_16x16x32_bf16 v[44:47], a[80:83], v[28:31], v[44:47]
ds_read_b128 v[20:23], v6 offset:28672
v_and_b32 v145, 0xffff0000, v134
v_mfma_f32_16x16x32_bf16 v[52:55], a[80:83], v[32:35], v[52:55]
ds_read_b128 v[24:27], v6 offset:28928
v_lshlrev_b32 v146, 16, v135
v_mfma_f32_16x16x32_bf16 v[56:59], a[84:87], v[32:35], v[56:59]
buffer_load_dwordx4 v8, s[8:11], s20 offen offset:3072 sc1 lds
v_and_b32 v147, 0xffff0000, v135
v_mfma_f32_16x16x32_bf16 v[48:51], a[84:87], v[28:31], v[48:51]
s_waitcnt lgkmcnt(4)
s_add_u32 s20, s20, s23
s_add_u32 m0, s22, 114688
v_mfma_f32_16x16x32_bf16 v[44:47], a[88:91], v[36:39], v[44:47]
ds_read_b128 v[28:31], v6 offset:32768
v_add_f32 v140, v140, v144
v_mfma_f32_16x16x32_bf16 v[52:55], a[88:91], v[40:43], v[52:55]
ds_read_b128 v[32:35], v6 offset:33024
v_add_f32 v141, v141, v145
v_mfma_f32_16x16x32_bf16 v[56:59], a[92:95], v[40:43], v[56:59]
buffer_load_dwordx4 v8, s[8:11], s20 offen sc1 lds
v_add_f32 v142, v142, v146
v_mfma_f32_16x16x32_bf16 v[48:51], a[92:95], v[36:39], v[48:51]
s_waitcnt lgkmcnt(4)
v_add_f32 v143, v143, v147
s_add_u32 s38, s36, 1
v_mfma_f32_16x16x32_bf16 v[44:47], a[96:99], v[12:15], v[44:47]
s_min_u32 s38, s38, s37
ds_read_b128 v[36:39], v6 offset:34816
v_lshlrev_b32 v144, 16, v136
v_mfma_f32_16x16x32_bf16 v[52:55], a[96:99], v[16:19], v[52:55]
ds_read_b128 v[40:43], v6 offset:35072
v_and_b32 v145, 0xffff0000, v136
v_mfma_f32_16x16x32_bf16 v[56:59], a[100:103], v[16:19], v[56:59]
v_lshlrev_b32 v146, 16, v137
v_mfma_f32_16x16x32_bf16 v[48:51], a[100:103], v[12:15], v[48:51]
s_waitcnt lgkmcnt(4)
v_and_b32 v147, 0xffff0000, v137
v_mfma_f32_16x16x32_bf16 v[44:47], a[104:107], v[20:23], v[44:47]
ds_read_b128 v[12:15], v6 offset:36864
v_add_f32 v140, v140, v144
v_mfma_f32_16x16x32_bf16 v[52:55], a[104:107], v[24:27], v[52:55]
ds_read_b128 v[16:19], v6 offset:37120
v_add_f32 v141, v141, v145
v_mfma_f32_16x16x32_bf16 v[56:59], a[108:111], v[24:27], v[56:59]
buffer_load_dwordx4 v8, s[8:11], s20 offen offset:1024 sc1 lds
v_add_f32 v142, v142, v146
v_mfma_f32_16x16x32_bf16 v[48:51], a[108:111], v[20:23], v[48:51]
s_waitcnt lgkmcnt(4)
v_add_f32 v143, v143, v147
v_mfma_f32_16x16x32_bf16 v[44:47], a[112:115], v[28:31], v[44:47]
ds_read_b128 v[20:23], v6 offset:38912
v_lshlrev_b32 v144, 16, v138
v_mfma_f32_16x16x32_bf16 v[52:55], a[112:115], v[32:35], v[52:55]
ds_read_b128 v[24:27], v6 offset:39168
v_and_b32 v145, 0xffff0000, v138
v_mfma_f32_16x16x32_bf16 v[56:59], a[116:119], v[32:35], v[56:59]
s_waitcnt vmcnt(21)
v_cmp_gt_u32 s[62:63], s38, v111
v_mfma_f32_16x16x32_bf16 v[48:51], a[116:119], v[28:31], v[48:51]
s_waitcnt lgkmcnt(4)
v_lshlrev_b32 v146, 16, v139
v_mfma_f32_16x16x32_bf16 v[44:47], a[120:123], v[36:39], v[44:47]
s_and_b64 s[62:63], s[62:63], s[50:51]
ds_read_b128 v[28:31], v6 offset:40960
v_and_b32 v147, 0xffff0000, v139
v_mfma_f32_16x16x32_bf16 v[52:55], a[120:123], v[40:43], v[52:55]
s_mov_b32 s55, s42
ds_read_b128 v[32:35], v6 offset:41216
v_add_f32 v140, v140, v144
v_mfma_f32_16x16x32_bf16 v[56:59], a[124:127], v[40:43], v[56:59]
buffer_load_dwordx4 v8, s[8:11], s20 offen offset:2048 sc1 lds
v_add_f32 v141, v141, v145
v_mfma_f32_16x16x32_bf16 v[48:51], a[124:127], v[36:39], v[48:51]
s_waitcnt lgkmcnt(4)
v_add_f32 v142, v142, v146
s_mov_b32 s42, s41
v_mfma_f32_16x16x32_bf16 v[44:47], a[128:131], v[12:15], v[44:47]
s_mov_b32 s41, s43
ds_read_b128 v[36:39], v6 offset:43008
v_add_f32 v143, v143, v147
v_mfma_f32_16x16x32_bf16 v[52:55], a[128:131], v[16:19], v[52:55]
s_mov_b32 s59, s58
ds_read_b128 v[40:43], v6 offset:43264
v_mul_f32 v144, s40, v140
v_mfma_f32_16x16x32_bf16 v[56:59], a[132:135], v[16:19], v[56:59]
s_cbranch_scc1 main_kernel_fj0_za0
main_kernel_fj0_zb0:
s_mov_b32 s58, s57
v_mfma_f32_16x16x32_bf16 v[48:51], a[132:135], v[12:15], v[48:51]
s_waitcnt lgkmcnt(4)
v_exp_f32 v144, v144
v_mfma_f32_16x16x32_bf16 v[44:47], a[136:139], v[20:23], v[44:47]
s_mov_b32 s57, s60
ds_read_b128 v[12:15], v6 offset:45056
v_mul_f32 v145, s40, v141
v_mfma_f32_16x16x32_bf16 v[52:55], a[136:139], v[24:27], v[52:55]
s_add_u32 s43, s43, 32768
ds_read_b128 v[16:19], v6 offset:45312
v_mul_f32 v146, s40, v142
v_mfma_f32_16x16x32_bf16 v[56:59], a[140:143], v[24:27], v[56:59]
buffer_load_dwordx4 v8, s[8:11], s20 offen offset:3072 sc1 lds
v_mul_f32 v147, s40, v143
v_mfma_f32_16x16x32_bf16 v[48:51], a[140:143], v[20:23], v[48:51]
s_waitcnt lgkmcnt(4)
s_add_u32 s20, s20, s28
s_add_u32 m0, s22, 0
v_mfma_f32_16x16x32_bf16 v[44:47], a[144:147], v[28:31], v[44:47]
s_waitcnt vmcnt(19)
s_barrier
ds_read_b128 v[20:23], v6 offset:49152
v_mfma_f32_16x16x32_bf16 v[52:55], a[144:147], v[32:35], v[52:55]
s_cmp_lt_u32 s36, s37
ds_read_b128 v[24:27], v6 offset:49408
s_cselect_b32 s20, s20, 0x40000000
v_mfma_f32_16x16x32_bf16 v[56:59], a[148:151], v[32:35], v[56:59]
buffer_load_dwordx4 v200, s[12:15], s68 offen nt lds
v_add_f32 v144, 1.0, v144
v_mfma_f32_16x16x32_bf16 v[48:51], a[148:151], v[28:31], v[48:51]
s_waitcnt lgkmcnt(4)
v_exp_f32 v145, v145
v_mfma_f32_16x16x32_bf16 v[44:47], a[152:155], v[36:39], v[44:47]
buffer_load_dword v111, v109, s[8:11], 0 offen sc1
ds_read_b128 v[28:31], v6 offset:51200
v_mfma_f32_16x16x32_bf16 v[52:55], a[152:155], v[40:43], v[52:55]
s_waitcnt vmcnt(45)
ds_read_b128 v[32:35], v6 offset:51456
v_add_f32 v145, 1.0, v145
v_mfma_f32_16x16x32_bf16 v[56:59], a[156:159], v[40:43], v[56:59]
s_ashr_i32 s26, s39, 1
s_max_i32 s26, s26, 0
v_mov_b32 v112, s26
v_mfma_f32_16x16x32_bf16 v[48:51], a[156:159], v[36:39], v[48:51]
s_waitcnt lgkmcnt(4)
v_exp_f32 v146, v146
v_mfma_f32_16x16x32_bf16 v[44:47], a[160:163], v[12:15], v[44:47]
buffer_store_dword v112, v108, s[8:11], 0 offen sc1
ds_read_b128 v[36:39], v6 offset:53248
v_mfma_f32_16x16x32_bf16 v[52:55], a[160:163], v[16:19], v[52:55]
s_add_u32 s36, s36, 1
ds_read_b128 v[40:43], v6 offset:53504
v_add_f32 v146, 1.0, v146
v_mfma_f32_16x16x32_bf16 v[56:59], a[164:167], v[16:19], v[56:59]
buffer_load_dwordx4 v201, s[12:15], s68 offen offset:1024 nt lds
s_sub_u32 s27, s43, s44
v_mfma_f32_16x16x32_bf16 v[48:51], a[164:167], v[12:15], v[48:51]
s_waitcnt lgkmcnt(4)
v_exp_f32 v147, v147
v_mfma_f32_16x16x32_bf16 v[44:47], a[168:171], v[20:23], v[44:47]
s_cmp_eq_u32 s27, 229376
ds_read_b128 v[12:15], v6 offset:55296
v_add_f32 v147, 1.0, v147
v_mfma_f32_16x16x32_bf16 v[52:55], a[168:171], v[24:27], v[52:55]
s_cselect_b32 s43, s44, s43
ds_read_b128 v[16:19], v6 offset:55552
s_cselect_b32 s27, 0x10000, 0
v_mfma_f32_16x16x32_bf16 v[56:59], a[172:175], v[24:27], v[56:59]
s_xor_b32 s60, s60, s27
v_rcp_f32 v144, v144
v_mfma_f32_16x16x32_bf16 v[48:51], a[172:175], v[20:23], v[48:51]
s_waitcnt lgkmcnt(4)
v_rcp_f32 v145, v145
v_mfma_f32_16x16x32_bf16 v[44:47], a[176:179], v[28:31], v[44:47]
s_sub_u32 s64, 0x10000, s57
ds_read_b128 v[20:23], v6 offset:57344
v_mul_f32 v140, v140, v144
v_mfma_f32_16x16x32_bf16 v[52:55], a[176:179], v[32:35], v[52:55]
s_add_u32 s65, s57, 0x3f800000
ds_read_b128 v[24:27], v6 offset:57600
v_mul_f32 v141, v141, v145
v_mfma_f32_16x16x32_bf16 v[56:59], a[180:183], v[32:35], v[56:59]
buffer_load_dwordx4 v202, s[12:15], s68 offen offset:2048 nt lds
v_cvt_pk_bf16_f32 v160, v140, v141
v_mfma_f32_16x16x32_bf16 v[48:51], a[180:183], v[28:31], v[48:51]
s_waitcnt lgkmcnt(4)
v_rcp_f32 v146, v146
v_mfma_f32_16x16x32_bf16 v[44:47], a[184:187], v[36:39], v[44:47]
ds_read_b128 v[28:31], v6 offset:59392
v_mul_f32 v142, v142, v146
v_mfma_f32_16x16x32_bf16 v[52:55], a[184:187], v[40:43], v[52:55]
ds_read_b128 v[32:35], v6 offset:59648
v_mfma_f32_16x16x32_bf16 v[56:59], a[188:191], v[40:43], v[56:59]
v_rcp_f32 v147, v147
v_mfma_f32_16x16x32_bf16 v[48:51], a[188:191], v[36:39], v[48:51]
s_waitcnt lgkmcnt(4)
v_mul_f32 v143, v143, v147
v_mfma_f32_16x16x32_bf16 v[44:47], a[192:195], v[12:15], v[44:47]
ds_read_b128 v[36:39], v6 offset:61440
v_cvt_pk_bf16_f32 v161, v142, v143
v_mfma_f32_16x16x32_bf16 v[52:55], a[192:195], v[16:19], v[52:55]
ds_read_b128 v[40:43], v6 offset:61696
v_mfma_f32_16x16x32_bf16 v[56:59], a[196:199], v[16:19], v[56:59]
buffer_load_dwordx4 v203, s[12:15], s68 offen offset:3072 nt lds
v_mfma_f32_16x16x32_bf16 v[48:51], a[196:199], v[12:15], v[48:51]
s_waitcnt lgkmcnt(4)
s_add_u32 s68, s68, s75
s_add_u32 m0, s22, 16384
v_mfma_f32_16x16x32_bf16 v[44:47], a[200:203], v[20:23], v[44:47]
buffer_store_dwordx2 v[160:161], v121, s[8:11], s56 offen sc1
ds_read_b128 v[12:15], v7 offset:0
v_mfma_f32_16x16x32_bf16 v[52:55], a[200:203], v[24:27], v[52:55]
s_mov_b32 s56, s47
ds_read_b128 v[16:19], v7 offset:256
s_mov_b32 s47, s46
v_mfma_f32_16x16x32_bf16 v[56:59], a[204:207], v[24:27], v[56:59]
s_mov_b32 s46, s45
buffer_load_dwordx4 v200, s[12:15], s68 offen nt lds
v_mfma_f32_16x16x32_bf16 v[48:51], a[204:207], v[20:23], v[48:51]
s_waitcnt lgkmcnt(4)
s_add_u32 s45, s45, 65536
s_add_u32 s39, s39, 1
v_mfma_f32_16x16x32_bf16 v[44:47], a[208:211], v[28:31], v[44:47]
ds_read_b128 v[20:23], v7 offset:2048
v_mfma_f32_16x16x32_bf16 v[52:55], a[208:211], v[32:35], v[52:55]
ds_read_b128 v[24:27], v7 offset:2304
v_mfma_f32_16x16x32_bf16 v[56:59], a[212:215], v[32:35], v[56:59]
v_mfma_f32_16x16x32_bf16 v[48:51], a[212:215], v[28:31], v[48:51]
s_waitcnt lgkmcnt(4)
v_mfma_f32_16x16x32_bf16 v[44:47], a[216:219], v[36:39], v[44:47]
ds_read_b128 v[28:31], v7 offset:4096
v_mfma_f32_16x16x32_bf16 v[52:55], a[216:219], v[40:43], v[52:55]
ds_read_b128 v[32:35], v7 offset:4352
v_mfma_f32_16x16x32_bf16 v[56:59], a[220:223], v[40:43], v[56:59]
buffer_load_dwordx4 v201, s[12:15], s68 offen offset:1024 nt lds
v_mfma_f32_16x16x32_bf16 v[48:51], a[220:223], v[36:39], v[48:51]
s_waitcnt lgkmcnt(4)
v_mfma_f32_16x16x32_bf16 v[60:63], a[0:3], v[12:15], 0
ds_read_b128 v[36:39], v7 offset:6144
v_mfma_f32_16x16x32_bf16 v[68:71], a[0:3], v[16:19], 0
ds_read_b128 v[40:43], v7 offset:6400
v_cvt_pk_bf16_f32 v84, v44, v45
v_mfma_f32_16x16x32_bf16 v[72:75], a[4:7], v[16:19], 0
v_add_u32 v47, s64, v47
v_mfma_f32_16x16x32_bf16 v[64:67], a[4:7], v[12:15], 0
s_waitcnt lgkmcnt(4)
v_cvt_pk_bf16_f32 v85, v46, s65
v_mfma_f32_16x16x32_bf16 v[60:63], a[8:11], v[20:23], v[60:63]
ds_read_b128 v[12:15], v7 offset:8192
v_bfi_b32 v85, s66, v47, v85
v_mfma_f32_16x16x32_bf16 v[68:71], a[8:11], v[24:27], v[68:71]
ds_read_b128 v[16:19], v7 offset:8448
v_cvt_pk_bf16_f32 v86, v48, v49
v_mfma_f32_16x16x32_bf16 v[72:75], a[12:15], v[24:27], v[72:75]
buffer_load_dwordx4 v202, s[12:15], s68 offen offset:2048 nt lds
v_add_u32 v51, s64, v51
v_mfma_f32_16x16x32_bf16 v[64:67], a[12:15], v[20:23], v[64:67]
s_waitcnt lgkmcnt(4)
v_cvt_pk_bf16_f32 v87, v50, s65
v_mfma_f32_16x16x32_bf16 v[60:63], a[16:19], v[28:31], v[60:63]
buffer_load_dwordx2 v[132:133], v118, s[8:11], s42 offen offset:0 sc1
ds_read_b128 v[20:23], v7 offset:10240
v_mfma_f32_16x16x32_bf16 v[68:71], a[16:19], v[32:35], v[68:71]
ds_read_b128 v[24:27], v7 offset:10496
v_bfi_b32 v87, s66, v51, v87
v_mfma_f32_16x16x32_bf16 v[72:75], a[20:23], v[32:35], v[72:75]
buffer_store_dwordx4 v[84:87], v116, s[8:11], s41 offen
v_cvt_pk_bf16_f32 v88, v52, v53
v_mfma_f32_16x16x32_bf16 v[64:67], a[20:23], v[28:31], v[64:67]
s_waitcnt lgkmcnt(4)
v_add_u32 v55, s64, v55
v_mfma_f32_16x16x32_bf16 v[60:63], a[24:27], v[36:39], v[60:63]
buffer_load_dwordx2 v[134:135], v118, s[8:11], s42 offen offset:2048 sc1
ds_read_b128 v[28:31], v7 offset:12288
v_mfma_f32_16x16x32_bf16 v[68:71], a[24:27], v[40:43], v[68:71]
ds_read_b128 v[32:35], v7 offset:12544
v_cvt_pk_bf16_f32 v89, v54, s65
v_mfma_f32_16x16x32_bf16 v[72:75], a[28:31], v[40:43], v[72:75]
buffer_load_dwordx4 v203, s[12:15], s68 offen offset:3072 nt lds
v_bfi_b32 v89, s66, v55, v89
v_mfma_f32_16x16x32_bf16 v[64:67], a[28:31], v[36:39], v[64:67]
s_waitcnt lgkmcnt(4)
s_add_u32 s68, s68, s75
s_add_u32 m0, s22, 32768
v_mfma_f32_16x16x32_bf16 v[60:63], a[32:35], v[12:15], v[60:63]
s_waitcnt vmcnt(18)
s_barrier
ds_read_b128 v[36:39], v7 offset:16384
v_mfma_f32_16x16x32_bf16 v[68:71], a[32:35], v[16:19], v[68:71]
s_waitcnt vmcnt(21)
ds_read_b128 v[40:43], v7 offset:16640
v_cvt_pk_bf16_f32 v90, v56, v57
v_mfma_f32_16x16x32_bf16 v[72:75], a[36:39], v[16:19], v[72:75]
buffer_load_dwordx4 v200, s[12:15], s68 offen nt lds
v_add_u32 v59, s64, v59
v_mfma_f32_16x16x32_bf16 v[64:67], a[36:39], v[12:15], v[64:67]
s_waitcnt lgkmcnt(4)
v_cvt_pk_bf16_f32 v91, v58, s65
v_mfma_f32_16x16x32_bf16 v[60:63], a[40:43], v[20:23], v[60:63]
buffer_load_dwordx2 v[136:137], v119, s[8:11], s42 offen offset:0 sc1
ds_read_b128 v[12:15], v7 offset:18432
v_mfma_f32_16x16x32_bf16 v[68:71], a[40:43], v[24:27], v[68:71]
ds_read_b128 v[16:19], v7 offset:18688
v_bfi_b32 v91, s66, v59, v91
v_mfma_f32_16x16x32_bf16 v[72:75], a[44:47], v[24:27], v[72:75]
buffer_store_dwordx4 v[88:91], v117, s[8:11], s41 offen
v_bitop3_b32 v162, v125, v127, s59 bitop3:0x7e
v_mfma_f32_16x16x32_bf16 v[64:67], a[44:47], v[20:23], v[64:67]
s_waitcnt lgkmcnt(4)
v_bitop3_b32 v163, v129, v131, s59 bitop3:0x7e
v_mfma_f32_16x16x32_bf16 v[60:63], a[48:51], v[28:31], v[60:63]
buffer_load_dwordx2 v[138:139], v119, s[8:11], s42 offen offset:2048 sc1
ds_read_b128 v[20:23], v7 offset:20480
v_mfma_f32_16x16x32_bf16 v[68:71], a[48:51], v[32:35], v[68:71]
ds_read_b128 v[24:27], v7 offset:20736
v_or_b32 v162, v162, v163
v_mfma_f32_16x16x32_bf16 v[72:75], a[52:55], v[32:35], v[72:75]
buffer_load_dwordx4 v201, s[12:15], s68 offen offset:1024 nt lds
v_and_b32 v162, 0x10000, v162
v_mfma_f32_16x16x32_bf16 v[64:67], a[52:55], v[28:31], v[64:67]
s_waitcnt lgkmcnt(4)
v_cmp_ne_u32 vcc, 0, v162
v_mfma_f32_16x16x32_bf16 v[60:63], a[56:59], v[36:39], v[60:63]
ds_read_b128 v[28:31], v7 offset:22528
v_mfma_f32_16x16x32_bf16 v[68:71], a[56:59], v[40:43], v[68:71]
ds_read_b128 v[32:35], v7 offset:22784
v_mfma_f32_16x16x32_bf16 v[72:75], a[60:63], v[40:43], v[72:75]
s_cbranch_vccnz main_kernel_fj0_zc1
main_kernel_fj0_zk1:
v_mfma_f32_16x16x32_bf16 v[64:67], a[60:63], v[36:39], v[64:67]
s_waitcnt lgkmcnt(4)
v_lshlrev_b32 v144, 16, v124
v_mfma_f32_16x16x32_bf16 v[60:63], a[64:67], v[12:15], v[60:63]
ds_read_b128 v[36:39], v7 offset:24576
v_and_b32 v145, 0xffff0000, v124
v_mfma_f32_16x16x32_bf16 v[68:71], a[64:67], v[16:19], v[68:71]
ds_read_b128 v[40:43], v7 offset:24832
v_lshlrev_b32 v146, 16, v125
v_mfma_f32_16x16x32_bf16 v[72:75], a[68:71], v[16:19], v[72:75]
buffer_load_dwordx4 v202, s[12:15], s68 offen offset:2048 nt lds
v_and_b32 v147, 0xffff0000, v125
v_mfma_f32_16x16x32_bf16 v[64:67], a[68:71], v[12:15], v[64:67]
s_waitcnt lgkmcnt(4)
v_add_f32 v140, v148, v144
v_mfma_f32_16x16x32_bf16 v[60:63], a[72:75], v[20:23], v[60:63]
ds_read_b128 v[12:15], v7 offset:26624
v_add_f32 v141, v149, v145
v_mfma_f32_16x16x32_bf16 v[68:71], a[72:75], v[24:27], v[68:71]
ds_read_b128 v[16:19], v7 offset:26880
v_add_f32 v142, v150, v146
v_mfma_f32_16x16x32_bf16 v[72:75], a[76:79], v[24:27], v[72:75]
v_add_f32 v143, v151, v147
v_mfma_f32_16x16x32_bf16 v[64:67], a[76:79], v[20:23], v[64:67]
s_waitcnt lgkmcnt(4)
v_lshlrev_b32 v144, 16, v126
v_mfma_f32_16x16x32_bf16 v[60:63], a[80:83], v[28:31], v[60:63]
ds_read_b128 v[20:23], v7 offset:28672
v_and_b32 v145, 0xffff0000, v126
v_mfma_f32_16x16x32_bf16 v[68:71], a[80:83], v[32:35], v[68:71]
ds_read_b128 v[24:27], v7 offset:28928
v_lshlrev_b32 v146, 16, v127
v_mfma_f32_16x16x32_bf16 v[72:75], a[84:87], v[32:35], v[72:75]
buffer_load_dwordx4 v203, s[12:15], s68 offen offset:3072 nt lds
v_and_b32 v147, 0xffff0000, v127
v_mfma_f32_16x16x32_bf16 v[64:67], a[84:87], v[28:31], v[64:67]
s_waitcnt lgkmcnt(4)
s_add_u32 s68, s68, s75
s_add_u32 m0, s22, 49152
v_mfma_f32_16x16x32_bf16 v[60:63], a[88:91], v[36:39], v[60:63]
ds_read_b128 v[28:31], v7 offset:32768
v_add_f32 v140, v140, v144
v_mfma_f32_16x16x32_bf16 v[68:71], a[88:91], v[40:43], v[68:71]
ds_read_b128 v[32:35], v7 offset:33024
v_add_f32 v141, v141, v145
v_mfma_f32_16x16x32_bf16 v[72:75], a[92:95], v[40:43], v[72:75]
buffer_load_dwordx4 v200, s[12:15], s68 offen nt lds
v_add_f32 v142, v142, v146
v_mfma_f32_16x16x32_bf16 v[64:67], a[92:95], v[36:39], v[64:67]
s_waitcnt lgkmcnt(4)
v_add_f32 v143, v143, v147
s_add_u32 s38, s36, 1
v_mfma_f32_16x16x32_bf16 v[60:63], a[96:99], v[12:15], v[60:63]
s_min_u32 s38, s38, s37
ds_read_b128 v[36:39], v7 offset:34816
v_lshlrev_b32 v144, 16, v128
v_mfma_f32_16x16x32_bf16 v[68:71], a[96:99], v[16:19], v[68:71]
ds_read_b128 v[40:43], v7 offset:35072
v_and_b32 v145, 0xffff0000, v128
v_mfma_f32_16x16x32_bf16 v[72:75], a[100:103], v[16:19], v[72:75]
v_lshlrev_b32 v146, 16, v129
v_mfma_f32_16x16x32_bf16 v[64:67], a[100:103], v[12:15], v[64:67]
s_waitcnt lgkmcnt(4)
v_and_b32 v147, 0xffff0000, v129
v_mfma_f32_16x16x32_bf16 v[60:63], a[104:107], v[20:23], v[60:63]
ds_read_b128 v[12:15], v7 offset:36864
v_add_f32 v140, v140, v144
v_mfma_f32_16x16x32_bf16 v[68:71], a[104:107], v[24:27], v[68:71]
ds_read_b128 v[16:19], v7 offset:37120
v_add_f32 v141, v141, v145
v_mfma_f32_16x16x32_bf16 v[72:75], a[108:111], v[24:27], v[72:75]
buffer_load_dwordx4 v201, s[12:15], s68 offen offset:1024 nt lds
v_add_f32 v142, v142, v146
v_mfma_f32_16x16x32_bf16 v[64:67], a[108:111], v[20:23], v[64:67]
s_waitcnt lgkmcnt(4)
v_add_f32 v143, v143, v147
v_mfma_f32_16x16x32_bf16 v[60:63], a[112:115], v[28:31], v[60:63]
ds_read_b128 v[20:23], v7 offset:38912
v_lshlrev_b32 v144, 16, v130
v_mfma_f32_16x16x32_bf16 v[68:71], a[112:115], v[32:35], v[68:71]
ds_read_b128 v[24:27], v7 offset:39168
v_and_b32 v145, 0xffff0000, v130
v_mfma_f32_16x16x32_bf16 v[72:75], a[116:119], v[32:35], v[72:75]
s_waitcnt vmcnt(21)
v_cmp_gt_u32 s[62:63], s38, v111
v_mfma_f32_16x16x32_bf16 v[64:67], a[116:119], v[28:31], v[64:67]
s_waitcnt lgkmcnt(4)
v_lshlrev_b32 v146, 16, v131
v_mfma_f32_16x16x32_bf16 v[60:63], a[120:123], v[36:39], v[60:63]
s_and_b64 s[62:63], s[62:63], s[50:51]
ds_read_b128 v[28:31], v7 offset:40960
v_and_b32 v147, 0xffff0000, v131
v_mfma_f32_16x16x32_bf16 v[68:71], a[120:123], v[40:43], v[68:71]
s_mov_b32 s55, s42
ds_read_b128 v[32:35], v7 offset:41216
v_add_f32 v140, v140, v144
v_mfma_f32_16x16x32_bf16 v[72:75], a[124:127], v[40:43], v[72:75]
buffer_load_dwordx4 v202, s[12:15], s68 offen offset:2048 nt lds
v_add_f32 v141, v141, v145
v_mfma_f32_16x16x32_bf16 v[64:67], a[124:127], v[36:39], v[64:67]
s_waitcnt lgkmcnt(4)
v_add_f32 v142, v142, v146
s_mov_b32 s42, s41
v_mfma_f32_16x16x32_bf16 v[60:63], a[128:131], v[12:15], v[60:63]
s_mov_b32 s41, s43
ds_read_b128 v[36:39], v7 offset:43008
v_add_f32 v143, v143, v147
v_mfma_f32_16x16x32_bf16 v[68:71], a[128:131], v[16:19], v[68:71]
s_mov_b32 s59, s58
ds_read_b128 v[40:43], v7 offset:43264
v_mul_f32 v144, s40, v140
v_mfma_f32_16x16x32_bf16 v[72:75], a[132:135], v[16:19], v[72:75]
s_cbranch_scc1 main_kernel_fj0_za1
main_kernel_fj0_zb1:
s_mov_b32 s58, s57
v_mfma_f32_16x16x32_bf16 v[64:67], a[132:135], v[12:15], v[64:67]
s_waitcnt lgkmcnt(4)
v_exp_f32 v144, v144
v_mfma_f32_16x16x32_bf16 v[60:63], a[136:139], v[20:23], v[60:63]
s_mov_b32 s57, s60
ds_read_b128 v[12:15], v7 offset:45056
v_mul_f32 v145, s40, v141
v_mfma_f32_16x16x32_bf16 v[68:71], a[136:139], v[24:27], v[68:71]
s_add_u32 s43, s43, 32768
ds_read_b128 v[16:19], v7 offset:45312
v_mul_f32 v146, s40, v142
v_mfma_f32_16x16x32_bf16 v[72:75], a[140:143], v[24:27], v[72:75]
buffer_load_dwordx4 v203, s[12:15], s68 offen offset:3072 nt lds
v_mul_f32 v147, s40, v143
v_mfma_f32_16x16x32_bf16 v[64:67], a[140:143], v[20:23], v[64:67]
s_waitcnt lgkmcnt(4)
s_add_u32 s68, s68, s75
s_add_u32 m0, s22, 65536
v_mfma_f32_16x16x32_bf16 v[60:63], a[144:147], v[28:31], v[60:63]
s_waitcnt vmcnt(25)
s_barrier
ds_read_b128 v[20:23], v7 offset:49152
v_mfma_f32_16x16x32_bf16 v[68:71], a[144:147], v[32:35], v[68:71]
s_cmp_lt_u32 s36, s37
ds_read_b128 v[24:27], v7 offset:49408
s_cselect_b32 s20, s20, 0x40000000
v_mfma_f32_16x16x32_bf16 v[72:75], a[148:151], v[32:35], v[72:75]
buffer_load_dwordx4 v200, s[12:15], s68 offen nt lds
v_add_f32 v144, 1.0, v144
v_mfma_f32_16x16x32_bf16 v[64:67], a[148:151], v[28:31], v[64:67]
s_waitcnt lgkmcnt(4)
v_exp_f32 v145, v145
v_mfma_f32_16x16x32_bf16 v[60:63], a[152:155], v[36:39], v[60:63]
buffer_load_dword v111, v109, s[8:11], 0 offen sc1
ds_read_b128 v[28:31], v7 offset:51200
v_mfma_f32_16x16x32_bf16 v[68:71], a[152:155], v[40:43], v[68:71]
s_waitcnt vmcnt(45)
ds_read_b128 v[32:35], v7 offset:51456
v_add_f32 v145, 1.0, v145
v_mfma_f32_16x16x32_bf16 v[72:75], a[156:159], v[40:43], v[72:75]
s_ashr_i32 s26, s39, 1
s_max_i32 s26, s26, 0
v_mov_b32 v112, s26
v_mfma_f32_16x16x32_bf16 v[64:67], a[156:159], v[36:39], v[64:67]
s_waitcnt lgkmcnt(4)
v_exp_f32 v146, v146
v_mfma_f32_16x16x32_bf16 v[60:63], a[160:163], v[12:15], v[60:63]
buffer_store_dword v112, v108, s[8:11], 0 offen sc1
ds_read_b128 v[36:39], v7 offset:53248
v_mfma_f32_16x16x32_bf16 v[68:71], a[160:163], v[16:19], v[68:71]
s_add_u32 s36, s36, 1
ds_read_b128 v[40:43], v7 offset:53504
v_add_f32 v146, 1.0, v146
v_mfma_f32_16x16x32_bf16 v[72:75], a[164:167], v[16:19], v[72:75]
buffer_load_dwordx4 v201, s[12:15], s68 offen offset:1024 nt lds
s_sub_u32 s27, s43, s44
v_mfma_f32_16x16x32_bf16 v[64:67], a[164:167], v[12:15], v[64:67]
s_waitcnt lgkmcnt(4)
v_exp_f32 v147, v147
v_mfma_f32_16x16x32_bf16 v[60:63], a[168:171], v[20:23], v[60:63]
s_cmp_eq_u32 s27, 229376
ds_read_b128 v[12:15], v7 offset:55296
v_add_f32 v147, 1.0, v147
v_mfma_f32_16x16x32_bf16 v[68:71], a[168:171], v[24:27], v[68:71]
s_cselect_b32 s43, s44, s43
ds_read_b128 v[16:19], v7 offset:55552
s_cselect_b32 s27, 0x10000, 0
v_mfma_f32_16x16x32_bf16 v[72:75], a[172:175], v[24:27], v[72:75]
s_xor_b32 s60, s60, s27
v_rcp_f32 v144, v144
v_mfma_f32_16x16x32_bf16 v[64:67], a[172:175], v[20:23], v[64:67]
s_waitcnt lgkmcnt(4)
v_rcp_f32 v145, v145
v_mfma_f32_16x16x32_bf16 v[60:63], a[176:179], v[28:31], v[60:63]
s_sub_u32 s64, 0x10000, s57
ds_read_b128 v[20:23], v7 offset:57344
v_mul_f32 v140, v140, v144
v_mfma_f32_16x16x32_bf16 v[68:71], a[176:179], v[32:35], v[68:71]
s_add_u32 s65, s57, 0x3f800000
ds_read_b128 v[24:27], v7 offset:57600
v_mul_f32 v141, v141, v145
v_mfma_f32_16x16x32_bf16 v[72:75], a[180:183], v[32:35], v[72:75]
buffer_load_dwordx4 v202, s[12:15], s68 offen offset:2048 nt lds
v_cvt_pk_bf16_f32 v160, v140, v141
v_mfma_f32_16x16x32_bf16 v[64:67], a[180:183], v[28:31], v[64:67]
s_waitcnt lgkmcnt(4)
v_rcp_f32 v146, v146
v_mfma_f32_16x16x32_bf16 v[60:63], a[184:187], v[36:39], v[60:63]
ds_read_b128 v[28:31], v7 offset:59392
v_mul_f32 v142, v142, v146
v_mfma_f32_16x16x32_bf16 v[68:71], a[184:187], v[40:43], v[68:71]
ds_read_b128 v[32:35], v7 offset:59648
v_mfma_f32_16x16x32_bf16 v[72:75], a[188:191], v[40:43], v[72:75]
v_rcp_f32 v147, v147
v_mfma_f32_16x16x32_bf16 v[64:67], a[188:191], v[36:39], v[64:67]
s_waitcnt lgkmcnt(4)
v_mul_f32 v143, v143, v147
v_mfma_f32_16x16x32_bf16 v[60:63], a[192:195], v[12:15], v[60:63]
ds_read_b128 v[36:39], v7 offset:61440
v_cvt_pk_bf16_f32 v161, v142, v143
v_mfma_f32_16x16x32_bf16 v[68:71], a[192:195], v[16:19], v[68:71]
ds_read_b128 v[40:43], v7 offset:61696
v_mfma_f32_16x16x32_bf16 v[72:75], a[196:199], v[16:19], v[72:75]
buffer_load_dwordx4 v203, s[12:15], s68 offen offset:3072 nt lds
v_mfma_f32_16x16x32_bf16 v[64:67], a[196:199], v[12:15], v[64:67]
s_waitcnt lgkmcnt(4)
s_add_u32 s68, s68, s75
s_add_u32 m0, s22, 81920
v_mfma_f32_16x16x32_bf16 v[60:63], a[200:203], v[20:23], v[60:63]
buffer_store_dwordx2 v[160:161], v121, s[8:11], s56 offen sc1
ds_read_b128 v[12:15], v6 offset:0
v_mfma_f32_16x16x32_bf16 v[68:71], a[200:203], v[24:27], v[68:71]
s_mov_b32 s56, s47
ds_read_b128 v[16:19], v6 offset:256
s_mov_b32 s47, s46
v_mfma_f32_16x16x32_bf16 v[72:75], a[204:207], v[24:27], v[72:75]
s_mov_b32 s46, s45
buffer_load_dwordx4 v200, s[12:15], s68 offen nt lds
v_mfma_f32_16x16x32_bf16 v[64:67], a[204:207], v[20:23], v[64:67]
s_waitcnt lgkmcnt(4)
s_add_u32 s45, s45, 65536
s_add_u32 s39, s39, 1
v_mfma_f32_16x16x32_bf16 v[60:63], a[208:211], v[28:31], v[60:63]
ds_read_b128 v[20:23], v6 offset:2048
v_mfma_f32_16x16x32_bf16 v[68:71], a[208:211], v[32:35], v[68:71]
ds_read_b128 v[24:27], v6 offset:2304
v_mfma_f32_16x16x32_bf16 v[72:75], a[212:215], v[32:35], v[72:75]
v_mfma_f32_16x16x32_bf16 v[64:67], a[212:215], v[28:31], v[64:67]
s_waitcnt lgkmcnt(4)
v_mfma_f32_16x16x32_bf16 v[60:63], a[216:219], v[36:39], v[60:63]
ds_read_b128 v[28:31], v6 offset:4096
v_mfma_f32_16x16x32_bf16 v[68:71], a[216:219], v[40:43], v[68:71]
ds_read_b128 v[32:35], v6 offset:4352
v_mfma_f32_16x16x32_bf16 v[72:75], a[220:223], v[40:43], v[72:75]
s_sub_u32 s24, s24, 1
buffer_load_dwordx4 v201, s[12:15], s68 offen offset:1024 nt lds
v_mfma_f32_16x16x32_bf16 v[64:67], a[220:223], v[36:39], v[64:67]
s_waitcnt lgkmcnt(4)
s_barrier
s_add_u32 m0, s22, 81920
s_nop 0
buffer_load_dwordx4 v202, s[12:15], s68 offen offset:2048 nt lds
buffer_load_dwordx4 v203, s[12:15], s68 offen offset:3072 nt lds
s_add_u32 s68, s68, s75
s_add_u32 m0, s22, 98304
s_nop 0
buffer_load_dwordx4 v200, s[12:15], s68 offen nt lds
buffer_load_dwordx4 v201, s[12:15], s68 offen offset:1024 nt lds
buffer_load_dwordx4 v202, s[12:15], s68 offen offset:2048 nt lds
buffer_load_dwordx4 v203, s[12:15], s68 offen offset:3072 nt lds
s_add_u32 s68, s68, s75
s_add_u32 m0, s22, 114688
s_nop 0
buffer_load_dwordx4 v200, s[12:15], s68 offen nt lds
buffer_load_dwordx4 v201, s[12:15], s68 offen offset:1024 nt lds
buffer_load_dwordx4 v202, s[12:15], s68 offen offset:2048 nt lds
buffer_load_dwordx4 v203, s[12:15], s68 offen offset:3072 nt lds
v_cvt_pk_bf16_f32 v84, v60, v61
v_add_u32 v63, s64, v63
v_cvt_pk_bf16_f32 v85, v62, s65
v_bfi_b32 v85, s66, v63, v85
v_cvt_pk_bf16_f32 v86, v64, v65
v_add_u32 v67, s64, v67
v_cvt_pk_bf16_f32 v87, v66, s65
v_bfi_b32 v87, s66, v67, v87
v_cvt_pk_bf16_f32 v88, v68, v69
v_add_u32 v71, s64, v71
v_cvt_pk_bf16_f32 v89, v70, s65
v_bfi_b32 v89, s66, v71, v89
v_cvt_pk_bf16_f32 v90, v72, v73
v_add_u32 v75, s64, v75
v_cvt_pk_bf16_f32 v91, v74, s65
v_bfi_b32 v91, s66, v75, v91
buffer_store_dwordx4 v[84:87], v116, s[8:11], s41 offen
buffer_store_dwordx4 v[88:91], v117, s[8:11], s41 offen
buffer_load_dwordx2 v[124:125], v118, s[8:11], s42 offen offset:0 sc1
buffer_load_dwordx2 v[126:127], v118, s[8:11], s42 offen offset:2048 sc1
buffer_load_dwordx2 v[128:129], v119, s[8:11], s42 offen offset:0 sc1
buffer_load_dwordx2 v[130:131], v119, s[8:11], s42 offen offset:2048 sc1
s_waitcnt vmcnt(6)
v_bitop3_b32 v162, v133, v135, s59 bitop3:0x7e
v_bitop3_b32 v163, v137, v139, s59 bitop3:0x7e
v_or_b32 v162, v162, v163
v_and_b32 v162, 0x10000, v162
v_cmp_ne_u32 vcc, 0, v162
s_cbranch_vccnz main_kernel_fj0_c2
main_kernel_fj0_k2:
v_lshlrev_b32 v144, 16, v132
v_and_b32 v145, 0xffff0000, v132
v_lshlrev_b32 v146, 16, v133
v_and_b32 v147, 0xffff0000, v133
v_add_f32 v140, v148, v144
v_add_f32 v141, v149, v145
v_add_f32 v142, v150, v146
v_add_f32 v143, v151, v147
v_lshlrev_b32 v144, 16, v134
v_and_b32 v145, 0xffff0000, v134
v_lshlrev_b32 v146, 16, v135
v_and_b32 v147, 0xffff0000, v135
v_add_f32 v140, v140, v144
v_add_f32 v141, v141, v145
v_add_f32 v142, v142, v146
v_add_f32 v143, v143, v147
v_lshlrev_b32 v144, 16, v136
v_and_b32 v145, 0xffff0000, v136
v_lshlrev_b32 v146, 16, v137
v_and_b32 v147, 0xffff0000, v137
v_add_f32 v140, v140, v144
v_add_f32 v141, v141, v145
v_add_f32 v142, v142, v146
v_add_f32 v143, v143, v147
v_lshlrev_b32 v144, 16, v138
v_and_b32 v145, 0xffff0000, v138
v_lshlrev_b32 v146, 16, v139
v_and_b32 v147, 0xffff0000, v139
v_add_f32 v140, v140, v144
v_add_f32 v141, v141, v145
v_add_f32 v142, v142, v146
v_add_f32 v143, v143, v147
v_mul_f32 v144, s40, v140
v_mul_f32 v145, s40, v141
v_mul_f32 v146, s40, v142
v_mul_f32 v147, s40, v143
v_exp_f32 v144, v144
v_exp_f32 v145, v145
v_exp_f32 v146, v146
v_exp_f32 v147, v147
v_add_f32 v144, 1.0, v144
v_add_f32 v145, 1.0, v145
v_add_f32 v146, 1.0, v146
v_add_f32 v147, 1.0, v147
v_rcp_f32 v144, v144
v_rcp_f32 v145, v145
v_rcp_f32 v146, v146
v_rcp_f32 v147, v147
v_mul_f32 v140, v140, v144
v_mul_f32 v141, v141, v145
v_mul_f32 v142, v142, v146
v_mul_f32 v143, v143, v147
v_cvt_pk_bf16_f32 v160, v140, v141
v_cvt_pk_bf16_f32 v161, v142, v143
buffer_store_dwordx2 v[160:161], v121, s[8:11], s56 offen sc1
buffer_load_dwordx2 v[132:133], v118, s[8:11], s41 offen offset:0 sc1
buffer_load_dwordx2 v[134:135], v118, s[8:11], s41 offen offset:2048 sc1
buffer_load_dwordx2 v[136:137], v119, s[8:11], s41 offen offset:0 sc1
buffer_load_dwordx2 v[138:139], v119, s[8:11], s41 offen offset:2048 sc1
s_waitcnt vmcnt(5)
v_bitop3_b32 v162, v125, v127, s58 bitop3:0x7e
v_bitop3_b32 v163, v129, v131, s58 bitop3:0x7e
v_or_b32 v162, v162, v163
v_and_b32 v162, 0x10000, v162
v_cmp_ne_u32 vcc, 0, v162
s_cbranch_vccnz main_kernel_fj0_c3
main_kernel_fj0_k3:
v_lshlrev_b32 v144, 16, v124
v_and_b32 v145, 0xffff0000, v124
v_lshlrev_b32 v146, 16, v125
v_and_b32 v147, 0xffff0000, v125
v_add_f32 v140, v148, v144
v_add_f32 v141, v149, v145
v_add_f32 v142, v150, v146
v_add_f32 v143, v151, v147
v_lshlrev_b32 v144, 16, v126
v_and_b32 v145, 0xffff0000, v126
v_lshlrev_b32 v146, 16, v127
v_and_b32 v147, 0xffff0000, v127
v_add_f32 v140, v140, v144
v_add_f32 v141, v141, v145
v_add_f32 v142, v142, v146
v_add_f32 v143, v143, v147
v_lshlrev_b32 v144, 16, v128
v_and_b32 v145, 0xffff0000, v128
v_lshlrev_b32 v146, 16, v129
v_and_b32 v147, 0xffff0000, v129
v_add_f32 v140, v140, v144
v_add_f32 v141, v141, v145
v_add_f32 v142, v142, v146
v_add_f32 v143, v143, v147
v_lshlrev_b32 v144, 16, v130
v_and_b32 v145, 0xffff0000, v130
v_lshlrev_b32 v146, 16, v131
v_and_b32 v147, 0xffff0000, v131
v_add_f32 v140, v140, v144
v_add_f32 v141, v141, v145
v_add_f32 v142, v142, v146
v_add_f32 v143, v143, v147
v_mul_f32 v144, s40, v140
v_mul_f32 v145, s40, v141
v_mul_f32 v146, s40, v142
v_mul_f32 v147, s40, v143
v_exp_f32 v144, v144
v_exp_f32 v145, v145
v_exp_f32 v146, v146
v_exp_f32 v147, v147
v_add_f32 v144, 1.0, v144
v_add_f32 v145, 1.0, v145
v_add_f32 v146, 1.0, v146
v_add_f32 v147, 1.0, v147
v_rcp_f32 v144, v144
v_rcp_f32 v145, v145
v_rcp_f32 v146, v146
v_rcp_f32 v147, v147
v_mul_f32 v140, v140, v144
v_mul_f32 v141, v141, v145
v_mul_f32 v142, v142, v146
v_mul_f32 v143, v143, v147
v_cvt_pk_bf16_f32 v160, v140, v141
v_cvt_pk_bf16_f32 v161, v142, v143
buffer_store_dwordx2 v[160:161], v121, s[8:11], s47 offen sc1
s_waitcnt vmcnt(1)
v_bitop3_b32 v162, v133, v135, s57 bitop3:0x7e
v_bitop3_b32 v163, v137, v139, s57 bitop3:0x7e
v_or_b32 v162, v162, v163
v_and_b32 v162, 0x10000, v162
v_cmp_ne_u32 vcc, 0, v162
s_cbranch_vccnz main_kernel_fj0_c4
main_kernel_fj0_k4:
v_lshlrev_b32 v144, 16, v132
v_and_b32 v145, 0xffff0000, v132
v_lshlrev_b32 v146, 16, v133
v_and_b32 v147, 0xffff0000, v133
v_add_f32 v140, v148, v144
v_add_f32 v141, v149, v145
v_add_f32 v142, v150, v146
v_add_f32 v143, v151, v147
v_lshlrev_b32 v144, 16, v134
v_and_b32 v145, 0xffff0000, v134
v_lshlrev_b32 v146, 16, v135
v_and_b32 v147, 0xffff0000, v135
v_add_f32 v140, v140, v144
v_add_f32 v141, v141, v145
v_add_f32 v142, v142, v146
v_add_f32 v143, v143, v147
v_lshlrev_b32 v144, 16, v136
v_and_b32 v145, 0xffff0000, v136
v_lshlrev_b32 v146, 16, v137
v_and_b32 v147, 0xffff0000, v137
v_add_f32 v140, v140, v144
v_add_f32 v141, v141, v145
v_add_f32 v142, v142, v146
v_add_f32 v143, v143, v147
v_lshlrev_b32 v144, 16, v138
v_and_b32 v145, 0xffff0000, v138
v_lshlrev_b32 v146, 16, v139
v_and_b32 v147, 0xffff0000, v139
v_add_f32 v140, v140, v144
v_add_f32 v141, v141, v145
v_add_f32 v142, v142, v146
v_add_f32 v143, v143, v147
v_mul_f32 v144, s40, v140
v_mul_f32 v145, s40, v141
v_mul_f32 v146, s40, v142
v_mul_f32 v147, s40, v143
v_exp_f32 v144, v144
v_exp_f32 v145, v145
v_exp_f32 v146, v146
v_exp_f32 v147, v147
v_add_f32 v144, 1.0, v144
v_add_f32 v145, 1.0, v145
v_add_f32 v146, 1.0, v146
v_add_f32 v147, 1.0, v147
v_rcp_f32 v144, v144
v_rcp_f32 v145, v145
v_rcp_f32 v146, v146
v_rcp_f32 v147, v147
v_mul_f32 v140, v140, v144
v_mul_f32 v141, v141, v145
v_mul_f32 v142, v142, v146
v_mul_f32 v143, v143, v147
v_cvt_pk_bf16_f32 v160, v140, v141
v_cvt_pk_bf16_f32 v161, v142, v143
buffer_store_dwordx2 v[160:161], v121, s[8:11], s46 offen sc1
s_branch main_kernel_fj0_dn
main_kernel_fj0_c0:
s_add_u32 s54, s54, 1
s_cmp_ge_u32 s54, 131072
s_cbranch_scc1 main_kernel_fj0_k0
buffer_load_dwordx2 v[132:133], v118, s[8:11], s55 offen offset:0 sc1
buffer_load_dwordx2 v[134:135], v118, s[8:11], s55 offen offset:2048 sc1
buffer_load_dwordx2 v[136:137], v119, s[8:11], s55 offen offset:0 sc1
buffer_load_dwordx2 v[138:139], v119, s[8:11], s55 offen offset:2048 sc1
s_waitcnt vmcnt(0)
v_bitop3_b32 v162, v133, v135, s59 bitop3:0x7e
v_bitop3_b32 v163, v137, v139, s59 bitop3:0x7e
v_or_b32 v162, v162, v163
v_and_b32 v162, 0x10000, v162
v_cmp_ne_u32 vcc, 0, v162
s_cbranch_vccnz main_kernel_fj0_c0
s_branch main_kernel_fj0_k0
main_kernel_fj0_a0:
main_kernel_fj0_w0:
buffer_load_dword v111, v109, s[8:11], 0 offen sc1
s_waitcnt vmcnt(0)
v_cmp_gt_u32 s[62:63], s38, v111
s_and_b64 s[62:63], s[62:63], s[50:51]
s_cbranch_scc0 main_kernel_fj0_w0_ok
s_add_u32 s54, s54, 1
s_cmp_ge_u32 s54, 131072
s_cbranch_scc1 main_kernel_fj0_w0_ok
s_sleep 1
s_branch main_kernel_fj0_w0
main_kernel_fj0_w0_ok:
s_branch main_kernel_fj0_b0
main_kernel_fj0_c1:
s_add_u32 s54, s54, 1
s_cmp_ge_u32 s54, 131072
s_cbranch_scc1 main_kernel_fj0_k1
buffer_load_dwordx2 v[124:125], v118, s[8:11], s55 offen offset:0 sc1
buffer_load_dwordx2 v[126:127], v118, s[8:11], s55 offen offset:2048 sc1
buffer_load_dwordx2 v[128:129], v119, s[8:11], s55 offen offset:0 sc1
buffer_load_dwordx2 v[130:131], v119, s[8:11], s55 offen offset:2048 sc1
s_waitcnt vmcnt(0)
v_bitop3_b32 v162, v125, v127, s59 bitop3:0x7e
v_bitop3_b32 v163, v129, v131, s59 bitop3:0x7e
v_or_b32 v162, v162, v163
v_and_b32 v162, 0x10000, v162
v_cmp_ne_u32 vcc, 0, v162
s_cbranch_vccnz main_kernel_fj0_c1
s_branch main_kernel_fj0_k1
main_kernel_fj0_a1:
main_kernel_fj0_w1:
buffer_load_dword v111, v109, s[8:11], 0 offen sc1
s_waitcnt vmcnt(0)
v_cmp_gt_u32 s[62:63], s38, v111
s_and_b64 s[62:63], s[62:63], s[50:51]
s_cbranch_scc0 main_kernel_fj0_w1_ok
s_add_u32 s54, s54, 1
s_cmp_ge_u32 s54, 131072
s_cbranch_scc1 main_kernel_fj0_w1_ok
s_sleep 1
s_branch main_kernel_fj0_w1
main_kernel_fj0_w1_ok:
s_branch main_kernel_fj0_b1
main_kernel_fj0_c2:
s_add_u32 s54, s54, 1
s_cmp_ge_u32 s54, 131072
s_cbranch_scc1 main_kernel_fj0_k2
buffer_load_dwordx2 v[132:133], v118, s[8:11], s55 offen offset:0 sc1
buffer_load_dwordx2 v[134:135], v118, s[8:11], s55 offen offset:2048 sc1
buffer_load_dwordx2 v[136:137], v119, s[8:11], s55 offen offset:0 sc1
buffer_load_dwordx2 v[138:139], v119, s[8:11], s55 offen offset:2048 sc1
s_waitcnt vmcnt(0)
v_bitop3_b32 v162, v133, v135, s59 bitop3:0x7e
v_bitop3_b32 v163, v137, v139, s59 bitop3:0x7e
v_or_b32 v162, v162, v163
v_and_b32 v162, 0x10000, v162
v_cmp_ne_u32 vcc, 0, v162
s_cbranch_vccnz main_kernel_fj0_c2
s_branch main_kernel_fj0_k2
main_kernel_fj0_c3:
s_add_u32 s54, s54, 1
s_cmp_ge_u32 s54, 131072
s_cbranch_scc1 main_kernel_fj0_k3
buffer_load_dwordx2 v[124:125], v118, s[8:11], s42 offen offset:0 sc1
buffer_load_dwordx2 v[126:127], v118, s[8:11], s42 offen offset:2048 sc1
buffer_load_dwordx2 v[128:129], v119, s[8:11], s42 offen offset:0 sc1
buffer_load_dwordx2 v[130:131], v119, s[8:11], s42 offen offset:2048 sc1
s_waitcnt vmcnt(0)
v_bitop3_b32 v162, v125, v127, s58 bitop3:0x7e
v_bitop3_b32 v163, v129, v131, s58 bitop3:0x7e
v_or_b32 v162, v162, v163
v_and_b32 v162, 0x10000, v162
v_cmp_ne_u32 vcc, 0, v162
s_cbranch_vccnz main_kernel_fj0_c3
s_branch main_kernel_fj0_k3
main_kernel_fj0_c4:
s_add_u32 s54, s54, 1
s_cmp_ge_u32 s54, 131072
s_cbranch_scc1 main_kernel_fj0_k4
buffer_load_dwordx2 v[132:133], v118, s[8:11], s41 offen offset:0 sc1
buffer_load_dwordx2 v[134:135], v118, s[8:11], s41 offen offset:2048 sc1
buffer_load_dwordx2 v[136:137], v119, s[8:11], s41 offen offset:0 sc1
buffer_load_dwordx2 v[138:139], v119, s[8:11], s41 offen offset:2048 sc1
s_waitcnt vmcnt(0)
v_bitop3_b32 v162, v133, v135, s57 bitop3:0x7e
v_bitop3_b32 v163, v137, v139, s57 bitop3:0x7e
v_or_b32 v162, v162, v163
v_and_b32 v162, 0x10000, v162
v_cmp_ne_u32 vcc, 0, v162
s_cbranch_vccnz main_kernel_fj0_c4
s_branch main_kernel_fj0_k4
main_kernel_fj0_zc0:
s_add_u32 s54, s54, 1
s_cmp_ge_u32 s54, 131072
s_cbranch_scc1 main_kernel_fj0_zk0
buffer_load_dwordx2 v[132:133], v118, s[8:11], s55 offen offset:0 sc1
buffer_load_dwordx2 v[134:135], v118, s[8:11], s55 offen offset:2048 sc1
buffer_load_dwordx2 v[136:137], v119, s[8:11], s55 offen offset:0 sc1
buffer_load_dwordx2 v[138:139], v119, s[8:11], s55 offen offset:2048 sc1
s_waitcnt vmcnt(0)
v_bitop3_b32 v162, v133, v135, s59 bitop3:0x7e
v_bitop3_b32 v163, v137, v139, s59 bitop3:0x7e
v_or_b32 v162, v162, v163
v_and_b32 v162, 0x10000, v162
v_cmp_ne_u32 vcc, 0, v162
s_cbranch_vccnz main_kernel_fj0_zc0
s_branch main_kernel_fj0_zk0
main_kernel_fj0_za0:
main_kernel_fj0_zw0:
buffer_load_dword v111, v109, s[8:11], 0 offen sc1
s_waitcnt vmcnt(0)
v_cmp_gt_u32 s[62:63], s38, v111
s_and_b64 s[62:63], s[62:63], s[50:51]
s_cbranch_scc0 main_kernel_fj0_zw0_ok
s_add_u32 s54, s54, 1
s_cmp_ge_u32 s54, 131072
s_cbranch_scc1 main_kernel_fj0_zw0_ok
s_sleep 1
s_branch main_kernel_fj0_zw0
main_kernel_fj0_zw0_ok:
s_branch main_kernel_fj0_zb0
main_kernel_fj0_zc1:
s_add_u32 s54, s54, 1
s_cmp_ge_u32 s54, 131072
s_cbranch_scc1 main_kernel_fj0_zk1
buffer_load_dwordx2 v[124:125], v118, s[8:11], s55 offen offset:0 sc1
buffer_load_dwordx2 v[126:127], v118, s[8:11], s55 offen offset:2048 sc1
buffer_load_dwordx2 v[128:129], v119, s[8:11], s55 offen offset:0 sc1
buffer_load_dwordx2 v[130:131], v119, s[8:11], s55 offen offset:2048 sc1
s_waitcnt vmcnt(0)
v_bitop3_b32 v162, v125, v127, s59 bitop3:0x7e
v_bitop3_b32 v163, v129, v131, s59 bitop3:0x7e
v_or_b32 v162, v162, v163
v_and_b32 v162, 0x10000, v162
v_cmp_ne_u32 vcc, 0, v162
s_cbranch_vccnz main_kernel_fj0_zc1
s_branch main_kernel_fj0_zk1
main_kernel_fj0_za1:
main_kernel_fj0_zw1:
buffer_load_dword v111, v109, s[8:11], 0 offen sc1
s_waitcnt vmcnt(0)
v_cmp_gt_u32 s[62:63], s38, v111
s_and_b64 s[62:63], s[62:63], s[50:51]
s_cbranch_scc0 main_kernel_fj0_zw1_ok
s_add_u32 s54, s54, 1
s_cmp_ge_u32 s54, 131072
s_cbranch_scc1 main_kernel_fj0_zw1_ok
s_sleep 1
s_branch main_kernel_fj0_zw1
main_kernel_fj0_zw1_ok:
s_branch main_kernel_fj0_zb1
main_kernel_fj0_dn:
s_branch main_kernel_fe
main_kernel_fs:
main_kernel_fj1_wa:
buffer_load_dword v111, v109, s[8:11], 0 offen sc1
s_waitcnt vmcnt(0)
v_cmp_gt_u32 vcc, 2, v111
s_and_b64 vcc, vcc, s[50:51]
s_cbranch_scc0 main_kernel_fj1_wa_ok
s_add_u32 s54, s54, 1
s_cmp_ge_u32 s54, 131072
s_cbranch_scc1 main_kernel_fj1_wa_ok
s_sleep 1
s_branch main_kernel_fj1_wa
main_kernel_fj1_wa_ok:
s_mov_b32 s39, -4
s_barrier
s_mov_b32 s26, 0
s_mov_b32 s41, 0x40000000
s_mov_b32 s42, 0x40000000
s_mov_b32 s55, 0x40000000
s_mov_b32 s46, 0x40000000
s_mov_b32 s47, 0x40000000
s_mov_b32 s56, 0x40000000
s_mov_b32 s57, 0
s_mov_b32 s58, 0
s_mov_b32 s59, 0
s_mov_b32 s64, 0
s_mov_b32 s65, 0
s_mov_b32 s66, 0xfffe0000
v_mov_b32 v132, 0
v_mov_b32 v133, 0
v_mov_b32 v134, 0
v_mov_b32 v135, 0
v_mov_b32 v136, 0
v_mov_b32 v137, 0
v_mov_b32 v138, 0
v_mov_b32 v139, 0
s_mov_b32 s20, s52
s_mov_b32 s36, 0
s_lshr_b32 s24, s37, 1
s_sub_u32 s24, s24, 2
s_mov_b32 m0, s22
s_nop 0
buffer_load_dwordx4 v8, s[8:11], s20 offen sc1 lds
buffer_load_dword v2, v11, s[8:11], 0 offen
buffer_load_dword v2, v11, s[8:11], 0 offen
s_add_u32 s36, s36, 1
buffer_load_dwordx4 v8, s[8:11], s20 offen offset:1024 sc1 lds
buffer_load_dwordx4 v8, s[8:11], s20 offen offset:2048 sc1 lds
buffer_load_dwordx4 v8, s[8:11], s20 offen offset:3072 sc1 lds
s_add_u32 s20, s20, s23
s_add_u32 m0, s22, 16384
buffer_load_dword v2, v11, s[8:11], 0 offen
buffer_load_dwordx4 v8, s[8:11], s20 offen sc1 lds
buffer_load_dwordx4 v8, s[8:11], s20 offen offset:1024 sc1 lds
buffer_load_dwordx4 v8, s[8:11], s20 offen offset:2048 sc1 lds
buffer_load_dword v2, v11, s[8:11], 0 offen
buffer_load_dword v2, v11, s[8:11], 0 offen
buffer_load_dword v2, v11, s[8:11], 0 offen
buffer_load_dwordx4 v8, s[8:11], s20 offen offset:3072 sc1 lds
s_add_u32 s20, s20, s23
s_add_u32 m0, s22, 32768
s_nop 0
buffer_load_dwordx4 v8, s[8:11], s20 offen sc1 lds
buffer_load_dword v2, v11, s[8:11], 0 offen
buffer_load_dword v2, v11, s[8:11], 0 offen
buffer_load_dword v2, v11, s[8:11], 0 offen
buffer_load_dwordx4 v8, s[8:11], s20 offen offset:1024 sc1 lds
buffer_load_dwordx4 v8, s[8:11], s20 offen offset:2048 sc1 lds
buffer_load_dwordx4 v8, s[8:11], s20 offen offset:3072 sc1 lds
s_add_u32 s20, s20, s23
s_add_u32 m0, s22, 49152
s_nop 0
buffer_load_dwordx4 v8, s[8:11], s20 offen sc1 lds
buffer_load_dwordx4 v8, s[8:11], s20 offen offset:1024 sc1 lds
buffer_load_dwordx4 v8, s[8:11], s20 offen offset:2048 sc1 lds
buffer_load_dwordx4 v8, s[8:11], s20 offen offset:3072 sc1 lds
s_add_u32 s20, s20, s28
s_add_u32 m0, s22, 65536
s_cmp_lt_u32 s36, s37
s_cselect_b32 s20, s20, 0x40000000
buffer_load_dwordx4 v8, s[8:11], s20 offen sc1 lds
buffer_load_dword v2, v11, s[8:11], 0 offen
buffer_load_dword v2, v11, s[8:11], 0 offen
s_add_u32 s36, s36, 1
buffer_load_dwordx4 v8, s[8:11], s20 offen offset:1024 sc1 lds
buffer_load_dwordx4 v8, s[8:11], s20 offen offset:2048 sc1 lds
buffer_load_dwordx4 v8, s[8:11], s20 offen offset:3072 sc1 lds
s_add_u32 s20, s20, s23
s_add_u32 m0, s22, 81920
buffer_load_dword v2, v11, s[8:11], 0 offen
buffer_load_dwordx4 v8, s[8:11], s20 offen sc1 lds
buffer_load_dwordx4 v8, s[8:11], s20 offen offset:1024 sc1 lds
s_waitcnt vmcnt(28)
s_barrier
ds_read_b128 v[12:15], v6 offset:0
ds_read_b128 v[16:19], v6 offset:256
ds_read_b128 v[20:23], v6 offset:2048
ds_read_b128 v[24:27], v6 offset:2304
ds_read_b128 v[28:31], v6 offset:4096
ds_read_b128 v[32:35], v6 offset:4352
s_waitcnt lgkmcnt(0)
.p2align 3
main_kernel_fj1_lp:
v_mfma_f32_16x16x32_bf16 v[44:47], a[0:3], v[12:15], 0
ds_read_b128 v[36:39], v6 offset:6144
v_mfma_f32_16x16x32_bf16 v[52:55], a[0:3], v[16:19], 0
ds_read_b128 v[40:43], v6 offset:6400
v_cvt_pk_bf16_f32 v84, v60, v61
v_mfma_f32_16x16x32_bf16 v[56:59], a[4:7], v[16:19], 0
v_add_u32 v63, s64, v63
v_mfma_f32_16x16x32_bf16 v[48:51], a[4:7], v[12:15], 0
s_waitcnt lgkmcnt(4)
v_cvt_pk_bf16_f32 v85, v62, s65
v_mfma_f32_16x16x32_bf16 v[44:47], a[8:11], v[20:23], v[44:47]
ds_read_b128 v[12:15], v6 offset:8192
v_bfi_b32 v85, s66, v63, v85
v_mfma_f32_16x16x32_bf16 v[52:55], a[8:11], v[24:27], v[52:55]
ds_read_b128 v[16:19], v6 offset:8448
v_cvt_pk_bf16_f32 v86, v64, v65
v_mfma_f32_16x16x32_bf16 v[56:59], a[12:15], v[24:27], v[56:59]
buffer_load_dwordx4 v8, s[8:11], s20 offen offset:2048 sc1 lds
v_add_u32 v67, s64, v67
v_mfma_f32_16x16x32_bf16 v[48:51], a[12:15], v[20:23], v[48:51]
s_waitcnt lgkmcnt(4)
v_cvt_pk_bf16_f32 v87, v66, s65
v_mfma_f32_16x16x32_bf16 v[44:47], a[16:19], v[28:31], v[44:47]
buffer_load_dwordx2 v[124:125], v118, s[8:11], s42 offen offset:0 sc1
ds_read_b128 v[20:23], v6 offset:10240
v_mfma_f32_16x16x32_bf16 v[52:55], a[16:19], v[32:35], v[52:55]
ds_read_b128 v[24:27], v6 offset:10496
v_bfi_b32 v87, s66, v67, v87
v_mfma_f32_16x16x32_bf16 v[56:59], a[20:23], v[32:35], v[56:59]
buffer_store_dwordx4 v[84:87], v116, s[8:11], s41 offen sc1
v_cvt_pk_bf16_f32 v88, v68, v69
v_mfma_f32_16x16x32_bf16 v[48:51], a[20:23], v[28:31], v[48:51]
s_waitcnt lgkmcnt(4)
v_add_u32 v71, s64, v71
v_mfma_f32_16x16x32_bf16 v[44:47], a[24:27], v[36:39], v[44:47]
buffer_load_dwordx2 v[126:127], v118, s[8:11], s42 offen offset:2048 sc1
ds_read_b128 v[28:31], v6 offset:12288
v_mfma_f32_16x16x32_bf16 v[52:55], a[24:27], v[40:43], v[52:55]
ds_read_b128 v[32:35], v6 offset:12544
v_cvt_pk_bf16_f32 v89, v70, s65
v_mfma_f32_16x16x32_bf16 v[56:59], a[28:31], v[40:43], v[56:59]
buffer_load_dwordx4 v8, s[8:11], s20 offen offset:3072 sc1 lds
v_bfi_b32 v89, s66, v71, v89
v_mfma_f32_16x16x32_bf16 v[48:51], a[28:31], v[36:39], v[48:51]
s_waitcnt lgkmcnt(4)
s_add_u32 s20, s20, s23
s_add_u32 m0, s22, 98304
v_mfma_f32_16x16x32_bf16 v[44:47], a[32:35], v[12:15], v[44:47]
s_waitcnt vmcnt(18)
s_barrier
ds_read_b128 v[36:39], v6 offset:16384
v_mfma_f32_16x16x32_bf16 v[52:55], a[32:35], v[16:19], v[52:55]
s_waitcnt vmcnt(21)
ds_read_b128 v[40:43], v6 offset:16640
v_cvt_pk_bf16_f32 v90, v72, v73
v_mfma_f32_16x16x32_bf16 v[56:59], a[36:39], v[16:19], v[56:59]
buffer_load_dwordx4 v8, s[8:11], s20 offen sc1 lds
v_add_u32 v75, s64, v75
v_mfma_f32_16x16x32_bf16 v[48:51], a[36:39], v[12:15], v[48:51]
s_waitcnt lgkmcnt(4)
v_cvt_pk_bf16_f32 v91, v74, s65
v_mfma_f32_16x16x32_bf16 v[44:47], a[40:43], v[20:23], v[44:47]
buffer_load_dwordx2 v[128:129], v119, s[8:11], s42 offen offset:0 sc1
ds_read_b128 v[12:15], v6 offset:18432
v_mfma_f32_16x16x32_bf16 v[52:55], a[40:43], v[24:27], v[52:55]
ds_read_b128 v[16:19], v6 offset:18688
v_bfi_b32 v91, s66, v75, v91
v_mfma_f32_16x16x32_bf16 v[56:59], a[44:47], v[24:27], v[56:59]
buffer_store_dwordx4 v[88:91], v117, s[8:11], s41 offen sc1
v_bitop3_b32 v162, v133, v135, s59 bitop3:0x7e
v_mfma_f32_16x16x32_bf16 v[48:51], a[44:47], v[20:23], v[48:51]
s_waitcnt lgkmcnt(4)
v_bitop3_b32 v163, v137, v139, s59 bitop3:0x7e
v_mfma_f32_16x16x32_bf16 v[44:47], a[48:51], v[28:31], v[44:47]
buffer_load_dwordx2 v[130:131], v119, s[8:11], s42 offen offset:2048 sc1
ds_read_b128 v[20:23], v6 offset:20480
v_mfma_f32_16x16x32_bf16 v[52:55], a[48:51], v[32:35], v[52:55]
ds_read_b128 v[24:27], v6 offset:20736
v_or_b32 v162, v162, v163
v_mfma_f32_16x16x32_bf16 v[56:59], a[52:55], v[32:35], v[56:59]
buffer_load_dwordx4 v8, s[8:11], s20 offen offset:1024 sc1 lds
v_and_b32 v162, 0x10000, v162
v_mfma_f32_16x16x32_bf16 v[48:51], a[52:55], v[28:31], v[48:51]
s_waitcnt lgkmcnt(4)
v_cmp_ne_u32 vcc, 0, v162
v_mfma_f32_16x16x32_bf16 v[44:47], a[56:59], v[36:39], v[44:47]
ds_read_b128 v[28:31], v6 offset:22528
v_mfma_f32_16x16x32_bf16 v[52:55], a[56:59], v[40:43], v[52:55]
ds_read_b128 v[32:35], v6 offset:22784
v_mfma_f32_16x16x32_bf16 v[56:59], a[60:63], v[40:43], v[56:59]
s_cbranch_vccnz main_kernel_fj1_c0
main_kernel_fj1_k0:
v_mfma_f32_16x16x32_bf16 v[48:51], a[60:63], v[36:39], v[48:51]
s_waitcnt lgkmcnt(4)
v_lshlrev_b32 v144, 16, v132
v_mfma_f32_16x16x32_bf16 v[44:47], a[64:67], v[12:15], v[44:47]
ds_read_b128 v[36:39], v6 offset:24576
v_and_b32 v145, 0xffff0000, v132
v_mfma_f32_16x16x32_bf16 v[52:55], a[64:67], v[16:19], v[52:55]
ds_read_b128 v[40:43], v6 offset:24832
v_lshlrev_b32 v146, 16, v133
v_mfma_f32_16x16x32_bf16 v[56:59], a[68:71], v[16:19], v[56:59]
buffer_load_dwordx4 v8, s[8:11], s20 offen offset:2048 sc1 lds
v_and_b32 v147, 0xffff0000, v133
v_mfma_f32_16x16x32_bf16 v[48:51], a[68:71], v[12:15], v[48:51]
s_waitcnt lgkmcnt(4)
v_add_f32 v140, v148, v144
v_mfma_f32_16x16x32_bf16 v[44:47], a[72:75], v[20:23], v[44:47]
ds_read_b128 v[12:15], v6 offset:26624
v_add_f32 v141, v149, v145
v_mfma_f32_16x16x32_bf16 v[52:55], a[72:75], v[24:27], v[52:55]
ds_read_b128 v[16:19], v6 offset:26880
v_add_f32 v142, v150, v146
v_mfma_f32_16x16x32_bf16 v[56:59], a[76:79], v[24:27], v[56:59]
v_add_f32 v143, v151, v147
v_mfma_f32_16x16x32_bf16 v[48:51], a[76:79], v[20:23], v[48:51]
s_waitcnt lgkmcnt(4)
v_lshlrev_b32 v144, 16, v134
v_mfma_f32_16x16x32_bf16 v[44:47], a[80:83], v[28:31], v[44:47]
ds_read_b128 v[20:23], v6 offset:28672
v_and_b32 v145, 0xffff0000, v134
v_mfma_f32_16x16x32_bf16 v[52:55], a[80:83], v[32:35], v[52:55]
ds_read_b128 v[24:27], v6 offset:28928
v_lshlrev_b32 v146, 16, v135
v_mfma_f32_16x16x32_bf16 v[56:59], a[84:87], v[32:35], v[56:59]
buffer_load_dwordx4 v8, s[8:11], s20 offen offset:3072 sc1 lds
v_and_b32 v147, 0xffff0000, v135
v_mfma_f32_16x16x32_bf16 v[48:51], a[84:87], v[28:31], v[48:51]
s_waitcnt lgkmcnt(4)
s_add_u32 s20, s20, s23
s_add_u32 m0, s22, 114688
v_mfma_f32_16x16x32_bf16 v[44:47], a[88:91], v[36:39], v[44:47]
ds_read_b128 v[28:31], v6 offset:32768
v_add_f32 v140, v140, v144
v_mfma_f32_16x16x32_bf16 v[52:55], a[88:91], v[40:43], v[52:55]
ds_read_b128 v[32:35], v6 offset:33024
v_add_f32 v141, v141, v145
v_mfma_f32_16x16x32_bf16 v[56:59], a[92:95], v[40:43], v[56:59]
buffer_load_dwordx4 v8, s[8:11], s20 offen sc1 lds
v_add_f32 v142, v142, v146
v_mfma_f32_16x16x32_bf16 v[48:51], a[92:95], v[36:39], v[48:51]
s_waitcnt lgkmcnt(4)
v_add_f32 v143, v143, v147
s_add_u32 s38, s36, 1
v_mfma_f32_16x16x32_bf16 v[44:47], a[96:99], v[12:15], v[44:47]
s_min_u32 s38, s38, s37
ds_read_b128 v[36:39], v6 offset:34816
v_lshlrev_b32 v144, 16, v136
v_mfma_f32_16x16x32_bf16 v[52:55], a[96:99], v[16:19], v[52:55]
ds_read_b128 v[40:43], v6 offset:35072
v_and_b32 v145, 0xffff0000, v136
v_mfma_f32_16x16x32_bf16 v[56:59], a[100:103], v[16:19], v[56:59]
v_lshlrev_b32 v146, 16, v137
v_mfma_f32_16x16x32_bf16 v[48:51], a[100:103], v[12:15], v[48:51]
s_waitcnt lgkmcnt(4)
v_and_b32 v147, 0xffff0000, v137
v_mfma_f32_16x16x32_bf16 v[44:47], a[104:107], v[20:23], v[44:47]
ds_read_b128 v[12:15], v6 offset:36864
v_add_f32 v140, v140, v144
v_mfma_f32_16x16x32_bf16 v[52:55], a[104:107], v[24:27], v[52:55]
ds_read_b128 v[16:19], v6 offset:37120
v_add_f32 v141, v141, v145
v_mfma_f32_16x16x32_bf16 v[56:59], a[108:111], v[24:27], v[56:59]
buffer_load_dwordx4 v8, s[8:11], s20 offen offset:1024 sc1 lds
v_add_f32 v142, v142, v146
v_mfma_f32_16x16x32_bf16 v[48:51], a[108:111], v[20:23], v[48:51]
s_waitcnt lgkmcnt(4)
v_add_f32 v143, v143, v147
v_mfma_f32_16x16x32_bf16 v[44:47], a[112:115], v[28:31], v[44:47]
ds_read_b128 v[20:23], v6 offset:38912
v_lshlrev_b32 v144, 16, v138
v_mfma_f32_16x16x32_bf16 v[52:55], a[112:115], v[32:35], v[52:55]
ds_read_b128 v[24:27], v6 offset:39168
v_and_b32 v145, 0xffff0000, v138
v_mfma_f32_16x16x32_bf16 v[56:59], a[116:119], v[32:35], v[56:59]
s_waitcnt vmcnt(21)
v_cmp_gt_u32 s[62:63], s38, v111
v_mfma_f32_16x16x32_bf16 v[48:51], a[116:119], v[28:31], v[48:51]
s_waitcnt lgkmcnt(4)
v_lshlrev_b32 v146, 16, v139
v_mfma_f32_16x16x32_bf16 v[44:47], a[120:123], v[36:39], v[44:47]
s_and_b64 s[62:63], s[62:63], s[50:51]
ds_read_b128 v[28:31], v6 offset:40960
v_and_b32 v147, 0xffff0000, v139
v_mfma_f32_16x16x32_bf16 v[52:55], a[120:123], v[40:43], v[52:55]
s_mov_b32 s55, s42
ds_read_b128 v[32:35], v6 offset:41216
v_add_f32 v140, v140, v144
v_mfma_f32_16x16x32_bf16 v[56:59], a[124:127], v[40:43], v[56:59]
buffer_load_dwordx4 v8, s[8:11], s20 offen offset:2048 sc1 lds
v_add_f32 v141, v141, v145
v_mfma_f32_16x16x32_bf16 v[48:51], a[124:127], v[36:39], v[48:51]
s_waitcnt lgkmcnt(4)
v_add_f32 v142, v142, v146
s_mov_b32 s42, s41
v_mfma_f32_16x16x32_bf16 v[44:47], a[128:131], v[12:15], v[44:47]
s_mov_b32 s41, s43
ds_read_b128 v[36:39], v6 offset:43008
v_add_f32 v143, v143, v147
v_mfma_f32_16x16x32_bf16 v[52:55], a[128:131], v[16:19], v[52:55]
s_mov_b32 s59, s58
ds_read_b128 v[40:43], v6 offset:43264
v_mul_f32 v144, s40, v140
v_mfma_f32_16x16x32_bf16 v[56:59], a[132:135], v[16:19], v[56:59]
s_cbranch_scc1 main_kernel_fj1_a0
main_kernel_fj1_b0:
s_mov_b32 s58, s57
v_mfma_f32_16x16x32_bf16 v[48:51], a[132:135], v[12:15], v[48:51]
s_waitcnt lgkmcnt(4)
v_exp_f32 v144, v144
v_mfma_f32_16x16x32_bf16 v[44:47], a[136:139], v[20:23], v[44:47]
s_mov_b32 s57, s60
ds_read_b128 v[12:15], v6 offset:45056
v_mul_f32 v145, s40, v141
v_mfma_f32_16x16x32_bf16 v[52:55], a[136:139], v[24:27], v[52:55]
s_add_u32 s43, s43, 32768
ds_read_b128 v[16:19], v6 offset:45312
v_mul_f32 v146, s40, v142
v_mfma_f32_16x16x32_bf16 v[56:59], a[140:143], v[24:27], v[56:59]
buffer_load_dwordx4 v8, s[8:11], s20 offen offset:3072 sc1 lds
v_mul_f32 v147, s40, v143
v_mfma_f32_16x16x32_bf16 v[48:51], a[140:143], v[20:23], v[48:51]
s_waitcnt lgkmcnt(4)
s_add_u32 s20, s20, s28
s_add_u32 m0, s22, 0
v_mfma_f32_16x16x32_bf16 v[44:47], a[144:147], v[28:31], v[44:47]
s_waitcnt vmcnt(19)
s_barrier
ds_read_b128 v[20:23], v6 offset:49152
v_mfma_f32_16x16x32_bf16 v[52:55], a[144:147], v[32:35], v[52:55]
s_cmp_lt_u32 s36, s37
ds_read_b128 v[24:27], v6 offset:49408
s_cselect_b32 s20, s20, 0x40000000
v_mfma_f32_16x16x32_bf16 v[56:59], a[148:151], v[32:35], v[56:59]
buffer_load_dwordx4 v8, s[8:11], s20 offen sc1 lds
v_add_f32 v144, 1.0, v144
v_mfma_f32_16x16x32_bf16 v[48:51], a[148:151], v[28:31], v[48:51]
s_waitcnt lgkmcnt(4)
v_exp_f32 v145, v145
v_mfma_f32_16x16x32_bf16 v[44:47], a[152:155], v[36:39], v[44:47]
buffer_load_dword v111, v109, s[8:11], 0 offen sc1
ds_read_b128 v[28:31], v6 offset:51200
v_mfma_f32_16x16x32_bf16 v[52:55], a[152:155], v[40:43], v[52:55]
s_waitcnt vmcnt(45)
ds_read_b128 v[32:35], v6 offset:51456
v_add_f32 v145, 1.0, v145
v_mfma_f32_16x16x32_bf16 v[56:59], a[156:159], v[40:43], v[56:59]
s_ashr_i32 s26, s39, 1
s_max_i32 s26, s26, 0
v_mov_b32 v112, s26
v_mfma_f32_16x16x32_bf16 v[48:51], a[156:159], v[36:39], v[48:51]
s_waitcnt lgkmcnt(4)
v_exp_f32 v146, v146
v_mfma_f32_16x16x32_bf16 v[44:47], a[160:163], v[12:15], v[44:47]
buffer_store_dword v112, v108, s[8:11], 0 offen sc1
ds_read_b128 v[36:39], v6 offset:53248
v_mfma_f32_16x16x32_bf16 v[52:55], a[160:163], v[16:19], v[52:55]
s_add_u32 s36, s36, 1
ds_read_b128 v[40:43], v6 offset:53504
v_add_f32 v146, 1.0, v146
v_mfma_f32_16x16x32_bf16 v[56:59], a[164:167], v[16:19], v[56:59]
buffer_load_dwordx4 v8, s[8:11], s20 offen offset:1024 sc1 lds
s_sub_u32 s27, s43, s44
v_mfma_f32_16x16x32_bf16 v[48:51], a[164:167], v[12:15], v[48:51]
s_waitcnt lgkmcnt(4)
v_exp_f32 v147, v147
v_mfma_f32_16x16x32_bf16 v[44:47], a[168:171], v[20:23], v[44:47]
s_cmp_eq_u32 s27, 229376
ds_read_b128 v[12:15], v6 offset:55296
v_add_f32 v147, 1.0, v147
v_mfma_f32_16x16x32_bf16 v[52:55], a[168:171], v[24:27], v[52:55]
s_cselect_b32 s43, s44, s43
ds_read_b128 v[16:19], v6 offset:55552
s_cselect_b32 s27, 0x10000, 0
v_mfma_f32_16x16x32_bf16 v[56:59], a[172:175], v[24:27], v[56:59]
s_xor_b32 s60, s60, s27
v_rcp_f32 v144, v144
v_mfma_f32_16x16x32_bf16 v[48:51], a[172:175], v[20:23], v[48:51]
s_waitcnt lgkmcnt(4)
v_rcp_f32 v145, v145
v_mfma_f32_16x16x32_bf16 v[44:47], a[176:179], v[28:31], v[44:47]
s_sub_u32 s64, 0x10000, s57
ds_read_b128 v[20:23], v6 offset:57344
v_mul_f32 v140, v140, v144
v_mfma_f32_16x16x32_bf16 v[52:55], a[176:179], v[32:35], v[52:55]
s_add_u32 s65, s57, 0x3f800000
ds_read_b128 v[24:27], v6 offset:57600
v_mul_f32 v141, v141, v145
v_mfma_f32_16x16x32_bf16 v[56:59], a[180:183], v[32:35], v[56:59]
buffer_load_dwordx4 v8, s[8:11], s20 offen offset:2048 sc1 lds
v_cvt_pk_bf16_f32 v160, v140, v141
v_mfma_f32_16x16x32_bf16 v[48:51], a[180:183], v[28:31], v[48:51]
s_waitcnt lgkmcnt(4)
v_rcp_f32 v146, v146
v_mfma_f32_16x16x32_bf16 v[44:47], a[184:187], v[36:39], v[44:47]
ds_read_b128 v[28:31], v6 offset:59392
v_mul_f32 v142, v142, v146
v_mfma_f32_16x16x32_bf16 v[52:55], a[184:187], v[40:43], v[52:55]
ds_read_b128 v[32:35], v6 offset:59648
v_mfma_f32_16x16x32_bf16 v[56:59], a[188:191], v[40:43], v[56:59]
v_rcp_f32 v147, v147
v_mfma_f32_16x16x32_bf16 v[48:51], a[188:191], v[36:39], v[48:51]
s_waitcnt lgkmcnt(4)
v_mul_f32 v143, v143, v147
v_mfma_f32_16x16x32_bf16 v[44:47], a[192:195], v[12:15], v[44:47]
ds_read_b128 v[36:39], v6 offset:61440
v_cvt_pk_bf16_f32 v161, v142, v143
v_mfma_f32_16x16x32_bf16 v[52:55], a[192:195], v[16:19], v[52:55]
ds_read_b128 v[40:43], v6 offset:61696
v_mfma_f32_16x16x32_bf16 v[56:59], a[196:199], v[16:19], v[56:59]
buffer_load_dwordx4 v8, s[8:11], s20 offen offset:3072 sc1 lds
v_mfma_f32_16x16x32_bf16 v[48:51], a[196:199], v[12:15], v[48:51]
s_waitcnt lgkmcnt(4)
s_add_u32 s20, s20, s23
s_add_u32 m0, s22, 16384
v_mfma_f32_16x16x32_bf16 v[44:47], a[200:203], v[20:23], v[44:47]
buffer_store_dwordx2 v[160:161], v121, s[8:11], s56 offen sc1
ds_read_b128 v[12:15], v7 offset:0
v_mfma_f32_16x16x32_bf16 v[52:55], a[200:203], v[24:27], v[52:55]
s_mov_b32 s56, s47
ds_read_b128 v[16:19], v7 offset:256
s_mov_b32 s47, s46
v_mfma_f32_16x16x32_bf16 v[56:59], a[204:207], v[24:27], v[56:59]
s_mov_b32 s46, s45
buffer_load_dwordx4 v8, s[8:11], s20 offen sc1 lds
v_mfma_f32_16x16x32_bf16 v[48:51], a[204:207], v[20:23], v[48:51]
s_waitcnt lgkmcnt(4)
s_add_u32 s45, s45, 65536
s_add_u32 s39, s39, 1
v_mfma_f32_16x16x32_bf16 v[44:47], a[208:211], v[28:31], v[44:47]
ds_read_b128 v[20:23], v7 offset:2048
v_mfma_f32_16x16x32_bf16 v[52:55], a[208:211], v[32:35], v[52:55]
ds_read_b128 v[24:27], v7 offset:2304
v_mfma_f32_16x16x32_bf16 v[56:59], a[212:215], v[32:35], v[56:59]
v_mfma_f32_16x16x32_bf16 v[48:51], a[212:215], v[28:31], v[48:51]
s_waitcnt lgkmcnt(4)
v_mfma_f32_16x16x32_bf16 v[44:47], a[216:219], v[36:39], v[44:47]
ds_read_b128 v[28:31], v7 offset:4096
v_mfma_f32_16x16x32_bf16 v[52:55], a[216:219], v[40:43], v[52:55]
ds_read_b128 v[32:35], v7 offset:4352
v_mfma_f32_16x16x32_bf16 v[56:59], a[220:223], v[40:43], v[56:59]
buffer_load_dwordx4 v8, s[8:11], s20 offen offset:1024 sc1 lds
v_mfma_f32_16x16x32_bf16 v[48:51], a[220:223], v[36:39], v[48:51]
s_waitcnt lgkmcnt(4)
v_mfma_f32_16x16x32_bf16 v[60:63], a[0:3], v[12:15], 0
ds_read_b128 v[36:39], v7 offset:6144
v_mfma_f32_16x16x32_bf16 v[68:71], a[0:3], v[16:19], 0
ds_read_b128 v[40:43], v7 offset:6400
v_cvt_pk_bf16_f32 v84, v44, v45
v_mfma_f32_16x16x32_bf16 v[72:75], a[4:7], v[16:19], 0
v_add_u32 v47, s64, v47
v_mfma_f32_16x16x32_bf16 v[64:67], a[4:7], v[12:15], 0
s_waitcnt lgkmcnt(4)
v_cvt_pk_bf16_f32 v85, v46, s65
v_mfma_f32_16x16x32_bf16 v[60:63], a[8:11], v[20:23], v[60:63]
ds_read_b128 v[12:15], v7 offset:8192
v_bfi_b32 v85, s66, v47, v85
v_mfma_f32_16x16x32_bf16 v[68:71], a[8:11], v[24:27], v[68:71]
ds_read_b128 v[16:19], v7 offset:8448
v_cvt_pk_bf16_f32 v86, v48, v49
v_mfma_f32_16x16x32_bf16 v[72:75], a[12:15], v[24:27], v[72:75]
buffer_load_dwordx4 v8, s[8:11], s20 offen offset:2048 sc1 lds
v_add_u32 v51, s64, v51
v_mfma_f32_16x16x32_bf16 v[64:67], a[12:15], v[20:23], v[64:67]
s_waitcnt lgkmcnt(4)
v_cvt_pk_bf16_f32 v87, v50, s65
v_mfma_f32_16x16x32_bf16 v[60:63], a[16:19], v[28:31], v[60:63]
buffer_load_dwordx2 v[132:133], v118, s[8:11], s42 offen offset:0 sc1
ds_read_b128 v[20:23], v7 offset:10240
v_mfma_f32_16x16x32_bf16 v[68:71], a[16:19], v[32:35], v[68:71]
ds_read_b128 v[24:27], v7 offset:10496
v_bfi_b32 v87, s66, v51, v87
v_mfma_f32_16x16x32_bf16 v[72:75], a[20:23], v[32:35], v[72:75]
buffer_store_dwordx4 v[84:87], v116, s[8:11], s41 offen sc1
v_cvt_pk_bf16_f32 v88, v52, v53
v_mfma_f32_16x16x32_bf16 v[64:67], a[20:23], v[28:31], v[64:67]
s_waitcnt lgkmcnt(4)
v_add_u32 v55, s64, v55
v_mfma_f32_16x16x32_bf16 v[60:63], a[24:27], v[36:39], v[60:63]
buffer_load_dwordx2 v[134:135], v118, s[8:11], s42 offen offset:2048 sc1
ds_read_b128 v[28:31], v7 offset:12288
v_mfma_f32_16x16x32_bf16 v[68:71], a[24:27], v[40:43], v[68:71]
ds_read_b128 v[32:35], v7 offset:12544
v_cvt_pk_bf16_f32 v89, v54, s65
v_mfma_f32_16x16x32_bf16 v[72:75], a[28:31], v[40:43], v[72:75]
buffer_load_dwordx4 v8, s[8:11], s20 offen offset:3072 sc1 lds
v_bfi_b32 v89, s66, v55, v89
v_mfma_f32_16x16x32_bf16 v[64:67], a[28:31], v[36:39], v[64:67]
s_waitcnt lgkmcnt(4)
s_add_u32 s20, s20, s23
s_add_u32 m0, s22, 32768
v_mfma_f32_16x16x32_bf16 v[60:63], a[32:35], v[12:15], v[60:63]
s_waitcnt vmcnt(18)
s_barrier
ds_read_b128 v[36:39], v7 offset:16384
v_mfma_f32_16x16x32_bf16 v[68:71], a[32:35], v[16:19], v[68:71]
s_waitcnt vmcnt(21)
ds_read_b128 v[40:43], v7 offset:16640
v_cvt_pk_bf16_f32 v90, v56, v57
v_mfma_f32_16x16x32_bf16 v[72:75], a[36:39], v[16:19], v[72:75]
buffer_load_dwordx4 v8, s[8:11], s20 offen sc1 lds
v_add_u32 v59, s64, v59
v_mfma_f32_16x16x32_bf16 v[64:67], a[36:39], v[12:15], v[64:67]
s_waitcnt lgkmcnt(4)
v_cvt_pk_bf16_f32 v91, v58, s65
v_mfma_f32_16x16x32_bf16 v[60:63], a[40:43], v[20:23], v[60:63]
buffer_load_dwordx2 v[136:137], v119, s[8:11], s42 offen offset:0 sc1
ds_read_b128 v[12:15], v7 offset:18432
v_mfma_f32_16x16x32_bf16 v[68:71], a[40:43], v[24:27], v[68:71]
ds_read_b128 v[16:19], v7 offset:18688
v_bfi_b32 v91, s66, v59, v91
v_mfma_f32_16x16x32_bf16 v[72:75], a[44:47], v[24:27], v[72:75]
buffer_store_dwordx4 v[88:91], v117, s[8:11], s41 offen sc1
v_bitop3_b32 v162, v125, v127, s59 bitop3:0x7e
v_mfma_f32_16x16x32_bf16 v[64:67], a[44:47], v[20:23], v[64:67]
s_waitcnt lgkmcnt(4)
v_bitop3_b32 v163, v129, v131, s59 bitop3:0x7e
v_mfma_f32_16x16x32_bf16 v[60:63], a[48:51], v[28:31], v[60:63]
buffer_load_dwordx2 v[138:139], v119, s[8:11], s42 offen offset:2048 sc1
ds_read_b128 v[20:23], v7 offset:20480
v_mfma_f32_16x16x32_bf16 v[68:71], a[48:51], v[32:35], v[68:71]
ds_read_b128 v[24:27], v7 offset:20736
v_or_b32 v162, v162, v163
v_mfma_f32_16x16x32_bf16 v[72:75], a[52:55], v[32:35], v[72:75]
buffer_load_dwordx4 v8, s[8:11], s20 offen offset:1024 sc1 lds
v_and_b32 v162, 0x10000, v162
v_mfma_f32_16x16x32_bf16 v[64:67], a[52:55], v[28:31], v[64:67]
s_waitcnt lgkmcnt(4)
v_cmp_ne_u32 vcc, 0, v162
v_mfma_f32_16x16x32_bf16 v[60:63], a[56:59], v[36:39], v[60:63]
ds_read_b128 v[28:31], v7 offset:22528
v_mfma_f32_16x16x32_bf16 v[68:71], a[56:59], v[40:43], v[68:71]
ds_read_b128 v[32:35], v7 offset:22784
v_mfma_f32_16x16x32_bf16 v[72:75], a[60:63], v[40:43], v[72:75]
s_cbranch_vccnz main_kernel_fj1_c1
main_kernel_fj1_k1:
v_mfma_f32_16x16x32_bf16 v[64:67], a[60:63], v[36:39], v[64:67]
s_waitcnt lgkmcnt(4)
v_lshlrev_b32 v144, 16, v124
v_mfma_f32_16x16x32_bf16 v[60:63], a[64:67], v[12:15], v[60:63]
ds_read_b128 v[36:39], v7 offset:24576
v_and_b32 v145, 0xffff0000, v124
v_mfma_f32_16x16x32_bf16 v[68:71], a[64:67], v[16:19], v[68:71]
ds_read_b128 v[40:43], v7 offset:24832
v_lshlrev_b32 v146, 16, v125
v_mfma_f32_16x16x32_bf16 v[72:75], a[68:71], v[16:19], v[72:75]
buffer_load_dwordx4 v8, s[8:11], s20 offen offset:2048 sc1 lds
v_and_b32 v147, 0xffff0000, v125
v_mfma_f32_16x16x32_bf16 v[64:67], a[68:71], v[12:15], v[64:67]
s_waitcnt lgkmcnt(4)
v_add_f32 v140, v148, v144
v_mfma_f32_16x16x32_bf16 v[60:63], a[72:75], v[20:23], v[60:63]
ds_read_b128 v[12:15], v7 offset:26624
v_add_f32 v141, v149, v145
v_mfma_f32_16x16x32_bf16 v[68:71], a[72:75], v[24:27], v[68:71]
ds_read_b128 v[16:19], v7 offset:26880
v_add_f32 v142, v150, v146
v_mfma_f32_16x16x32_bf16 v[72:75], a[76:79], v[24:27], v[72:75]
v_add_f32 v143, v151, v147
v_mfma_f32_16x16x32_bf16 v[64:67], a[76:79], v[20:23], v[64:67]
s_waitcnt lgkmcnt(4)
v_lshlrev_b32 v144, 16, v126
v_mfma_f32_16x16x32_bf16 v[60:63], a[80:83], v[28:31], v[60:63]
ds_read_b128 v[20:23], v7 offset:28672
v_and_b32 v145, 0xffff0000, v126
v_mfma_f32_16x16x32_bf16 v[68:71], a[80:83], v[32:35], v[68:71]
ds_read_b128 v[24:27], v7 offset:28928
v_lshlrev_b32 v146, 16, v127
v_mfma_f32_16x16x32_bf16 v[72:75], a[84:87], v[32:35], v[72:75]
buffer_load_dwordx4 v8, s[8:11], s20 offen offset:3072 sc1 lds
v_and_b32 v147, 0xffff0000, v127
v_mfma_f32_16x16x32_bf16 v[64:67], a[84:87], v[28:31], v[64:67]
s_waitcnt lgkmcnt(4)
s_add_u32 s20, s20, s23
s_add_u32 m0, s22, 49152
v_mfma_f32_16x16x32_bf16 v[60:63], a[88:91], v[36:39], v[60:63]
ds_read_b128 v[28:31], v7 offset:32768
v_add_f32 v140, v140, v144
v_mfma_f32_16x16x32_bf16 v[68:71], a[88:91], v[40:43], v[68:71]
ds_read_b128 v[32:35], v7 offset:33024
v_add_f32 v141, v141, v145
v_mfma_f32_16x16x32_bf16 v[72:75], a[92:95], v[40:43], v[72:75]
buffer_load_dwordx4 v8, s[8:11], s20 offen sc1 lds
v_add_f32 v142, v142, v146
v_mfma_f32_16x16x32_bf16 v[64:67], a[92:95], v[36:39], v[64:67]
s_waitcnt lgkmcnt(4)
v_add_f32 v143, v143, v147
s_add_u32 s38, s36, 1
v_mfma_f32_16x16x32_bf16 v[60:63], a[96:99], v[12:15], v[60:63]
s_min_u32 s38, s38, s37
ds_read_b128 v[36:39], v7 offset:34816
v_lshlrev_b32 v144, 16, v128
v_mfma_f32_16x16x32_bf16 v[68:71], a[96:99], v[16:19], v[68:71]
ds_read_b128 v[40:43], v7 offset:35072
v_and_b32 v145, 0xffff0000, v128
v_mfma_f32_16x16x32_bf16 v[72:75], a[100:103], v[16:19], v[72:75]
v_lshlrev_b32 v146, 16, v129
v_mfma_f32_16x16x32_bf16 v[64:67], a[100:103], v[12:15], v[64:67]
s_waitcnt lgkmcnt(4)
v_and_b32 v147, 0xffff0000, v129
v_mfma_f32_16x16x32_bf16 v[60:63], a[104:107], v[20:23], v[60:63]
ds_read_b128 v[12:15], v7 offset:36864
v_add_f32 v140, v140, v144
v_mfma_f32_16x16x32_bf16 v[68:71], a[104:107], v[24:27], v[68:71]
ds_read_b128 v[16:19], v7 offset:37120
v_add_f32 v141, v141, v145
v_mfma_f32_16x16x32_bf16 v[72:75], a[108:111], v[24:27], v[72:75]
buffer_load_dwordx4 v8, s[8:11], s20 offen offset:1024 sc1 lds
v_add_f32 v142, v142, v146
v_mfma_f32_16x16x32_bf16 v[64:67], a[108:111], v[20:23], v[64:67]
s_waitcnt lgkmcnt(4)
v_add_f32 v143, v143, v147
v_mfma_f32_16x16x32_bf16 v[60:63], a[112:115], v[28:31], v[60:63]
ds_read_b128 v[20:23], v7 offset:38912
v_lshlrev_b32 v144, 16, v130
v_mfma_f32_16x16x32_bf16 v[68:71], a[112:115], v[32:35], v[68:71]
ds_read_b128 v[24:27], v7 offset:39168
v_and_b32 v145, 0xffff0000, v130
v_mfma_f32_16x16x32_bf16 v[72:75], a[116:119], v[32:35], v[72:75]
s_waitcnt vmcnt(21)
v_cmp_gt_u32 s[62:63], s38, v111
v_mfma_f32_16x16x32_bf16 v[64:67], a[116:119], v[28:31], v[64:67]
s_waitcnt lgkmcnt(4)
v_lshlrev_b32 v146, 16, v131
v_mfma_f32_16x16x32_bf16 v[60:63], a[120:123], v[36:39], v[60:63]
s_and_b64 s[62:63], s[62:63], s[50:51]
ds_read_b128 v[28:31], v7 offset:40960
v_and_b32 v147, 0xffff0000, v131
v_mfma_f32_16x16x32_bf16 v[68:71], a[120:123], v[40:43], v[68:71]
s_mov_b32 s55, s42
ds_read_b128 v[32:35], v7 offset:41216
v_add_f32 v140, v140, v144
v_mfma_f32_16x16x32_bf16 v[72:75], a[124:127], v[40:43], v[72:75]
buffer_load_dwordx4 v8, s[8:11], s20 offen offset:2048 sc1 lds
v_add_f32 v141, v141, v145
v_mfma_f32_16x16x32_bf16 v[64:67], a[124:127], v[36:39], v[64:67]
s_waitcnt lgkmcnt(4)
v_add_f32 v142, v142, v146
s_mov_b32 s42, s41
v_mfma_f32_16x16x32_bf16 v[60:63], a[128:131], v[12:15], v[60:63]
s_mov_b32 s41, s43
ds_read_b128 v[36:39], v7 offset:43008
v_add_f32 v143, v143, v147
v_mfma_f32_16x16x32_bf16 v[68:71], a[128:131], v[16:19], v[68:71]
s_mov_b32 s59, s58
ds_read_b128 v[40:43], v7 offset:43264
v_mul_f32 v144, s40, v140
v_mfma_f32_16x16x32_bf16 v[72:75], a[132:135], v[16:19], v[72:75]
s_cbranch_scc1 main_kernel_fj1_a1
main_kernel_fj1_b1:
s_mov_b32 s58, s57
v_mfma_f32_16x16x32_bf16 v[64:67], a[132:135], v[12:15], v[64:67]
s_waitcnt lgkmcnt(4)
v_exp_f32 v144, v144
v_mfma_f32_16x16x32_bf16 v[60:63], a[136:139], v[20:23], v[60:63]
s_mov_b32 s57, s60
ds_read_b128 v[12:15], v7 offset:45056
v_mul_f32 v145, s40, v141
v_mfma_f32_16x16x32_bf16 v[68:71], a[136:139], v[24:27], v[68:71]
s_add_u32 s43, s43, 32768
ds_read_b128 v[16:19], v7 offset:45312
v_mul_f32 v146, s40, v142
v_mfma_f32_16x16x32_bf16 v[72:75], a[140:143], v[24:27], v[72:75]
buffer_load_dwordx4 v8, s[8:11], s20 offen offset:3072 sc1 lds
v_mul_f32 v147, s40, v143
v_mfma_f32_16x16x32_bf16 v[64:67], a[140:143], v[20:23], v[64:67]
s_waitcnt lgkmcnt(4)
s_add_u32 s20, s20, s28
s_add_u32 m0, s22, 65536
v_mfma_f32_16x16x32_bf16 v[60:63], a[144:147], v[28:31], v[60:63]
s_waitcnt vmcnt(19)
s_barrier
ds_read_b128 v[20:23], v7 offset:49152
v_mfma_f32_16x16x32_bf16 v[68:71], a[144:147], v[32:35], v[68:71]
s_cmp_lt_u32 s36, s37
ds_read_b128 v[24:27], v7 offset:49408
s_cselect_b32 s20, s20, 0x40000000
v_mfma_f32_16x16x32_bf16 v[72:75], a[148:151], v[32:35], v[72:75]
buffer_load_dwordx4 v8, s[8:11], s20 offen sc1 lds
v_add_f32 v144, 1.0, v144
v_mfma_f32_16x16x32_bf16 v[64:67], a[148:151], v[28:31], v[64:67]
s_waitcnt lgkmcnt(4)
v_exp_f32 v145, v145
v_mfma_f32_16x16x32_bf16 v[60:63], a[152:155], v[36:39], v[60:63]
buffer_load_dword v111, v109, s[8:11], 0 offen sc1
ds_read_b128 v[28:31], v7 offset:51200
v_mfma_f32_16x16x32_bf16 v[68:71], a[152:155], v[40:43], v[68:71]
s_waitcnt vmcnt(45)
ds_read_b128 v[32:35], v7 offset:51456
v_add_f32 v145, 1.0, v145
v_mfma_f32_16x16x32_bf16 v[72:75], a[156:159], v[40:43], v[72:75]
s_ashr_i32 s26, s39, 1
s_max_i32 s26, s26, 0
v_mov_b32 v112, s26
v_mfma_f32_16x16x32_bf16 v[64:67], a[156:159], v[36:39], v[64:67]
s_waitcnt lgkmcnt(4)
v_exp_f32 v146, v146
v_mfma_f32_16x16x32_bf16 v[60:63], a[160:163], v[12:15], v[60:63]
buffer_store_dword v112, v108, s[8:11], 0 offen sc1
ds_read_b128 v[36:39], v7 offset:53248
v_mfma_f32_16x16x32_bf16 v[68:71], a[160:163], v[16:19], v[68:71]
s_add_u32 s36, s36, 1
ds_read_b128 v[40:43], v7 offset:53504
v_add_f32 v146, 1.0, v146
v_mfma_f32_16x16x32_bf16 v[72:75], a[164:167], v[16:19], v[72:75]
buffer_load_dwordx4 v8, s[8:11], s20 offen offset:1024 sc1 lds
s_sub_u32 s27, s43, s44
v_mfma_f32_16x16x32_bf16 v[64:67], a[164:167], v[12:15], v[64:67]
s_waitcnt lgkmcnt(4)
v_exp_f32 v147, v147
v_mfma_f32_16x16x32_bf16 v[60:63], a[168:171], v[20:23], v[60:63]
s_cmp_eq_u32 s27, 229376
ds_read_b128 v[12:15], v7 offset:55296
v_add_f32 v147, 1.0, v147
v_mfma_f32_16x16x32_bf16 v[68:71], a[168:171], v[24:27], v[68:71]
s_cselect_b32 s43, s44, s43
ds_read_b128 v[16:19], v7 offset:55552
s_cselect_b32 s27, 0x10000, 0
v_mfma_f32_16x16x32_bf16 v[72:75], a[172:175], v[24:27], v[72:75]
s_xor_b32 s60, s60, s27
v_rcp_f32 v144, v144
v_mfma_f32_16x16x32_bf16 v[64:67], a[172:175], v[20:23], v[64:67]
s_waitcnt lgkmcnt(4)
v_rcp_f32 v145, v145
v_mfma_f32_16x16x32_bf16 v[60:63], a[176:179], v[28:31], v[60:63]
s_sub_u32 s64, 0x10000, s57
ds_read_b128 v[20:23], v7 offset:57344
v_mul_f32 v140, v140, v144
v_mfma_f32_16x16x32_bf16 v[68:71], a[176:179], v[32:35], v[68:71]
s_add_u32 s65, s57, 0x3f800000
ds_read_b128 v[24:27], v7 offset:57600
v_mul_f32 v141, v141, v145
v_mfma_f32_16x16x32_bf16 v[72:75], a[180:183], v[32:35], v[72:75]
buffer_load_dwordx4 v8, s[8:11], s20 offen offset:2048 sc1 lds
v_cvt_pk_bf16_f32 v160, v140, v141
v_mfma_f32_16x16x32_bf16 v[64:67], a[180:183], v[28:31], v[64:67]
s_waitcnt lgkmcnt(4)
v_rcp_f32 v146, v146
v_mfma_f32_16x16x32_bf16 v[60:63], a[184:187], v[36:39], v[60:63]
ds_read_b128 v[28:31], v7 offset:59392
v_mul_f32 v142, v142, v146
v_mfma_f32_16x16x32_bf16 v[68:71], a[184:187], v[40:43], v[68:71]
ds_read_b128 v[32:35], v7 offset:59648
v_mfma_f32_16x16x32_bf16 v[72:75], a[188:191], v[40:43], v[72:75]
v_rcp_f32 v147, v147
v_mfma_f32_16x16x32_bf16 v[64:67], a[188:191], v[36:39], v[64:67]
s_waitcnt lgkmcnt(4)
v_mul_f32 v143, v143, v147
v_mfma_f32_16x16x32_bf16 v[60:63], a[192:195], v[12:15], v[60:63]
ds_read_b128 v[36:39], v7 offset:61440
v_cvt_pk_bf16_f32 v161, v142, v143
v_mfma_f32_16x16x32_bf16 v[68:71], a[192:195], v[16:19], v[68:71]
ds_read_b128 v[40:43], v7 offset:61696
v_mfma_f32_16x16x32_bf16 v[72:75], a[196:199], v[16:19], v[72:75]
buffer_load_dwordx4 v8, s[8:11], s20 offen offset:3072 sc1 lds
v_mfma_f32_16x16x32_bf16 v[64:67], a[196:199], v[12:15], v[64:67]
s_waitcnt lgkmcnt(4)
s_add_u32 s20, s20, s23
s_add_u32 m0, s22, 81920
v_mfma_f32_16x16x32_bf16 v[60:63], a[200:203], v[20:23], v[60:63]
buffer_store_dwordx2 v[160:161], v121, s[8:11], s56 offen sc1
ds_read_b128 v[12:15], v6 offset:0
v_mfma_f32_16x16x32_bf16 v[68:71], a[200:203], v[24:27], v[68:71]
s_mov_b32 s56, s47
ds_read_b128 v[16:19], v6 offset:256
s_mov_b32 s47, s46
v_mfma_f32_16x16x32_bf16 v[72:75], a[204:207], v[24:27], v[72:75]
s_mov_b32 s46, s45
buffer_load_dwordx4 v8, s[8:11], s20 offen sc1 lds
v_mfma_f32_16x16x32_bf16 v[64:67], a[204:207], v[20:23], v[64:67]
s_waitcnt lgkmcnt(4)
s_add_u32 s45, s45, 65536
s_add_u32 s39, s39, 1
v_mfma_f32_16x16x32_bf16 v[60:63], a[208:211], v[28:31], v[60:63]
ds_read_b128 v[20:23], v6 offset:2048
v_mfma_f32_16x16x32_bf16 v[68:71], a[208:211], v[32:35], v[68:71]
ds_read_b128 v[24:27], v6 offset:2304
v_mfma_f32_16x16x32_bf16 v[72:75], a[212:215], v[32:35], v[72:75]
v_mfma_f32_16x16x32_bf16 v[64:67], a[212:215], v[28:31], v[64:67]
s_waitcnt lgkmcnt(4)
v_mfma_f32_16x16x32_bf16 v[60:63], a[216:219], v[36:39], v[60:63]
ds_read_b128 v[28:31], v6 offset:4096
v_mfma_f32_16x16x32_bf16 v[68:71], a[216:219], v[40:43], v[68:71]
ds_read_b128 v[32:35], v6 offset:4352
v_mfma_f32_16x16x32_bf16 v[72:75], a[220:223], v[40:43], v[72:75]
s_sub_u32 s24, s24, 1
buffer_load_dwordx4 v8, s[8:11], s20 offen offset:1024 sc1 lds
v_mfma_f32_16x16x32_bf16 v[64:67], a[220:223], v[36:39], v[64:67]
s_waitcnt lgkmcnt(4)
s_cbranch_scc0 main_kernel_fj1_lp
v_mfma_f32_16x16x32_bf16 v[44:47], a[0:3], v[12:15], 0
ds_read_b128 v[36:39], v6 offset:6144
v_mfma_f32_16x16x32_bf16 v[52:55], a[0:3], v[16:19], 0
ds_read_b128 v[40:43], v6 offset:6400
v_cvt_pk_bf16_f32 v84, v60, v61
v_mfma_f32_16x16x32_bf16 v[56:59], a[4:7], v[16:19], 0
v_add_u32 v63, s64, v63
v_mfma_f32_16x16x32_bf16 v[48:51], a[4:7], v[12:15], 0
s_waitcnt lgkmcnt(4)
v_cvt_pk_bf16_f32 v85, v62, s65
v_mfma_f32_16x16x32_bf16 v[44:47], a[8:11], v[20:23], v[44:47]
ds_read_b128 v[12:15], v6 offset:8192
v_bfi_b32 v85, s66, v63, v85
v_mfma_f32_16x16x32_bf16 v[52:55], a[8:11], v[24:27], v[52:55]
ds_read_b128 v[16:19], v6 offset:8448
v_cvt_pk_bf16_f32 v86, v64, v65
v_mfma_f32_16x16x32_bf16 v[56:59], a[12:15], v[24:27], v[56:59]
buffer_load_dwordx4 v8, s[8:11], s20 offen offset:2048 sc1 lds
v_add_u32 v67, s64, v67
v_mfma_f32_16x16x32_bf16 v[48:51], a[12:15], v[20:23], v[48:51]
s_waitcnt lgkmcnt(4)
v_cvt_pk_bf16_f32 v87, v66, s65
v_mfma_f32_16x16x32_bf16 v[44:47], a[16:19], v[28:31], v[44:47]
buffer_load_dwordx2 v[124:125], v118, s[8:11], s42 offen offset:0 sc1
ds_read_b128 v[20:23], v6 offset:10240
v_mfma_f32_16x16x32_bf16 v[52:55], a[16:19], v[32:35], v[52:55]
ds_read_b128 v[24:27], v6 offset:10496
v_bfi_b32 v87, s66, v67, v87
v_mfma_f32_16x16x32_bf16 v[56:59], a[20:23], v[32:35], v[56:59]
buffer_store_dwordx4 v[84:87], v116, s[8:11], s41 offen sc1
v_cvt_pk_bf16_f32 v88, v68, v69
v_mfma_f32_16x16x32_bf16 v[48:51], a[20:23], v[28:31], v[48:51]
s_waitcnt lgkmcnt(4)
v_add_u32 v71, s64, v71
v_mfma_f32_16x16x32_bf16 v[44:47], a[24:27], v[36:39], v[44:47]
buffer_load_dwordx2 v[126:127], v118, s[8:11], s42 offen offset:2048 sc1
ds_read_b128 v[28:31], v6 offset:12288
v_mfma_f32_16x16x32_bf16 v[52:55], a[24:27], v[40:43], v[52:55]
ds_read_b128 v[32:35], v6 offset:12544
v_cvt_pk_bf16_f32 v89, v70, s65
v_mfma_f32_16x16x32_bf16 v[56:59], a[28:31], v[40:43], v[56:59]
buffer_load_dwordx4 v8, s[8:11], s20 offen offset:3072 sc1 lds
v_bfi_b32 v89, s66, v71, v89
v_mfma_f32_16x16x32_bf16 v[48:51], a[28:31], v[36:39], v[48:51]
s_waitcnt lgkmcnt(4)
s_add_u32 s20, s20, s23
s_add_u32 m0, s22, 98304
v_mfma_f32_16x16x32_bf16 v[44:47], a[32:35], v[12:15], v[44:47]
s_waitcnt vmcnt(18)
s_barrier
ds_read_b128 v[36:39], v6 offset:16384
v_mfma_f32_16x16x32_bf16 v[52:55], a[32:35], v[16:19], v[52:55]
s_waitcnt vmcnt(21)
ds_read_b128 v[40:43], v6 offset:16640
v_cvt_pk_bf16_f32 v90, v72, v73
v_mfma_f32_16x16x32_bf16 v[56:59], a[36:39], v[16:19], v[56:59]
buffer_load_dwordx4 v8, s[8:11], s20 offen sc1 lds
v_add_u32 v75, s64, v75
v_mfma_f32_16x16x32_bf16 v[48:51], a[36:39], v[12:15], v[48:51]
s_waitcnt lgkmcnt(4)
v_cvt_pk_bf16_f32 v91, v74, s65
v_mfma_f32_16x16x32_bf16 v[44:47], a[40:43], v[20:23], v[44:47]
buffer_load_dwordx2 v[128:129], v119, s[8:11], s42 offen offset:0 sc1
ds_read_b128 v[12:15], v6 offset:18432
v_mfma_f32_16x16x32_bf16 v[52:55], a[40:43], v[24:27], v[52:55]
ds_read_b128 v[16:19], v6 offset:18688
v_bfi_b32 v91, s66, v75, v91
v_mfma_f32_16x16x32_bf16 v[56:59], a[44:47], v[24:27], v[56:59]
buffer_store_dwordx4 v[88:91], v117, s[8:11], s41 offen sc1
v_bitop3_b32 v162, v133, v135, s59 bitop3:0x7e
v_mfma_f32_16x16x32_bf16 v[48:51], a[44:47], v[20:23], v[48:51]
s_waitcnt lgkmcnt(4)
v_bitop3_b32 v163, v137, v139, s59 bitop3:0x7e
v_mfma_f32_16x16x32_bf16 v[44:47], a[48:51], v[28:31], v[44:47]
buffer_load_dwordx2 v[130:131], v119, s[8:11], s42 offen offset:2048 sc1
ds_read_b128 v[20:23], v6 offset:20480
v_mfma_f32_16x16x32_bf16 v[52:55], a[48:51], v[32:35], v[52:55]
ds_read_b128 v[24:27], v6 offset:20736
v_or_b32 v162, v162, v163
v_mfma_f32_16x16x32_bf16 v[56:59], a[52:55], v[32:35], v[56:59]
buffer_load_dwordx4 v8, s[8:11], s20 offen offset:1024 sc1 lds
v_and_b32 v162, 0x10000, v162
v_mfma_f32_16x16x32_bf16 v[48:51], a[52:55], v[28:31], v[48:51]
s_waitcnt lgkmcnt(4)
v_cmp_ne_u32 vcc, 0, v162
v_mfma_f32_16x16x32_bf16 v[44:47], a[56:59], v[36:39], v[44:47]
ds_read_b128 v[28:31], v6 offset:22528
v_mfma_f32_16x16x32_bf16 v[52:55], a[56:59], v[40:43], v[52:55]
ds_read_b128 v[32:35], v6 offset:22784
v_mfma_f32_16x16x32_bf16 v[56:59], a[60:63], v[40:43], v[56:59]
s_cbranch_vccnz main_kernel_fj1_zc0
main_kernel_fj1_zk0:
v_mfma_f32_16x16x32_bf16 v[48:51], a[60:63], v[36:39], v[48:51]
s_waitcnt lgkmcnt(4)
v_lshlrev_b32 v144, 16, v132
v_mfma_f32_16x16x32_bf16 v[44:47], a[64:67], v[12:15], v[44:47]
ds_read_b128 v[36:39], v6 offset:24576
v_and_b32 v145, 0xffff0000, v132
v_mfma_f32_16x16x32_bf16 v[52:55], a[64:67], v[16:19], v[52:55]
ds_read_b128 v[40:43], v6 offset:24832
v_lshlrev_b32 v146, 16, v133
v_mfma_f32_16x16x32_bf16 v[56:59], a[68:71], v[16:19], v[56:59]
buffer_load_dwordx4 v8, s[8:11], s20 offen offset:2048 sc1 lds
v_and_b32 v147, 0xffff0000, v133
v_mfma_f32_16x16x32_bf16 v[48:51], a[68:71], v[12:15], v[48:51]
s_waitcnt lgkmcnt(4)
v_add_f32 v140, v148, v144
v_mfma_f32_16x16x32_bf16 v[44:47], a[72:75], v[20:23], v[44:47]
ds_read_b128 v[12:15], v6 offset:26624
v_add_f32 v141, v149, v145
v_mfma_f32_16x16x32_bf16 v[52:55], a[72:75], v[24:27], v[52:55]
ds_read_b128 v[16:19], v6 offset:26880
v_add_f32 v142, v150, v146
v_mfma_f32_16x16x32_bf16 v[56:59], a[76:79], v[24:27], v[56:59]
v_add_f32 v143, v151, v147
v_mfma_f32_16x16x32_bf16 v[48:51], a[76:79], v[20:23], v[48:51]
s_waitcnt lgkmcnt(4)
v_lshlrev_b32 v144, 16, v134
v_mfma_f32_16x16x32_bf16 v[44:47], a[80:83], v[28:31], v[44:47]
ds_read_b128 v[20:23], v6 offset:28672
v_and_b32 v145, 0xffff0000, v134
v_mfma_f32_16x16x32_bf16 v[52:55], a[80:83], v[32:35], v[52:55]
ds_read_b128 v[24:27], v6 offset:28928
v_lshlrev_b32 v146, 16, v135
v_mfma_f32_16x16x32_bf16 v[56:59], a[84:87], v[32:35], v[56:59]
buffer_load_dwordx4 v8, s[8:11], s20 offen offset:3072 sc1 lds
v_and_b32 v147, 0xffff0000, v135
v_mfma_f32_16x16x32_bf16 v[48:51], a[84:87], v[28:31], v[48:51]
s_waitcnt lgkmcnt(4)
s_add_u32 s20, s20, s23
s_add_u32 m0, s22, 114688
v_mfma_f32_16x16x32_bf16 v[44:47], a[88:91], v[36:39], v[44:47]
ds_read_b128 v[28:31], v6 offset:32768
v_add_f32 v140, v140, v144
v_mfma_f32_16x16x32_bf16 v[52:55], a[88:91], v[40:43], v[52:55]
ds_read_b128 v[32:35], v6 offset:33024
v_add_f32 v141, v141, v145
v_mfma_f32_16x16x32_bf16 v[56:59], a[92:95], v[40:43], v[56:59]
buffer_load_dwordx4 v8, s[8:11], s20 offen sc1 lds
v_add_f32 v142, v142, v146
v_mfma_f32_16x16x32_bf16 v[48:51], a[92:95], v[36:39], v[48:51]
s_waitcnt lgkmcnt(4)
v_add_f32 v143, v143, v147
s_add_u32 s38, s36, 1
v_mfma_f32_16x16x32_bf16 v[44:47], a[96:99], v[12:15], v[44:47]
s_min_u32 s38, s38, s37
ds_read_b128 v[36:39], v6 offset:34816
v_lshlrev_b32 v144, 16, v136
v_mfma_f32_16x16x32_bf16 v[52:55], a[96:99], v[16:19], v[52:55]
ds_read_b128 v[40:43], v6 offset:35072
v_and_b32 v145, 0xffff0000, v136
v_mfma_f32_16x16x32_bf16 v[56:59], a[100:103], v[16:19], v[56:59]
v_lshlrev_b32 v146, 16, v137
v_mfma_f32_16x16x32_bf16 v[48:51], a[100:103], v[12:15], v[48:51]
s_waitcnt lgkmcnt(4)
v_and_b32 v147, 0xffff0000, v137
v_mfma_f32_16x16x32_bf16 v[44:47], a[104:107], v[20:23], v[44:47]
ds_read_b128 v[12:15], v6 offset:36864
v_add_f32 v140, v140, v144
v_mfma_f32_16x16x32_bf16 v[52:55], a[104:107], v[24:27], v[52:55]
ds_read_b128 v[16:19], v6 offset:37120
v_add_f32 v141, v141, v145
v_mfma_f32_16x16x32_bf16 v[56:59], a[108:111], v[24:27], v[56:59]
buffer_load_dwordx4 v8, s[8:11], s20 offen offset:1024 sc1 lds
v_add_f32 v142, v142, v146
v_mfma_f32_16x16x32_bf16 v[48:51], a[108:111], v[20:23], v[48:51]
s_waitcnt lgkmcnt(4)
v_add_f32 v143, v143, v147
v_mfma_f32_16x16x32_bf16 v[44:47], a[112:115], v[28:31], v[44:47]
ds_read_b128 v[20:23], v6 offset:38912
v_lshlrev_b32 v144, 16, v138
v_mfma_f32_16x16x32_bf16 v[52:55], a[112:115], v[32:35], v[52:55]
ds_read_b128 v[24:27], v6 offset:39168
v_and_b32 v145, 0xffff0000, v138
v_mfma_f32_16x16x32_bf16 v[56:59], a[116:119], v[32:35], v[56:59]
s_waitcnt vmcnt(21)
v_cmp_gt_u32 s[62:63], s38, v111
v_mfma_f32_16x16x32_bf16 v[48:51], a[116:119], v[28:31], v[48:51]
s_waitcnt lgkmcnt(4)
v_lshlrev_b32 v146, 16, v139
v_mfma_f32_16x16x32_bf16 v[44:47], a[120:123], v[36:39], v[44:47]
s_and_b64 s[62:63], s[62:63], s[50:51]
ds_read_b128 v[28:31], v6 offset:40960
v_and_b32 v147, 0xffff0000, v139
v_mfma_f32_16x16x32_bf16 v[52:55], a[120:123], v[40:43], v[52:55]
s_mov_b32 s55, s42
ds_read_b128 v[32:35], v6 offset:41216
v_add_f32 v140, v140, v144
v_mfma_f32_16x16x32_bf16 v[56:59], a[124:127], v[40:43], v[56:59]
buffer_load_dwordx4 v8, s[8:11], s20 offen offset:2048 sc1 lds
v_add_f32 v141, v141, v145
v_mfma_f32_16x16x32_bf16 v[48:51], a[124:127], v[36:39], v[48:51]
s_waitcnt lgkmcnt(4)
v_add_f32 v142, v142, v146
s_mov_b32 s42, s41
v_mfma_f32_16x16x32_bf16 v[44:47], a[128:131], v[12:15], v[44:47]
s_mov_b32 s41, s43
ds_read_b128 v[36:39], v6 offset:43008
v_add_f32 v143, v143, v147
v_mfma_f32_16x16x32_bf16 v[52:55], a[128:131], v[16:19], v[52:55]
s_mov_b32 s59, s58
ds_read_b128 v[40:43], v6 offset:43264
v_mul_f32 v144, s40, v140
v_mfma_f32_16x16x32_bf16 v[56:59], a[132:135], v[16:19], v[56:59]
s_cbranch_scc1 main_kernel_fj1_za0
main_kernel_fj1_zb0:
s_mov_b32 s58, s57
v_mfma_f32_16x16x32_bf16 v[48:51], a[132:135], v[12:15], v[48:51]
s_waitcnt lgkmcnt(4)
v_exp_f32 v144, v144
v_mfma_f32_16x16x32_bf16 v[44:47], a[136:139], v[20:23], v[44:47]
s_mov_b32 s57, s60
ds_read_b128 v[12:15], v6 offset:45056
v_mul_f32 v145, s40, v141
v_mfma_f32_16x16x32_bf16 v[52:55], a[136:139], v[24:27], v[52:55]
s_add_u32 s43, s43, 32768
ds_read_b128 v[16:19], v6 offset:45312
v_mul_f32 v146, s40, v142
v_mfma_f32_16x16x32_bf16 v[56:59], a[140:143], v[24:27], v[56:59]
buffer_load_dwordx4 v8, s[8:11], s20 offen offset:3072 sc1 lds
v_mul_f32 v147, s40, v143
v_mfma_f32_16x16x32_bf16 v[48:51], a[140:143], v[20:23], v[48:51]
s_waitcnt lgkmcnt(4)
s_add_u32 s20, s20, s28
s_add_u32 m0, s22, 0
v_mfma_f32_16x16x32_bf16 v[44:47], a[144:147], v[28:31], v[44:47]
s_waitcnt vmcnt(19)
s_barrier
ds_read_b128 v[20:23], v6 offset:49152
v_mfma_f32_16x16x32_bf16 v[52:55], a[144:147], v[32:35], v[52:55]
s_cmp_lt_u32 s36, s37
ds_read_b128 v[24:27], v6 offset:49408
s_cselect_b32 s20, s20, 0x40000000
v_mfma_f32_16x16x32_bf16 v[56:59], a[148:151], v[32:35], v[56:59]
buffer_load_dwordx4 v200, s[12:15], s68 offen nt lds
v_add_f32 v144, 1.0, v144
v_mfma_f32_16x16x32_bf16 v[48:51], a[148:151], v[28:31], v[48:51]
s_waitcnt lgkmcnt(4)
v_exp_f32 v145, v145
v_mfma_f32_16x16x32_bf16 v[44:47], a[152:155], v[36:39], v[44:47]
buffer_load_dword v111, v109, s[8:11], 0 offen sc1
ds_read_b128 v[28:31], v6 offset:51200
v_mfma_f32_16x16x32_bf16 v[52:55], a[152:155], v[40:43], v[52:55]
s_waitcnt vmcnt(45)
ds_read_b128 v[32:35], v6 offset:51456
v_add_f32 v145, 1.0, v145
v_mfma_f32_16x16x32_bf16 v[56:59], a[156:159], v[40:43], v[56:59]
s_ashr_i32 s26, s39, 1
s_max_i32 s26, s26, 0
v_mov_b32 v112, s26
v_mfma_f32_16x16x32_bf16 v[48:51], a[156:159], v[36:39], v[48:51]
s_waitcnt lgkmcnt(4)
v_exp_f32 v146, v146
v_mfma_f32_16x16x32_bf16 v[44:47], a[160:163], v[12:15], v[44:47]
buffer_store_dword v112, v108, s[8:11], 0 offen sc1
ds_read_b128 v[36:39], v6 offset:53248
v_mfma_f32_16x16x32_bf16 v[52:55], a[160:163], v[16:19], v[52:55]
s_add_u32 s36, s36, 1
ds_read_b128 v[40:43], v6 offset:53504
v_add_f32 v146, 1.0, v146
v_mfma_f32_16x16x32_bf16 v[56:59], a[164:167], v[16:19], v[56:59]
buffer_load_dwordx4 v201, s[12:15], s68 offen offset:1024 nt lds
s_sub_u32 s27, s43, s44
v_mfma_f32_16x16x32_bf16 v[48:51], a[164:167], v[12:15], v[48:51]
s_waitcnt lgkmcnt(4)
v_exp_f32 v147, v147
v_mfma_f32_16x16x32_bf16 v[44:47], a[168:171], v[20:23], v[44:47]
s_cmp_eq_u32 s27, 229376
ds_read_b128 v[12:15], v6 offset:55296
v_add_f32 v147, 1.0, v147
v_mfma_f32_16x16x32_bf16 v[52:55], a[168:171], v[24:27], v[52:55]
s_cselect_b32 s43, s44, s43
ds_read_b128 v[16:19], v6 offset:55552
s_cselect_b32 s27, 0x10000, 0
v_mfma_f32_16x16x32_bf16 v[56:59], a[172:175], v[24:27], v[56:59]
s_xor_b32 s60, s60, s27
v_rcp_f32 v144, v144
v_mfma_f32_16x16x32_bf16 v[48:51], a[172:175], v[20:23], v[48:51]
s_waitcnt lgkmcnt(4)
v_rcp_f32 v145, v145
v_mfma_f32_16x16x32_bf16 v[44:47], a[176:179], v[28:31], v[44:47]
s_sub_u32 s64, 0x10000, s57
ds_read_b128 v[20:23], v6 offset:57344
v_mul_f32 v140, v140, v144
v_mfma_f32_16x16x32_bf16 v[52:55], a[176:179], v[32:35], v[52:55]
s_add_u32 s65, s57, 0x3f800000
ds_read_b128 v[24:27], v6 offset:57600
v_mul_f32 v141, v141, v145
v_mfma_f32_16x16x32_bf16 v[56:59], a[180:183], v[32:35], v[56:59]
buffer_load_dwordx4 v202, s[12:15], s68 offen offset:2048 nt lds
v_cvt_pk_bf16_f32 v160, v140, v141
v_mfma_f32_16x16x32_bf16 v[48:51], a[180:183], v[28:31], v[48:51]
s_waitcnt lgkmcnt(4)
v_rcp_f32 v146, v146
v_mfma_f32_16x16x32_bf16 v[44:47], a[184:187], v[36:39], v[44:47]
ds_read_b128 v[28:31], v6 offset:59392
v_mul_f32 v142, v142, v146
v_mfma_f32_16x16x32_bf16 v[52:55], a[184:187], v[40:43], v[52:55]
ds_read_b128 v[32:35], v6 offset:59648
v_mfma_f32_16x16x32_bf16 v[56:59], a[188:191], v[40:43], v[56:59]
v_rcp_f32 v147, v147
v_mfma_f32_16x16x32_bf16 v[48:51], a[188:191], v[36:39], v[48:51]
s_waitcnt lgkmcnt(4)
v_mul_f32 v143, v143, v147
v_mfma_f32_16x16x32_bf16 v[44:47], a[192:195], v[12:15], v[44:47]
ds_read_b128 v[36:39], v6 offset:61440
v_cvt_pk_bf16_f32 v161, v142, v143
v_mfma_f32_16x16x32_bf16 v[52:55], a[192:195], v[16:19], v[52:55]
ds_read_b128 v[40:43], v6 offset:61696
v_mfma_f32_16x16x32_bf16 v[56:59], a[196:199], v[16:19], v[56:59]
buffer_load_dwordx4 v203, s[12:15], s68 offen offset:3072 nt lds
v_mfma_f32_16x16x32_bf16 v[48:51], a[196:199], v[12:15], v[48:51]
s_waitcnt lgkmcnt(4)
s_add_u32 s68, s68, s75
s_add_u32 m0, s22, 16384
v_mfma_f32_16x16x32_bf16 v[44:47], a[200:203], v[20:23], v[44:47]
buffer_store_dwordx2 v[160:161], v121, s[8:11], s56 offen sc1
ds_read_b128 v[12:15], v7 offset:0
v_mfma_f32_16x16x32_bf16 v[52:55], a[200:203], v[24:27], v[52:55]
s_mov_b32 s56, s47
ds_read_b128 v[16:19], v7 offset:256
s_mov_b32 s47, s46
v_mfma_f32_16x16x32_bf16 v[56:59], a[204:207], v[24:27], v[56:59]
s_mov_b32 s46, s45
buffer_load_dwordx4 v200, s[12:15], s68 offen nt lds
v_mfma_f32_16x16x32_bf16 v[48:51], a[204:207], v[20:23], v[48:51]
s_waitcnt lgkmcnt(4)
s_add_u32 s45, s45, 65536
s_add_u32 s39, s39, 1
v_mfma_f32_16x16x32_bf16 v[44:47], a[208:211], v[28:31], v[44:47]
ds_read_b128 v[20:23], v7 offset:2048
v_mfma_f32_16x16x32_bf16 v[52:55], a[208:211], v[32:35], v[52:55]
ds_read_b128 v[24:27], v7 offset:2304
v_mfma_f32_16x16x32_bf16 v[56:59], a[212:215], v[32:35], v[56:59]
v_mfma_f32_16x16x32_bf16 v[48:51], a[212:215], v[28:31], v[48:51]
s_waitcnt lgkmcnt(4)
v_mfma_f32_16x16x32_bf16 v[44:47], a[216:219], v[36:39], v[44:47]
ds_read_b128 v[28:31], v7 offset:4096
v_mfma_f32_16x16x32_bf16 v[52:55], a[216:219], v[40:43], v[52:55]
ds_read_b128 v[32:35], v7 offset:4352
v_mfma_f32_16x16x32_bf16 v[56:59], a[220:223], v[40:43], v[56:59]
buffer_load_dwordx4 v201, s[12:15], s68 offen offset:1024 nt lds
v_mfma_f32_16x16x32_bf16 v[48:51], a[220:223], v[36:39], v[48:51]
s_waitcnt lgkmcnt(4)
v_mfma_f32_16x16x32_bf16 v[60:63], a[0:3], v[12:15], 0
ds_read_b128 v[36:39], v7 offset:6144
v_mfma_f32_16x16x32_bf16 v[68:71], a[0:3], v[16:19], 0
ds_read_b128 v[40:43], v7 offset:6400
v_cvt_pk_bf16_f32 v84, v44, v45
v_mfma_f32_16x16x32_bf16 v[72:75], a[4:7], v[16:19], 0
v_add_u32 v47, s64, v47
v_mfma_f32_16x16x32_bf16 v[64:67], a[4:7], v[12:15], 0
s_waitcnt lgkmcnt(4)
v_cvt_pk_bf16_f32 v85, v46, s65
v_mfma_f32_16x16x32_bf16 v[60:63], a[8:11], v[20:23], v[60:63]
ds_read_b128 v[12:15], v7 offset:8192
v_bfi_b32 v85, s66, v47, v85
v_mfma_f32_16x16x32_bf16 v[68:71], a[8:11], v[24:27], v[68:71]
ds_read_b128 v[16:19], v7 offset:8448
v_cvt_pk_bf16_f32 v86, v48, v49
v_mfma_f32_16x16x32_bf16 v[72:75], a[12:15], v[24:27], v[72:75]
buffer_load_dwordx4 v202, s[12:15], s68 offen offset:2048 nt lds
v_add_u32 v51, s64, v51
v_mfma_f32_16x16x32_bf16 v[64:67], a[12:15], v[20:23], v[64:67]
s_waitcnt lgkmcnt(4)
v_cvt_pk_bf16_f32 v87, v50, s65
v_mfma_f32_16x16x32_bf16 v[60:63], a[16:19], v[28:31], v[60:63]
buffer_load_dwordx2 v[132:133], v118, s[8:11], s42 offen offset:0 sc1
ds_read_b128 v[20:23], v7 offset:10240
v_mfma_f32_16x16x32_bf16 v[68:71], a[16:19], v[32:35], v[68:71]
ds_read_b128 v[24:27], v7 offset:10496
v_bfi_b32 v87, s66, v51, v87
v_mfma_f32_16x16x32_bf16 v[72:75], a[20:23], v[32:35], v[72:75]
buffer_store_dwordx4 v[84:87], v116, s[8:11], s41 offen sc1
v_cvt_pk_bf16_f32 v88, v52, v53
v_mfma_f32_16x16x32_bf16 v[64:67], a[20:23], v[28:31], v[64:67]
s_waitcnt lgkmcnt(4)
v_add_u32 v55, s64, v55
v_mfma_f32_16x16x32_bf16 v[60:63], a[24:27], v[36:39], v[60:63]
buffer_load_dwordx2 v[134:135], v118, s[8:11], s42 offen offset:2048 sc1
ds_read_b128 v[28:31], v7 offset:12288
v_mfma_f32_16x16x32_bf16 v[68:71], a[24:27], v[40:43], v[68:71]
ds_read_b128 v[32:35], v7 offset:12544
v_cvt_pk_bf16_f32 v89, v54, s65
v_mfma_f32_16x16x32_bf16 v[72:75], a[28:31], v[40:43], v[72:75]
buffer_load_dwordx4 v203, s[12:15], s68 offen offset:3072 nt lds
v_bfi_b32 v89, s66, v55, v89
v_mfma_f32_16x16x32_bf16 v[64:67], a[28:31], v[36:39], v[64:67]
s_waitcnt lgkmcnt(4)
s_add_u32 s68, s68, s75
s_add_u32 m0, s22, 32768
v_mfma_f32_16x16x32_bf16 v[60:63], a[32:35], v[12:15], v[60:63]
s_waitcnt vmcnt(18)
s_barrier
ds_read_b128 v[36:39], v7 offset:16384
v_mfma_f32_16x16x32_bf16 v[68:71], a[32:35], v[16:19], v[68:71]
s_waitcnt vmcnt(21)
ds_read_b128 v[40:43], v7 offset:16640
v_cvt_pk_bf16_f32 v90, v56, v57
v_mfma_f32_16x16x32_bf16 v[72:75], a[36:39], v[16:19], v[72:75]
buffer_load_dwordx4 v200, s[12:15], s68 offen nt lds
v_add_u32 v59, s64, v59
v_mfma_f32_16x16x32_bf16 v[64:67], a[36:39], v[12:15], v[64:67]
s_waitcnt lgkmcnt(4)
v_cvt_pk_bf16_f32 v91, v58, s65
v_mfma_f32_16x16x32_bf16 v[60:63], a[40:43], v[20:23], v[60:63]
buffer_load_dwordx2 v[136:137], v119, s[8:11], s42 offen offset:0 sc1
ds_read_b128 v[12:15], v7 offset:18432
v_mfma_f32_16x16x32_bf16 v[68:71], a[40:43], v[24:27], v[68:71]
ds_read_b128 v[16:19], v7 offset:18688
v_bfi_b32 v91, s66, v59, v91
v_mfma_f32_16x16x32_bf16 v[72:75], a[44:47], v[24:27], v[72:75]
buffer_store_dwordx4 v[88:91], v117, s[8:11], s41 offen sc1
v_bitop3_b32 v162, v125, v127, s59 bitop3:0x7e
v_mfma_f32_16x16x32_bf16 v[64:67], a[44:47], v[20:23], v[64:67]
s_waitcnt lgkmcnt(4)
v_bitop3_b32 v163, v129, v131, s59 bitop3:0x7e
v_mfma_f32_16x16x32_bf16 v[60:63], a[48:51], v[28:31], v[60:63]
buffer_load_dwordx2 v[138:139], v119, s[8:11], s42 offen offset:2048 sc1
ds_read_b128 v[20:23], v7 offset:20480
v_mfma_f32_16x16x32_bf16 v[68:71], a[48:51], v[32:35], v[68:71]
ds_read_b128 v[24:27], v7 offset:20736
v_or_b32 v162, v162, v163
v_mfma_f32_16x16x32_bf16 v[72:75], a[52:55], v[32:35], v[72:75]
buffer_load_dwordx4 v201, s[12:15], s68 offen offset:1024 nt lds
v_and_b32 v162, 0x10000, v162
v_mfma_f32_16x16x32_bf16 v[64:67], a[52:55], v[28:31], v[64:67]
s_waitcnt lgkmcnt(4)
v_cmp_ne_u32 vcc, 0, v162
v_mfma_f32_16x16x32_bf16 v[60:63], a[56:59], v[36:39], v[60:63]
ds_read_b128 v[28:31], v7 offset:22528
v_mfma_f32_16x16x32_bf16 v[68:71], a[56:59], v[40:43], v[68:71]
ds_read_b128 v[32:35], v7 offset:22784
v_mfma_f32_16x16x32_bf16 v[72:75], a[60:63], v[40:43], v[72:75]
s_cbranch_vccnz main_kernel_fj1_zc1
main_kernel_fj1_zk1:
v_mfma_f32_16x16x32_bf16 v[64:67], a[60:63], v[36:39], v[64:67]
s_waitcnt lgkmcnt(4)
v_lshlrev_b32 v144, 16, v124
v_mfma_f32_16x16x32_bf16 v[60:63], a[64:67], v[12:15], v[60:63]
ds_read_b128 v[36:39], v7 offset:24576
v_and_b32 v145, 0xffff0000, v124
v_mfma_f32_16x16x32_bf16 v[68:71], a[64:67], v[16:19], v[68:71]
ds_read_b128 v[40:43], v7 offset:24832
v_lshlrev_b32 v146, 16, v125
v_mfma_f32_16x16x32_bf16 v[72:75], a[68:71], v[16:19], v[72:75]
buffer_load_dwordx4 v202, s[12:15], s68 offen offset:2048 nt lds
v_and_b32 v147, 0xffff0000, v125
v_mfma_f32_16x16x32_bf16 v[64:67], a[68:71], v[12:15], v[64:67]
s_waitcnt lgkmcnt(4)
v_add_f32 v140, v148, v144
v_mfma_f32_16x16x32_bf16 v[60:63], a[72:75], v[20:23], v[60:63]
ds_read_b128 v[12:15], v7 offset:26624
v_add_f32 v141, v149, v145
v_mfma_f32_16x16x32_bf16 v[68:71], a[72:75], v[24:27], v[68:71]
ds_read_b128 v[16:19], v7 offset:26880
v_add_f32 v142, v150, v146
v_mfma_f32_16x16x32_bf16 v[72:75], a[76:79], v[24:27], v[72:75]
v_add_f32 v143, v151, v147
v_mfma_f32_16x16x32_bf16 v[64:67], a[76:79], v[20:23], v[64:67]
s_waitcnt lgkmcnt(4)
v_lshlrev_b32 v144, 16, v126
v_mfma_f32_16x16x32_bf16 v[60:63], a[80:83], v[28:31], v[60:63]
ds_read_b128 v[20:23], v7 offset:28672
v_and_b32 v145, 0xffff0000, v126
v_mfma_f32_16x16x32_bf16 v[68:71], a[80:83], v[32:35], v[68:71]
ds_read_b128 v[24:27], v7 offset:28928
v_lshlrev_b32 v146, 16, v127
v_mfma_f32_16x16x32_bf16 v[72:75], a[84:87], v[32:35], v[72:75]
buffer_load_dwordx4 v203, s[12:15], s68 offen offset:3072 nt lds
v_and_b32 v147, 0xffff0000, v127
v_mfma_f32_16x16x32_bf16 v[64:67], a[84:87], v[28:31], v[64:67]
s_waitcnt lgkmcnt(4)
s_add_u32 s68, s68, s75
s_add_u32 m0, s22, 49152
v_mfma_f32_16x16x32_bf16 v[60:63], a[88:91], v[36:39], v[60:63]
ds_read_b128 v[28:31], v7 offset:32768
v_add_f32 v140, v140, v144
v_mfma_f32_16x16x32_bf16 v[68:71], a[88:91], v[40:43], v[68:71]
ds_read_b128 v[32:35], v7 offset:33024
v_add_f32 v141, v141, v145
v_mfma_f32_16x16x32_bf16 v[72:75], a[92:95], v[40:43], v[72:75]
buffer_load_dwordx4 v200, s[12:15], s68 offen nt lds
v_add_f32 v142, v142, v146
v_mfma_f32_16x16x32_bf16 v[64:67], a[92:95], v[36:39], v[64:67]
s_waitcnt lgkmcnt(4)
v_add_f32 v143, v143, v147
s_add_u32 s38, s36, 1
v_mfma_f32_16x16x32_bf16 v[60:63], a[96:99], v[12:15], v[60:63]
s_min_u32 s38, s38, s37
ds_read_b128 v[36:39], v7 offset:34816
v_lshlrev_b32 v144, 16, v128
v_mfma_f32_16x16x32_bf16 v[68:71], a[96:99], v[16:19], v[68:71]
ds_read_b128 v[40:43], v7 offset:35072
v_and_b32 v145, 0xffff0000, v128
v_mfma_f32_16x16x32_bf16 v[72:75], a[100:103], v[16:19], v[72:75]
v_lshlrev_b32 v146, 16, v129
v_mfma_f32_16x16x32_bf16 v[64:67], a[100:103], v[12:15], v[64:67]
s_waitcnt lgkmcnt(4)
v_and_b32 v147, 0xffff0000, v129
v_mfma_f32_16x16x32_bf16 v[60:63], a[104:107], v[20:23], v[60:63]
ds_read_b128 v[12:15], v7 offset:36864
v_add_f32 v140, v140, v144
v_mfma_f32_16x16x32_bf16 v[68:71], a[104:107], v[24:27], v[68:71]
ds_read_b128 v[16:19], v7 offset:37120
v_add_f32 v141, v141, v145
v_mfma_f32_16x16x32_bf16 v[72:75], a[108:111], v[24:27], v[72:75]
buffer_load_dwordx4 v201, s[12:15], s68 offen offset:1024 nt lds
v_add_f32 v142, v142, v146
v_mfma_f32_16x16x32_bf16 v[64:67], a[108:111], v[20:23], v[64:67]
s_waitcnt lgkmcnt(4)
v_add_f32 v143, v143, v147
v_mfma_f32_16x16x32_bf16 v[60:63], a[112:115], v[28:31], v[60:63]
ds_read_b128 v[20:23], v7 offset:38912
v_lshlrev_b32 v144, 16, v130
v_mfma_f32_16x16x32_bf16 v[68:71], a[112:115], v[32:35], v[68:71]
ds_read_b128 v[24:27], v7 offset:39168
v_and_b32 v145, 0xffff0000, v130
v_mfma_f32_16x16x32_bf16 v[72:75], a[116:119], v[32:35], v[72:75]
s_waitcnt vmcnt(21)
v_cmp_gt_u32 s[62:63], s38, v111
v_mfma_f32_16x16x32_bf16 v[64:67], a[116:119], v[28:31], v[64:67]
s_waitcnt lgkmcnt(4)
v_lshlrev_b32 v146, 16, v131
v_mfma_f32_16x16x32_bf16 v[60:63], a[120:123], v[36:39], v[60:63]
s_and_b64 s[62:63], s[62:63], s[50:51]
ds_read_b128 v[28:31], v7 offset:40960
v_and_b32 v147, 0xffff0000, v131
v_mfma_f32_16x16x32_bf16 v[68:71], a[120:123], v[40:43], v[68:71]
s_mov_b32 s55, s42
ds_read_b128 v[32:35], v7 offset:41216
v_add_f32 v140, v140, v144
v_mfma_f32_16x16x32_bf16 v[72:75], a[124:127], v[40:43], v[72:75]
buffer_load_dwordx4 v202, s[12:15], s68 offen offset:2048 nt lds
v_add_f32 v141, v141, v145
v_mfma_f32_16x16x32_bf16 v[64:67], a[124:127], v[36:39], v[64:67]
s_waitcnt lgkmcnt(4)
v_add_f32 v142, v142, v146
s_mov_b32 s42, s41
v_mfma_f32_16x16x32_bf16 v[60:63], a[128:131], v[12:15], v[60:63]
s_mov_b32 s41, s43
ds_read_b128 v[36:39], v7 offset:43008
v_add_f32 v143, v143, v147
v_mfma_f32_16x16x32_bf16 v[68:71], a[128:131], v[16:19], v[68:71]
s_mov_b32 s59, s58
ds_read_b128 v[40:43], v7 offset:43264
v_mul_f32 v144, s40, v140
v_mfma_f32_16x16x32_bf16 v[72:75], a[132:135], v[16:19], v[72:75]
s_cbranch_scc1 main_kernel_fj1_za1
main_kernel_fj1_zb1:
s_mov_b32 s58, s57
v_mfma_f32_16x16x32_bf16 v[64:67], a[132:135], v[12:15], v[64:67]
s_waitcnt lgkmcnt(4)
v_exp_f32 v144, v144
v_mfma_f32_16x16x32_bf16 v[60:63], a[136:139], v[20:23], v[60:63]
s_mov_b32 s57, s60
ds_read_b128 v[12:15], v7 offset:45056
v_mul_f32 v145, s40, v141
v_mfma_f32_16x16x32_bf16 v[68:71], a[136:139], v[24:27], v[68:71]
s_add_u32 s43, s43, 32768
ds_read_b128 v[16:19], v7 offset:45312
v_mul_f32 v146, s40, v142
v_mfma_f32_16x16x32_bf16 v[72:75], a[140:143], v[24:27], v[72:75]
buffer_load_dwordx4 v203, s[12:15], s68 offen offset:3072 nt lds
v_mul_f32 v147, s40, v143
v_mfma_f32_16x16x32_bf16 v[64:67], a[140:143], v[20:23], v[64:67]
s_waitcnt lgkmcnt(4)
s_add_u32 s68, s68, s75
s_add_u32 m0, s22, 65536
v_mfma_f32_16x16x32_bf16 v[60:63], a[144:147], v[28:31], v[60:63]
s_waitcnt vmcnt(25)
s_barrier
ds_read_b128 v[20:23], v7 offset:49152
v_mfma_f32_16x16x32_bf16 v[68:71], a[144:147], v[32:35], v[68:71]
s_cmp_lt_u32 s36, s37
ds_read_b128 v[24:27], v7 offset:49408
s_cselect_b32 s20, s20, 0x40000000
v_mfma_f32_16x16x32_bf16 v[72:75], a[148:151], v[32:35], v[72:75]
buffer_load_dwordx4 v200, s[12:15], s68 offen nt lds
v_add_f32 v144, 1.0, v144
v_mfma_f32_16x16x32_bf16 v[64:67], a[148:151], v[28:31], v[64:67]
s_waitcnt lgkmcnt(4)
v_exp_f32 v145, v145
v_mfma_f32_16x16x32_bf16 v[60:63], a[152:155], v[36:39], v[60:63]
buffer_load_dword v111, v109, s[8:11], 0 offen sc1
ds_read_b128 v[28:31], v7 offset:51200
v_mfma_f32_16x16x32_bf16 v[68:71], a[152:155], v[40:43], v[68:71]
s_waitcnt vmcnt(45)
ds_read_b128 v[32:35], v7 offset:51456
v_add_f32 v145, 1.0, v145
v_mfma_f32_16x16x32_bf16 v[72:75], a[156:159], v[40:43], v[72:75]
s_ashr_i32 s26, s39, 1
s_max_i32 s26, s26, 0
v_mov_b32 v112, s26
v_mfma_f32_16x16x32_bf16 v[64:67], a[156:159], v[36:39], v[64:67]
s_waitcnt lgkmcnt(4)
v_exp_f32 v146, v146
v_mfma_f32_16x16x32_bf16 v[60:63], a[160:163], v[12:15], v[60:63]
buffer_store_dword v112, v108, s[8:11], 0 offen sc1
ds_read_b128 v[36:39], v7 offset:53248
v_mfma_f32_16x16x32_bf16 v[68:71], a[160:163], v[16:19], v[68:71]
s_add_u32 s36, s36, 1
ds_read_b128 v[40:43], v7 offset:53504
v_add_f32 v146, 1.0, v146
v_mfma_f32_16x16x32_bf16 v[72:75], a[164:167], v[16:19], v[72:75]
buffer_load_dwordx4 v201, s[12:15], s68 offen offset:1024 nt lds
s_sub_u32 s27, s43, s44
v_mfma_f32_16x16x32_bf16 v[64:67], a[164:167], v[12:15], v[64:67]
s_waitcnt lgkmcnt(4)
v_exp_f32 v147, v147
v_mfma_f32_16x16x32_bf16 v[60:63], a[168:171], v[20:23], v[60:63]
s_cmp_eq_u32 s27, 229376
ds_read_b128 v[12:15], v7 offset:55296
v_add_f32 v147, 1.0, v147
v_mfma_f32_16x16x32_bf16 v[68:71], a[168:171], v[24:27], v[68:71]
s_cselect_b32 s43, s44, s43
ds_read_b128 v[16:19], v7 offset:55552
s_cselect_b32 s27, 0x10000, 0
v_mfma_f32_16x16x32_bf16 v[72:75], a[172:175], v[24:27], v[72:75]
s_xor_b32 s60, s60, s27
v_rcp_f32 v144, v144
v_mfma_f32_16x16x32_bf16 v[64:67], a[172:175], v[20:23], v[64:67]
s_waitcnt lgkmcnt(4)
v_rcp_f32 v145, v145
v_mfma_f32_16x16x32_bf16 v[60:63], a[176:179], v[28:31], v[60:63]
s_sub_u32 s64, 0x10000, s57
ds_read_b128 v[20:23], v7 offset:57344
v_mul_f32 v140, v140, v144
v_mfma_f32_16x16x32_bf16 v[68:71], a[176:179], v[32:35], v[68:71]
s_add_u32 s65, s57, 0x3f800000
ds_read_b128 v[24:27], v7 offset:57600
v_mul_f32 v141, v141, v145
v_mfma_f32_16x16x32_bf16 v[72:75], a[180:183], v[32:35], v[72:75]
buffer_load_dwordx4 v202, s[12:15], s68 offen offset:2048 nt lds
v_cvt_pk_bf16_f32 v160, v140, v141
v_mfma_f32_16x16x32_bf16 v[64:67], a[180:183], v[28:31], v[64:67]
s_waitcnt lgkmcnt(4)
v_rcp_f32 v146, v146
v_mfma_f32_16x16x32_bf16 v[60:63], a[184:187], v[36:39], v[60:63]
ds_read_b128 v[28:31], v7 offset:59392
v_mul_f32 v142, v142, v146
v_mfma_f32_16x16x32_bf16 v[68:71], a[184:187], v[40:43], v[68:71]
ds_read_b128 v[32:35], v7 offset:59648
v_mfma_f32_16x16x32_bf16 v[72:75], a[188:191], v[40:43], v[72:75]
v_rcp_f32 v147, v147
v_mfma_f32_16x16x32_bf16 v[64:67], a[188:191], v[36:39], v[64:67]
s_waitcnt lgkmcnt(4)
v_mul_f32 v143, v143, v147
v_mfma_f32_16x16x32_bf16 v[60:63], a[192:195], v[12:15], v[60:63]
ds_read_b128 v[36:39], v7 offset:61440
v_cvt_pk_bf16_f32 v161, v142, v143
v_mfma_f32_16x16x32_bf16 v[68:71], a[192:195], v[16:19], v[68:71]
ds_read_b128 v[40:43], v7 offset:61696
v_mfma_f32_16x16x32_bf16 v[72:75], a[196:199], v[16:19], v[72:75]
buffer_load_dwordx4 v203, s[12:15], s68 offen offset:3072 nt lds
v_mfma_f32_16x16x32_bf16 v[64:67], a[196:199], v[12:15], v[64:67]
s_waitcnt lgkmcnt(4)
s_add_u32 s68, s68, s75
s_add_u32 m0, s22, 81920
v_mfma_f32_16x16x32_bf16 v[60:63], a[200:203], v[20:23], v[60:63]
buffer_store_dwordx2 v[160:161], v121, s[8:11], s56 offen sc1
ds_read_b128 v[12:15], v6 offset:0
v_mfma_f32_16x16x32_bf16 v[68:71], a[200:203], v[24:27], v[68:71]
s_mov_b32 s56, s47
ds_read_b128 v[16:19], v6 offset:256
s_mov_b32 s47, s46
v_mfma_f32_16x16x32_bf16 v[72:75], a[204:207], v[24:27], v[72:75]
s_mov_b32 s46, s45
buffer_load_dwordx4 v200, s[12:15], s68 offen nt lds
v_mfma_f32_16x16x32_bf16 v[64:67], a[204:207], v[20:23], v[64:67]
s_waitcnt lgkmcnt(4)
s_add_u32 s45, s45, 65536
s_add_u32 s39, s39, 1
v_mfma_f32_16x16x32_bf16 v[60:63], a[208:211], v[28:31], v[60:63]
ds_read_b128 v[20:23], v6 offset:2048
v_mfma_f32_16x16x32_bf16 v[68:71], a[208:211], v[32:35], v[68:71]
ds_read_b128 v[24:27], v6 offset:2304
v_mfma_f32_16x16x32_bf16 v[72:75], a[212:215], v[32:35], v[72:75]
v_mfma_f32_16x16x32_bf16 v[64:67], a[212:215], v[28:31], v[64:67]
s_waitcnt lgkmcnt(4)
v_mfma_f32_16x16x32_bf16 v[60:63], a[216:219], v[36:39], v[60:63]
ds_read_b128 v[28:31], v6 offset:4096
v_mfma_f32_16x16x32_bf16 v[68:71], a[216:219], v[40:43], v[68:71]
ds_read_b128 v[32:35], v6 offset:4352
v_mfma_f32_16x16x32_bf16 v[72:75], a[220:223], v[40:43], v[72:75]
s_sub_u32 s24, s24, 1
buffer_load_dwordx4 v201, s[12:15], s68 offen offset:1024 nt lds
v_mfma_f32_16x16x32_bf16 v[64:67], a[220:223], v[36:39], v[64:67]
s_waitcnt lgkmcnt(4)
s_barrier
s_add_u32 m0, s22, 81920
s_nop 0
buffer_load_dwordx4 v202, s[12:15], s68 offen offset:2048 nt lds
buffer_load_dwordx4 v203, s[12:15], s68 offen offset:3072 nt lds
s_add_u32 s68, s68, s75
s_add_u32 m0, s22, 98304
s_nop 0
buffer_load_dwordx4 v200, s[12:15], s68 offen nt lds
buffer_load_dwordx4 v201, s[12:15], s68 offen offset:1024 nt lds
buffer_load_dwordx4 v202, s[12:15], s68 offen offset:2048 nt lds
buffer_load_dwordx4 v203, s[12:15], s68 offen offset:3072 nt lds
s_add_u32 s68, s68, s75
s_add_u32 m0, s22, 114688
s_nop 0
buffer_load_dwordx4 v200, s[12:15], s68 offen nt lds
buffer_load_dwordx4 v201, s[12:15], s68 offen offset:1024 nt lds
buffer_load_dwordx4 v202, s[12:15], s68 offen offset:2048 nt lds
buffer_load_dwordx4 v203, s[12:15], s68 offen offset:3072 nt lds
v_cvt_pk_bf16_f32 v84, v60, v61
v_add_u32 v63, s64, v63
v_cvt_pk_bf16_f32 v85, v62, s65
v_bfi_b32 v85, s66, v63, v85
v_cvt_pk_bf16_f32 v86, v64, v65
v_add_u32 v67, s64, v67
v_cvt_pk_bf16_f32 v87, v66, s65
v_bfi_b32 v87, s66, v67, v87
v_cvt_pk_bf16_f32 v88, v68, v69
v_add_u32 v71, s64, v71
v_cvt_pk_bf16_f32 v89, v70, s65
v_bfi_b32 v89, s66, v71, v89
v_cvt_pk_bf16_f32 v90, v72, v73
v_add_u32 v75, s64, v75
v_cvt_pk_bf16_f32 v91, v74, s65
v_bfi_b32 v91, s66, v75, v91
buffer_store_dwordx4 v[84:87], v116, s[8:11], s41 offen sc1
buffer_store_dwordx4 v[88:91], v117, s[8:11], s41 offen sc1
buffer_load_dwordx2 v[124:125], v118, s[8:11], s42 offen offset:0 sc1
buffer_load_dwordx2 v[126:127], v118, s[8:11], s42 offen offset:2048 sc1
buffer_load_dwordx2 v[128:129], v119, s[8:11], s42 offen offset:0 sc1
buffer_load_dwordx2 v[130:131], v119, s[8:11], s42 offen offset:2048 sc1
s_waitcnt vmcnt(6)
v_bitop3_b32 v162, v133, v135, s59 bitop3:0x7e
v_bitop3_b32 v163, v137, v139, s59 bitop3:0x7e
v_or_b32 v162, v162, v163
v_and_b32 v162, 0x10000, v162
v_cmp_ne_u32 vcc, 0, v162
s_cbranch_vccnz main_kernel_fj1_c2
main_kernel_fj1_k2:
v_lshlrev_b32 v144, 16, v132
v_and_b32 v145, 0xffff0000, v132
v_lshlrev_b32 v146, 16, v133
v_and_b32 v147, 0xffff0000, v133
v_add_f32 v140, v148, v144
v_add_f32 v141, v149, v145
v_add_f32 v142, v150, v146
v_add_f32 v143, v151, v147
v_lshlrev_b32 v144, 16, v134
v_and_b32 v145, 0xffff0000, v134
v_lshlrev_b32 v146, 16, v135
v_and_b32 v147, 0xffff0000, v135
v_add_f32 v140, v140, v144
v_add_f32 v141, v141, v145
v_add_f32 v142, v142, v146
v_add_f32 v143, v143, v147
v_lshlrev_b32 v144, 16, v136
v_and_b32 v145, 0xffff0000, v136
v_lshlrev_b32 v146, 16, v137
v_and_b32 v147, 0xffff0000, v137
v_add_f32 v140, v140, v144
v_add_f32 v141, v141, v145
v_add_f32 v142, v142, v146
v_add_f32 v143, v143, v147
v_lshlrev_b32 v144, 16, v138
v_and_b32 v145, 0xffff0000, v138
v_lshlrev_b32 v146, 16, v139
v_and_b32 v147, 0xffff0000, v139
v_add_f32 v140, v140, v144
v_add_f32 v141, v141, v145
v_add_f32 v142, v142, v146
v_add_f32 v143, v143, v147
v_mul_f32 v144, s40, v140
v_mul_f32 v145, s40, v141
v_mul_f32 v146, s40, v142
v_mul_f32 v147, s40, v143
v_exp_f32 v144, v144
v_exp_f32 v145, v145
v_exp_f32 v146, v146
v_exp_f32 v147, v147
v_add_f32 v144, 1.0, v144
v_add_f32 v145, 1.0, v145
v_add_f32 v146, 1.0, v146
v_add_f32 v147, 1.0, v147
v_rcp_f32 v144, v144
v_rcp_f32 v145, v145
v_rcp_f32 v146, v146
v_rcp_f32 v147, v147
v_mul_f32 v140, v140, v144
v_mul_f32 v141, v141, v145
v_mul_f32 v142, v142, v146
v_mul_f32 v143, v143, v147
v_cvt_pk_bf16_f32 v160, v140, v141
v_cvt_pk_bf16_f32 v161, v142, v143
buffer_store_dwordx2 v[160:161], v121, s[8:11], s56 offen sc1
buffer_load_dwordx2 v[132:133], v118, s[8:11], s41 offen offset:0 sc1
buffer_load_dwordx2 v[134:135], v118, s[8:11], s41 offen offset:2048 sc1
buffer_load_dwordx2 v[136:137], v119, s[8:11], s41 offen offset:0 sc1
buffer_load_dwordx2 v[138:139], v119, s[8:11], s41 offen offset:2048 sc1
s_waitcnt vmcnt(5)
v_bitop3_b32 v162, v125, v127, s58 bitop3:0x7e
v_bitop3_b32 v163, v129, v131, s58 bitop3:0x7e
v_or_b32 v162, v162, v163
v_and_b32 v162, 0x10000, v162
v_cmp_ne_u32 vcc, 0, v162
s_cbranch_vccnz main_kernel_fj1_c3
main_kernel_fj1_k3:
v_lshlrev_b32 v144, 16, v124
v_and_b32 v145, 0xffff0000, v124
v_lshlrev_b32 v146, 16, v125
v_and_b32 v147, 0xffff0000, v125
v_add_f32 v140, v148, v144
v_add_f32 v141, v149, v145
v_add_f32 v142, v150, v146
v_add_f32 v143, v151, v147
v_lshlrev_b32 v144, 16, v126
v_and_b32 v145, 0xffff0000, v126
v_lshlrev_b32 v146, 16, v127
v_and_b32 v147, 0xffff0000, v127
v_add_f32 v140, v140, v144
v_add_f32 v141, v141, v145
v_add_f32 v142, v142, v146
v_add_f32 v143, v143, v147
v_lshlrev_b32 v144, 16, v128
v_and_b32 v145, 0xffff0000, v128
v_lshlrev_b32 v146, 16, v129
v_and_b32 v147, 0xffff0000, v129
v_add_f32 v140, v140, v144
v_add_f32 v141, v141, v145
v_add_f32 v142, v142, v146
v_add_f32 v143, v143, v147
v_lshlrev_b32 v144, 16, v130
v_and_b32 v145, 0xffff0000, v130
v_lshlrev_b32 v146, 16, v131
v_and_b32 v147, 0xffff0000, v131
v_add_f32 v140, v140, v144
v_add_f32 v141, v141, v145
v_add_f32 v142, v142, v146
v_add_f32 v143, v143, v147
v_mul_f32 v144, s40, v140
v_mul_f32 v145, s40, v141
v_mul_f32 v146, s40, v142
v_mul_f32 v147, s40, v143
v_exp_f32 v144, v144
v_exp_f32 v145, v145
v_exp_f32 v146, v146
v_exp_f32 v147, v147
v_add_f32 v144, 1.0, v144
v_add_f32 v145, 1.0, v145
v_add_f32 v146, 1.0, v146
v_add_f32 v147, 1.0, v147
v_rcp_f32 v144, v144
v_rcp_f32 v145, v145
v_rcp_f32 v146, v146
v_rcp_f32 v147, v147
v_mul_f32 v140, v140, v144
v_mul_f32 v141, v141, v145
v_mul_f32 v142, v142, v146
v_mul_f32 v143, v143, v147
v_cvt_pk_bf16_f32 v160, v140, v141
v_cvt_pk_bf16_f32 v161, v142, v143
buffer_store_dwordx2 v[160:161], v121, s[8:11], s47 offen sc1
s_waitcnt vmcnt(1)
v_bitop3_b32 v162, v133, v135, s57 bitop3:0x7e
v_bitop3_b32 v163, v137, v139, s57 bitop3:0x7e
v_or_b32 v162, v162, v163
v_and_b32 v162, 0x10000, v162
v_cmp_ne_u32 vcc, 0, v162
s_cbranch_vccnz main_kernel_fj1_c4
main_kernel_fj1_k4:
v_lshlrev_b32 v144, 16, v132
v_and_b32 v145, 0xffff0000, v132
v_lshlrev_b32 v146, 16, v133
v_and_b32 v147, 0xffff0000, v133
v_add_f32 v140, v148, v144
v_add_f32 v141, v149, v145
v_add_f32 v142, v150, v146
v_add_f32 v143, v151, v147
v_lshlrev_b32 v144, 16, v134
v_and_b32 v145, 0xffff0000, v134
v_lshlrev_b32 v146, 16, v135
v_and_b32 v147, 0xffff0000, v135
v_add_f32 v140, v140, v144
v_add_f32 v141, v141, v145
v_add_f32 v142, v142, v146
v_add_f32 v143, v143, v147
v_lshlrev_b32 v144, 16, v136
v_and_b32 v145, 0xffff0000, v136
v_lshlrev_b32 v146, 16, v137
v_and_b32 v147, 0xffff0000, v137
v_add_f32 v140, v140, v144
v_add_f32 v141, v141, v145
v_add_f32 v142, v142, v146
v_add_f32 v143, v143, v147
v_lshlrev_b32 v144, 16, v138
v_and_b32 v145, 0xffff0000, v138
v_lshlrev_b32 v146, 16, v139
v_and_b32 v147, 0xffff0000, v139
v_add_f32 v140, v140, v144
v_add_f32 v141, v141, v145
v_add_f32 v142, v142, v146
v_add_f32 v143, v143, v147
v_mul_f32 v144, s40, v140
v_mul_f32 v145, s40, v141
v_mul_f32 v146, s40, v142
v_mul_f32 v147, s40, v143
v_exp_f32 v144, v144
v_exp_f32 v145, v145
v_exp_f32 v146, v146
v_exp_f32 v147, v147
v_add_f32 v144, 1.0, v144
v_add_f32 v145, 1.0, v145
v_add_f32 v146, 1.0, v146
v_add_f32 v147, 1.0, v147
v_rcp_f32 v144, v144
v_rcp_f32 v145, v145
v_rcp_f32 v146, v146
v_rcp_f32 v147, v147
v_mul_f32 v140, v140, v144
v_mul_f32 v141, v141, v145
v_mul_f32 v142, v142, v146
v_mul_f32 v143, v143, v147
v_cvt_pk_bf16_f32 v160, v140, v141
v_cvt_pk_bf16_f32 v161, v142, v143
buffer_store_dwordx2 v[160:161], v121, s[8:11], s46 offen sc1
s_branch main_kernel_fj1_dn
main_kernel_fj1_c0:
s_add_u32 s54, s54, 1
s_cmp_ge_u32 s54, 131072
s_cbranch_scc1 main_kernel_fj1_k0
buffer_load_dwordx2 v[132:133], v118, s[8:11], s55 offen offset:0 sc1
buffer_load_dwordx2 v[134:135], v118, s[8:11], s55 offen offset:2048 sc1
buffer_load_dwordx2 v[136:137], v119, s[8:11], s55 offen offset:0 sc1
buffer_load_dwordx2 v[138:139], v119, s[8:11], s55 offen offset:2048 sc1
s_waitcnt vmcnt(0)
v_bitop3_b32 v162, v133, v135, s59 bitop3:0x7e
v_bitop3_b32 v163, v137, v139, s59 bitop3:0x7e
v_or_b32 v162, v162, v163
v_and_b32 v162, 0x10000, v162
v_cmp_ne_u32 vcc, 0, v162
s_cbranch_vccnz main_kernel_fj1_c0
s_branch main_kernel_fj1_k0
main_kernel_fj1_a0:
main_kernel_fj1_w0:
buffer_load_dword v111, v109, s[8:11], 0 offen sc1
s_waitcnt vmcnt(0)
v_cmp_gt_u32 s[62:63], s38, v111
s_and_b64 s[62:63], s[62:63], s[50:51]
s_cbranch_scc0 main_kernel_fj1_w0_ok
s_add_u32 s54, s54, 1
s_cmp_ge_u32 s54, 131072
s_cbranch_scc1 main_kernel_fj1_w0_ok
s_sleep 1
s_branch main_kernel_fj1_w0
main_kernel_fj1_w0_ok:
s_branch main_kernel_fj1_b0
main_kernel_fj1_c1:
s_add_u32 s54, s54, 1
s_cmp_ge_u32 s54, 131072
s_cbranch_scc1 main_kernel_fj1_k1
buffer_load_dwordx2 v[124:125], v118, s[8:11], s55 offen offset:0 sc1
buffer_load_dwordx2 v[126:127], v118, s[8:11], s55 offen offset:2048 sc1
buffer_load_dwordx2 v[128:129], v119, s[8:11], s55 offen offset:0 sc1
buffer_load_dwordx2 v[130:131], v119, s[8:11], s55 offen offset:2048 sc1
s_waitcnt vmcnt(0)
v_bitop3_b32 v162, v125, v127, s59 bitop3:0x7e
v_bitop3_b32 v163, v129, v131, s59 bitop3:0x7e
v_or_b32 v162, v162, v163
v_and_b32 v162, 0x10000, v162
v_cmp_ne_u32 vcc, 0, v162
s_cbranch_vccnz main_kernel_fj1_c1
s_branch main_kernel_fj1_k1
main_kernel_fj1_a1:
main_kernel_fj1_w1:
buffer_load_dword v111, v109, s[8:11], 0 offen sc1
s_waitcnt vmcnt(0)
v_cmp_gt_u32 s[62:63], s38, v111
s_and_b64 s[62:63], s[62:63], s[50:51]
s_cbranch_scc0 main_kernel_fj1_w1_ok
s_add_u32 s54, s54, 1
s_cmp_ge_u32 s54, 131072
s_cbranch_scc1 main_kernel_fj1_w1_ok
s_sleep 1
s_branch main_kernel_fj1_w1
main_kernel_fj1_w1_ok:
s_branch main_kernel_fj1_b1
main_kernel_fj1_c2:
s_add_u32 s54, s54, 1
s_cmp_ge_u32 s54, 131072
s_cbranch_scc1 main_kernel_fj1_k2
buffer_load_dwordx2 v[132:133], v118, s[8:11], s55 offen offset:0 sc1
buffer_load_dwordx2 v[134:135], v118, s[8:11], s55 offen offset:2048 sc1
buffer_load_dwordx2 v[136:137], v119, s[8:11], s55 offen offset:0 sc1
buffer_load_dwordx2 v[138:139], v119, s[8:11], s55 offen offset:2048 sc1
s_waitcnt vmcnt(0)
v_bitop3_b32 v162, v133, v135, s59 bitop3:0x7e
v_bitop3_b32 v163, v137, v139, s59 bitop3:0x7e
v_or_b32 v162, v162, v163
v_and_b32 v162, 0x10000, v162
v_cmp_ne_u32 vcc, 0, v162
s_cbranch_vccnz main_kernel_fj1_c2
s_branch main_kernel_fj1_k2
main_kernel_fj1_c3:
s_add_u32 s54, s54, 1
s_cmp_ge_u32 s54, 131072
s_cbranch_scc1 main_kernel_fj1_k3
buffer_load_dwordx2 v[124:125], v118, s[8:11], s42 offen offset:0 sc1
buffer_load_dwordx2 v[126:127], v118, s[8:11], s42 offen offset:2048 sc1
buffer_load_dwordx2 v[128:129], v119, s[8:11], s42 offen offset:0 sc1
buffer_load_dwordx2 v[130:131], v119, s[8:11], s42 offen offset:2048 sc1
s_waitcnt vmcnt(0)
v_bitop3_b32 v162, v125, v127, s58 bitop3:0x7e
v_bitop3_b32 v163, v129, v131, s58 bitop3:0x7e
v_or_b32 v162, v162, v163
v_and_b32 v162, 0x10000, v162
v_cmp_ne_u32 vcc, 0, v162
s_cbranch_vccnz main_kernel_fj1_c3
s_branch main_kernel_fj1_k3
main_kernel_fj1_c4:
s_add_u32 s54, s54, 1
s_cmp_ge_u32 s54, 131072
s_cbranch_scc1 main_kernel_fj1_k4
buffer_load_dwordx2 v[132:133], v118, s[8:11], s41 offen offset:0 sc1
buffer_load_dwordx2 v[134:135], v118, s[8:11], s41 offen offset:2048 sc1
buffer_load_dwordx2 v[136:137], v119, s[8:11], s41 offen offset:0 sc1
buffer_load_dwordx2 v[138:139], v119, s[8:11], s41 offen offset:2048 sc1
s_waitcnt vmcnt(0)
v_bitop3_b32 v162, v133, v135, s57 bitop3:0x7e
v_bitop3_b32 v163, v137, v139, s57 bitop3:0x7e
v_or_b32 v162, v162, v163
v_and_b32 v162, 0x10000, v162
v_cmp_ne_u32 vcc, 0, v162
s_cbranch_vccnz main_kernel_fj1_c4
s_branch main_kernel_fj1_k4
main_kernel_fj1_zc0:
s_add_u32 s54, s54, 1
s_cmp_ge_u32 s54, 131072
s_cbranch_scc1 main_kernel_fj1_zk0
buffer_load_dwordx2 v[132:133], v118, s[8:11], s55 offen offset:0 sc1
buffer_load_dwordx2 v[134:135], v118, s[8:11], s55 offen offset:2048 sc1
buffer_load_dwordx2 v[136:137], v119, s[8:11], s55 offen offset:0 sc1
buffer_load_dwordx2 v[138:139], v119, s[8:11], s55 offen offset:2048 sc1
s_waitcnt vmcnt(0)
v_bitop3_b32 v162, v133, v135, s59 bitop3:0x7e
v_bitop3_b32 v163, v137, v139, s59 bitop3:0x7e
v_or_b32 v162, v162, v163
v_and_b32 v162, 0x10000, v162
v_cmp_ne_u32 vcc, 0, v162
s_cbranch_vccnz main_kernel_fj1_zc0
s_branch main_kernel_fj1_zk0
main_kernel_fj1_za0:
main_kernel_fj1_zw0:
buffer_load_dword v111, v109, s[8:11], 0 offen sc1
s_waitcnt vmcnt(0)
v_cmp_gt_u32 s[62:63], s38, v111
s_and_b64 s[62:63], s[62:63], s[50:51]
s_cbranch_scc0 main_kernel_fj1_zw0_ok
s_add_u32 s54, s54, 1
s_cmp_ge_u32 s54, 131072
s_cbranch_scc1 main_kernel_fj1_zw0_ok
s_sleep 1
s_branch main_kernel_fj1_zw0
main_kernel_fj1_zw0_ok:
s_branch main_kernel_fj1_zb0
main_kernel_fj1_zc1:
s_add_u32 s54, s54, 1
s_cmp_ge_u32 s54, 131072
s_cbranch_scc1 main_kernel_fj1_zk1
buffer_load_dwordx2 v[124:125], v118, s[8:11], s55 offen offset:0 sc1
buffer_load_dwordx2 v[126:127], v118, s[8:11], s55 offen offset:2048 sc1
buffer_load_dwordx2 v[128:129], v119, s[8:11], s55 offen offset:0 sc1
buffer_load_dwordx2 v[130:131], v119, s[8:11], s55 offen offset:2048 sc1
s_waitcnt vmcnt(0)
v_bitop3_b32 v162, v125, v127, s59 bitop3:0x7e
v_bitop3_b32 v163, v129, v131, s59 bitop3:0x7e
v_or_b32 v162, v162, v163
v_and_b32 v162, 0x10000, v162
v_cmp_ne_u32 vcc, 0, v162
s_cbranch_vccnz main_kernel_fj1_zc1
s_branch main_kernel_fj1_zk1
main_kernel_fj1_za1:
main_kernel_fj1_zw1:
buffer_load_dword v111, v109, s[8:11], 0 offen sc1
s_waitcnt vmcnt(0)
v_cmp_gt_u32 s[62:63], s38, v111
s_and_b64 s[62:63], s[62:63], s[50:51]
s_cbranch_scc0 main_kernel_fj1_zw1_ok
s_add_u32 s54, s54, 1
s_cmp_ge_u32 s54, 131072
s_cbranch_scc1 main_kernel_fj1_zw1_ok
s_sleep 1
s_branch main_kernel_fj1_zw1
main_kernel_fj1_zw1_ok:
s_branch main_kernel_fj1_zb1
main_kernel_fj1_dn:
main_kernel_fe:
s_waitcnt vmcnt(0)
v_mov_b32 v112, 32
buffer_store_dword v112, v108, s[8:11], 0 offen sc1
main_kernel_wo:
s_barrier
s_lshl_b32 s74, s94, 21
s_lshl_b32 s75, s95, 8
s_add_u32 s74, s74, s75
s_add_u32 s12, s82, s74
s_addc_u32 s13, s83, 0
s_sub_u32 s14, 0x800000, s74
s_mov_b32 s15, 0x00020000
s_mov_b32 s30, 2048
v_lshrrev_b32 v2, 4, v1
v_lshlrev_b32 v3, 2, v2
v_and_b32 v4, 15, v1
v_xor_b32 v4, v4, v3
v_lshlrev_b32 v4, 4, v4
s_lshl_b32 s26, s25, 6
v_add_u32 v2, s26, v2
v_mul_lo_u32 v2, v2, s30
v_add_u32 v92, v2, v4
v_xor_b32 v93, 16, v92
s_lshl_b32 s49, s30, 2
s_sub_u32 s75, s73, 28
s_cselect_b32 s75, 3, s72
s_cmp_lg_u32 s75, 1
s_cbranch_scc1 main_kernel_w2
s_lshl_b32 m0, s25, 14
s_mul_i32 s26, s30, 0
buffer_load_dwordx4 v92, s[12:15], s26 offen nt lds
s_add_u32 m0, m0, 1024
s_add_u32 s26, s26, s49
buffer_load_dwordx4 v93, s[12:15], s26 offen nt lds
s_add_u32 m0, m0, 1024
s_add_u32 s26, s26, s49
buffer_load_dwordx4 v92, s[12:15], s26 offen nt lds
s_add_u32 m0, m0, 1024
s_add_u32 s26, s26, s49
buffer_load_dwordx4 v93, s[12:15], s26 offen nt lds
s_add_u32 m0, m0, 1024
s_add_u32 s26, s26, s49
buffer_load_dwordx4 v92, s[12:15], s26 offen nt lds
s_add_u32 m0, m0, 1024
s_add_u32 s26, s26, s49
buffer_load_dwordx4 v93, s[12:15], s26 offen nt lds
s_add_u32 m0, m0, 1024
s_add_u32 s26, s26, s49
buffer_load_dwordx4 v92, s[12:15], s26 offen nt lds
s_add_u32 m0, m0, 1024
s_add_u32 s26, s26, s49
buffer_load_dwordx4 v93, s[12:15], s26 offen nt lds
s_add_u32 m0, m0, 1024
s_add_u32 s26, s26, s49
buffer_load_dwordx4 v92, s[12:15], s26 offen nt lds
s_add_u32 m0, m0, 1024
s_add_u32 s26, s26, s49
buffer_load_dwordx4 v93, s[12:15], s26 offen nt lds
s_add_u32 m0, m0, 1024
s_add_u32 s26, s26, s49
buffer_load_dwordx4 v92, s[12:15], s26 offen nt lds
s_add_u32 m0, m0, 1024
s_add_u32 s26, s26, s49
buffer_load_dwordx4 v93, s[12:15], s26 offen nt lds
s_add_u32 m0, m0, 1024
s_add_u32 s26, s26, s49
buffer_load_dwordx4 v92, s[12:15], s26 offen nt lds
s_add_u32 m0, m0, 1024
s_add_u32 s26, s26, s49
buffer_load_dwordx4 v93, s[12:15], s26 offen nt lds
s_add_u32 m0, m0, 1024
s_add_u32 s26, s26, s49
buffer_load_dwordx4 v92, s[12:15], s26 offen nt lds
s_add_u32 m0, m0, 1024
s_add_u32 s26, s26, s49
buffer_load_dwordx4 v93, s[12:15], s26 offen nt lds
s_lshl_b32 m0, s25, 14
s_add_u32 m0, m0, 0x10000
s_mul_i32 s26, s30, 256
buffer_load_dwordx4 v92, s[12:15], s26 offen nt lds
s_add_u32 m0, m0, 1024
s_add_u32 s26, s26, s49
buffer_load_dwordx4 v93, s[12:15], s26 offen nt lds
s_add_u32 m0, m0, 1024
s_add_u32 s26, s26, s49
buffer_load_dwordx4 v92, s[12:15], s26 offen nt lds
s_add_u32 m0, m0, 1024
s_add_u32 s26, s26, s49
buffer_load_dwordx4 v93, s[12:15], s26 offen nt lds
s_add_u32 m0, m0, 1024
s_add_u32 s26, s26, s49
buffer_load_dwordx4 v92, s[12:15], s26 offen nt lds
s_add_u32 m0, m0, 1024
s_add_u32 s26, s26, s49
buffer_load_dwordx4 v93, s[12:15], s26 offen nt lds
s_add_u32 m0, m0, 1024
s_add_u32 s26, s26, s49
buffer_load_dwordx4 v92, s[12:15], s26 offen nt lds
s_add_u32 m0, m0, 1024
s_add_u32 s26, s26, s49
buffer_load_dwordx4 v93, s[12:15], s26 offen nt lds
s_add_u32 m0, m0, 1024
s_add_u32 s26, s26, s49
buffer_load_dwordx4 v92, s[12:15], s26 offen nt lds
s_add_u32 m0, m0, 1024
s_add_u32 s26, s26, s49
buffer_load_dwordx4 v93, s[12:15], s26 offen nt lds
s_add_u32 m0, m0, 1024
s_add_u32 s26, s26, s49
buffer_load_dwordx4 v92, s[12:15], s26 offen nt lds
s_add_u32 m0, m0, 1024
s_add_u32 s26, s26, s49
buffer_load_dwordx4 v93, s[12:15], s26 offen nt lds
s_add_u32 m0, m0, 1024
s_add_u32 s26, s26, s49
buffer_load_dwordx4 v92, s[12:15], s26 offen nt lds
s_add_u32 m0, m0, 1024
s_add_u32 s26, s26, s49
buffer_load_dwordx4 v93, s[12:15], s26 offen nt lds
s_add_u32 m0, m0, 1024
s_add_u32 s26, s26, s49
buffer_load_dwordx4 v92, s[12:15], s26 offen nt lds
s_add_u32 m0, m0, 1024
s_add_u32 s26, s26, s49
buffer_load_dwordx4 v93, s[12:15], s26 offen nt lds
main_kernel_w2:
v_lshrrev_b32 v2, 5, v1
v_lshlrev_b32 v2, 12, v2
v_bfe_u32 v3, v1, 4, 1
v_lshl_add_u32 v2, v3, 10, v2
v_bfe_u32 v4, v1, 2, 2
v_lshl_add_u32 v2, v4, 8, v2
v_xor_b32 v4, s25, v4
v_lshl_add_u32 v3, v4, 2, v3
v_and_b32 v4, 3, v1
v_xor_b32 v3, v3, v4
v_lshl_add_u32 v94, v3, 4, v2
v_xor_b32 v95, 8, v94
v_add_u32 v96, 0x10000, v94
v_add_u32 v97, 0x10000, v95
v_lshl_add_u32 v8, v1, 4, s22
s_mov_b32 s16, s92
s_mov_b32 s17, s93
s_mov_b32 s18, 0x400000
s_mov_b32 s19, 0x00020000
s_mov_b32 s32, s96
s_mov_b32 s33, s97
s_mov_b32 s34, 0x400000
s_mov_b32 s35, 0x00020000
s_cmp_eq_u32 s98, 0
s_cselect_b32 s45, 0, 327680
s_cselect_b32 s37, 34, 30
s_cselect_b32 s61, -2, 2
s_cselect_b32 s67, 4, 0
s_lshl_b32 s48, s67, 16
s_lshl_b32 s31, s94, 16
s_add_u32 s31, s31, 0x4c00000
s_lshl_b32 s52, s45, 2
s_add_u32 s52, s52, s31
s_mov_b32 s53, 475136
s_mov_b32 s23, 16384
s_lshl_b32 s26, s98, 3
s_add_u32 s26, s26, s95
s_mul_i32 s44, s26, 229376
s_add_u32 s44, s44, 107085824
v_bfe_u32 v2, v1, 3, 1
v_lshlrev_b32 v2, 13, v2
v_and_b32 v3, 7, v1
v_lshl_add_u32 v2, v3, 4, v2
v_lshrrev_b32 v4, 4, v1
v_lshl_add_u32 v2, v4, 7, v2
s_lshl_b32 s26, s94, 11
s_lshl_b32 s27, s25, 9
s_add_u32 s26, s26, s27
v_add_u32 v116, s26, v2
v_add_u32 v117, 16384, v116
s_lshl_b32 s26, s94, 13
s_add_u32 s26, s26, s27
v_lshl_add_u32 v118, v1, 3, s26
v_add_u32 v119, 4096, v118
s_lshl_b32 s26, s94, 14
s_add_u32 s27, s27, s26
s_lshl_b32 s26, s95, 11
s_add_u32 s27, s27, s26
s_add_u32 s27, s27, 0x4400000
v_lshl_add_u32 v121, v1, 3, s27
s_lshl_b32 s26, s95, 8
s_lshl_b32 s27, s25, 6
s_add_u32 s26, s26, s27
v_lshl_add_u32 v4, v4, 4, s26
v_and_b32 v3, 1, v1
v_lshl_add_u32 v3, v3, 3, v4
v_bfe_u32 v2, v1, 1, 3
v_lshl_add_u32 v120, v2, 11, v3
s_lshl_b32 s26, s94, 14
v_add_u32 v120, s26, v120
s_cmp_eq_u32 s98, 0
s_cselect_b32 s43, s44, s43
s_cselect_b32 s60, 0, s60
s_lshl_b32 s75, s94, 10
s_lshl_b32 s68, s98, 12
s_add_u32 s75, s75, s68
s_add_u32 s75, s75, 0x6a02e00
v_lshrrev_b32 v2, 2, v1
v_and_b32 v3, 3, v1
v_lshlrev_b32 v3, 2, v3
v_lshl_add_u32 v2, v2, 7, v3
v_add_u32 v2, s75, v2
s_cmp_eq_u32 s25, 0
s_cselect_b32 s50, 0xffffffff, 0
s_mov_b32 s51, 0
v_cndmask_b32 v109, v11, v2, s[50:51]
s_lshl_b32 s75, s73, 7
s_add_u32 s75, s75, 0x6a05d80
v_lshl_add_u32 v2, v1, 2, s75
s_cmp_eq_u32 s25, 0
s_cselect_b32 s51, 15, 0
s_mov_b32 vcc_lo, 0
s_mov_b32 vcc_hi, s51
v_cndmask_b32 v109, v109, v2, vcc
s_waitcnt vmcnt(16)
s_barrier
ds_read_b64_tr_b16 a[0:1], v94 offset:0
ds_read_b64_tr_b16 a[2:3], v94 offset:2048
ds_read_b64_tr_b16 a[4:5], v95 offset:0
ds_read_b64_tr_b16 a[6:7], v95 offset:2048
ds_read_b64_tr_b16 a[8:9], v94 offset:8192
ds_read_b64_tr_b16 a[10:11], v94 offset:10240
ds_read_b64_tr_b16 a[12:13], v95 offset:8192
ds_read_b64_tr_b16 a[14:15], v95 offset:10240
ds_read_b64_tr_b16 a[16:17], v94 offset:16384
ds_read_b64_tr_b16 a[18:19], v94 offset:18432
ds_read_b64_tr_b16 a[20:21], v95 offset:16384
ds_read_b64_tr_b16 a[22:23], v95 offset:18432
ds_read_b64_tr_b16 a[24:25], v94 offset:24576
ds_read_b64_tr_b16 a[26:27], v94 offset:26624
ds_read_b64_tr_b16 a[28:29], v95 offset:24576
ds_read_b64_tr_b16 a[30:31], v95 offset:26624
ds_read_b64_tr_b16 a[32:33], v94 offset:32768
ds_read_b64_tr_b16 a[34:35], v94 offset:34816
ds_read_b64_tr_b16 a[36:37], v95 offset:32768
ds_read_b64_tr_b16 a[38:39], v95 offset:34816
ds_read_b64_tr_b16 a[40:41], v94 offset:40960
ds_read_b64_tr_b16 a[42:43], v94 offset:43008
ds_read_b64_tr_b16 a[44:45], v95 offset:40960
ds_read_b64_tr_b16 a[46:47], v95 offset:43008
ds_read_b64_tr_b16 a[48:49], v94 offset:49152
ds_read_b64_tr_b16 a[50:51], v94 offset:51200
ds_read_b64_tr_b16 a[52:53], v95 offset:49152
ds_read_b64_tr_b16 a[54:55], v95 offset:51200
ds_read_b64_tr_b16 a[56:57], v94 offset:57344
ds_read_b64_tr_b16 a[58:59], v94 offset:59392
ds_read_b64_tr_b16 a[60:61], v95 offset:57344
ds_read_b64_tr_b16 a[62:63], v95 offset:59392
s_waitcnt lgkmcnt(0)
s_barrier
s_lshl_b32 m0, s25, 14
s_mul_i32 s26, s30, 512
buffer_load_dwordx4 v92, s[12:15], s26 offen nt lds
s_add_u32 m0, m0, 1024
s_add_u32 s26, s26, s49
buffer_load_dwordx4 v93, s[12:15], s26 offen nt lds
s_add_u32 m0, m0, 1024
s_add_u32 s26, s26, s49
buffer_load_dwordx4 v92, s[12:15], s26 offen nt lds
s_add_u32 m0, m0, 1024
s_add_u32 s26, s26, s49
buffer_load_dwordx4 v93, s[12:15], s26 offen nt lds
s_add_u32 m0, m0, 1024
s_add_u32 s26, s26, s49
buffer_load_dwordx4 v92, s[12:15], s26 offen nt lds
s_add_u32 m0, m0, 1024
s_add_u32 s26, s26, s49
buffer_load_dwordx4 v93, s[12:15], s26 offen nt lds
s_add_u32 m0, m0, 1024
s_add_u32 s26, s26, s49
buffer_load_dwordx4 v92, s[12:15], s26 offen nt lds
s_add_u32 m0, m0, 1024
s_add_u32 s26, s26, s49
buffer_load_dwordx4 v93, s[12:15], s26 offen nt lds
s_add_u32 m0, m0, 1024
s_add_u32 s26, s26, s49
buffer_load_dwordx4 v92, s[12:15], s26 offen nt lds
s_add_u32 m0, m0, 1024
s_add_u32 s26, s26, s49
buffer_load_dwordx4 v93, s[12:15], s26 offen nt lds
s_add_u32 m0, m0, 1024
s_add_u32 s26, s26, s49
buffer_load_dwordx4 v92, s[12:15], s26 offen nt lds
s_add_u32 m0, m0, 1024
s_add_u32 s26, s26, s49
buffer_load_dwordx4 v93, s[12:15], s26 offen nt lds
s_add_u32 m0, m0, 1024
s_add_u32 s26, s26, s49
buffer_load_dwordx4 v92, s[12:15], s26 offen nt lds
s_add_u32 m0, m0, 1024
s_add_u32 s26, s26, s49
buffer_load_dwordx4 v93, s[12:15], s26 offen nt lds
s_add_u32 m0, m0, 1024
s_add_u32 s26, s26, s49
buffer_load_dwordx4 v92, s[12:15], s26 offen nt lds
s_add_u32 m0, m0, 1024
s_add_u32 s26, s26, s49
buffer_load_dwordx4 v93, s[12:15], s26 offen nt lds
s_waitcnt vmcnt(16)
s_barrier
ds_read_b64_tr_b16 a[64:65], v96 offset:0
ds_read_b64_tr_b16 a[66:67], v96 offset:2048
ds_read_b64_tr_b16 a[68:69], v97 offset:0
ds_read_b64_tr_b16 a[70:71], v97 offset:2048
ds_read_b64_tr_b16 a[72:73], v96 offset:8192
ds_read_b64_tr_b16 a[74:75], v96 offset:10240
ds_read_b64_tr_b16 a[76:77], v97 offset:8192
ds_read_b64_tr_b16 a[78:79], v97 offset:10240
ds_read_b64_tr_b16 a[80:81], v96 offset:16384
ds_read_b64_tr_b16 a[82:83], v96 offset:18432
ds_read_b64_tr_b16 a[84:85], v97 offset:16384
ds_read_b64_tr_b16 a[86:87], v97 offset:18432
ds_read_b64_tr_b16 a[88:89], v96 offset:24576
ds_read_b64_tr_b16 a[90:91], v96 offset:26624
ds_read_b64_tr_b16 a[92:93], v97 offset:24576
ds_read_b64_tr_b16 a[94:95], v97 offset:26624
ds_read_b64_tr_b16 a[96:97], v96 offset:32768
ds_read_b64_tr_b16 a[98:99], v96 offset:34816
ds_read_b64_tr_b16 a[100:101], v97 offset:32768
ds_read_b64_tr_b16 a[102:103], v97 offset:34816
ds_read_b64_tr_b16 a[104:105], v96 offset:40960
ds_read_b64_tr_b16 a[106:107], v96 offset:43008
ds_read_b64_tr_b16 a[108:109], v97 offset:40960
ds_read_b64_tr_b16 a[110:111], v97 offset:43008
ds_read_b64_tr_b16 a[112:113], v96 offset:49152
ds_read_b64_tr_b16 a[114:115], v96 offset:51200
ds_read_b64_tr_b16 a[116:117], v97 offset:49152
ds_read_b64_tr_b16 a[118:119], v97 offset:51200
ds_read_b64_tr_b16 a[120:121], v96 offset:57344
ds_read_b64_tr_b16 a[122:123], v96 offset:59392
ds_read_b64_tr_b16 a[124:125], v97 offset:57344
ds_read_b64_tr_b16 a[126:127], v97 offset:59392
s_waitcnt lgkmcnt(0)
s_barrier
s_lshl_b32 m0, s25, 14
s_add_u32 m0, m0, 0x10000
s_mul_i32 s26, s30, 768
buffer_load_dwordx4 v92, s[12:15], s26 offen nt lds
s_add_u32 m0, m0, 1024
s_add_u32 s26, s26, s49
buffer_load_dwordx4 v93, s[12:15], s26 offen nt lds
s_add_u32 m0, m0, 1024
s_add_u32 s26, s26, s49
buffer_load_dwordx4 v92, s[12:15], s26 offen nt lds
s_add_u32 m0, m0, 1024
s_add_u32 s26, s26, s49
buffer_load_dwordx4 v93, s[12:15], s26 offen nt lds
s_add_u32 m0, m0, 1024
s_add_u32 s26, s26, s49
buffer_load_dwordx4 v92, s[12:15], s26 offen nt lds
s_add_u32 m0, m0, 1024
s_add_u32 s26, s26, s49
buffer_load_dwordx4 v93, s[12:15], s26 offen nt lds
s_add_u32 m0, m0, 1024
s_add_u32 s26, s26, s49
buffer_load_dwordx4 v92, s[12:15], s26 offen nt lds
s_add_u32 m0, m0, 1024
s_add_u32 s26, s26, s49
buffer_load_dwordx4 v93, s[12:15], s26 offen nt lds
s_add_u32 m0, m0, 1024
s_add_u32 s26, s26, s49
buffer_load_dwordx4 v92, s[12:15], s26 offen nt lds
s_add_u32 m0, m0, 1024
s_add_u32 s26, s26, s49
buffer_load_dwordx4 v93, s[12:15], s26 offen nt lds
s_add_u32 m0, m0, 1024
s_add_u32 s26, s26, s49
buffer_load_dwordx4 v92, s[12:15], s26 offen nt lds
s_add_u32 m0, m0, 1024
s_add_u32 s26, s26, s49
buffer_load_dwordx4 v93, s[12:15], s26 offen nt lds
s_add_u32 m0, m0, 1024
s_add_u32 s26, s26, s49
buffer_load_dwordx4 v92, s[12:15], s26 offen nt lds
s_add_u32 m0, m0, 1024
s_add_u32 s26, s26, s49
buffer_load_dwordx4 v93, s[12:15], s26 offen nt lds
s_add_u32 m0, m0, 1024
s_add_u32 s26, s26, s49
buffer_load_dwordx4 v92, s[12:15], s26 offen nt lds
s_add_u32 m0, m0, 1024
s_add_u32 s26, s26, s49
buffer_load_dwordx4 v93, s[12:15], s26 offen nt lds
s_waitcnt vmcnt(16)
s_barrier
ds_read_b64_tr_b16 a[128:129], v94 offset:0
ds_read_b64_tr_b16 a[130:131], v94 offset:2048
ds_read_b64_tr_b16 a[132:133], v95 offset:0
ds_read_b64_tr_b16 a[134:135], v95 offset:2048
ds_read_b64_tr_b16 a[136:137], v94 offset:8192
ds_read_b64_tr_b16 a[138:139], v94 offset:10240
ds_read_b64_tr_b16 a[140:141], v95 offset:8192
ds_read_b64_tr_b16 a[142:143], v95 offset:10240
ds_read_b64_tr_b16 a[144:145], v94 offset:16384
ds_read_b64_tr_b16 a[146:147], v94 offset:18432
ds_read_b64_tr_b16 a[148:149], v95 offset:16384
ds_read_b64_tr_b16 a[150:151], v95 offset:18432
ds_read_b64_tr_b16 a[152:153], v94 offset:24576
ds_read_b64_tr_b16 a[154:155], v94 offset:26624
ds_read_b64_tr_b16 a[156:157], v95 offset:24576
ds_read_b64_tr_b16 a[158:159], v95 offset:26624
ds_read_b64_tr_b16 a[160:161], v94 offset:32768
ds_read_b64_tr_b16 a[162:163], v94 offset:34816
ds_read_b64_tr_b16 a[164:165], v95 offset:32768
ds_read_b64_tr_b16 a[166:167], v95 offset:34816
ds_read_b64_tr_b16 a[168:169], v94 offset:40960
ds_read_b64_tr_b16 a[170:171], v94 offset:43008
ds_read_b64_tr_b16 a[172:173], v95 offset:40960
ds_read_b64_tr_b16 a[174:175], v95 offset:43008
ds_read_b64_tr_b16 a[176:177], v94 offset:49152
ds_read_b64_tr_b16 a[178:179], v94 offset:51200
ds_read_b64_tr_b16 a[180:181], v95 offset:49152
ds_read_b64_tr_b16 a[182:183], v95 offset:51200
ds_read_b64_tr_b16 a[184:185], v94 offset:57344
ds_read_b64_tr_b16 a[186:187], v94 offset:59392
ds_read_b64_tr_b16 a[188:189], v95 offset:57344
ds_read_b64_tr_b16 a[190:191], v95 offset:59392
s_waitcnt lgkmcnt(0)
s_barrier
s_waitcnt vmcnt(0)
s_barrier
ds_read_b64_tr_b16 a[192:193], v96 offset:0
ds_read_b64_tr_b16 a[194:195], v96 offset:2048
ds_read_b64_tr_b16 a[196:197], v97 offset:0
ds_read_b64_tr_b16 a[198:199], v97 offset:2048
ds_read_b64_tr_b16 a[200:201], v96 offset:8192
ds_read_b64_tr_b16 a[202:203], v96 offset:10240
ds_read_b64_tr_b16 a[204:205], v97 offset:8192
ds_read_b64_tr_b16 a[206:207], v97 offset:10240
ds_read_b64_tr_b16 a[208:209], v96 offset:16384
ds_read_b64_tr_b16 a[210:211], v96 offset:18432
ds_read_b64_tr_b16 a[212:213], v97 offset:16384
ds_read_b64_tr_b16 a[214:215], v97 offset:18432
ds_read_b64_tr_b16 a[216:217], v96 offset:24576
ds_read_b64_tr_b16 a[218:219], v96 offset:26624
ds_read_b64_tr_b16 a[220:221], v97 offset:24576
ds_read_b64_tr_b16 a[222:223], v97 offset:26624
ds_read_b64_tr_b16 a[224:225], v96 offset:32768
ds_read_b64_tr_b16 a[226:227], v96 offset:34816
ds_read_b64_tr_b16 a[228:229], v97 offset:32768
ds_read_b64_tr_b16 a[230:231], v97 offset:34816
ds_read_b64_tr_b16 a[232:233], v96 offset:40960
ds_read_b64_tr_b16 a[234:235], v96 offset:43008
ds_read_b64_tr_b16 a[236:237], v97 offset:40960
ds_read_b64_tr_b16 a[238:239], v97 offset:43008
ds_read_b64_tr_b16 a[240:241], v96 offset:49152
ds_read_b64_tr_b16 a[242:243], v96 offset:51200
ds_read_b64_tr_b16 a[244:245], v97 offset:49152
ds_read_b64_tr_b16 a[246:247], v97 offset:51200
ds_read_b64_tr_b16 a[248:249], v96 offset:57344
ds_read_b64_tr_b16 a[250:251], v96 offset:59392
ds_read_b64_tr_b16 a[252:253], v97 offset:57344
ds_read_b64_tr_b16 a[254:255], v97 offset:59392
s_waitcnt lgkmcnt(0)
s_barrier
s_cmp_eq_u32 s98, 0
s_cselect_b32 s38, 1, 4
s_cselect_b32 s68, 4096, 0
main_kernel_gw:
buffer_load_dword v111, v109, s[8:11], s68 offen sc1
s_waitcnt vmcnt(0)
v_cmp_gt_u32 vcc, s38, v111
s_and_b64 vcc, vcc, s[50:51]
s_cbranch_scc0 main_kernel_gw_ok
s_add_u32 s54, s54, 1
s_cmp_ge_u32 s54, 131072
s_cbranch_scc1 main_kernel_gw_ok
s_sleep 4
s_branch main_kernel_gw
main_kernel_gw_ok:
s_mov_b32 s68, 0
main_kernel_gx:
buffer_load_dword v111, v109, s[8:11], 0 offen sc1
s_waitcnt vmcnt(0)
v_cmp_gt_u32 vcc, s38, v111
s_and_b64 vcc, vcc, s[50:51]
s_cbranch_scc0 main_kernel_gx_ok
s_add_u32 s54, s54, 1
s_cmp_ge_u32 s54, 131072
s_cbranch_scc1 main_kernel_gx_ok
s_sleep 4
s_branch main_kernel_gx
main_kernel_gx_ok:
s_cmp_lg_u32 s3, 0
s_cbranch_scc1 main_kernel_ws
s_barrier
s_mov_b32 s26, 0
s_mov_b32 s41, 0x40000000
s_mov_b32 s42, 0x40000000
s_mov_b32 s55, 0x40000000
s_mov_b32 s46, 0x40000000
s_mov_b32 s47, 0x40000000
s_mov_b32 s56, 0x40000000
s_mov_b32 s57, 0
s_mov_b32 s58, 0
s_mov_b32 s59, 0
s_mov_b32 s64, 0
s_mov_b32 s65, 0
s_mov_b32 s66, 0xfffe0000
v_mov_b32 v132, 0
v_mov_b32 v133, 0
v_mov_b32 v134, 0
v_mov_b32 v135, 0
v_mov_b32 v136, 0
v_mov_b32 v137, 0
v_mov_b32 v138, 0
v_mov_b32 v139, 0
s_sub_u32 s37, s37, 2
s_mov_b32 s20, s52
s_mov_b32 s36, 0
s_lshr_b32 s24, s37, 1
s_sub_u32 s24, s24, 1
s_mov_b32 m0, s22
s_nop 0
buffer_load_dwordx4 v8, s[8:11], s20 offen sc1 lds
s_add_u32 s36, s36, 1
buffer_load_dword v2, v11, s[8:11], 0 offen
buffer_load_dwordx4 v8, s[8:11], s20 offen offset:1024 sc1 lds
buffer_load_dwordx4 v8, s[8:11], s20 offen offset:2048 sc1 lds
buffer_load_dwordx4 v8, s[8:11], s20 offen offset:3072 sc1 lds
s_add_u32 s20, s20, s23
s_add_u32 m0, s22, 16384
s_nop 0
buffer_load_dwordx4 v8, s[8:11], s20 offen sc1 lds
buffer_load_dwordx4 v8, s[8:11], s20 offen offset:1024 sc1 lds
buffer_load_dwordx4 v8, s[8:11], s20 offen offset:2048 sc1 lds
buffer_load_dword v2, v11, s[8:11], 0 offen
buffer_load_dword v2, v11, s[8:11], 0 offen
buffer_load_dword v2, v11, s[8:11], 0 offen
buffer_load_dwordx4 v8, s[8:11], s20 offen offset:3072 sc1 lds
s_add_u32 s20, s20, s23
buffer_load_dword v2, v11, s[8:11], 0 offen
s_add_u32 m0, s22, 32768
buffer_load_dword v2, v11, s[8:11], 0 offen
buffer_load_dwordx4 v8, s[8:11], s20 offen sc1 lds
buffer_load_dword v2, v11, s[8:11], 0 offen
buffer_load_dwordx4 v8, s[8:11], s20 offen offset:1024 sc1 lds
buffer_load_dwordx4 v8, s[8:11], s20 offen offset:2048 sc1 lds
buffer_load_dwordx4 v8, s[8:11], s20 offen offset:3072 sc1 lds
s_add_u32 s20, s20, s23
s_add_u32 m0, s22, 49152
s_nop 0
buffer_load_dwordx4 v8, s[8:11], s20 offen sc1 lds
buffer_load_dword v2, v11, s[8:11], 0 offen
buffer_load_dword v2, v11, s[8:11], 0 offen
buffer_load_dwordx4 v8, s[8:11], s20 offen offset:1024 sc1 lds
buffer_load_dwordx4 v8, s[8:11], s20 offen offset:2048 sc1 lds
s_cmp_le_u32 s36, s67
s_cselect_b32 s28, 212992, s53
buffer_load_dwordx4 v8, s[8:11], s20 offen offset:3072 sc1 lds
s_add_u32 s20, s20, s28
buffer_load_dword v2, v11, s[8:11], 0 offen
s_add_u32 m0, s22, 65536
s_cmp_lt_u32 s36, s37
s_cselect_b32 s20, s20, 0x40000000
buffer_load_dwordx4 v8, s[8:11], s20 offen sc1 lds
s_add_u32 s36, s36, 1
buffer_load_dword v2, v11, s[8:11], 0 offen
buffer_load_dwordx4 v8, s[8:11], s20 offen offset:1024 sc1 lds
buffer_load_dwordx4 v8, s[8:11], s20 offen offset:2048 sc1 lds
buffer_load_dwordx4 v8, s[8:11], s20 offen offset:3072 sc1 lds
s_add_u32 s20, s20, s23
s_add_u32 m0, s22, 81920
s_nop 0
buffer_load_dwordx4 v8, s[8:11], s20 offen sc1 lds
buffer_load_dwordx4 v8, s[8:11], s20 offen offset:1024 sc1 lds
s_waitcnt vmcnt(28)
s_barrier
ds_read_b128 v[12:15], v6 offset:0
ds_read_b128 v[16:19], v6 offset:256
ds_read_b128 v[20:23], v6 offset:2048
ds_read_b128 v[24:27], v6 offset:2304
ds_read_b128 v[28:31], v6 offset:4096
ds_read_b128 v[32:35], v6 offset:4352
s_waitcnt lgkmcnt(0)
.p2align 3
main_kernel_wj0_lp:
v_mfma_f32_16x16x32_bf16 v[44:47], a[0:3], v[12:15], 0
ds_read_b128 v[36:39], v6 offset:6144
v_mfma_f32_16x16x32_bf16 v[52:55], a[0:3], v[16:19], 0
ds_read_b128 v[40:43], v6 offset:6400
v_cvt_pk_bf16_f32 v84, v60, v61
v_mfma_f32_16x16x32_bf16 v[56:59], a[4:7], v[16:19], 0
v_add_u32 v63, s64, v63
v_mfma_f32_16x16x32_bf16 v[48:51], a[4:7], v[12:15], 0
s_waitcnt lgkmcnt(4)
v_cvt_pk_bf16_f32 v85, v62, s65
v_mfma_f32_16x16x32_bf16 v[44:47], a[8:11], v[20:23], v[44:47]
ds_read_b128 v[12:15], v6 offset:8192
v_bfi_b32 v85, s66, v63, v85
v_mfma_f32_16x16x32_bf16 v[52:55], a[8:11], v[24:27], v[52:55]
ds_read_b128 v[16:19], v6 offset:8448
v_cvt_pk_bf16_f32 v86, v64, v65
v_mfma_f32_16x16x32_bf16 v[56:59], a[12:15], v[24:27], v[56:59]
buffer_load_dwordx4 v8, s[8:11], s20 offen offset:2048 sc1 lds
v_add_u32 v67, s64, v67
v_mfma_f32_16x16x32_bf16 v[48:51], a[12:15], v[20:23], v[48:51]
s_waitcnt lgkmcnt(4)
v_cvt_pk_bf16_f32 v87, v66, s65
v_mfma_f32_16x16x32_bf16 v[44:47], a[16:19], v[28:31], v[44:47]
buffer_load_dwordx2 v[124:125], v118, s[8:11], s42 offen offset:0 sc1
ds_read_b128 v[20:23], v6 offset:10240
v_mfma_f32_16x16x32_bf16 v[52:55], a[16:19], v[32:35], v[52:55]
ds_read_b128 v[24:27], v6 offset:10496
v_bfi_b32 v87, s66, v67, v87
v_mfma_f32_16x16x32_bf16 v[56:59], a[20:23], v[32:35], v[56:59]
buffer_store_dwordx4 v[84:87], v116, s[8:11], s41 offen
v_cvt_pk_bf16_f32 v88, v68, v69
v_mfma_f32_16x16x32_bf16 v[48:51], a[20:23], v[28:31], v[48:51]
s_waitcnt lgkmcnt(4)
v_add_u32 v71, s64, v71
v_mfma_f32_16x16x32_bf16 v[44:47], a[24:27], v[36:39], v[44:47]
buffer_load_dwordx2 v[126:127], v118, s[8:11], s42 offen offset:2048 sc1
ds_read_b128 v[28:31], v6 offset:12288
v_mfma_f32_16x16x32_bf16 v[52:55], a[24:27], v[40:43], v[52:55]
ds_read_b128 v[32:35], v6 offset:12544
v_cvt_pk_bf16_f32 v89, v70, s65
v_mfma_f32_16x16x32_bf16 v[56:59], a[28:31], v[40:43], v[56:59]
buffer_load_dwordx4 v8, s[8:11], s20 offen offset:3072 sc1 lds
v_bfi_b32 v89, s66, v71, v89
v_mfma_f32_16x16x32_bf16 v[48:51], a[28:31], v[36:39], v[48:51]
s_waitcnt lgkmcnt(4)
v_cvt_pk_bf16_f32 v90, v72, v73
s_add_u32 s20, s20, s23
v_mfma_f32_16x16x32_bf16 v[44:47], a[32:35], v[12:15], v[44:47]
buffer_load_dwordx2 v[128:129], v119, s[8:11], s42 offen offset:0 sc1
ds_read_b128 v[36:39], v6 offset:14336
v_mfma_f32_16x16x32_bf16 v[52:55], a[32:35], v[16:19], v[52:55]
s_add_u32 m0, s22, 98304
ds_read_b128 v[40:43], v6 offset:14592
v_add_u32 v75, s64, v75
v_mfma_f32_16x16x32_bf16 v[56:59], a[36:39], v[16:19], v[56:59]
buffer_load_dwordx2 v[130:131], v119, s[8:11], s42 offen offset:2048 sc1
v_cvt_pk_bf16_f32 v91, v74, s65
v_mfma_f32_16x16x32_bf16 v[48:51], a[36:39], v[12:15], v[48:51]
s_waitcnt lgkmcnt(4)
v_bfi_b32 v91, s66, v75, v91
s_waitcnt vmcnt(26)
v_mfma_f32_16x16x32_bf16 v[44:47], a[40:43], v[20:23], v[44:47]
s_waitcnt vmcnt(21)
s_barrier
ds_read_b128 v[12:15], v6 offset:16384
v_mfma_f32_16x16x32_bf16 v[52:55], a[40:43], v[24:27], v[52:55]
ds_read_b128 v[16:19], v6 offset:16640
v_bitop3_b32 v162, v133, v135, s59 bitop3:0x7e
v_mfma_f32_16x16x32_bf16 v[56:59], a[44:47], v[24:27], v[56:59]
buffer_load_dwordx4 v8, s[8:11], s20 offen sc1 lds
v_bitop3_b32 v163, v137, v139, s59 bitop3:0x7e
v_mfma_f32_16x16x32_bf16 v[48:51], a[44:47], v[20:23], v[48:51]
s_waitcnt lgkmcnt(4)
v_or_b32 v162, v162, v163
v_mfma_f32_16x16x32_bf16 v[44:47], a[48:51], v[28:31], v[44:47]
ds_read_b128 v[20:23], v6 offset:18432
v_and_b32 v162, 0x10000, v162
v_mfma_f32_16x16x32_bf16 v[52:55], a[48:51], v[32:35], v[52:55]
ds_read_b128 v[24:27], v6 offset:18688
v_cmp_ne_u32 vcc, 0, v162
v_mfma_f32_16x16x32_bf16 v[56:59], a[52:55], v[32:35], v[56:59]
buffer_store_dwordx4 v[88:91], v117, s[8:11], s41 offen
v_mfma_f32_16x16x32_bf16 v[48:51], a[52:55], v[28:31], v[48:51]
s_waitcnt lgkmcnt(4)
v_mfma_f32_16x16x32_bf16 v[44:47], a[56:59], v[36:39], v[44:47]
ds_read_b128 v[28:31], v6 offset:20480
v_mfma_f32_16x16x32_bf16 v[52:55], a[56:59], v[40:43], v[52:55]
ds_read_b128 v[32:35], v6 offset:20736
v_mfma_f32_16x16x32_bf16 v[56:59], a[60:63], v[40:43], v[56:59]
buffer_load_dwordx4 v8, s[8:11], s20 offen offset:1024 sc1 lds
v_mfma_f32_16x16x32_bf16 v[48:51], a[60:63], v[36:39], v[48:51]
s_waitcnt lgkmcnt(4)
v_mfma_f32_16x16x32_bf16 v[44:47], a[64:67], v[12:15], v[44:47]
ds_read_b128 v[36:39], v6 offset:22528
v_mfma_f32_16x16x32_bf16 v[52:55], a[64:67], v[16:19], v[52:55]
ds_read_b128 v[40:43], v6 offset:22784
v_mfma_f32_16x16x32_bf16 v[56:59], a[68:71], v[16:19], v[56:59]
s_cbranch_vccnz main_kernel_wj0_c0
main_kernel_wj0_k0:
v_mfma_f32_16x16x32_bf16 v[48:51], a[68:71], v[12:15], v[48:51]
s_waitcnt lgkmcnt(4)
v_lshlrev_b32 v140, 16, v132
v_mfma_f32_16x16x32_bf16 v[44:47], a[72:75], v[20:23], v[44:47]
ds_read_b128 v[12:15], v6 offset:24576
v_and_b32 v141, 0xffff0000, v132
v_mfma_f32_16x16x32_bf16 v[52:55], a[72:75], v[24:27], v[52:55]
ds_read_b128 v[16:19], v6 offset:24832
v_lshlrev_b32 v142, 16, v133
v_mfma_f32_16x16x32_bf16 v[56:59], a[76:79], v[24:27], v[56:59]
buffer_load_dwordx4 v8, s[8:11], s20 offen offset:2048 sc1 lds
v_and_b32 v143, 0xffff0000, v133
v_mfma_f32_16x16x32_bf16 v[48:51], a[76:79], v[20:23], v[48:51]
s_waitcnt lgkmcnt(4)
v_lshlrev_b32 v144, 16, v134
v_mfma_f32_16x16x32_bf16 v[44:47], a[80:83], v[28:31], v[44:47]
ds_read_b128 v[20:23], v6 offset:26624
v_and_b32 v145, 0xffff0000, v134
v_mfma_f32_16x16x32_bf16 v[52:55], a[80:83], v[32:35], v[52:55]
ds_read_b128 v[24:27], v6 offset:26880
v_lshlrev_b32 v146, 16, v135
v_mfma_f32_16x16x32_bf16 v[56:59], a[84:87], v[32:35], v[56:59]
v_and_b32 v147, 0xffff0000, v135
v_mfma_f32_16x16x32_bf16 v[48:51], a[84:87], v[28:31], v[48:51]
s_waitcnt lgkmcnt(4)
v_add_f32 v140, v140, v144
v_mfma_f32_16x16x32_bf16 v[44:47], a[88:91], v[36:39], v[44:47]
ds_read_b128 v[28:31], v6 offset:28672
v_add_f32 v141, v141, v145
v_mfma_f32_16x16x32_bf16 v[52:55], a[88:91], v[40:43], v[52:55]
ds_read_b128 v[32:35], v6 offset:28928
v_add_f32 v142, v142, v146
v_mfma_f32_16x16x32_bf16 v[56:59], a[92:95], v[40:43], v[56:59]
buffer_load_dwordx4 v8, s[8:11], s20 offen offset:3072 sc1 lds
v_add_f32 v143, v143, v147
v_mfma_f32_16x16x32_bf16 v[48:51], a[92:95], v[36:39], v[48:51]
s_waitcnt lgkmcnt(4)
v_lshlrev_b32 v144, 16, v136
s_add_u32 s20, s20, s23
v_mfma_f32_16x16x32_bf16 v[44:47], a[96:99], v[12:15], v[44:47]
s_add_u32 m0, s22, 114688
ds_read_b128 v[36:39], v6 offset:30720
v_and_b32 v145, 0xffff0000, v136
v_mfma_f32_16x16x32_bf16 v[52:55], a[96:99], v[16:19], v[52:55]
ds_read_b128 v[40:43], v6 offset:30976
v_lshlrev_b32 v146, 16, v137
v_mfma_f32_16x16x32_bf16 v[56:59], a[100:103], v[16:19], v[56:59]
v_and_b32 v147, 0xffff0000, v137
v_mfma_f32_16x16x32_bf16 v[48:51], a[100:103], v[12:15], v[48:51]
s_waitcnt lgkmcnt(4)
v_add_f32 v140, v140, v144
v_mfma_f32_16x16x32_bf16 v[44:47], a[104:107], v[20:23], v[44:47]
ds_read_b128 v[12:15], v6 offset:32768
v_add_f32 v141, v141, v145
v_mfma_f32_16x16x32_bf16 v[52:55], a[104:107], v[24:27], v[52:55]
ds_read_b128 v[16:19], v6 offset:33024
v_add_f32 v142, v142, v146
v_mfma_f32_16x16x32_bf16 v[56:59], a[108:111], v[24:27], v[56:59]
buffer_load_dwordx4 v8, s[8:11], s20 offen sc1 lds
v_add_f32 v143, v143, v147
v_mfma_f32_16x16x32_bf16 v[48:51], a[108:111], v[20:23], v[48:51]
s_waitcnt lgkmcnt(4)
v_lshlrev_b32 v144, 16, v138
v_mfma_f32_16x16x32_bf16 v[44:47], a[112:115], v[28:31], v[44:47]
buffer_load_dwordx2 v[152:153], v121, s[8:11], s47 offen sc1
ds_read_b128 v[20:23], v6 offset:34816
v_mfma_f32_16x16x32_bf16 v[52:55], a[112:115], v[32:35], v[52:55]
ds_read_b128 v[24:27], v6 offset:35072
v_and_b32 v145, 0xffff0000, v138
v_mfma_f32_16x16x32_bf16 v[56:59], a[116:119], v[32:35], v[56:59]
buffer_load_dwordx2 v[154:155], v120, s[16:19], s47 offen
v_lshlrev_b32 v146, 16, v139
v_mfma_f32_16x16x32_bf16 v[48:51], a[116:119], v[28:31], v[48:51]
s_waitcnt lgkmcnt(4)
v_and_b32 v147, 0xffff0000, v139
s_add_i32 s38, s36, s61
v_mfma_f32_16x16x32_bf16 v[44:47], a[120:123], v[36:39], v[44:47]
s_lshr_b32 s75, s36, 1
ds_read_b128 v[28:31], v6 offset:36864
v_add_f32 v140, v140, v144
v_mfma_f32_16x16x32_bf16 v[52:55], a[120:123], v[40:43], v[52:55]
s_max_i32 s38, s38, s75
ds_read_b128 v[32:35], v6 offset:37120
v_add_f32 v141, v141, v145
v_mfma_f32_16x16x32_bf16 v[56:59], a[124:127], v[40:43], v[56:59]
buffer_load_dwordx4 v8, s[8:11], s20 offen offset:1024 sc1 lds
v_add_f32 v142, v142, v146
v_mfma_f32_16x16x32_bf16 v[48:51], a[124:127], v[36:39], v[48:51]
s_waitcnt lgkmcnt(4)
v_add_f32 v143, v143, v147
s_min_i32 s38, s38, 29
v_mfma_f32_16x16x32_bf16 v[44:47], a[128:131], v[12:15], v[44:47]
s_waitcnt vmcnt(27)
ds_read_b128 v[36:39], v6 offset:38912
v_lshlrev_b32 v144, 16, v156
v_mfma_f32_16x16x32_bf16 v[52:55], a[128:131], v[16:19], v[52:55]
s_mov_b32 s55, s42
ds_read_b128 v[40:43], v6 offset:39168
v_and_b32 v145, 0xffff0000, v156
v_mfma_f32_16x16x32_bf16 v[56:59], a[132:135], v[16:19], v[56:59]
s_mov_b32 s42, s41
v_lshlrev_b32 v146, 16, v157
s_mov_b32 s41, s43
v_mfma_f32_16x16x32_bf16 v[48:51], a[132:135], v[12:15], v[48:51]
s_waitcnt lgkmcnt(4)
v_and_b32 v147, 0xffff0000, v157
s_mov_b32 s59, s58
v_mfma_f32_16x16x32_bf16 v[44:47], a[136:139], v[20:23], v[44:47]
s_mov_b32 s58, s57
ds_read_b128 v[12:15], v6 offset:40960
v_lshlrev_b32 v148, 16, v158
v_mfma_f32_16x16x32_bf16 v[52:55], a[136:139], v[24:27], v[52:55]
s_mov_b32 s57, s60
ds_read_b128 v[16:19], v6 offset:41216
v_and_b32 v149, 0xffff0000, v158
v_mfma_f32_16x16x32_bf16 v[56:59], a[140:143], v[24:27], v[56:59]
s_waitcnt vmcnt(21)
buffer_load_dwordx4 v8, s[8:11], s20 offen offset:2048 sc1 lds
v_mfma_f32_16x16x32_bf16 v[48:51], a[140:143], v[20:23], v[48:51]
s_waitcnt lgkmcnt(4)
v_cmp_ge_u32 s[62:63], s38, v111
s_cmp_le_u32 s36, s67
v_mfma_f32_16x16x32_bf16 v[44:47], a[144:147], v[28:31], v[44:47]
s_cselect_b32 s28, 212992, s53
ds_read_b128 v[20:23], v6 offset:43008
v_lshlrev_b32 v150, 16, v159
v_mfma_f32_16x16x32_bf16 v[52:55], a[144:147], v[32:35], v[52:55]
s_and_b64 s[62:63], s[62:63], s[50:51]
ds_read_b128 v[24:27], v6 offset:43264
v_and_b32 v151, 0xffff0000, v159
v_mfma_f32_16x16x32_bf16 v[56:59], a[148:151], v[32:35], v[56:59]
s_cbranch_scc1 main_kernel_wj0_a0
main_kernel_wj0_b0:
s_add_u32 s43, s43, 32768
v_mfma_f32_16x16x32_bf16 v[48:51], a[148:151], v[28:31], v[48:51]
s_waitcnt lgkmcnt(4)
v_fma_f32 v140, v140, v144, v148
s_sub_u32 s27, s43, s44
v_mfma_f32_16x16x32_bf16 v[44:47], a[152:155], v[36:39], v[44:47]
s_cmp_eq_u32 s27, 229376
ds_read_b128 v[28:31], v6 offset:45056
v_fma_f32 v141, v141, v145, v149
v_mfma_f32_16x16x32_bf16 v[52:55], a[152:155], v[40:43], v[52:55]
s_cselect_b32 s43, s44, s43
ds_read_b128 v[32:35], v6 offset:45312
v_fma_f32 v142, v142, v146, v150
v_mfma_f32_16x16x32_bf16 v[56:59], a[156:159], v[40:43], v[56:59]
buffer_load_dwordx4 v8, s[8:11], s20 offen offset:3072 sc1 lds
v_fma_f32 v143, v143, v147, v151
v_mfma_f32_16x16x32_bf16 v[48:51], a[156:159], v[36:39], v[48:51]
s_waitcnt lgkmcnt(4)
v_cvt_pk_bf16_f32 v160, v140, v141
s_cselect_b32 s27, 0x10000, 0
v_mfma_f32_16x16x32_bf16 v[44:47], a[160:163], v[12:15], v[44:47]
s_add_u32 s20, s20, s28
ds_read_b128 v[36:39], v6 offset:47104
v_cvt_pk_bf16_f32 v161, v142, v143
v_mfma_f32_16x16x32_bf16 v[52:55], a[160:163], v[16:19], v[52:55]
buffer_store_dwordx2 v[160:161], v120, s[32:35], s56 offen
ds_read_b128 v[40:43], v6 offset:47360
v_mfma_f32_16x16x32_bf16 v[56:59], a[164:167], v[16:19], v[56:59]
s_add_u32 m0, s22, 0
s_cmp_lt_u32 s36, s37
s_cselect_b32 s20, s20, 0x40000000
v_mfma_f32_16x16x32_bf16 v[48:51], a[164:167], v[12:15], v[48:51]
s_waitcnt lgkmcnt(4)
s_xor_b32 s60, s60, s27
s_sub_u32 s64, 0x10000, s57
v_mfma_f32_16x16x32_bf16 v[44:47], a[168:171], v[20:23], v[44:47]
s_waitcnt vmcnt(21)
s_barrier
ds_read_b128 v[12:15], v6 offset:49152
v_mfma_f32_16x16x32_bf16 v[52:55], a[168:171], v[24:27], v[52:55]
s_add_u32 s65, s57, 0x3f800000
ds_read_b128 v[16:19], v6 offset:49408
s_mov_b32 s56, s47
v_mfma_f32_16x16x32_bf16 v[56:59], a[172:175], v[24:27], v[56:59]
s_mov_b32 s47, s46
buffer_load_dwordx4 v8, s[8:11], s20 offen sc1 lds
v_mfma_f32_16x16x32_bf16 v[48:51], a[172:175], v[20:23], v[48:51]
s_waitcnt lgkmcnt(4)
s_add_u32 s36, s36, 1
s_xor_b32 s68, s68, 4096
v_mfma_f32_16x16x32_bf16 v[44:47], a[176:179], v[28:31], v[44:47]
s_cmp_ge_u32 s38, 2
ds_read_b128 v[20:23], v6 offset:51200
s_cselect_b32 s68, 0, s68
v_mfma_f32_16x16x32_bf16 v[52:55], a[176:179], v[32:35], v[52:55]
buffer_load_dword v111, v109, s[8:11], s68 offen sc1
ds_read_b128 v[24:27], v6 offset:51456
v_mfma_f32_16x16x32_bf16 v[56:59], a[180:183], v[32:35], v[56:59]
s_mov_b32 s46, s45
s_cmp_lt_u32 s45, s48
s_cselect_b32 s27, 16, 17
v_mfma_f32_16x16x32_bf16 v[48:51], a[180:183], v[28:31], v[48:51]
s_waitcnt lgkmcnt(4)
s_bitset1_b32 s26, s27
s_add_u32 s45, s45, s26
v_mfma_f32_16x16x32_bf16 v[44:47], a[184:187], v[36:39], v[44:47]
s_mov_b32 s26, 0
ds_read_b128 v[28:31], v6 offset:53248
v_mfma_f32_16x16x32_bf16 v[52:55], a[184:187], v[40:43], v[52:55]
ds_read_b128 v[32:35], v6 offset:53504
v_mfma_f32_16x16x32_bf16 v[56:59], a[188:191], v[40:43], v[56:59]
buffer_load_dwordx4 v8, s[8:11], s20 offen offset:1024 sc1 lds
v_mfma_f32_16x16x32_bf16 v[48:51], a[188:191], v[36:39], v[48:51]
s_waitcnt lgkmcnt(4)
v_mfma_f32_16x16x32_bf16 v[44:47], a[192:195], v[12:15], v[44:47]
ds_read_b128 v[36:39], v6 offset:55296
v_mfma_f32_16x16x32_bf16 v[52:55], a[192:195], v[16:19], v[52:55]
ds_read_b128 v[40:43], v6 offset:55552
v_mfma_f32_16x16x32_bf16 v[56:59], a[196:199], v[16:19], v[56:59]
v_mfma_f32_16x16x32_bf16 v[48:51], a[196:199], v[12:15], v[48:51]
s_waitcnt lgkmcnt(4)
v_mfma_f32_16x16x32_bf16 v[44:47], a[200:203], v[20:23], v[44:47]
ds_read_b128 v[12:15], v6 offset:57344
v_mfma_f32_16x16x32_bf16 v[52:55], a[200:203], v[24:27], v[52:55]
ds_read_b128 v[16:19], v6 offset:57600
v_mfma_f32_16x16x32_bf16 v[56:59], a[204:207], v[24:27], v[56:59]
buffer_load_dwordx4 v8, s[8:11], s20 offen offset:2048 sc1 lds
v_mfma_f32_16x16x32_bf16 v[48:51], a[204:207], v[20:23], v[48:51]
s_waitcnt lgkmcnt(4)
v_mfma_f32_16x16x32_bf16 v[44:47], a[208:211], v[28:31], v[44:47]
ds_read_b128 v[20:23], v6 offset:59392
v_mfma_f32_16x16x32_bf16 v[52:55], a[208:211], v[32:35], v[52:55]
ds_read_b128 v[24:27], v6 offset:59648
v_mfma_f32_16x16x32_bf16 v[56:59], a[212:215], v[32:35], v[56:59]
v_mfma_f32_16x16x32_bf16 v[48:51], a[212:215], v[28:31], v[48:51]
s_waitcnt lgkmcnt(4)
v_mfma_f32_16x16x32_bf16 v[44:47], a[216:219], v[36:39], v[44:47]
ds_read_b128 v[28:31], v6 offset:61440
v_mfma_f32_16x16x32_bf16 v[52:55], a[216:219], v[40:43], v[52:55]
ds_read_b128 v[32:35], v6 offset:61696
v_mfma_f32_16x16x32_bf16 v[56:59], a[220:223], v[40:43], v[56:59]
buffer_load_dwordx4 v8, s[8:11], s20 offen offset:3072 sc1 lds
v_mfma_f32_16x16x32_bf16 v[48:51], a[220:223], v[36:39], v[48:51]
s_waitcnt lgkmcnt(4)
s_add_u32 s20, s20, s23
s_add_u32 m0, s22, 16384
v_mfma_f32_16x16x32_bf16 v[44:47], a[224:227], v[12:15], v[44:47]
ds_read_b128 v[36:39], v6 offset:63488
v_mfma_f32_16x16x32_bf16 v[52:55], a[224:227], v[16:19], v[52:55]
ds_read_b128 v[40:43], v6 offset:63744
v_mfma_f32_16x16x32_bf16 v[56:59], a[228:231], v[16:19], v[56:59]
v_mfma_f32_16x16x32_bf16 v[48:51], a[228:231], v[12:15], v[48:51]
s_waitcnt lgkmcnt(4)
v_mfma_f32_16x16x32_bf16 v[44:47], a[232:235], v[20:23], v[44:47]
ds_read_b128 v[12:15], v7 offset:0
v_mfma_f32_16x16x32_bf16 v[52:55], a[232:235], v[24:27], v[52:55]
ds_read_b128 v[16:19], v7 offset:256
v_mfma_f32_16x16x32_bf16 v[56:59], a[236:239], v[24:27], v[56:59]
buffer_load_dwordx4 v8, s[8:11], s20 offen sc1 lds
v_mfma_f32_16x16x32_bf16 v[48:51], a[236:239], v[20:23], v[48:51]
s_waitcnt lgkmcnt(4)
v_mfma_f32_16x16x32_bf16 v[44:47], a[240:243], v[28:31], v[44:47]
ds_read_b128 v[20:23], v7 offset:2048
v_mfma_f32_16x16x32_bf16 v[52:55], a[240:243], v[32:35], v[52:55]
ds_read_b128 v[24:27], v7 offset:2304
v_mfma_f32_16x16x32_bf16 v[56:59], a[244:247], v[32:35], v[56:59]
v_mfma_f32_16x16x32_bf16 v[48:51], a[244:247], v[28:31], v[48:51]
s_waitcnt lgkmcnt(4)
v_mfma_f32_16x16x32_bf16 v[44:47], a[248:251], v[36:39], v[44:47]
ds_read_b128 v[28:31], v7 offset:4096
v_mfma_f32_16x16x32_bf16 v[52:55], a[248:251], v[40:43], v[52:55]
ds_read_b128 v[32:35], v7 offset:4352
v_mfma_f32_16x16x32_bf16 v[56:59], a[252:255], v[40:43], v[56:59]
buffer_load_dwordx4 v8, s[8:11], s20 offen offset:1024 sc1 lds
v_mfma_f32_16x16x32_bf16 v[48:51], a[252:255], v[36:39], v[48:51]
s_waitcnt lgkmcnt(4)
v_mfma_f32_16x16x32_bf16 v[60:63], a[0:3], v[12:15], 0
ds_read_b128 v[36:39], v7 offset:6144
v_mfma_f32_16x16x32_bf16 v[68:71], a[0:3], v[16:19], 0
ds_read_b128 v[40:43], v7 offset:6400
v_cvt_pk_bf16_f32 v84, v44, v45
v_mfma_f32_16x16x32_bf16 v[72:75], a[4:7], v[16:19], 0
v_add_u32 v47, s64, v47
v_mfma_f32_16x16x32_bf16 v[64:67], a[4:7], v[12:15], 0
s_waitcnt lgkmcnt(4)
v_cvt_pk_bf16_f32 v85, v46, s65
v_mfma_f32_16x16x32_bf16 v[60:63], a[8:11], v[20:23], v[60:63]
ds_read_b128 v[12:15], v7 offset:8192
v_bfi_b32 v85, s66, v47, v85
v_mfma_f32_16x16x32_bf16 v[68:71], a[8:11], v[24:27], v[68:71]
ds_read_b128 v[16:19], v7 offset:8448
v_cvt_pk_bf16_f32 v86, v48, v49
v_mfma_f32_16x16x32_bf16 v[72:75], a[12:15], v[24:27], v[72:75]
buffer_load_dwordx4 v8, s[8:11], s20 offen offset:2048 sc1 lds
v_add_u32 v51, s64, v51
v_mfma_f32_16x16x32_bf16 v[64:67], a[12:15], v[20:23], v[64:67]
s_waitcnt lgkmcnt(4)
v_cvt_pk_bf16_f32 v87, v50, s65
v_mfma_f32_16x16x32_bf16 v[60:63], a[16:19], v[28:31], v[60:63]
buffer_load_dwordx2 v[132:133], v118, s[8:11], s42 offen offset:0 sc1
ds_read_b128 v[20:23], v7 offset:10240
v_mfma_f32_16x16x32_bf16 v[68:71], a[16:19], v[32:35], v[68:71]
ds_read_b128 v[24:27], v7 offset:10496
v_bfi_b32 v87, s66, v51, v87
v_mfma_f32_16x16x32_bf16 v[72:75], a[20:23], v[32:35], v[72:75]
buffer_store_dwordx4 v[84:87], v116, s[8:11], s41 offen
v_cvt_pk_bf16_f32 v88, v52, v53
v_mfma_f32_16x16x32_bf16 v[64:67], a[20:23], v[28:31], v[64:67]
s_waitcnt lgkmcnt(4)
v_add_u32 v55, s64, v55
v_mfma_f32_16x16x32_bf16 v[60:63], a[24:27], v[36:39], v[60:63]
buffer_load_dwordx2 v[134:135], v118, s[8:11], s42 offen offset:2048 sc1
ds_read_b128 v[28:31], v7 offset:12288
v_mfma_f32_16x16x32_bf16 v[68:71], a[24:27], v[40:43], v[68:71]
ds_read_b128 v[32:35], v7 offset:12544
v_cvt_pk_bf16_f32 v89, v54, s65
v_mfma_f32_16x16x32_bf16 v[72:75], a[28:31], v[40:43], v[72:75]
buffer_load_dwordx4 v8, s[8:11], s20 offen offset:3072 sc1 lds
v_bfi_b32 v89, s66, v55, v89
v_mfma_f32_16x16x32_bf16 v[64:67], a[28:31], v[36:39], v[64:67]
s_waitcnt lgkmcnt(4)
v_cvt_pk_bf16_f32 v90, v56, v57
s_add_u32 s20, s20, s23
v_mfma_f32_16x16x32_bf16 v[60:63], a[32:35], v[12:15], v[60:63]
buffer_load_dwordx2 v[136:137], v119, s[8:11], s42 offen offset:0 sc1
ds_read_b128 v[36:39], v7 offset:14336
v_mfma_f32_16x16x32_bf16 v[68:71], a[32:35], v[16:19], v[68:71]
s_add_u32 m0, s22, 32768
ds_read_b128 v[40:43], v7 offset:14592
v_add_u32 v59, s64, v59
v_mfma_f32_16x16x32_bf16 v[72:75], a[36:39], v[16:19], v[72:75]
buffer_load_dwordx2 v[138:139], v119, s[8:11], s42 offen offset:2048 sc1
v_cvt_pk_bf16_f32 v91, v58, s65
v_mfma_f32_16x16x32_bf16 v[64:67], a[36:39], v[12:15], v[64:67]
s_waitcnt lgkmcnt(4)
v_bfi_b32 v91, s66, v59, v91
s_waitcnt vmcnt(26)
v_mfma_f32_16x16x32_bf16 v[60:63], a[40:43], v[20:23], v[60:63]
s_waitcnt vmcnt(21)
s_barrier
ds_read_b128 v[12:15], v7 offset:16384
v_mfma_f32_16x16x32_bf16 v[68:71], a[40:43], v[24:27], v[68:71]
ds_read_b128 v[16:19], v7 offset:16640
v_bitop3_b32 v162, v125, v127, s59 bitop3:0x7e
v_mfma_f32_16x16x32_bf16 v[72:75], a[44:47], v[24:27], v[72:75]
buffer_load_dwordx4 v8, s[8:11], s20 offen sc1 lds
v_bitop3_b32 v163, v129, v131, s59 bitop3:0x7e
v_mfma_f32_16x16x32_bf16 v[64:67], a[44:47], v[20:23], v[64:67]
s_waitcnt lgkmcnt(4)
v_or_b32 v162, v162, v163
v_mfma_f32_16x16x32_bf16 v[60:63], a[48:51], v[28:31], v[60:63]
ds_read_b128 v[20:23], v7 offset:18432
v_and_b32 v162, 0x10000, v162
v_mfma_f32_16x16x32_bf16 v[68:71], a[48:51], v[32:35], v[68:71]
ds_read_b128 v[24:27], v7 offset:18688
v_cmp_ne_u32 vcc, 0, v162
v_mfma_f32_16x16x32_bf16 v[72:75], a[52:55], v[32:35], v[72:75]
buffer_store_dwordx4 v[88:91], v117, s[8:11], s41 offen
v_mfma_f32_16x16x32_bf16 v[64:67], a[52:55], v[28:31], v[64:67]
s_waitcnt lgkmcnt(4)
v_mfma_f32_16x16x32_bf16 v[60:63], a[56:59], v[36:39], v[60:63]
ds_read_b128 v[28:31], v7 offset:20480
v_mfma_f32_16x16x32_bf16 v[68:71], a[56:59], v[40:43], v[68:71]
ds_read_b128 v[32:35], v7 offset:20736
v_mfma_f32_16x16x32_bf16 v[72:75], a[60:63], v[40:43], v[72:75]
buffer_load_dwordx4 v8, s[8:11], s20 offen offset:1024 sc1 lds
v_mfma_f32_16x16x32_bf16 v[64:67], a[60:63], v[36:39], v[64:67]
s_waitcnt lgkmcnt(4)
v_mfma_f32_16x16x32_bf16 v[60:63], a[64:67], v[12:15], v[60:63]
ds_read_b128 v[36:39], v7 offset:22528
v_mfma_f32_16x16x32_bf16 v[68:71], a[64:67], v[16:19], v[68:71]
ds_read_b128 v[40:43], v7 offset:22784
v_mfma_f32_16x16x32_bf16 v[72:75], a[68:71], v[16:19], v[72:75]
s_cbranch_vccnz main_kernel_wj0_c1
main_kernel_wj0_k1:
v_mfma_f32_16x16x32_bf16 v[64:67], a[68:71], v[12:15], v[64:67]
s_waitcnt lgkmcnt(4)
v_lshlrev_b32 v140, 16, v124
v_mfma_f32_16x16x32_bf16 v[60:63], a[72:75], v[20:23], v[60:63]
ds_read_b128 v[12:15], v7 offset:24576
v_and_b32 v141, 0xffff0000, v124
v_mfma_f32_16x16x32_bf16 v[68:71], a[72:75], v[24:27], v[68:71]
ds_read_b128 v[16:19], v7 offset:24832
v_lshlrev_b32 v142, 16, v125
v_mfma_f32_16x16x32_bf16 v[72:75], a[76:79], v[24:27], v[72:75]
buffer_load_dwordx4 v8, s[8:11], s20 offen offset:2048 sc1 lds
v_and_b32 v143, 0xffff0000, v125
v_mfma_f32_16x16x32_bf16 v[64:67], a[76:79], v[20:23], v[64:67]
s_waitcnt lgkmcnt(4)
v_lshlrev_b32 v144, 16, v126
v_mfma_f32_16x16x32_bf16 v[60:63], a[80:83], v[28:31], v[60:63]
ds_read_b128 v[20:23], v7 offset:26624
v_and_b32 v145, 0xffff0000, v126
v_mfma_f32_16x16x32_bf16 v[68:71], a[80:83], v[32:35], v[68:71]
ds_read_b128 v[24:27], v7 offset:26880
v_lshlrev_b32 v146, 16, v127
v_mfma_f32_16x16x32_bf16 v[72:75], a[84:87], v[32:35], v[72:75]
v_and_b32 v147, 0xffff0000, v127
v_mfma_f32_16x16x32_bf16 v[64:67], a[84:87], v[28:31], v[64:67]
s_waitcnt lgkmcnt(4)
v_add_f32 v140, v140, v144
v_mfma_f32_16x16x32_bf16 v[60:63], a[88:91], v[36:39], v[60:63]
ds_read_b128 v[28:31], v7 offset:28672
v_add_f32 v141, v141, v145
v_mfma_f32_16x16x32_bf16 v[68:71], a[88:91], v[40:43], v[68:71]
ds_read_b128 v[32:35], v7 offset:28928
v_add_f32 v142, v142, v146
v_mfma_f32_16x16x32_bf16 v[72:75], a[92:95], v[40:43], v[72:75]
buffer_load_dwordx4 v8, s[8:11], s20 offen offset:3072 sc1 lds
v_add_f32 v143, v143, v147
v_mfma_f32_16x16x32_bf16 v[64:67], a[92:95], v[36:39], v[64:67]
s_waitcnt lgkmcnt(4)
v_lshlrev_b32 v144, 16, v128
s_add_u32 s20, s20, s23
v_mfma_f32_16x16x32_bf16 v[60:63], a[96:99], v[12:15], v[60:63]
s_add_u32 m0, s22, 49152
ds_read_b128 v[36:39], v7 offset:30720
v_and_b32 v145, 0xffff0000, v128
v_mfma_f32_16x16x32_bf16 v[68:71], a[96:99], v[16:19], v[68:71]
ds_read_b128 v[40:43], v7 offset:30976
v_lshlrev_b32 v146, 16, v129
v_mfma_f32_16x16x32_bf16 v[72:75], a[100:103], v[16:19], v[72:75]
v_and_b32 v147, 0xffff0000, v129
v_mfma_f32_16x16x32_bf16 v[64:67], a[100:103], v[12:15], v[64:67]
s_waitcnt lgkmcnt(4)
v_add_f32 v140, v140, v144
v_mfma_f32_16x16x32_bf16 v[60:63], a[104:107], v[20:23], v[60:63]
ds_read_b128 v[12:15], v7 offset:32768
v_add_f32 v141, v141, v145
v_mfma_f32_16x16x32_bf16 v[68:71], a[104:107], v[24:27], v[68:71]
ds_read_b128 v[16:19], v7 offset:33024
v_add_f32 v142, v142, v146
v_mfma_f32_16x16x32_bf16 v[72:75], a[108:111], v[24:27], v[72:75]
buffer_load_dwordx4 v8, s[8:11], s20 offen sc1 lds
v_add_f32 v143, v143, v147
v_mfma_f32_16x16x32_bf16 v[64:67], a[108:111], v[20:23], v[64:67]
s_waitcnt lgkmcnt(4)
v_lshlrev_b32 v144, 16, v130
v_mfma_f32_16x16x32_bf16 v[60:63], a[112:115], v[28:31], v[60:63]
buffer_load_dwordx2 v[156:157], v121, s[8:11], s47 offen sc1
ds_read_b128 v[20:23], v7 offset:34816
v_mfma_f32_16x16x32_bf16 v[68:71], a[112:115], v[32:35], v[68:71]
ds_read_b128 v[24:27], v7 offset:35072
v_and_b32 v145, 0xffff0000, v130
v_mfma_f32_16x16x32_bf16 v[72:75], a[116:119], v[32:35], v[72:75]
buffer_load_dwordx2 v[158:159], v120, s[16:19], s47 offen
v_lshlrev_b32 v146, 16, v131
v_mfma_f32_16x16x32_bf16 v[64:67], a[116:119], v[28:31], v[64:67]
s_waitcnt lgkmcnt(4)
v_and_b32 v147, 0xffff0000, v131
s_add_i32 s38, s36, s61
v_mfma_f32_16x16x32_bf16 v[60:63], a[120:123], v[36:39], v[60:63]
s_lshr_b32 s75, s36, 1
ds_read_b128 v[28:31], v7 offset:36864
v_add_f32 v140, v140, v144
v_mfma_f32_16x16x32_bf16 v[68:71], a[120:123], v[40:43], v[68:71]
s_max_i32 s38, s38, s75
ds_read_b128 v[32:35], v7 offset:37120
v_add_f32 v141, v141, v145
v_mfma_f32_16x16x32_bf16 v[72:75], a[124:127], v[40:43], v[72:75]
buffer_load_dwordx4 v8, s[8:11], s20 offen offset:1024 sc1 lds
v_add_f32 v142, v142, v146
v_mfma_f32_16x16x32_bf16 v[64:67], a[124:127], v[36:39], v[64:67]
s_waitcnt lgkmcnt(4)
v_add_f32 v143, v143, v147
s_min_i32 s38, s38, 29
v_mfma_f32_16x16x32_bf16 v[60:63], a[128:131], v[12:15], v[60:63]
s_waitcnt vmcnt(27)
ds_read_b128 v[36:39], v7 offset:38912
v_lshlrev_b32 v144, 16, v152
v_mfma_f32_16x16x32_bf16 v[68:71], a[128:131], v[16:19], v[68:71]
s_mov_b32 s55, s42
ds_read_b128 v[40:43], v7 offset:39168
v_and_b32 v145, 0xffff0000, v152
v_mfma_f32_16x16x32_bf16 v[72:75], a[132:135], v[16:19], v[72:75]
s_mov_b32 s42, s41
v_lshlrev_b32 v146, 16, v153
s_mov_b32 s41, s43
v_mfma_f32_16x16x32_bf16 v[64:67], a[132:135], v[12:15], v[64:67]
s_waitcnt lgkmcnt(4)
v_and_b32 v147, 0xffff0000, v153
s_mov_b32 s59, s58
v_mfma_f32_16x16x32_bf16 v[60:63], a[136:139], v[20:23], v[60:63]
s_mov_b32 s58, s57
ds_read_b128 v[12:15], v7 offset:40960
v_lshlrev_b32 v148, 16, v154
v_mfma_f32_16x16x32_bf16 v[68:71], a[136:139], v[24:27], v[68:71]
s_mov_b32 s57, s60
ds_read_b128 v[16:19], v7 offset:41216
v_and_b32 v149, 0xffff0000, v154
v_mfma_f32_16x16x32_bf16 v[72:75], a[140:143], v[24:27], v[72:75]
s_waitcnt vmcnt(21)
buffer_load_dwordx4 v8, s[8:11], s20 offen offset:2048 sc1 lds
v_mfma_f32_16x16x32_bf16 v[64:67], a[140:143], v[20:23], v[64:67]
s_waitcnt lgkmcnt(4)
v_cmp_ge_u32 s[62:63], s38, v111
s_cmp_le_u32 s36, s67
v_mfma_f32_16x16x32_bf16 v[60:63], a[144:147], v[28:31], v[60:63]
s_cselect_b32 s28, 212992, s53
ds_read_b128 v[20:23], v7 offset:43008
v_lshlrev_b32 v150, 16, v155
v_mfma_f32_16x16x32_bf16 v[68:71], a[144:147], v[32:35], v[68:71]
s_and_b64 s[62:63], s[62:63], s[50:51]
ds_read_b128 v[24:27], v7 offset:43264
v_and_b32 v151, 0xffff0000, v155
v_mfma_f32_16x16x32_bf16 v[72:75], a[148:151], v[32:35], v[72:75]
s_cbranch_scc1 main_kernel_wj0_a1
main_kernel_wj0_b1:
s_add_u32 s43, s43, 32768
v_mfma_f32_16x16x32_bf16 v[64:67], a[148:151], v[28:31], v[64:67]
s_waitcnt lgkmcnt(4)
v_fma_f32 v140, v140, v144, v148
s_sub_u32 s27, s43, s44
v_mfma_f32_16x16x32_bf16 v[60:63], a[152:155], v[36:39], v[60:63]
s_cmp_eq_u32 s27, 229376
ds_read_b128 v[28:31], v7 offset:45056
v_fma_f32 v141, v141, v145, v149
v_mfma_f32_16x16x32_bf16 v[68:71], a[152:155], v[40:43], v[68:71]
s_cselect_b32 s43, s44, s43
ds_read_b128 v[32:35], v7 offset:45312
v_fma_f32 v142, v142, v146, v150
v_mfma_f32_16x16x32_bf16 v[72:75], a[156:159], v[40:43], v[72:75]
buffer_load_dwordx4 v8, s[8:11], s20 offen offset:3072 sc1 lds
v_fma_f32 v143, v143, v147, v151
v_mfma_f32_16x16x32_bf16 v[64:67], a[156:159], v[36:39], v[64:67]
s_waitcnt lgkmcnt(4)
v_cvt_pk_bf16_f32 v160, v140, v141
s_cselect_b32 s27, 0x10000, 0
v_mfma_f32_16x16x32_bf16 v[60:63], a[160:163], v[12:15], v[60:63]
s_add_u32 s20, s20, s28
ds_read_b128 v[36:39], v7 offset:47104
v_cvt_pk_bf16_f32 v161, v142, v143
v_mfma_f32_16x16x32_bf16 v[68:71], a[160:163], v[16:19], v[68:71]
buffer_store_dwordx2 v[160:161], v120, s[32:35], s56 offen
ds_read_b128 v[40:43], v7 offset:47360
v_mfma_f32_16x16x32_bf16 v[72:75], a[164:167], v[16:19], v[72:75]
s_add_u32 m0, s22, 65536
s_cmp_lt_u32 s36, s37
s_cselect_b32 s20, s20, 0x40000000
v_mfma_f32_16x16x32_bf16 v[64:67], a[164:167], v[12:15], v[64:67]
s_waitcnt lgkmcnt(4)
s_xor_b32 s60, s60, s27
s_sub_u32 s64, 0x10000, s57
v_mfma_f32_16x16x32_bf16 v[60:63], a[168:171], v[20:23], v[60:63]
s_waitcnt vmcnt(21)
s_barrier
ds_read_b128 v[12:15], v7 offset:49152
v_mfma_f32_16x16x32_bf16 v[68:71], a[168:171], v[24:27], v[68:71]
s_add_u32 s65, s57, 0x3f800000
ds_read_b128 v[16:19], v7 offset:49408
s_mov_b32 s56, s47
v_mfma_f32_16x16x32_bf16 v[72:75], a[172:175], v[24:27], v[72:75]
s_mov_b32 s47, s46
buffer_load_dwordx4 v8, s[8:11], s20 offen sc1 lds
v_mfma_f32_16x16x32_bf16 v[64:67], a[172:175], v[20:23], v[64:67]
s_waitcnt lgkmcnt(4)
s_add_u32 s36, s36, 1
s_xor_b32 s68, s68, 4096
v_mfma_f32_16x16x32_bf16 v[60:63], a[176:179], v[28:31], v[60:63]
s_cmp_ge_u32 s38, 2
ds_read_b128 v[20:23], v7 offset:51200
s_cselect_b32 s68, 0, s68
v_mfma_f32_16x16x32_bf16 v[68:71], a[176:179], v[32:35], v[68:71]
buffer_load_dword v111, v109, s[8:11], s68 offen sc1
ds_read_b128 v[24:27], v7 offset:51456
v_mfma_f32_16x16x32_bf16 v[72:75], a[180:183], v[32:35], v[72:75]
s_mov_b32 s46, s45
s_cmp_lt_u32 s45, s48
s_cselect_b32 s27, 16, 17
v_mfma_f32_16x16x32_bf16 v[64:67], a[180:183], v[28:31], v[64:67]
s_waitcnt lgkmcnt(4)
s_bitset1_b32 s26, s27
s_add_u32 s45, s45, s26
v_mfma_f32_16x16x32_bf16 v[60:63], a[184:187], v[36:39], v[60:63]
s_mov_b32 s26, 0
ds_read_b128 v[28:31], v7 offset:53248
v_mfma_f32_16x16x32_bf16 v[68:71], a[184:187], v[40:43], v[68:71]
ds_read_b128 v[32:35], v7 offset:53504
v_mfma_f32_16x16x32_bf16 v[72:75], a[188:191], v[40:43], v[72:75]
buffer_load_dwordx4 v8, s[8:11], s20 offen offset:1024 sc1 lds
v_mfma_f32_16x16x32_bf16 v[64:67], a[188:191], v[36:39], v[64:67]
s_waitcnt lgkmcnt(4)
v_mfma_f32_16x16x32_bf16 v[60:63], a[192:195], v[12:15], v[60:63]
ds_read_b128 v[36:39], v7 offset:55296
v_mfma_f32_16x16x32_bf16 v[68:71], a[192:195], v[16:19], v[68:71]
ds_read_b128 v[40:43], v7 offset:55552
v_mfma_f32_16x16x32_bf16 v[72:75], a[196:199], v[16:19], v[72:75]
v_mfma_f32_16x16x32_bf16 v[64:67], a[196:199], v[12:15], v[64:67]
s_waitcnt lgkmcnt(4)
v_mfma_f32_16x16x32_bf16 v[60:63], a[200:203], v[20:23], v[60:63]
ds_read_b128 v[12:15], v7 offset:57344
v_mfma_f32_16x16x32_bf16 v[68:71], a[200:203], v[24:27], v[68:71]
ds_read_b128 v[16:19], v7 offset:57600
v_mfma_f32_16x16x32_bf16 v[72:75], a[204:207], v[24:27], v[72:75]
buffer_load_dwordx4 v8, s[8:11], s20 offen offset:2048 sc1 lds
v_mfma_f32_16x16x32_bf16 v[64:67], a[204:207], v[20:23], v[64:67]
s_waitcnt lgkmcnt(4)
v_mfma_f32_16x16x32_bf16 v[60:63], a[208:211], v[28:31], v[60:63]
ds_read_b128 v[20:23], v7 offset:59392
v_mfma_f32_16x16x32_bf16 v[68:71], a[208:211], v[32:35], v[68:71]
ds_read_b128 v[24:27], v7 offset:59648
v_mfma_f32_16x16x32_bf16 v[72:75], a[212:215], v[32:35], v[72:75]
v_mfma_f32_16x16x32_bf16 v[64:67], a[212:215], v[28:31], v[64:67]
s_waitcnt lgkmcnt(4)
v_mfma_f32_16x16x32_bf16 v[60:63], a[216:219], v[36:39], v[60:63]
ds_read_b128 v[28:31], v7 offset:61440
v_mfma_f32_16x16x32_bf16 v[68:71], a[216:219], v[40:43], v[68:71]
ds_read_b128 v[32:35], v7 offset:61696
v_mfma_f32_16x16x32_bf16 v[72:75], a[220:223], v[40:43], v[72:75]
buffer_load_dwordx4 v8, s[8:11], s20 offen offset:3072 sc1 lds
v_mfma_f32_16x16x32_bf16 v[64:67], a[220:223], v[36:39], v[64:67]
s_waitcnt lgkmcnt(4)
s_add_u32 s20, s20, s23
s_add_u32 m0, s22, 81920
v_mfma_f32_16x16x32_bf16 v[60:63], a[224:227], v[12:15], v[60:63]
ds_read_b128 v[36:39], v7 offset:63488
v_mfma_f32_16x16x32_bf16 v[68:71], a[224:227], v[16:19], v[68:71]
ds_read_b128 v[40:43], v7 offset:63744
v_mfma_f32_16x16x32_bf16 v[72:75], a[228:231], v[16:19], v[72:75]
v_mfma_f32_16x16x32_bf16 v[64:67], a[228:231], v[12:15], v[64:67]
s_waitcnt lgkmcnt(4)
v_mfma_f32_16x16x32_bf16 v[60:63], a[232:235], v[20:23], v[60:63]
ds_read_b128 v[12:15], v6 offset:0
v_mfma_f32_16x16x32_bf16 v[68:71], a[232:235], v[24:27], v[68:71]
ds_read_b128 v[16:19], v6 offset:256
v_mfma_f32_16x16x32_bf16 v[72:75], a[236:239], v[24:27], v[72:75]
buffer_load_dwordx4 v8, s[8:11], s20 offen sc1 lds
v_mfma_f32_16x16x32_bf16 v[64:67], a[236:239], v[20:23], v[64:67]
s_waitcnt lgkmcnt(4)
v_mfma_f32_16x16x32_bf16 v[60:63], a[240:243], v[28:31], v[60:63]
ds_read_b128 v[20:23], v6 offset:2048
v_mfma_f32_16x16x32_bf16 v[68:71], a[240:243], v[32:35], v[68:71]
ds_read_b128 v[24:27], v6 offset:2304
v_mfma_f32_16x16x32_bf16 v[72:75], a[244:247], v[32:35], v[72:75]
v_mfma_f32_16x16x32_bf16 v[64:67], a[244:247], v[28:31], v[64:67]
s_waitcnt lgkmcnt(4)
v_mfma_f32_16x16x32_bf16 v[60:63], a[248:251], v[36:39], v[60:63]
ds_read_b128 v[28:31], v6 offset:4096
v_mfma_f32_16x16x32_bf16 v[68:71], a[248:251], v[40:43], v[68:71]
ds_read_b128 v[32:35], v6 offset:4352
v_mfma_f32_16x16x32_bf16 v[72:75], a[252:255], v[40:43], v[72:75]
s_sub_u32 s24, s24, 1
buffer_load_dwordx4 v8, s[8:11], s20 offen offset:1024 sc1 lds
v_mfma_f32_16x16x32_bf16 v[64:67], a[252:255], v[36:39], v[64:67]
s_waitcnt lgkmcnt(4)
s_cbranch_scc0 main_kernel_wj0_lp
v_cvt_pk_bf16_f32 v84, v60, v61
v_add_u32 v63, s64, v63
v_cvt_pk_bf16_f32 v85, v62, s65
v_bfi_b32 v85, s66, v63, v85
s_nop 1
v_cvt_pk_bf16_f32 v86, v64, v65
v_add_u32 v67, s64, v67
v_cvt_pk_bf16_f32 v87, v66, s65
v_bfi_b32 v87, s66, v67, v87
v_cvt_pk_bf16_f32 v88, v68, v69
v_add_u32 v71, s64, v71
v_cvt_pk_bf16_f32 v89, v70, s65
v_bfi_b32 v89, s66, v71, v89
v_cvt_pk_bf16_f32 v90, v72, v73
v_add_u32 v75, s64, v75
v_cvt_pk_bf16_f32 v91, v74, s65
v_bfi_b32 v91, s66, v75, v91
buffer_store_dwordx4 v[84:87], v116, s[8:11], s41 offen
buffer_store_dwordx4 v[88:91], v117, s[8:11], s41 offen
buffer_load_dwordx2 v[124:125], v118, s[8:11], s42 offen offset:0 sc1
buffer_load_dwordx2 v[126:127], v118, s[8:11], s42 offen offset:2048 sc1
buffer_load_dwordx2 v[128:129], v119, s[8:11], s42 offen offset:0 sc1
buffer_load_dwordx2 v[130:131], v119, s[8:11], s42 offen offset:2048 sc1
buffer_load_dwordx2 v[152:153], v121, s[8:11], s47 offen sc1
buffer_load_dwordx2 v[154:155], v120, s[16:19], s47 offen
s_waitcnt vmcnt(8)
v_bitop3_b32 v162, v133, v135, s59 bitop3:0x7e
v_bitop3_b32 v163, v137, v139, s59 bitop3:0x7e
v_or_b32 v162, v162, v163
v_and_b32 v162, 0x10000, v162
v_cmp_ne_u32 vcc, 0, v162
s_cbranch_vccnz main_kernel_wj0_c2
main_kernel_wj0_k2:
v_lshlrev_b32 v140, 16, v132
v_and_b32 v141, 0xffff0000, v132
v_lshlrev_b32 v142, 16, v133
v_and_b32 v143, 0xffff0000, v133
v_lshlrev_b32 v144, 16, v134
v_and_b32 v145, 0xffff0000, v134
v_lshlrev_b32 v146, 16, v135
v_and_b32 v147, 0xffff0000, v135
v_add_f32 v140, v140, v144
v_add_f32 v141, v141, v145
v_add_f32 v142, v142, v146
v_add_f32 v143, v143, v147
v_lshlrev_b32 v144, 16, v136
v_and_b32 v145, 0xffff0000, v136
v_lshlrev_b32 v146, 16, v137
v_and_b32 v147, 0xffff0000, v137
v_add_f32 v140, v140, v144
v_add_f32 v141, v141, v145
v_add_f32 v142, v142, v146
v_add_f32 v143, v143, v147
v_lshlrev_b32 v144, 16, v138
v_and_b32 v145, 0xffff0000, v138
v_lshlrev_b32 v146, 16, v139
v_and_b32 v147, 0xffff0000, v139
v_add_f32 v140, v140, v144
v_add_f32 v141, v141, v145
v_add_f32 v142, v142, v146
v_add_f32 v143, v143, v147
v_lshlrev_b32 v144, 16, v156
v_and_b32 v145, 0xffff0000, v156
v_lshlrev_b32 v146, 16, v157
v_and_b32 v147, 0xffff0000, v157
v_lshlrev_b32 v148, 16, v158
v_and_b32 v149, 0xffff0000, v158
v_lshlrev_b32 v150, 16, v159
v_and_b32 v151, 0xffff0000, v159
v_fma_f32 v140, v140, v144, v148
v_fma_f32 v141, v141, v145, v149
v_fma_f32 v142, v142, v146, v150
v_fma_f32 v143, v143, v147, v151
v_cvt_pk_bf16_f32 v160, v140, v141
v_cvt_pk_bf16_f32 v161, v142, v143
buffer_store_dwordx2 v[160:161], v120, s[32:35], s56 offen
buffer_load_dwordx2 v[132:133], v118, s[8:11], s41 offen offset:0 sc1
buffer_load_dwordx2 v[134:135], v118, s[8:11], s41 offen offset:2048 sc1
buffer_load_dwordx2 v[136:137], v119, s[8:11], s41 offen offset:0 sc1
buffer_load_dwordx2 v[138:139], v119, s[8:11], s41 offen offset:2048 sc1
buffer_load_dwordx2 v[156:157], v121, s[8:11], s46 offen sc1
buffer_load_dwordx2 v[158:159], v120, s[16:19], s46 offen
s_waitcnt vmcnt(7)
v_bitop3_b32 v162, v125, v127, s58 bitop3:0x7e
v_bitop3_b32 v163, v129, v131, s58 bitop3:0x7e
v_or_b32 v162, v162, v163
v_and_b32 v162, 0x10000, v162
v_cmp_ne_u32 vcc, 0, v162
s_cbranch_vccnz main_kernel_wj0_c3
main_kernel_wj0_k3:
v_lshlrev_b32 v140, 16, v124
v_and_b32 v141, 0xffff0000, v124
v_lshlrev_b32 v142, 16, v125
v_and_b32 v143, 0xffff0000, v125
v_lshlrev_b32 v144, 16, v126
v_and_b32 v145, 0xffff0000, v126
v_lshlrev_b32 v146, 16, v127
v_and_b32 v147, 0xffff0000, v127
v_add_f32 v140, v140, v144
v_add_f32 v141, v141, v145
v_add_f32 v142, v142, v146
v_add_f32 v143, v143, v147
v_lshlrev_b32 v144, 16, v128
v_and_b32 v145, 0xffff0000, v128
v_lshlrev_b32 v146, 16, v129
v_and_b32 v147, 0xffff0000, v129
v_add_f32 v140, v140, v144
v_add_f32 v141, v141, v145
v_add_f32 v142, v142, v146
v_add_f32 v143, v143, v147
v_lshlrev_b32 v144, 16, v130
v_and_b32 v145, 0xffff0000, v130
v_lshlrev_b32 v146, 16, v131
v_and_b32 v147, 0xffff0000, v131
v_add_f32 v140, v140, v144
v_add_f32 v141, v141, v145
v_add_f32 v142, v142, v146
v_add_f32 v143, v143, v147
v_lshlrev_b32 v144, 16, v152
v_and_b32 v145, 0xffff0000, v152
v_lshlrev_b32 v146, 16, v153
v_and_b32 v147, 0xffff0000, v153
v_lshlrev_b32 v148, 16, v154
v_and_b32 v149, 0xffff0000, v154
v_lshlrev_b32 v150, 16, v155
v_and_b32 v151, 0xffff0000, v155
v_fma_f32 v140, v140, v144, v148
v_fma_f32 v141, v141, v145, v149
v_fma_f32 v142, v142, v146, v150
v_fma_f32 v143, v143, v147, v151
v_cvt_pk_bf16_f32 v160, v140, v141
v_cvt_pk_bf16_f32 v161, v142, v143
buffer_store_dwordx2 v[160:161], v120, s[32:35], s47 offen
s_waitcnt vmcnt(1)
v_bitop3_b32 v162, v133, v135, s57 bitop3:0x7e
v_bitop3_b32 v163, v137, v139, s57 bitop3:0x7e
v_or_b32 v162, v162, v163
v_and_b32 v162, 0x10000, v162
v_cmp_ne_u32 vcc, 0, v162
s_cbranch_vccnz main_kernel_wj0_c4
main_kernel_wj0_k4:
v_lshlrev_b32 v140, 16, v132
v_and_b32 v141, 0xffff0000, v132
v_lshlrev_b32 v142, 16, v133
v_and_b32 v143, 0xffff0000, v133
v_lshlrev_b32 v144, 16, v134
v_and_b32 v145, 0xffff0000, v134
v_lshlrev_b32 v146, 16, v135
v_and_b32 v147, 0xffff0000, v135
v_add_f32 v140, v140, v144
v_add_f32 v141, v141, v145
v_add_f32 v142, v142, v146
v_add_f32 v143, v143, v147
v_lshlrev_b32 v144, 16, v136
v_and_b32 v145, 0xffff0000, v136
v_lshlrev_b32 v146, 16, v137
v_and_b32 v147, 0xffff0000, v137
v_add_f32 v140, v140, v144
v_add_f32 v141, v141, v145
v_add_f32 v142, v142, v146
v_add_f32 v143, v143, v147
v_lshlrev_b32 v144, 16, v138
v_and_b32 v145, 0xffff0000, v138
v_lshlrev_b32 v146, 16, v139
v_and_b32 v147, 0xffff0000, v139
v_add_f32 v140, v140, v144
v_add_f32 v141, v141, v145
v_add_f32 v142, v142, v146
v_add_f32 v143, v143, v147
v_lshlrev_b32 v144, 16, v156
v_and_b32 v145, 0xffff0000, v156
v_lshlrev_b32 v146, 16, v157
v_and_b32 v147, 0xffff0000, v157
v_lshlrev_b32 v148, 16, v158
v_and_b32 v149, 0xffff0000, v158
v_lshlrev_b32 v150, 16, v159
v_and_b32 v151, 0xffff0000, v159
v_fma_f32 v140, v140, v144, v148
v_fma_f32 v141, v141, v145, v149
v_fma_f32 v142, v142, v146, v150
v_fma_f32 v143, v143, v147, v151
v_cvt_pk_bf16_f32 v160, v140, v141
v_cvt_pk_bf16_f32 v161, v142, v143
buffer_store_dwordx2 v[160:161], v120, s[32:35], s46 offen
s_branch main_kernel_wj0_dn
main_kernel_wj0_c0:
s_add_u32 s54, s54, 1
s_cmp_ge_u32 s54, 131072
s_cbranch_scc1 main_kernel_wj0_k0
buffer_load_dwordx2 v[132:133], v118, s[8:11], s55 offen offset:0 sc1
buffer_load_dwordx2 v[134:135], v118, s[8:11], s55 offen offset:2048 sc1
buffer_load_dwordx2 v[136:137], v119, s[8:11], s55 offen offset:0 sc1
buffer_load_dwordx2 v[138:139], v119, s[8:11], s55 offen offset:2048 sc1
s_waitcnt vmcnt(0)
v_bitop3_b32 v162, v133, v135, s59 bitop3:0x7e
v_bitop3_b32 v163, v137, v139, s59 bitop3:0x7e
v_or_b32 v162, v162, v163
v_and_b32 v162, 0x10000, v162
v_cmp_ne_u32 vcc, 0, v162
s_cbranch_vccnz main_kernel_wj0_c0
s_branch main_kernel_wj0_k0
main_kernel_wj0_a0:
main_kernel_wj0_w0:
buffer_load_dword v111, v109, s[8:11], s68 offen sc1
s_waitcnt vmcnt(0)
v_cmp_ge_u32 s[62:63], s38, v111
s_and_b64 s[62:63], s[62:63], s[50:51]
s_cbranch_scc0 main_kernel_wj0_w0_ok
s_add_u32 s54, s54, 1
s_cmp_ge_u32 s54, 131072
s_cbranch_scc1 main_kernel_wj0_w0_ok
s_sleep 1
s_branch main_kernel_wj0_w0
main_kernel_wj0_w0_ok:
s_branch main_kernel_wj0_b0
main_kernel_wj0_c1:
s_add_u32 s54, s54, 1
s_cmp_ge_u32 s54, 131072
s_cbranch_scc1 main_kernel_wj0_k1
buffer_load_dwordx2 v[124:125], v118, s[8:11], s55 offen offset:0 sc1
buffer_load_dwordx2 v[126:127], v118, s[8:11], s55 offen offset:2048 sc1
buffer_load_dwordx2 v[128:129], v119, s[8:11], s55 offen offset:0 sc1
buffer_load_dwordx2 v[130:131], v119, s[8:11], s55 offen offset:2048 sc1
s_waitcnt vmcnt(0)
v_bitop3_b32 v162, v125, v127, s59 bitop3:0x7e
v_bitop3_b32 v163, v129, v131, s59 bitop3:0x7e
v_or_b32 v162, v162, v163
v_and_b32 v162, 0x10000, v162
v_cmp_ne_u32 vcc, 0, v162
s_cbranch_vccnz main_kernel_wj0_c1
s_branch main_kernel_wj0_k1
main_kernel_wj0_a1:
main_kernel_wj0_w1:
buffer_load_dword v111, v109, s[8:11], s68 offen sc1
s_waitcnt vmcnt(0)
v_cmp_ge_u32 s[62:63], s38, v111
s_and_b64 s[62:63], s[62:63], s[50:51]
s_cbranch_scc0 main_kernel_wj0_w1_ok
s_add_u32 s54, s54, 1
s_cmp_ge_u32 s54, 131072
s_cbranch_scc1 main_kernel_wj0_w1_ok
s_sleep 1
s_branch main_kernel_wj0_w1
main_kernel_wj0_w1_ok:
s_branch main_kernel_wj0_b1
main_kernel_wj0_c2:
s_add_u32 s54, s54, 1
s_cmp_ge_u32 s54, 131072
s_cbranch_scc1 main_kernel_wj0_k2
buffer_load_dwordx2 v[132:133], v118, s[8:11], s55 offen offset:0 sc1
buffer_load_dwordx2 v[134:135], v118, s[8:11], s55 offen offset:2048 sc1
buffer_load_dwordx2 v[136:137], v119, s[8:11], s55 offen offset:0 sc1
buffer_load_dwordx2 v[138:139], v119, s[8:11], s55 offen offset:2048 sc1
s_waitcnt vmcnt(0)
v_bitop3_b32 v162, v133, v135, s59 bitop3:0x7e
v_bitop3_b32 v163, v137, v139, s59 bitop3:0x7e
v_or_b32 v162, v162, v163
v_and_b32 v162, 0x10000, v162
v_cmp_ne_u32 vcc, 0, v162
s_cbranch_vccnz main_kernel_wj0_c2
s_branch main_kernel_wj0_k2
main_kernel_wj0_c3:
s_add_u32 s54, s54, 1
s_cmp_ge_u32 s54, 131072
s_cbranch_scc1 main_kernel_wj0_k3
buffer_load_dwordx2 v[124:125], v118, s[8:11], s42 offen offset:0 sc1
buffer_load_dwordx2 v[126:127], v118, s[8:11], s42 offen offset:2048 sc1
buffer_load_dwordx2 v[128:129], v119, s[8:11], s42 offen offset:0 sc1
buffer_load_dwordx2 v[130:131], v119, s[8:11], s42 offen offset:2048 sc1
s_waitcnt vmcnt(0)
v_bitop3_b32 v162, v125, v127, s58 bitop3:0x7e
v_bitop3_b32 v163, v129, v131, s58 bitop3:0x7e
v_or_b32 v162, v162, v163
v_and_b32 v162, 0x10000, v162
v_cmp_ne_u32 vcc, 0, v162
s_cbranch_vccnz main_kernel_wj0_c3
s_branch main_kernel_wj0_k3
main_kernel_wj0_c4:
s_add_u32 s54, s54, 1
s_cmp_ge_u32 s54, 131072
s_cbranch_scc1 main_kernel_wj0_k4
buffer_load_dwordx2 v[132:133], v118, s[8:11], s41 offen offset:0 sc1
buffer_load_dwordx2 v[134:135], v118, s[8:11], s41 offen offset:2048 sc1
buffer_load_dwordx2 v[136:137], v119, s[8:11], s41 offen offset:0 sc1
buffer_load_dwordx2 v[138:139], v119, s[8:11], s41 offen offset:2048 sc1
s_waitcnt vmcnt(0)
v_bitop3_b32 v162, v133, v135, s57 bitop3:0x7e
v_bitop3_b32 v163, v137, v139, s57 bitop3:0x7e
v_or_b32 v162, v162, v163
v_and_b32 v162, 0x10000, v162
v_cmp_ne_u32 vcc, 0, v162
s_cbranch_vccnz main_kernel_wj0_c4
s_branch main_kernel_wj0_k4
main_kernel_wj0_dn:
s_add_u32 s24, s37, 2
main_kernel_wj0_s:
s_lshl_b32 s20, s45, 2
s_add_u32 s20, s20, s31
s_add_u32 s37, s37, 1
s_add_i32 s38, s37, s61
buffer_load_dwordx2 v[154:155], v120, s[16:19], s45 offen
s_mov_b32 s41, s43
s_mov_b32 s59, s58
s_mov_b32 s58, s57
s_mov_b32 s57, s60
s_add_u32 s43, s43, 32768
s_sub_u32 s27, s43, s44
s_cmp_eq_u32 s27, 229376
s_cselect_b32 s43, s44, s43
s_cselect_b32 s27, 0x10000, 0
s_xor_b32 s60, s60, s27
s_sub_u32 s64, 0x10000, s57
s_add_u32 s65, s57, 0x3f800000
main_kernel_wj0_s_w:
buffer_load_dword v111, v109, s[8:11], 0 offen sc1
s_waitcnt vmcnt(0)
v_cmp_gt_u32 vcc, s38, v111
s_and_b64 vcc, vcc, s[50:51]
s_cbranch_scc0 main_kernel_wj0_s_w_ok
s_add_u32 s54, s54, 1
s_cmp_ge_u32 s54, 131072
s_cbranch_scc1 main_kernel_wj0_s_w_ok
s_branch main_kernel_wj0_s_w
main_kernel_wj0_s_w_ok:
s_barrier
s_add_u32 m0, s22, 0
s_nop 0
buffer_load_dwordx4 v8, s[8:11], s20 offen sc1 lds
buffer_load_dwordx4 v8, s[8:11], s20 offen offset:1024 sc1 lds
buffer_load_dwordx4 v8, s[8:11], s20 offen offset:2048 sc1 lds
buffer_load_dwordx4 v8, s[8:11], s20 offen offset:3072 sc1 lds
s_add_u32 s20, s20, s23
s_add_u32 m0, s22, 16384
s_nop 0
buffer_load_dwordx4 v8, s[8:11], s20 offen sc1 lds
buffer_load_dwordx4 v8, s[8:11], s20 offen offset:1024 sc1 lds
buffer_load_dwordx4 v8, s[8:11], s20 offen offset:2048 sc1 lds
buffer_load_dwordx4 v8, s[8:11], s20 offen offset:3072 sc1 lds
s_add_u32 s20, s20, s23
s_add_u32 m0, s22, 32768
s_nop 0
buffer_load_dwordx4 v8, s[8:11], s20 offen sc1 lds
buffer_load_dwordx4 v8, s[8:11], s20 offen offset:1024 sc1 lds
buffer_load_dwordx4 v8, s[8:11], s20 offen offset:2048 sc1 lds
buffer_load_dwordx4 v8, s[8:11], s20 offen offset:3072 sc1 lds
s_add_u32 s20, s20, s23
s_add_u32 m0, s22, 49152
s_nop 0
buffer_load_dwordx4 v8, s[8:11], s20 offen sc1 lds
buffer_load_dwordx4 v8, s[8:11], s20 offen offset:1024 sc1 lds
buffer_load_dwordx4 v8, s[8:11], s20 offen offset:2048 sc1 lds
buffer_load_dwordx4 v8, s[8:11], s20 offen offset:3072 sc1 lds
s_add_u32 s20, s20, s28
buffer_load_dwordx2 v[152:153], v121, s[8:11], s45 offen sc1
s_waitcnt vmcnt(13)
s_barrier
ds_read_b128 v[12:15], v6 offset:0
ds_read_b128 v[16:19], v6 offset:256
ds_read_b128 v[20:23], v6 offset:2048
ds_read_b128 v[24:27], v6 offset:2304
ds_read_b128 v[28:31], v6 offset:4096
ds_read_b128 v[32:35], v6 offset:4352
s_waitcnt lgkmcnt(4)
v_mfma_f32_16x16x32_bf16 v[44:47], a[0:3], v[12:15], 0
ds_read_b128 v[36:39], v6 offset:6144
v_mfma_f32_16x16x32_bf16 v[52:55], a[0:3], v[16:19], 0
ds_read_b128 v[40:43], v6 offset:6400
v_mfma_f32_16x16x32_bf16 v[56:59], a[4:7], v[16:19], 0
v_mfma_f32_16x16x32_bf16 v[48:51], a[4:7], v[12:15], 0
s_waitcnt lgkmcnt(4)
v_mfma_f32_16x16x32_bf16 v[44:47], a[8:11], v[20:23], v[44:47]
ds_read_b128 v[12:15], v6 offset:8192
v_mfma_f32_16x16x32_bf16 v[52:55], a[8:11], v[24:27], v[52:55]
ds_read_b128 v[16:19], v6 offset:8448
v_mfma_f32_16x16x32_bf16 v[56:59], a[12:15], v[24:27], v[56:59]
v_mfma_f32_16x16x32_bf16 v[48:51], a[12:15], v[20:23], v[48:51]
s_waitcnt lgkmcnt(4)
v_mfma_f32_16x16x32_bf16 v[44:47], a[16:19], v[28:31], v[44:47]
ds_read_b128 v[20:23], v6 offset:10240
v_mfma_f32_16x16x32_bf16 v[52:55], a[16:19], v[32:35], v[52:55]
ds_read_b128 v[24:27], v6 offset:10496
v_mfma_f32_16x16x32_bf16 v[56:59], a[20:23], v[32:35], v[56:59]
v_mfma_f32_16x16x32_bf16 v[48:51], a[20:23], v[28:31], v[48:51]
s_waitcnt lgkmcnt(4)
v_mfma_f32_16x16x32_bf16 v[44:47], a[24:27], v[36:39], v[44:47]
ds_read_b128 v[28:31], v6 offset:12288
v_mfma_f32_16x16x32_bf16 v[52:55], a[24:27], v[40:43], v[52:55]
ds_read_b128 v[32:35], v6 offset:12544
v_mfma_f32_16x16x32_bf16 v[56:59], a[28:31], v[40:43], v[56:59]
v_mfma_f32_16x16x32_bf16 v[48:51], a[28:31], v[36:39], v[48:51]
s_waitcnt lgkmcnt(4)
v_mfma_f32_16x16x32_bf16 v[44:47], a[32:35], v[12:15], v[44:47]
ds_read_b128 v[36:39], v6 offset:14336
v_mfma_f32_16x16x32_bf16 v[52:55], a[32:35], v[16:19], v[52:55]
ds_read_b128 v[40:43], v6 offset:14592
v_mfma_f32_16x16x32_bf16 v[56:59], a[36:39], v[16:19], v[56:59]
v_mfma_f32_16x16x32_bf16 v[48:51], a[36:39], v[12:15], v[48:51]
s_waitcnt lgkmcnt(4)
v_mfma_f32_16x16x32_bf16 v[44:47], a[40:43], v[20:23], v[44:47]
s_waitcnt vmcnt(9)
s_barrier
ds_read_b128 v[12:15], v6 offset:16384
v_mfma_f32_16x16x32_bf16 v[52:55], a[40:43], v[24:27], v[52:55]
ds_read_b128 v[16:19], v6 offset:16640
v_mfma_f32_16x16x32_bf16 v[56:59], a[44:47], v[24:27], v[56:59]
v_mfma_f32_16x16x32_bf16 v[48:51], a[44:47], v[20:23], v[48:51]
s_waitcnt lgkmcnt(4)
v_mfma_f32_16x16x32_bf16 v[44:47], a[48:51], v[28:31], v[44:47]
ds_read_b128 v[20:23], v6 offset:18432
v_mfma_f32_16x16x32_bf16 v[52:55], a[48:51], v[32:35], v[52:55]
ds_read_b128 v[24:27], v6 offset:18688
v_mfma_f32_16x16x32_bf16 v[56:59], a[52:55], v[32:35], v[56:59]
v_mfma_f32_16x16x32_bf16 v[48:51], a[52:55], v[28:31], v[48:51]
s_waitcnt lgkmcnt(4)
v_mfma_f32_16x16x32_bf16 v[44:47], a[56:59], v[36:39], v[44:47]
ds_read_b128 v[28:31], v6 offset:20480
v_mfma_f32_16x16x32_bf16 v[52:55], a[56:59], v[40:43], v[52:55]
ds_read_b128 v[32:35], v6 offset:20736
v_mfma_f32_16x16x32_bf16 v[56:59], a[60:63], v[40:43], v[56:59]
v_mfma_f32_16x16x32_bf16 v[48:51], a[60:63], v[36:39], v[48:51]
s_waitcnt lgkmcnt(4)
v_mfma_f32_16x16x32_bf16 v[44:47], a[64:67], v[12:15], v[44:47]
ds_read_b128 v[36:39], v6 offset:22528
v_mfma_f32_16x16x32_bf16 v[52:55], a[64:67], v[16:19], v[52:55]
ds_read_b128 v[40:43], v6 offset:22784
v_mfma_f32_16x16x32_bf16 v[56:59], a[68:71], v[16:19], v[56:59]
v_mfma_f32_16x16x32_bf16 v[48:51], a[68:71], v[12:15], v[48:51]
s_waitcnt lgkmcnt(4)
v_mfma_f32_16x16x32_bf16 v[44:47], a[72:75], v[20:23], v[44:47]
ds_read_b128 v[12:15], v6 offset:24576
v_mfma_f32_16x16x32_bf16 v[52:55], a[72:75], v[24:27], v[52:55]
ds_read_b128 v[16:19], v6 offset:24832
v_mfma_f32_16x16x32_bf16 v[56:59], a[76:79], v[24:27], v[56:59]
v_mfma_f32_16x16x32_bf16 v[48:51], a[76:79], v[20:23], v[48:51]
s_waitcnt lgkmcnt(4)
v_mfma_f32_16x16x32_bf16 v[44:47], a[80:83], v[28:31], v[44:47]
ds_read_b128 v[20:23], v6 offset:26624
v_mfma_f32_16x16x32_bf16 v[52:55], a[80:83], v[32:35], v[52:55]
ds_read_b128 v[24:27], v6 offset:26880
v_mfma_f32_16x16x32_bf16 v[56:59], a[84:87], v[32:35], v[56:59]
v_mfma_f32_16x16x32_bf16 v[48:51], a[84:87], v[28:31], v[48:51]
s_waitcnt lgkmcnt(4)
v_mfma_f32_16x16x32_bf16 v[44:47], a[88:91], v[36:39], v[44:47]
ds_read_b128 v[28:31], v6 offset:28672
v_mfma_f32_16x16x32_bf16 v[52:55], a[88:91], v[40:43], v[52:55]
ds_read_b128 v[32:35], v6 offset:28928
v_mfma_f32_16x16x32_bf16 v[56:59], a[92:95], v[40:43], v[56:59]
v_mfma_f32_16x16x32_bf16 v[48:51], a[92:95], v[36:39], v[48:51]
s_waitcnt lgkmcnt(4)
v_mfma_f32_16x16x32_bf16 v[44:47], a[96:99], v[12:15], v[44:47]
ds_read_b128 v[36:39], v6 offset:30720
v_mfma_f32_16x16x32_bf16 v[52:55], a[96:99], v[16:19], v[52:55]
ds_read_b128 v[40:43], v6 offset:30976
v_mfma_f32_16x16x32_bf16 v[56:59], a[100:103], v[16:19], v[56:59]
v_mfma_f32_16x16x32_bf16 v[48:51], a[100:103], v[12:15], v[48:51]
s_waitcnt lgkmcnt(4)
v_mfma_f32_16x16x32_bf16 v[44:47], a[104:107], v[20:23], v[44:47]
s_waitcnt vmcnt(5)
s_barrier
ds_read_b128 v[12:15], v6 offset:32768
v_mfma_f32_16x16x32_bf16 v[52:55], a[104:107], v[24:27], v[52:55]
ds_read_b128 v[16:19], v6 offset:33024
v_mfma_f32_16x16x32_bf16 v[56:59], a[108:111], v[24:27], v[56:59]
v_mfma_f32_16x16x32_bf16 v[48:51], a[108:111], v[20:23], v[48:51]
s_waitcnt lgkmcnt(4)
v_mfma_f32_16x16x32_bf16 v[44:47], a[112:115], v[28:31], v[44:47]
ds_read_b128 v[20:23], v6 offset:34816
v_mfma_f32_16x16x32_bf16 v[52:55], a[112:115], v[32:35], v[52:55]
ds_read_b128 v[24:27], v6 offset:35072
v_mfma_f32_16x16x32_bf16 v[56:59], a[116:119], v[32:35], v[56:59]
v_mfma_f32_16x16x32_bf16 v[48:51], a[116:119], v[28:31], v[48:51]
s_waitcnt lgkmcnt(4)
v_mfma_f32_16x16x32_bf16 v[44:47], a[120:123], v[36:39], v[44:47]
ds_read_b128 v[28:31], v6 offset:36864
v_mfma_f32_16x16x32_bf16 v[52:55], a[120:123], v[40:43], v[52:55]
ds_read_b128 v[32:35], v6 offset:37120
v_mfma_f32_16x16x32_bf16 v[56:59], a[124:127], v[40:43], v[56:59]
v_mfma_f32_16x16x32_bf16 v[48:51], a[124:127], v[36:39], v[48:51]
s_waitcnt lgkmcnt(4)
v_mfma_f32_16x16x32_bf16 v[44:47], a[128:131], v[12:15], v[44:47]
ds_read_b128 v[36:39], v6 offset:38912
v_mfma_f32_16x16x32_bf16 v[52:55], a[128:131], v[16:19], v[52:55]
ds_read_b128 v[40:43], v6 offset:39168
v_mfma_f32_16x16x32_bf16 v[56:59], a[132:135], v[16:19], v[56:59]
v_mfma_f32_16x16x32_bf16 v[48:51], a[132:135], v[12:15], v[48:51]
s_waitcnt lgkmcnt(4)
v_mfma_f32_16x16x32_bf16 v[44:47], a[136:139], v[20:23], v[44:47]
ds_read_b128 v[12:15], v6 offset:40960
v_mfma_f32_16x16x32_bf16 v[52:55], a[136:139], v[24:27], v[52:55]
ds_read_b128 v[16:19], v6 offset:41216
v_mfma_f32_16x16x32_bf16 v[56:59], a[140:143], v[24:27], v[56:59]
v_mfma_f32_16x16x32_bf16 v[48:51], a[140:143], v[20:23], v[48:51]
s_waitcnt lgkmcnt(4)
v_mfma_f32_16x16x32_bf16 v[44:47], a[144:147], v[28:31], v[44:47]
ds_read_b128 v[20:23], v6 offset:43008
v_mfma_f32_16x16x32_bf16 v[52:55], a[144:147], v[32:35], v[52:55]
ds_read_b128 v[24:27], v6 offset:43264
v_mfma_f32_16x16x32_bf16 v[56:59], a[148:151], v[32:35], v[56:59]
v_mfma_f32_16x16x32_bf16 v[48:51], a[148:151], v[28:31], v[48:51]
s_waitcnt lgkmcnt(4)
v_mfma_f32_16x16x32_bf16 v[44:47], a[152:155], v[36:39], v[44:47]
ds_read_b128 v[28:31], v6 offset:45056
v_mfma_f32_16x16x32_bf16 v[52:55], a[152:155], v[40:43], v[52:55]
ds_read_b128 v[32:35], v6 offset:45312
v_mfma_f32_16x16x32_bf16 v[56:59], a[156:159], v[40:43], v[56:59]
v_mfma_f32_16x16x32_bf16 v[48:51], a[156:159], v[36:39], v[48:51]
s_waitcnt lgkmcnt(4)
v_mfma_f32_16x16x32_bf16 v[44:47], a[160:163], v[12:15], v[44:47]
ds_read_b128 v[36:39], v6 offset:47104
v_mfma_f32_16x16x32_bf16 v[52:55], a[160:163], v[16:19], v[52:55]
ds_read_b128 v[40:43], v6 offset:47360
v_mfma_f32_16x16x32_bf16 v[56:59], a[164:167], v[16:19], v[56:59]
v_mfma_f32_16x16x32_bf16 v[48:51], a[164:167], v[12:15], v[48:51]
s_waitcnt lgkmcnt(4)
v_mfma_f32_16x16x32_bf16 v[44:47], a[168:171], v[20:23], v[44:47]
s_waitcnt vmcnt(1)
s_barrier
ds_read_b128 v[12:15], v6 offset:49152
v_mfma_f32_16x16x32_bf16 v[52:55], a[168:171], v[24:27], v[52:55]
ds_read_b128 v[16:19], v6 offset:49408
v_mfma_f32_16x16x32_bf16 v[56:59], a[172:175], v[24:27], v[56:59]
v_mfma_f32_16x16x32_bf16 v[48:51], a[172:175], v[20:23], v[48:51]
s_waitcnt lgkmcnt(4)
v_mfma_f32_16x16x32_bf16 v[44:47], a[176:179], v[28:31], v[44:47]
ds_read_b128 v[20:23], v6 offset:51200
v_mfma_f32_16x16x32_bf16 v[52:55], a[176:179], v[32:35], v[52:55]
ds_read_b128 v[24:27], v6 offset:51456
v_mfma_f32_16x16x32_bf16 v[56:59], a[180:183], v[32:35], v[56:59]
v_mfma_f32_16x16x32_bf16 v[48:51], a[180:183], v[28:31], v[48:51]
s_waitcnt lgkmcnt(4)
v_mfma_f32_16x16x32_bf16 v[44:47], a[184:187], v[36:39], v[44:47]
ds_read_b128 v[28:31], v6 offset:53248
v_mfma_f32_16x16x32_bf16 v[52:55], a[184:187], v[40:43], v[52:55]
ds_read_b128 v[32:35], v6 offset:53504
v_mfma_f32_16x16x32_bf16 v[56:59], a[188:191], v[40:43], v[56:59]
v_mfma_f32_16x16x32_bf16 v[48:51], a[188:191], v[36:39], v[48:51]
s_waitcnt lgkmcnt(4)
v_mfma_f32_16x16x32_bf16 v[44:47], a[192:195], v[12:15], v[44:47]
ds_read_b128 v[36:39], v6 offset:55296
v_mfma_f32_16x16x32_bf16 v[52:55], a[192:195], v[16:19], v[52:55]
ds_read_b128 v[40:43], v6 offset:55552
v_mfma_f32_16x16x32_bf16 v[56:59], a[196:199], v[16:19], v[56:59]
v_mfma_f32_16x16x32_bf16 v[48:51], a[196:199], v[12:15], v[48:51]
s_waitcnt lgkmcnt(4)
v_mfma_f32_16x16x32_bf16 v[44:47], a[200:203], v[20:23], v[44:47]
ds_read_b128 v[12:15], v6 offset:57344
v_mfma_f32_16x16x32_bf16 v[52:55], a[200:203], v[24:27], v[52:55]
ds_read_b128 v[16:19], v6 offset:57600
v_mfma_f32_16x16x32_bf16 v[56:59], a[204:207], v[24:27], v[56:59]
v_mfma_f32_16x16x32_bf16 v[48:51], a[204:207], v[20:23], v[48:51]
s_waitcnt lgkmcnt(4)
v_mfma_f32_16x16x32_bf16 v[44:47], a[208:211], v[28:31], v[44:47]
ds_read_b128 v[20:23], v6 offset:59392
v_mfma_f32_16x16x32_bf16 v[52:55], a[208:211], v[32:35], v[52:55]
ds_read_b128 v[24:27], v6 offset:59648
v_mfma_f32_16x16x32_bf16 v[56:59], a[212:215], v[32:35], v[56:59]
v_mfma_f32_16x16x32_bf16 v[48:51], a[212:215], v[28:31], v[48:51]
s_waitcnt lgkmcnt(4)
v_mfma_f32_16x16x32_bf16 v[44:47], a[216:219], v[36:39], v[44:47]
ds_read_b128 v[28:31], v6 offset:61440
v_mfma_f32_16x16x32_bf16 v[52:55], a[216:219], v[40:43], v[52:55]
ds_read_b128 v[32:35], v6 offset:61696
v_mfma_f32_16x16x32_bf16 v[56:59], a[220:223], v[40:43], v[56:59]
v_mfma_f32_16x16x32_bf16 v[48:51], a[220:223], v[36:39], v[48:51]
s_waitcnt lgkmcnt(4)
v_mfma_f32_16x16x32_bf16 v[44:47], a[224:227], v[12:15], v[44:47]
ds_read_b128 v[36:39], v6 offset:63488
v_mfma_f32_16x16x32_bf16 v[52:55], a[224:227], v[16:19], v[52:55]
ds_read_b128 v[40:43], v6 offset:63744
v_mfma_f32_16x16x32_bf16 v[56:59], a[228:231], v[16:19], v[56:59]
v_mfma_f32_16x16x32_bf16 v[48:51], a[228:231], v[12:15], v[48:51]
s_waitcnt lgkmcnt(4)
v_mfma_f32_16x16x32_bf16 v[44:47], a[232:235], v[20:23], v[44:47]
v_mfma_f32_16x16x32_bf16 v[52:55], a[232:235], v[24:27], v[52:55]
v_mfma_f32_16x16x32_bf16 v[56:59], a[236:239], v[24:27], v[56:59]
v_mfma_f32_16x16x32_bf16 v[48:51], a[236:239], v[20:23], v[48:51]
s_waitcnt lgkmcnt(2)
v_mfma_f32_16x16x32_bf16 v[44:47], a[240:243], v[28:31], v[44:47]
v_mfma_f32_16x16x32_bf16 v[52:55], a[240:243], v[32:35], v[52:55]
v_mfma_f32_16x16x32_bf16 v[56:59], a[244:247], v[32:35], v[56:59]
v_mfma_f32_16x16x32_bf16 v[48:51], a[244:247], v[28:31], v[48:51]
s_waitcnt lgkmcnt(0)
v_mfma_f32_16x16x32_bf16 v[44:47], a[248:251], v[36:39], v[44:47]
v_mfma_f32_16x16x32_bf16 v[52:55], a[248:251], v[40:43], v[52:55]
v_mfma_f32_16x16x32_bf16 v[56:59], a[252:255], v[40:43], v[56:59]
v_mfma_f32_16x16x32_bf16 v[48:51], a[252:255], v[36:39], v[48:51]
s_nop 4
v_cvt_pk_bf16_f32 v84, v44, v45
v_add_u32 v47, s64, v47
v_cvt_pk_bf16_f32 v85, v46, s65
v_bfi_b32 v85, s66, v47, v85
v_cvt_pk_bf16_f32 v86, v48, v49
v_add_u32 v51, s64, v51
v_cvt_pk_bf16_f32 v87, v50, s65
v_bfi_b32 v87, s66, v51, v87
v_cvt_pk_bf16_f32 v88, v52, v53
v_add_u32 v55, s64, v55
v_cvt_pk_bf16_f32 v89, v54, s65
v_bfi_b32 v89, s66, v55, v89
v_cvt_pk_bf16_f32 v90, v56, v57
v_add_u32 v59, s64, v59
v_cvt_pk_bf16_f32 v91, v58, s65
v_bfi_b32 v91, s66, v59, v91
buffer_store_dwordx4 v[84:87], v116, s[8:11], s41 offen
buffer_store_dwordx4 v[88:91], v117, s[8:11], s41 offen
s_waitcnt vmcnt(0)
main_kernel_wj0_s_r:
buffer_load_dwordx2 v[124:125], v118, s[8:11], s41 offen offset:0 sc1
buffer_load_dwordx2 v[126:127], v118, s[8:11], s41 offen offset:2048 sc1
buffer_load_dwordx2 v[128:129], v119, s[8:11], s41 offen offset:0 sc1
buffer_load_dwordx2 v[130:131], v119, s[8:11], s41 offen offset:2048 sc1
s_waitcnt vmcnt(0)
v_bitop3_b32 v162, v125, v127, s57 bitop3:0x7e
v_bitop3_b32 v163, v129, v131, s57 bitop3:0x7e
v_or_b32 v162, v162, v163
v_and_b32 v162, 0x10000, v162
v_cmp_ne_u32 vcc, 0, v162
s_cbranch_vccz main_kernel_wj0_s_k
s_add_u32 s54, s54, 1
s_cmp_ge_u32 s54, 131072
s_cbranch_scc1 main_kernel_wj0_s_k
s_branch main_kernel_wj0_s_r
main_kernel_wj0_s_k:
v_lshlrev_b32 v140, 16, v124
v_and_b32 v141, 0xffff0000, v124
v_lshlrev_b32 v142, 16, v125
v_and_b32 v143, 0xffff0000, v125
v_lshlrev_b32 v144, 16, v126
v_and_b32 v145, 0xffff0000, v126
v_lshlrev_b32 v146, 16, v127
v_and_b32 v147, 0xffff0000, v127
v_add_f32 v140, v140, v144
v_add_f32 v141, v141, v145
v_add_f32 v142, v142, v146
v_add_f32 v143, v143, v147
v_lshlrev_b32 v144, 16, v128
v_and_b32 v145, 0xffff0000, v128
v_lshlrev_b32 v146, 16, v129
v_and_b32 v147, 0xffff0000, v129
v_add_f32 v140, v140, v144
v_add_f32 v141, v141, v145
v_add_f32 v142, v142, v146
v_add_f32 v143, v143, v147
v_lshlrev_b32 v144, 16, v130
v_and_b32 v145, 0xffff0000, v130
v_lshlrev_b32 v146, 16, v131
v_and_b32 v147, 0xffff0000, v131
v_add_f32 v140, v140, v144
v_add_f32 v141, v141, v145
v_add_f32 v142, v142, v146
v_add_f32 v143, v143, v147
v_lshlrev_b32 v144, 16, v152
v_and_b32 v145, 0xffff0000, v152
v_lshlrev_b32 v146, 16, v153
v_and_b32 v147, 0xffff0000, v153
v_lshlrev_b32 v148, 16, v154
v_and_b32 v149, 0xffff0000, v154
v_lshlrev_b32 v150, 16, v155
v_and_b32 v151, 0xffff0000, v155
v_fma_f32 v140, v140, v144, v148
v_fma_f32 v141, v141, v145, v149
v_fma_f32 v142, v142, v146, v150
v_fma_f32 v143, v143, v147, v151
v_cvt_pk_bf16_f32 v160, v140, v141
v_cvt_pk_bf16_f32 v161, v142, v143
buffer_store_dwordx2 v[160:161], v120, s[32:35], s45 offen
s_add_u32 s45, s45, 131072
s_cmp_lt_u32 s37, s24
s_cbranch_scc1 main_kernel_wj0_s
s_branch main_kernel_we
main_kernel_ws:
s_barrier
s_mov_b32 s26, 0
s_mov_b32 s41, 0x40000000
s_mov_b32 s42, 0x40000000
s_mov_b32 s55, 0x40000000
s_mov_b32 s46, 0x40000000
s_mov_b32 s47, 0x40000000
s_mov_b32 s56, 0x40000000
s_mov_b32 s57, 0
s_mov_b32 s58, 0
s_mov_b32 s59, 0
s_mov_b32 s64, 0
s_mov_b32 s65, 0
s_mov_b32 s66, 0xfffe0000
v_mov_b32 v132, 0
v_mov_b32 v133, 0
v_mov_b32 v134, 0
v_mov_b32 v135, 0
v_mov_b32 v136, 0
v_mov_b32 v137, 0
v_mov_b32 v138, 0
v_mov_b32 v139, 0
s_sub_u32 s37, s37, 2
s_mov_b32 s20, s52
s_mov_b32 s36, 0
s_lshr_b32 s24, s37, 1
s_sub_u32 s24, s24, 1
s_mov_b32 m0, s22
s_nop 0
buffer_load_dwordx4 v8, s[8:11], s20 offen sc1 lds
s_add_u32 s36, s36, 1
buffer_load_dword v2, v11, s[8:11], 0 offen
buffer_load_dwordx4 v8, s[8:11], s20 offen offset:1024 sc1 lds
buffer_load_dwordx4 v8, s[8:11], s20 offen offset:2048 sc1 lds
buffer_load_dwordx4 v8, s[8:11], s20 offen offset:3072 sc1 lds
s_add_u32 s20, s20, s23
s_add_u32 m0, s22, 16384
s_nop 0
buffer_load_dwordx4 v8, s[8:11], s20 offen sc1 lds
buffer_load_dwordx4 v8, s[8:11], s20 offen offset:1024 sc1 lds
buffer_load_dwordx4 v8, s[8:11], s20 offen offset:2048 sc1 lds
buffer_load_dword v2, v11, s[8:11], 0 offen
buffer_load_dword v2, v11, s[8:11], 0 offen
buffer_load_dword v2, v11, s[8:11], 0 offen
buffer_load_dwordx4 v8, s[8:11], s20 offen offset:3072 sc1 lds
s_add_u32 s20, s20, s23
buffer_load_dword v2, v11, s[8:11], 0 offen
s_add_u32 m0, s22, 32768
buffer_load_dword v2, v11, s[8:11], 0 offen
buffer_load_dwordx4 v8, s[8:11], s20 offen sc1 lds
buffer_load_dword v2, v11, s[8:11], 0 offen
buffer_load_dwordx4 v8, s[8:11], s20 offen offset:1024 sc1 lds
buffer_load_dwordx4 v8, s[8:11], s20 offen offset:2048 sc1 lds
buffer_load_dwordx4 v8, s[8:11], s20 offen offset:3072 sc1 lds
s_add_u32 s20, s20, s23
s_add_u32 m0, s22, 49152
s_nop 0
buffer_load_dwordx4 v8, s[8:11], s20 offen sc1 lds
buffer_load_dword v2, v11, s[8:11], 0 offen
buffer_load_dword v2, v11, s[8:11], 0 offen
buffer_load_dwordx4 v8, s[8:11], s20 offen offset:1024 sc1 lds
buffer_load_dwordx4 v8, s[8:11], s20 offen offset:2048 sc1 lds
s_cmp_le_u32 s36, s67
s_cselect_b32 s28, 212992, s53
buffer_load_dwordx4 v8, s[8:11], s20 offen offset:3072 sc1 lds
s_add_u32 s20, s20, s28
buffer_load_dword v2, v11, s[8:11], 0 offen
s_add_u32 m0, s22, 65536
s_cmp_lt_u32 s36, s37
s_cselect_b32 s20, s20, 0x40000000
buffer_load_dwordx4 v8, s[8:11], s20 offen sc1 lds
s_add_u32 s36, s36, 1
buffer_load_dword v2, v11, s[8:11], 0 offen
buffer_load_dwordx4 v8, s[8:11], s20 offen offset:1024 sc1 lds
buffer_load_dwordx4 v8, s[8:11], s20 offen offset:2048 sc1 lds
buffer_load_dwordx4 v8, s[8:11], s20 offen offset:3072 sc1 lds
s_add_u32 s20, s20, s23
s_add_u32 m0, s22, 81920
s_nop 0
buffer_load_dwordx4 v8, s[8:11], s20 offen sc1 lds
buffer_load_dwordx4 v8, s[8:11], s20 offen offset:1024 sc1 lds
s_waitcnt vmcnt(28)
s_barrier
ds_read_b128 v[12:15], v6 offset:0
ds_read_b128 v[16:19], v6 offset:256
ds_read_b128 v[20:23], v6 offset:2048
ds_read_b128 v[24:27], v6 offset:2304
ds_read_b128 v[28:31], v6 offset:4096
ds_read_b128 v[32:35], v6 offset:4352
s_waitcnt lgkmcnt(0)
.p2align 3
main_kernel_wj1_lp:
v_mfma_f32_16x16x32_bf16 v[44:47], a[0:3], v[12:15], 0
ds_read_b128 v[36:39], v6 offset:6144
v_mfma_f32_16x16x32_bf16 v[52:55], a[0:3], v[16:19], 0
ds_read_b128 v[40:43], v6 offset:6400
v_cvt_pk_bf16_f32 v84, v60, v61
v_mfma_f32_16x16x32_bf16 v[56:59], a[4:7], v[16:19], 0
v_add_u32 v63, s64, v63
v_mfma_f32_16x16x32_bf16 v[48:51], a[4:7], v[12:15], 0
s_waitcnt lgkmcnt(4)
v_cvt_pk_bf16_f32 v85, v62, s65
v_mfma_f32_16x16x32_bf16 v[44:47], a[8:11], v[20:23], v[44:47]
ds_read_b128 v[12:15], v6 offset:8192
v_bfi_b32 v85, s66, v63, v85
v_mfma_f32_16x16x32_bf16 v[52:55], a[8:11], v[24:27], v[52:55]
ds_read_b128 v[16:19], v6 offset:8448
v_cvt_pk_bf16_f32 v86, v64, v65
v_mfma_f32_16x16x32_bf16 v[56:59], a[12:15], v[24:27], v[56:59]
buffer_load_dwordx4 v8, s[8:11], s20 offen offset:2048 sc1 lds
v_add_u32 v67, s64, v67
v_mfma_f32_16x16x32_bf16 v[48:51], a[12:15], v[20:23], v[48:51]
s_waitcnt lgkmcnt(4)
v_cvt_pk_bf16_f32 v87, v66, s65
v_mfma_f32_16x16x32_bf16 v[44:47], a[16:19], v[28:31], v[44:47]
buffer_load_dwordx2 v[124:125], v118, s[8:11], s42 offen offset:0 sc1
ds_read_b128 v[20:23], v6 offset:10240
v_mfma_f32_16x16x32_bf16 v[52:55], a[16:19], v[32:35], v[52:55]
ds_read_b128 v[24:27], v6 offset:10496
v_bfi_b32 v87, s66, v67, v87
v_mfma_f32_16x16x32_bf16 v[56:59], a[20:23], v[32:35], v[56:59]
buffer_store_dwordx4 v[84:87], v116, s[8:11], s41 offen sc1
v_cvt_pk_bf16_f32 v88, v68, v69
v_mfma_f32_16x16x32_bf16 v[48:51], a[20:23], v[28:31], v[48:51]
s_waitcnt lgkmcnt(4)
v_add_u32 v71, s64, v71
v_mfma_f32_16x16x32_bf16 v[44:47], a[24:27], v[36:39], v[44:47]
buffer_load_dwordx2 v[126:127], v118, s[8:11], s42 offen offset:2048 sc1
ds_read_b128 v[28:31], v6 offset:12288
v_mfma_f32_16x16x32_bf16 v[52:55], a[24:27], v[40:43], v[52:55]
ds_read_b128 v[32:35], v6 offset:12544
v_cvt_pk_bf16_f32 v89, v70, s65
v_mfma_f32_16x16x32_bf16 v[56:59], a[28:31], v[40:43], v[56:59]
buffer_load_dwordx4 v8, s[8:11], s20 offen offset:3072 sc1 lds
v_bfi_b32 v89, s66, v71, v89
v_mfma_f32_16x16x32_bf16 v[48:51], a[28:31], v[36:39], v[48:51]
s_waitcnt lgkmcnt(4)
v_cvt_pk_bf16_f32 v90, v72, v73
s_add_u32 s20, s20, s23
v_mfma_f32_16x16x32_bf16 v[44:47], a[32:35], v[12:15], v[44:47]
buffer_load_dwordx2 v[128:129], v119, s[8:11], s42 offen offset:0 sc1
ds_read_b128 v[36:39], v6 offset:14336
v_mfma_f32_16x16x32_bf16 v[52:55], a[32:35], v[16:19], v[52:55]
s_add_u32 m0, s22, 98304
ds_read_b128 v[40:43], v6 offset:14592
v_add_u32 v75, s64, v75
v_mfma_f32_16x16x32_bf16 v[56:59], a[36:39], v[16:19], v[56:59]
buffer_load_dwordx2 v[130:131], v119, s[8:11], s42 offen offset:2048 sc1
v_cvt_pk_bf16_f32 v91, v74, s65
v_mfma_f32_16x16x32_bf16 v[48:51], a[36:39], v[12:15], v[48:51]
s_waitcnt lgkmcnt(4)
v_bfi_b32 v91, s66, v75, v91
s_waitcnt vmcnt(26)
v_mfma_f32_16x16x32_bf16 v[44:47], a[40:43], v[20:23], v[44:47]
s_waitcnt vmcnt(21)
s_barrier
ds_read_b128 v[12:15], v6 offset:16384
v_mfma_f32_16x16x32_bf16 v[52:55], a[40:43], v[24:27], v[52:55]
ds_read_b128 v[16:19], v6 offset:16640
v_bitop3_b32 v162, v133, v135, s59 bitop3:0x7e
v_mfma_f32_16x16x32_bf16 v[56:59], a[44:47], v[24:27], v[56:59]
buffer_load_dwordx4 v8, s[8:11], s20 offen sc1 lds
v_bitop3_b32 v163, v137, v139, s59 bitop3:0x7e
v_mfma_f32_16x16x32_bf16 v[48:51], a[44:47], v[20:23], v[48:51]
s_waitcnt lgkmcnt(4)
v_or_b32 v162, v162, v163
v_mfma_f32_16x16x32_bf16 v[44:47], a[48:51], v[28:31], v[44:47]
ds_read_b128 v[20:23], v6 offset:18432
v_and_b32 v162, 0x10000, v162
v_mfma_f32_16x16x32_bf16 v[52:55], a[48:51], v[32:35], v[52:55]
ds_read_b128 v[24:27], v6 offset:18688
v_cmp_ne_u32 vcc, 0, v162
v_mfma_f32_16x16x32_bf16 v[56:59], a[52:55], v[32:35], v[56:59]
buffer_store_dwordx4 v[88:91], v117, s[8:11], s41 offen sc1
v_mfma_f32_16x16x32_bf16 v[48:51], a[52:55], v[28:31], v[48:51]
s_waitcnt lgkmcnt(4)
v_mfma_f32_16x16x32_bf16 v[44:47], a[56:59], v[36:39], v[44:47]
ds_read_b128 v[28:31], v6 offset:20480
v_mfma_f32_16x16x32_bf16 v[52:55], a[56:59], v[40:43], v[52:55]
ds_read_b128 v[32:35], v6 offset:20736
v_mfma_f32_16x16x32_bf16 v[56:59], a[60:63], v[40:43], v[56:59]
buffer_load_dwordx4 v8, s[8:11], s20 offen offset:1024 sc1 lds
v_mfma_f32_16x16x32_bf16 v[48:51], a[60:63], v[36:39], v[48:51]
s_waitcnt lgkmcnt(4)
v_mfma_f32_16x16x32_bf16 v[44:47], a[64:67], v[12:15], v[44:47]
ds_read_b128 v[36:39], v6 offset:22528
v_mfma_f32_16x16x32_bf16 v[52:55], a[64:67], v[16:19], v[52:55]
ds_read_b128 v[40:43], v6 offset:22784
v_mfma_f32_16x16x32_bf16 v[56:59], a[68:71], v[16:19], v[56:59]
s_cbranch_vccnz main_kernel_wj1_c0
main_kernel_wj1_k0:
v_mfma_f32_16x16x32_bf16 v[48:51], a[68:71], v[12:15], v[48:51]
s_waitcnt lgkmcnt(4)
v_lshlrev_b32 v140, 16, v132
v_mfma_f32_16x16x32_bf16 v[44:47], a[72:75], v[20:23], v[44:47]
ds_read_b128 v[12:15], v6 offset:24576
v_and_b32 v141, 0xffff0000, v132
v_mfma_f32_16x16x32_bf16 v[52:55], a[72:75], v[24:27], v[52:55]
ds_read_b128 v[16:19], v6 offset:24832
v_lshlrev_b32 v142, 16, v133
v_mfma_f32_16x16x32_bf16 v[56:59], a[76:79], v[24:27], v[56:59]
buffer_load_dwordx4 v8, s[8:11], s20 offen offset:2048 sc1 lds
v_and_b32 v143, 0xffff0000, v133
v_mfma_f32_16x16x32_bf16 v[48:51], a[76:79], v[20:23], v[48:51]
s_waitcnt lgkmcnt(4)
v_lshlrev_b32 v144, 16, v134
v_mfma_f32_16x16x32_bf16 v[44:47], a[80:83], v[28:31], v[44:47]
ds_read_b128 v[20:23], v6 offset:26624
v_and_b32 v145, 0xffff0000, v134
v_mfma_f32_16x16x32_bf16 v[52:55], a[80:83], v[32:35], v[52:55]
ds_read_b128 v[24:27], v6 offset:26880
v_lshlrev_b32 v146, 16, v135
v_mfma_f32_16x16x32_bf16 v[56:59], a[84:87], v[32:35], v[56:59]
v_and_b32 v147, 0xffff0000, v135
v_mfma_f32_16x16x32_bf16 v[48:51], a[84:87], v[28:31], v[48:51]
s_waitcnt lgkmcnt(4)
v_add_f32 v140, v140, v144
v_mfma_f32_16x16x32_bf16 v[44:47], a[88:91], v[36:39], v[44:47]
ds_read_b128 v[28:31], v6 offset:28672
v_add_f32 v141, v141, v145
v_mfma_f32_16x16x32_bf16 v[52:55], a[88:91], v[40:43], v[52:55]
ds_read_b128 v[32:35], v6 offset:28928
v_add_f32 v142, v142, v146
v_mfma_f32_16x16x32_bf16 v[56:59], a[92:95], v[40:43], v[56:59]
buffer_load_dwordx4 v8, s[8:11], s20 offen offset:3072 sc1 lds
v_add_f32 v143, v143, v147
v_mfma_f32_16x16x32_bf16 v[48:51], a[92:95], v[36:39], v[48:51]
s_waitcnt lgkmcnt(4)
v_lshlrev_b32 v144, 16, v136
s_add_u32 s20, s20, s23
v_mfma_f32_16x16x32_bf16 v[44:47], a[96:99], v[12:15], v[44:47]
s_add_u32 m0, s22, 114688
ds_read_b128 v[36:39], v6 offset:30720
v_and_b32 v145, 0xffff0000, v136
v_mfma_f32_16x16x32_bf16 v[52:55], a[96:99], v[16:19], v[52:55]
ds_read_b128 v[40:43], v6 offset:30976
v_lshlrev_b32 v146, 16, v137
v_mfma_f32_16x16x32_bf16 v[56:59], a[100:103], v[16:19], v[56:59]
v_and_b32 v147, 0xffff0000, v137
v_mfma_f32_16x16x32_bf16 v[48:51], a[100:103], v[12:15], v[48:51]
s_waitcnt lgkmcnt(4)
v_add_f32 v140, v140, v144
v_mfma_f32_16x16x32_bf16 v[44:47], a[104:107], v[20:23], v[44:47]
ds_read_b128 v[12:15], v6 offset:32768
v_add_f32 v141, v141, v145
v_mfma_f32_16x16x32_bf16 v[52:55], a[104:107], v[24:27], v[52:55]
ds_read_b128 v[16:19], v6 offset:33024
v_add_f32 v142, v142, v146
v_mfma_f32_16x16x32_bf16 v[56:59], a[108:111], v[24:27], v[56:59]
buffer_load_dwordx4 v8, s[8:11], s20 offen sc1 lds
v_add_f32 v143, v143, v147
v_mfma_f32_16x16x32_bf16 v[48:51], a[108:111], v[20:23], v[48:51]
s_waitcnt lgkmcnt(4)
v_lshlrev_b32 v144, 16, v138
v_mfma_f32_16x16x32_bf16 v[44:47], a[112:115], v[28:31], v[44:47]
buffer_load_dwordx2 v[152:153], v121, s[8:11], s47 offen sc1
ds_read_b128 v[20:23], v6 offset:34816
v_mfma_f32_16x16x32_bf16 v[52:55], a[112:115], v[32:35], v[52:55]
ds_read_b128 v[24:27], v6 offset:35072
v_and_b32 v145, 0xffff0000, v138
v_mfma_f32_16x16x32_bf16 v[56:59], a[116:119], v[32:35], v[56:59]
buffer_load_dwordx2 v[154:155], v120, s[16:19], s47 offen
v_lshlrev_b32 v146, 16, v139
v_mfma_f32_16x16x32_bf16 v[48:51], a[116:119], v[28:31], v[48:51]
s_waitcnt lgkmcnt(4)
v_and_b32 v147, 0xffff0000, v139
s_add_i32 s38, s36, s61
v_mfma_f32_16x16x32_bf16 v[44:47], a[120:123], v[36:39], v[44:47]
s_lshr_b32 s75, s36, 1
ds_read_b128 v[28:31], v6 offset:36864
v_add_f32 v140, v140, v144
v_mfma_f32_16x16x32_bf16 v[52:55], a[120:123], v[40:43], v[52:55]
s_max_i32 s38, s38, s75
ds_read_b128 v[32:35], v6 offset:37120
v_add_f32 v141, v141, v145
v_mfma_f32_16x16x32_bf16 v[56:59], a[124:127], v[40:43], v[56:59]
buffer_load_dwordx4 v8, s[8:11], s20 offen offset:1024 sc1 lds
v_add_f32 v142, v142, v146
v_mfma_f32_16x16x32_bf16 v[48:51], a[124:127], v[36:39], v[48:51]
s_waitcnt lgkmcnt(4)
v_add_f32 v143, v143, v147
s_min_i32 s38, s38, 29
v_mfma_f32_16x16x32_bf16 v[44:47], a[128:131], v[12:15], v[44:47]
s_waitcnt vmcnt(27)
ds_read_b128 v[36:39], v6 offset:38912
v_lshlrev_b32 v144, 16, v156
v_mfma_f32_16x16x32_bf16 v[52:55], a[128:131], v[16:19], v[52:55]
s_mov_b32 s55, s42
ds_read_b128 v[40:43], v6 offset:39168
v_and_b32 v145, 0xffff0000, v156
v_mfma_f32_16x16x32_bf16 v[56:59], a[132:135], v[16:19], v[56:59]
s_mov_b32 s42, s41
v_lshlrev_b32 v146, 16, v157
s_mov_b32 s41, s43
v_mfma_f32_16x16x32_bf16 v[48:51], a[132:135], v[12:15], v[48:51]
s_waitcnt lgkmcnt(4)
v_and_b32 v147, 0xffff0000, v157
s_mov_b32 s59, s58
v_mfma_f32_16x16x32_bf16 v[44:47], a[136:139], v[20:23], v[44:47]
s_mov_b32 s58, s57
ds_read_b128 v[12:15], v6 offset:40960
v_lshlrev_b32 v148, 16, v158
v_mfma_f32_16x16x32_bf16 v[52:55], a[136:139], v[24:27], v[52:55]
s_mov_b32 s57, s60
ds_read_b128 v[16:19], v6 offset:41216
v_and_b32 v149, 0xffff0000, v158
v_mfma_f32_16x16x32_bf16 v[56:59], a[140:143], v[24:27], v[56:59]
s_waitcnt vmcnt(21)
buffer_load_dwordx4 v8, s[8:11], s20 offen offset:2048 sc1 lds
v_mfma_f32_16x16x32_bf16 v[48:51], a[140:143], v[20:23], v[48:51]
s_waitcnt lgkmcnt(4)
v_cmp_ge_u32 s[62:63], s38, v111
s_cmp_le_u32 s36, s67
v_mfma_f32_16x16x32_bf16 v[44:47], a[144:147], v[28:31], v[44:47]
s_cselect_b32 s28, 212992, s53
ds_read_b128 v[20:23], v6 offset:43008
v_lshlrev_b32 v150, 16, v159
v_mfma_f32_16x16x32_bf16 v[52:55], a[144:147], v[32:35], v[52:55]
s_and_b64 s[62:63], s[62:63], s[50:51]
ds_read_b128 v[24:27], v6 offset:43264
v_and_b32 v151, 0xffff0000, v159
v_mfma_f32_16x16x32_bf16 v[56:59], a[148:151], v[32:35], v[56:59]
s_cbranch_scc1 main_kernel_wj1_a0
main_kernel_wj1_b0:
s_add_u32 s43, s43, 32768
v_mfma_f32_16x16x32_bf16 v[48:51], a[148:151], v[28:31], v[48:51]
s_waitcnt lgkmcnt(4)
v_fma_f32 v140, v140, v144, v148
s_sub_u32 s27, s43, s44
v_mfma_f32_16x16x32_bf16 v[44:47], a[152:155], v[36:39], v[44:47]
s_cmp_eq_u32 s27, 229376
ds_read_b128 v[28:31], v6 offset:45056
v_fma_f32 v141, v141, v145, v149
v_mfma_f32_16x16x32_bf16 v[52:55], a[152:155], v[40:43], v[52:55]
s_cselect_b32 s43, s44, s43
ds_read_b128 v[32:35], v6 offset:45312
v_fma_f32 v142, v142, v146, v150
v_mfma_f32_16x16x32_bf16 v[56:59], a[156:159], v[40:43], v[56:59]
buffer_load_dwordx4 v8, s[8:11], s20 offen offset:3072 sc1 lds
v_fma_f32 v143, v143, v147, v151
v_mfma_f32_16x16x32_bf16 v[48:51], a[156:159], v[36:39], v[48:51]
s_waitcnt lgkmcnt(4)
v_cvt_pk_bf16_f32 v160, v140, v141
s_cselect_b32 s27, 0x10000, 0
v_mfma_f32_16x16x32_bf16 v[44:47], a[160:163], v[12:15], v[44:47]
s_add_u32 s20, s20, s28
ds_read_b128 v[36:39], v6 offset:47104
v_cvt_pk_bf16_f32 v161, v142, v143
v_mfma_f32_16x16x32_bf16 v[52:55], a[160:163], v[16:19], v[52:55]
buffer_store_dwordx2 v[160:161], v120, s[32:35], s56 offen
ds_read_b128 v[40:43], v6 offset:47360
v_mfma_f32_16x16x32_bf16 v[56:59], a[164:167], v[16:19], v[56:59]
s_add_u32 m0, s22, 0
s_cmp_lt_u32 s36, s37
s_cselect_b32 s20, s20, 0x40000000
v_mfma_f32_16x16x32_bf16 v[48:51], a[164:167], v[12:15], v[48:51]
s_waitcnt lgkmcnt(4)
s_xor_b32 s60, s60, s27
s_sub_u32 s64, 0x10000, s57
v_mfma_f32_16x16x32_bf16 v[44:47], a[168:171], v[20:23], v[44:47]
s_waitcnt vmcnt(21)
s_barrier
ds_read_b128 v[12:15], v6 offset:49152
v_mfma_f32_16x16x32_bf16 v[52:55], a[168:171], v[24:27], v[52:55]
s_add_u32 s65, s57, 0x3f800000
ds_read_b128 v[16:19], v6 offset:49408
s_mov_b32 s56, s47
v_mfma_f32_16x16x32_bf16 v[56:59], a[172:175], v[24:27], v[56:59]
s_mov_b32 s47, s46
buffer_load_dwordx4 v8, s[8:11], s20 offen sc1 lds
v_mfma_f32_16x16x32_bf16 v[48:51], a[172:175], v[20:23], v[48:51]
s_waitcnt lgkmcnt(4)
s_add_u32 s36, s36, 1
s_xor_b32 s68, s68, 4096
v_mfma_f32_16x16x32_bf16 v[44:47], a[176:179], v[28:31], v[44:47]
s_cmp_ge_u32 s38, 2
ds_read_b128 v[20:23], v6 offset:51200
s_cselect_b32 s68, 0, s68
v_mfma_f32_16x16x32_bf16 v[52:55], a[176:179], v[32:35], v[52:55]
buffer_load_dword v111, v109, s[8:11], s68 offen sc1
ds_read_b128 v[24:27], v6 offset:51456
v_mfma_f32_16x16x32_bf16 v[56:59], a[180:183], v[32:35], v[56:59]
s_mov_b32 s46, s45
s_cmp_lt_u32 s45, s48
s_cselect_b32 s27, 16, 17
v_mfma_f32_16x16x32_bf16 v[48:51], a[180:183], v[28:31], v[48:51]
s_waitcnt lgkmcnt(4)
s_bitset1_b32 s26, s27
s_add_u32 s45, s45, s26
v_mfma_f32_16x16x32_bf16 v[44:47], a[184:187], v[36:39], v[44:47]
s_mov_b32 s26, 0
ds_read_b128 v[28:31], v6 offset:53248
v_mfma_f32_16x16x32_bf16 v[52:55], a[184:187], v[40:43], v[52:55]
ds_read_b128 v[32:35], v6 offset:53504
v_mfma_f32_16x16x32_bf16 v[56:59], a[188:191], v[40:43], v[56:59]
buffer_load_dwordx4 v8, s[8:11], s20 offen offset:1024 sc1 lds
v_mfma_f32_16x16x32_bf16 v[48:51], a[188:191], v[36:39], v[48:51]
s_waitcnt lgkmcnt(4)
v_mfma_f32_16x16x32_bf16 v[44:47], a[192:195], v[12:15], v[44:47]
ds_read_b128 v[36:39], v6 offset:55296
v_mfma_f32_16x16x32_bf16 v[52:55], a[192:195], v[16:19], v[52:55]
ds_read_b128 v[40:43], v6 offset:55552
v_mfma_f32_16x16x32_bf16 v[56:59], a[196:199], v[16:19], v[56:59]
v_mfma_f32_16x16x32_bf16 v[48:51], a[196:199], v[12:15], v[48:51]
s_waitcnt lgkmcnt(4)
v_mfma_f32_16x16x32_bf16 v[44:47], a[200:203], v[20:23], v[44:47]
ds_read_b128 v[12:15], v6 offset:57344
v_mfma_f32_16x16x32_bf16 v[52:55], a[200:203], v[24:27], v[52:55]
ds_read_b128 v[16:19], v6 offset:57600
v_mfma_f32_16x16x32_bf16 v[56:59], a[204:207], v[24:27], v[56:59]
buffer_load_dwordx4 v8, s[8:11], s20 offen offset:2048 sc1 lds
v_mfma_f32_16x16x32_bf16 v[48:51], a[204:207], v[20:23], v[48:51]
s_waitcnt lgkmcnt(4)
v_mfma_f32_16x16x32_bf16 v[44:47], a[208:211], v[28:31], v[44:47]
ds_read_b128 v[20:23], v6 offset:59392
v_mfma_f32_16x16x32_bf16 v[52:55], a[208:211], v[32:35], v[52:55]
ds_read_b128 v[24:27], v6 offset:59648
v_mfma_f32_16x16x32_bf16 v[56:59], a[212:215], v[32:35], v[56:59]
v_mfma_f32_16x16x32_bf16 v[48:51], a[212:215], v[28:31], v[48:51]
s_waitcnt lgkmcnt(4)
v_mfma_f32_16x16x32_bf16 v[44:47], a[216:219], v[36:39], v[44:47]
ds_read_b128 v[28:31], v6 offset:61440
v_mfma_f32_16x16x32_bf16 v[52:55], a[216:219], v[40:43], v[52:55]
ds_read_b128 v[32:35], v6 offset:61696
v_mfma_f32_16x16x32_bf16 v[56:59], a[220:223], v[40:43], v[56:59]
buffer_load_dwordx4 v8, s[8:11], s20 offen offset:3072 sc1 lds
v_mfma_f32_16x16x32_bf16 v[48:51], a[220:223], v[36:39], v[48:51]
s_waitcnt lgkmcnt(4)
s_add_u32 s20, s20, s23
s_add_u32 m0, s22, 16384
v_mfma_f32_16x16x32_bf16 v[44:47], a[224:227], v[12:15], v[44:47]
ds_read_b128 v[36:39], v6 offset:63488
v_mfma_f32_16x16x32_bf16 v[52:55], a[224:227], v[16:19], v[52:55]
ds_read_b128 v[40:43], v6 offset:63744
v_mfma_f32_16x16x32_bf16 v[56:59], a[228:231], v[16:19], v[56:59]
v_mfma_f32_16x16x32_bf16 v[48:51], a[228:231], v[12:15], v[48:51]
s_waitcnt lgkmcnt(4)
v_mfma_f32_16x16x32_bf16 v[44:47], a[232:235], v[20:23], v[44:47]
ds_read_b128 v[12:15], v7 offset:0
v_mfma_f32_16x16x32_bf16 v[52:55], a[232:235], v[24:27], v[52:55]
ds_read_b128 v[16:19], v7 offset:256
v_mfma_f32_16x16x32_bf16 v[56:59], a[236:239], v[24:27], v[56:59]
buffer_load_dwordx4 v8, s[8:11], s20 offen sc1 lds
v_mfma_f32_16x16x32_bf16 v[48:51], a[236:239], v[20:23], v[48:51]
s_waitcnt lgkmcnt(4)
v_mfma_f32_16x16x32_bf16 v[44:47], a[240:243], v[28:31], v[44:47]
ds_read_b128 v[20:23], v7 offset:2048
v_mfma_f32_16x16x32_bf16 v[52:55], a[240:243], v[32:35], v[52:55]
ds_read_b128 v[24:27], v7 offset:2304
v_mfma_f32_16x16x32_bf16 v[56:59], a[244:247], v[32:35], v[56:59]
v_mfma_f32_16x16x32_bf16 v[48:51], a[244:247], v[28:31], v[48:51]
s_waitcnt lgkmcnt(4)
v_mfma_f32_16x16x32_bf16 v[44:47], a[248:251], v[36:39], v[44:47]
ds_read_b128 v[28:31], v7 offset:4096
v_mfma_f32_16x16x32_bf16 v[52:55], a[248:251], v[40:43], v[52:55]
ds_read_b128 v[32:35], v7 offset:4352
v_mfma_f32_16x16x32_bf16 v[56:59], a[252:255], v[40:43], v[56:59]
buffer_load_dwordx4 v8, s[8:11], s20 offen offset:1024 sc1 lds
v_mfma_f32_16x16x32_bf16 v[48:51], a[252:255], v[36:39], v[48:51]
s_waitcnt lgkmcnt(4)
v_mfma_f32_16x16x32_bf16 v[60:63], a[0:3], v[12:15], 0
ds_read_b128 v[36:39], v7 offset:6144
v_mfma_f32_16x16x32_bf16 v[68:71], a[0:3], v[16:19], 0
ds_read_b128 v[40:43], v7 offset:6400
v_cvt_pk_bf16_f32 v84, v44, v45
v_mfma_f32_16x16x32_bf16 v[72:75], a[4:7], v[16:19], 0
v_add_u32 v47, s64, v47
v_mfma_f32_16x16x32_bf16 v[64:67], a[4:7], v[12:15], 0
s_waitcnt lgkmcnt(4)
v_cvt_pk_bf16_f32 v85, v46, s65
v_mfma_f32_16x16x32_bf16 v[60:63], a[8:11], v[20:23], v[60:63]
ds_read_b128 v[12:15], v7 offset:8192
v_bfi_b32 v85, s66, v47, v85
v_mfma_f32_16x16x32_bf16 v[68:71], a[8:11], v[24:27], v[68:71]
ds_read_b128 v[16:19], v7 offset:8448
v_cvt_pk_bf16_f32 v86, v48, v49
v_mfma_f32_16x16x32_bf16 v[72:75], a[12:15], v[24:27], v[72:75]
buffer_load_dwordx4 v8, s[8:11], s20 offen offset:2048 sc1 lds
v_add_u32 v51, s64, v51
v_mfma_f32_16x16x32_bf16 v[64:67], a[12:15], v[20:23], v[64:67]
s_waitcnt lgkmcnt(4)
v_cvt_pk_bf16_f32 v87, v50, s65
v_mfma_f32_16x16x32_bf16 v[60:63], a[16:19], v[28:31], v[60:63]
buffer_load_dwordx2 v[132:133], v118, s[8:11], s42 offen offset:0 sc1
ds_read_b128 v[20:23], v7 offset:10240
v_mfma_f32_16x16x32_bf16 v[68:71], a[16:19], v[32:35], v[68:71]
ds_read_b128 v[24:27], v7 offset:10496
v_bfi_b32 v87, s66, v51, v87
v_mfma_f32_16x16x32_bf16 v[72:75], a[20:23], v[32:35], v[72:75]
buffer_store_dwordx4 v[84:87], v116, s[8:11], s41 offen sc1
v_cvt_pk_bf16_f32 v88, v52, v53
v_mfma_f32_16x16x32_bf16 v[64:67], a[20:23], v[28:31], v[64:67]
s_waitcnt lgkmcnt(4)
v_add_u32 v55, s64, v55
v_mfma_f32_16x16x32_bf16 v[60:63], a[24:27], v[36:39], v[60:63]
buffer_load_dwordx2 v[134:135], v118, s[8:11], s42 offen offset:2048 sc1
ds_read_b128 v[28:31], v7 offset:12288
v_mfma_f32_16x16x32_bf16 v[68:71], a[24:27], v[40:43], v[68:71]
ds_read_b128 v[32:35], v7 offset:12544
v_cvt_pk_bf16_f32 v89, v54, s65
v_mfma_f32_16x16x32_bf16 v[72:75], a[28:31], v[40:43], v[72:75]
buffer_load_dwordx4 v8, s[8:11], s20 offen offset:3072 sc1 lds
v_bfi_b32 v89, s66, v55, v89
v_mfma_f32_16x16x32_bf16 v[64:67], a[28:31], v[36:39], v[64:67]
s_waitcnt lgkmcnt(4)
v_cvt_pk_bf16_f32 v90, v56, v57
s_add_u32 s20, s20, s23
v_mfma_f32_16x16x32_bf16 v[60:63], a[32:35], v[12:15], v[60:63]
buffer_load_dwordx2 v[136:137], v119, s[8:11], s42 offen offset:0 sc1
ds_read_b128 v[36:39], v7 offset:14336
v_mfma_f32_16x16x32_bf16 v[68:71], a[32:35], v[16:19], v[68:71]
s_add_u32 m0, s22, 32768
ds_read_b128 v[40:43], v7 offset:14592
v_add_u32 v59, s64, v59
v_mfma_f32_16x16x32_bf16 v[72:75], a[36:39], v[16:19], v[72:75]
buffer_load_dwordx2 v[138:139], v119, s[8:11], s42 offen offset:2048 sc1
v_cvt_pk_bf16_f32 v91, v58, s65
v_mfma_f32_16x16x32_bf16 v[64:67], a[36:39], v[12:15], v[64:67]
s_waitcnt lgkmcnt(4)
v_bfi_b32 v91, s66, v59, v91
s_waitcnt vmcnt(26)
v_mfma_f32_16x16x32_bf16 v[60:63], a[40:43], v[20:23], v[60:63]
s_waitcnt vmcnt(21)
s_barrier
ds_read_b128 v[12:15], v7 offset:16384
v_mfma_f32_16x16x32_bf16 v[68:71], a[40:43], v[24:27], v[68:71]
ds_read_b128 v[16:19], v7 offset:16640
v_bitop3_b32 v162, v125, v127, s59 bitop3:0x7e
v_mfma_f32_16x16x32_bf16 v[72:75], a[44:47], v[24:27], v[72:75]
buffer_load_dwordx4 v8, s[8:11], s20 offen sc1 lds
v_bitop3_b32 v163, v129, v131, s59 bitop3:0x7e
v_mfma_f32_16x16x32_bf16 v[64:67], a[44:47], v[20:23], v[64:67]
s_waitcnt lgkmcnt(4)
v_or_b32 v162, v162, v163
v_mfma_f32_16x16x32_bf16 v[60:63], a[48:51], v[28:31], v[60:63]
ds_read_b128 v[20:23], v7 offset:18432
v_and_b32 v162, 0x10000, v162
v_mfma_f32_16x16x32_bf16 v[68:71], a[48:51], v[32:35], v[68:71]
ds_read_b128 v[24:27], v7 offset:18688
v_cmp_ne_u32 vcc, 0, v162
v_mfma_f32_16x16x32_bf16 v[72:75], a[52:55], v[32:35], v[72:75]
buffer_store_dwordx4 v[88:91], v117, s[8:11], s41 offen sc1
v_mfma_f32_16x16x32_bf16 v[64:67], a[52:55], v[28:31], v[64:67]
s_waitcnt lgkmcnt(4)
v_mfma_f32_16x16x32_bf16 v[60:63], a[56:59], v[36:39], v[60:63]
ds_read_b128 v[28:31], v7 offset:20480
v_mfma_f32_16x16x32_bf16 v[68:71], a[56:59], v[40:43], v[68:71]
ds_read_b128 v[32:35], v7 offset:20736
v_mfma_f32_16x16x32_bf16 v[72:75], a[60:63], v[40:43], v[72:75]
buffer_load_dwordx4 v8, s[8:11], s20 offen offset:1024 sc1 lds
v_mfma_f32_16x16x32_bf16 v[64:67], a[60:63], v[36:39], v[64:67]
s_waitcnt lgkmcnt(4)
v_mfma_f32_16x16x32_bf16 v[60:63], a[64:67], v[12:15], v[60:63]
ds_read_b128 v[36:39], v7 offset:22528
v_mfma_f32_16x16x32_bf16 v[68:71], a[64:67], v[16:19], v[68:71]
ds_read_b128 v[40:43], v7 offset:22784
v_mfma_f32_16x16x32_bf16 v[72:75], a[68:71], v[16:19], v[72:75]
s_cbranch_vccnz main_kernel_wj1_c1
main_kernel_wj1_k1:
v_mfma_f32_16x16x32_bf16 v[64:67], a[68:71], v[12:15], v[64:67]
s_waitcnt lgkmcnt(4)
v_lshlrev_b32 v140, 16, v124
v_mfma_f32_16x16x32_bf16 v[60:63], a[72:75], v[20:23], v[60:63]
ds_read_b128 v[12:15], v7 offset:24576
v_and_b32 v141, 0xffff0000, v124
v_mfma_f32_16x16x32_bf16 v[68:71], a[72:75], v[24:27], v[68:71]
ds_read_b128 v[16:19], v7 offset:24832
v_lshlrev_b32 v142, 16, v125
v_mfma_f32_16x16x32_bf16 v[72:75], a[76:79], v[24:27], v[72:75]
buffer_load_dwordx4 v8, s[8:11], s20 offen offset:2048 sc1 lds
v_and_b32 v143, 0xffff0000, v125
v_mfma_f32_16x16x32_bf16 v[64:67], a[76:79], v[20:23], v[64:67]
s_waitcnt lgkmcnt(4)
v_lshlrev_b32 v144, 16, v126
v_mfma_f32_16x16x32_bf16 v[60:63], a[80:83], v[28:31], v[60:63]
ds_read_b128 v[20:23], v7 offset:26624
v_and_b32 v145, 0xffff0000, v126
v_mfma_f32_16x16x32_bf16 v[68:71], a[80:83], v[32:35], v[68:71]
ds_read_b128 v[24:27], v7 offset:26880
v_lshlrev_b32 v146, 16, v127
v_mfma_f32_16x16x32_bf16 v[72:75], a[84:87], v[32:35], v[72:75]
v_and_b32 v147, 0xffff0000, v127
v_mfma_f32_16x16x32_bf16 v[64:67], a[84:87], v[28:31], v[64:67]
s_waitcnt lgkmcnt(4)
v_add_f32 v140, v140, v144
v_mfma_f32_16x16x32_bf16 v[60:63], a[88:91], v[36:39], v[60:63]
ds_read_b128 v[28:31], v7 offset:28672
v_add_f32 v141, v141, v145
v_mfma_f32_16x16x32_bf16 v[68:71], a[88:91], v[40:43], v[68:71]
ds_read_b128 v[32:35], v7 offset:28928
v_add_f32 v142, v142, v146
v_mfma_f32_16x16x32_bf16 v[72:75], a[92:95], v[40:43], v[72:75]
buffer_load_dwordx4 v8, s[8:11], s20 offen offset:3072 sc1 lds
v_add_f32 v143, v143, v147
v_mfma_f32_16x16x32_bf16 v[64:67], a[92:95], v[36:39], v[64:67]
s_waitcnt lgkmcnt(4)
v_lshlrev_b32 v144, 16, v128
s_add_u32 s20, s20, s23
v_mfma_f32_16x16x32_bf16 v[60:63], a[96:99], v[12:15], v[60:63]
s_add_u32 m0, s22, 49152
ds_read_b128 v[36:39], v7 offset:30720
v_and_b32 v145, 0xffff0000, v128
v_mfma_f32_16x16x32_bf16 v[68:71], a[96:99], v[16:19], v[68:71]
ds_read_b128 v[40:43], v7 offset:30976
v_lshlrev_b32 v146, 16, v129
v_mfma_f32_16x16x32_bf16 v[72:75], a[100:103], v[16:19], v[72:75]
v_and_b32 v147, 0xffff0000, v129
v_mfma_f32_16x16x32_bf16 v[64:67], a[100:103], v[12:15], v[64:67]
s_waitcnt lgkmcnt(4)
v_add_f32 v140, v140, v144
v_mfma_f32_16x16x32_bf16 v[60:63], a[104:107], v[20:23], v[60:63]
ds_read_b128 v[12:15], v7 offset:32768
v_add_f32 v141, v141, v145
v_mfma_f32_16x16x32_bf16 v[68:71], a[104:107], v[24:27], v[68:71]
ds_read_b128 v[16:19], v7 offset:33024
v_add_f32 v142, v142, v146
v_mfma_f32_16x16x32_bf16 v[72:75], a[108:111], v[24:27], v[72:75]
buffer_load_dwordx4 v8, s[8:11], s20 offen sc1 lds
v_add_f32 v143, v143, v147
v_mfma_f32_16x16x32_bf16 v[64:67], a[108:111], v[20:23], v[64:67]
s_waitcnt lgkmcnt(4)
v_lshlrev_b32 v144, 16, v130
v_mfma_f32_16x16x32_bf16 v[60:63], a[112:115], v[28:31], v[60:63]
buffer_load_dwordx2 v[156:157], v121, s[8:11], s47 offen sc1
ds_read_b128 v[20:23], v7 offset:34816
v_mfma_f32_16x16x32_bf16 v[68:71], a[112:115], v[32:35], v[68:71]
ds_read_b128 v[24:27], v7 offset:35072
v_and_b32 v145, 0xffff0000, v130
v_mfma_f32_16x16x32_bf16 v[72:75], a[116:119], v[32:35], v[72:75]
buffer_load_dwordx2 v[158:159], v120, s[16:19], s47 offen
v_lshlrev_b32 v146, 16, v131
v_mfma_f32_16x16x32_bf16 v[64:67], a[116:119], v[28:31], v[64:67]
s_waitcnt lgkmcnt(4)
v_and_b32 v147, 0xffff0000, v131
s_add_i32 s38, s36, s61
v_mfma_f32_16x16x32_bf16 v[60:63], a[120:123], v[36:39], v[60:63]
s_lshr_b32 s75, s36, 1
ds_read_b128 v[28:31], v7 offset:36864
v_add_f32 v140, v140, v144
v_mfma_f32_16x16x32_bf16 v[68:71], a[120:123], v[40:43], v[68:71]
s_max_i32 s38, s38, s75
ds_read_b128 v[32:35], v7 offset:37120
v_add_f32 v141, v141, v145
v_mfma_f32_16x16x32_bf16 v[72:75], a[124:127], v[40:43], v[72:75]
buffer_load_dwordx4 v8, s[8:11], s20 offen offset:1024 sc1 lds
v_add_f32 v142, v142, v146
v_mfma_f32_16x16x32_bf16 v[64:67], a[124:127], v[36:39], v[64:67]
s_waitcnt lgkmcnt(4)
v_add_f32 v143, v143, v147
s_min_i32 s38, s38, 29
v_mfma_f32_16x16x32_bf16 v[60:63], a[128:131], v[12:15], v[60:63]
s_waitcnt vmcnt(27)
ds_read_b128 v[36:39], v7 offset:38912
v_lshlrev_b32 v144, 16, v152
v_mfma_f32_16x16x32_bf16 v[68:71], a[128:131], v[16:19], v[68:71]
s_mov_b32 s55, s42
ds_read_b128 v[40:43], v7 offset:39168
v_and_b32 v145, 0xffff0000, v152
v_mfma_f32_16x16x32_bf16 v[72:75], a[132:135], v[16:19], v[72:75]
s_mov_b32 s42, s41
v_lshlrev_b32 v146, 16, v153
s_mov_b32 s41, s43
v_mfma_f32_16x16x32_bf16 v[64:67], a[132:135], v[12:15], v[64:67]
s_waitcnt lgkmcnt(4)
v_and_b32 v147, 0xffff0000, v153
s_mov_b32 s59, s58
v_mfma_f32_16x16x32_bf16 v[60:63], a[136:139], v[20:23], v[60:63]
s_mov_b32 s58, s57
ds_read_b128 v[12:15], v7 offset:40960
v_lshlrev_b32 v148, 16, v154
v_mfma_f32_16x16x32_bf16 v[68:71], a[136:139], v[24:27], v[68:71]
s_mov_b32 s57, s60
ds_read_b128 v[16:19], v7 offset:41216
v_and_b32 v149, 0xffff0000, v154
v_mfma_f32_16x16x32_bf16 v[72:75], a[140:143], v[24:27], v[72:75]
s_waitcnt vmcnt(21)
buffer_load_dwordx4 v8, s[8:11], s20 offen offset:2048 sc1 lds
v_mfma_f32_16x16x32_bf16 v[64:67], a[140:143], v[20:23], v[64:67]
s_waitcnt lgkmcnt(4)
v_cmp_ge_u32 s[62:63], s38, v111
s_cmp_le_u32 s36, s67
v_mfma_f32_16x16x32_bf16 v[60:63], a[144:147], v[28:31], v[60:63]
s_cselect_b32 s28, 212992, s53
ds_read_b128 v[20:23], v7 offset:43008
v_lshlrev_b32 v150, 16, v155
v_mfma_f32_16x16x32_bf16 v[68:71], a[144:147], v[32:35], v[68:71]
s_and_b64 s[62:63], s[62:63], s[50:51]
ds_read_b128 v[24:27], v7 offset:43264
v_and_b32 v151, 0xffff0000, v155
v_mfma_f32_16x16x32_bf16 v[72:75], a[148:151], v[32:35], v[72:75]
s_cbranch_scc1 main_kernel_wj1_a1
main_kernel_wj1_b1:
s_add_u32 s43, s43, 32768
v_mfma_f32_16x16x32_bf16 v[64:67], a[148:151], v[28:31], v[64:67]
s_waitcnt lgkmcnt(4)
v_fma_f32 v140, v140, v144, v148
s_sub_u32 s27, s43, s44
v_mfma_f32_16x16x32_bf16 v[60:63], a[152:155], v[36:39], v[60:63]
s_cmp_eq_u32 s27, 229376
ds_read_b128 v[28:31], v7 offset:45056
v_fma_f32 v141, v141, v145, v149
v_mfma_f32_16x16x32_bf16 v[68:71], a[152:155], v[40:43], v[68:71]
s_cselect_b32 s43, s44, s43
ds_read_b128 v[32:35], v7 offset:45312
v_fma_f32 v142, v142, v146, v150
v_mfma_f32_16x16x32_bf16 v[72:75], a[156:159], v[40:43], v[72:75]
buffer_load_dwordx4 v8, s[8:11], s20 offen offset:3072 sc1 lds
v_fma_f32 v143, v143, v147, v151
v_mfma_f32_16x16x32_bf16 v[64:67], a[156:159], v[36:39], v[64:67]
s_waitcnt lgkmcnt(4)
v_cvt_pk_bf16_f32 v160, v140, v141
s_cselect_b32 s27, 0x10000, 0
v_mfma_f32_16x16x32_bf16 v[60:63], a[160:163], v[12:15], v[60:63]
s_add_u32 s20, s20, s28
ds_read_b128 v[36:39], v7 offset:47104
v_cvt_pk_bf16_f32 v161, v142, v143
v_mfma_f32_16x16x32_bf16 v[68:71], a[160:163], v[16:19], v[68:71]
buffer_store_dwordx2 v[160:161], v120, s[32:35], s56 offen
ds_read_b128 v[40:43], v7 offset:47360
v_mfma_f32_16x16x32_bf16 v[72:75], a[164:167], v[16:19], v[72:75]
s_add_u32 m0, s22, 65536
s_cmp_lt_u32 s36, s37
s_cselect_b32 s20, s20, 0x40000000
v_mfma_f32_16x16x32_bf16 v[64:67], a[164:167], v[12:15], v[64:67]
s_waitcnt lgkmcnt(4)
s_xor_b32 s60, s60, s27
s_sub_u32 s64, 0x10000, s57
v_mfma_f32_16x16x32_bf16 v[60:63], a[168:171], v[20:23], v[60:63]
s_waitcnt vmcnt(21)
s_barrier
ds_read_b128 v[12:15], v7 offset:49152
v_mfma_f32_16x16x32_bf16 v[68:71], a[168:171], v[24:27], v[68:71]
s_add_u32 s65, s57, 0x3f800000
ds_read_b128 v[16:19], v7 offset:49408
s_mov_b32 s56, s47
v_mfma_f32_16x16x32_bf16 v[72:75], a[172:175], v[24:27], v[72:75]
s_mov_b32 s47, s46
buffer_load_dwordx4 v8, s[8:11], s20 offen sc1 lds
v_mfma_f32_16x16x32_bf16 v[64:67], a[172:175], v[20:23], v[64:67]
s_waitcnt lgkmcnt(4)
s_add_u32 s36, s36, 1
s_xor_b32 s68, s68, 4096
v_mfma_f32_16x16x32_bf16 v[60:63], a[176:179], v[28:31], v[60:63]
s_cmp_ge_u32 s38, 2
ds_read_b128 v[20:23], v7 offset:51200
s_cselect_b32 s68, 0, s68
v_mfma_f32_16x16x32_bf16 v[68:71], a[176:179], v[32:35], v[68:71]
buffer_load_dword v111, v109, s[8:11], s68 offen sc1
ds_read_b128 v[24:27], v7 offset:51456
v_mfma_f32_16x16x32_bf16 v[72:75], a[180:183], v[32:35], v[72:75]
s_mov_b32 s46, s45
s_cmp_lt_u32 s45, s48
s_cselect_b32 s27, 16, 17
v_mfma_f32_16x16x32_bf16 v[64:67], a[180:183], v[28:31], v[64:67]
s_waitcnt lgkmcnt(4)
s_bitset1_b32 s26, s27
s_add_u32 s45, s45, s26
v_mfma_f32_16x16x32_bf16 v[60:63], a[184:187], v[36:39], v[60:63]
s_mov_b32 s26, 0
ds_read_b128 v[28:31], v7 offset:53248
v_mfma_f32_16x16x32_bf16 v[68:71], a[184:187], v[40:43], v[68:71]
ds_read_b128 v[32:35], v7 offset:53504
v_mfma_f32_16x16x32_bf16 v[72:75], a[188:191], v[40:43], v[72:75]
buffer_load_dwordx4 v8, s[8:11], s20 offen offset:1024 sc1 lds
v_mfma_f32_16x16x32_bf16 v[64:67], a[188:191], v[36:39], v[64:67]
s_waitcnt lgkmcnt(4)
v_mfma_f32_16x16x32_bf16 v[60:63], a[192:195], v[12:15], v[60:63]
ds_read_b128 v[36:39], v7 offset:55296
v_mfma_f32_16x16x32_bf16 v[68:71], a[192:195], v[16:19], v[68:71]
ds_read_b128 v[40:43], v7 offset:55552
v_mfma_f32_16x16x32_bf16 v[72:75], a[196:199], v[16:19], v[72:75]
v_mfma_f32_16x16x32_bf16 v[64:67], a[196:199], v[12:15], v[64:67]
s_waitcnt lgkmcnt(4)
v_mfma_f32_16x16x32_bf16 v[60:63], a[200:203], v[20:23], v[60:63]
ds_read_b128 v[12:15], v7 offset:57344
v_mfma_f32_16x16x32_bf16 v[68:71], a[200:203], v[24:27], v[68:71]
ds_read_b128 v[16:19], v7 offset:57600
v_mfma_f32_16x16x32_bf16 v[72:75], a[204:207], v[24:27], v[72:75]
buffer_load_dwordx4 v8, s[8:11], s20 offen offset:2048 sc1 lds
v_mfma_f32_16x16x32_bf16 v[64:67], a[204:207], v[20:23], v[64:67]
s_waitcnt lgkmcnt(4)
v_mfma_f32_16x16x32_bf16 v[60:63], a[208:211], v[28:31], v[60:63]
ds_read_b128 v[20:23], v7 offset:59392
v_mfma_f32_16x16x32_bf16 v[68:71], a[208:211], v[32:35], v[68:71]
ds_read_b128 v[24:27], v7 offset:59648
v_mfma_f32_16x16x32_bf16 v[72:75], a[212:215], v[32:35], v[72:75]
v_mfma_f32_16x16x32_bf16 v[64:67], a[212:215], v[28:31], v[64:67]
s_waitcnt lgkmcnt(4)
v_mfma_f32_16x16x32_bf16 v[60:63], a[216:219], v[36:39], v[60:63]
ds_read_b128 v[28:31], v7 offset:61440
v_mfma_f32_16x16x32_bf16 v[68:71], a[216:219], v[40:43], v[68:71]
ds_read_b128 v[32:35], v7 offset:61696
v_mfma_f32_16x16x32_bf16 v[72:75], a[220:223], v[40:43], v[72:75]
buffer_load_dwordx4 v8, s[8:11], s20 offen offset:3072 sc1 lds
v_mfma_f32_16x16x32_bf16 v[64:67], a[220:223], v[36:39], v[64:67]
s_waitcnt lgkmcnt(4)
s_add_u32 s20, s20, s23
s_add_u32 m0, s22, 81920
v_mfma_f32_16x16x32_bf16 v[60:63], a[224:227], v[12:15], v[60:63]
ds_read_b128 v[36:39], v7 offset:63488
v_mfma_f32_16x16x32_bf16 v[68:71], a[224:227], v[16:19], v[68:71]
ds_read_b128 v[40:43], v7 offset:63744
v_mfma_f32_16x16x32_bf16 v[72:75], a[228:231], v[16:19], v[72:75]
v_mfma_f32_16x16x32_bf16 v[64:67], a[228:231], v[12:15], v[64:67]
s_waitcnt lgkmcnt(4)
v_mfma_f32_16x16x32_bf16 v[60:63], a[232:235], v[20:23], v[60:63]
ds_read_b128 v[12:15], v6 offset:0
v_mfma_f32_16x16x32_bf16 v[68:71], a[232:235], v[24:27], v[68:71]
ds_read_b128 v[16:19], v6 offset:256
v_mfma_f32_16x16x32_bf16 v[72:75], a[236:239], v[24:27], v[72:75]
buffer_load_dwordx4 v8, s[8:11], s20 offen sc1 lds
v_mfma_f32_16x16x32_bf16 v[64:67], a[236:239], v[20:23], v[64:67]
s_waitcnt lgkmcnt(4)
v_mfma_f32_16x16x32_bf16 v[60:63], a[240:243], v[28:31], v[60:63]
ds_read_b128 v[20:23], v6 offset:2048
v_mfma_f32_16x16x32_bf16 v[68:71], a[240:243], v[32:35], v[68:71]
ds_read_b128 v[24:27], v6 offset:2304
v_mfma_f32_16x16x32_bf16 v[72:75], a[244:247], v[32:35], v[72:75]
v_mfma_f32_16x16x32_bf16 v[64:67], a[244:247], v[28:31], v[64:67]
s_waitcnt lgkmcnt(4)
v_mfma_f32_16x16x32_bf16 v[60:63], a[248:251], v[36:39], v[60:63]
ds_read_b128 v[28:31], v6 offset:4096
v_mfma_f32_16x16x32_bf16 v[68:71], a[248:251], v[40:43], v[68:71]
ds_read_b128 v[32:35], v6 offset:4352
v_mfma_f32_16x16x32_bf16 v[72:75], a[252:255], v[40:43], v[72:75]
s_sub_u32 s24, s24, 1
buffer_load_dwordx4 v8, s[8:11], s20 offen offset:1024 sc1 lds
v_mfma_f32_16x16x32_bf16 v[64:67], a[252:255], v[36:39], v[64:67]
s_waitcnt lgkmcnt(4)
s_cbranch_scc0 main_kernel_wj1_lp
v_cvt_pk_bf16_f32 v84, v60, v61
v_add_u32 v63, s64, v63
v_cvt_pk_bf16_f32 v85, v62, s65
v_bfi_b32 v85, s66, v63, v85
s_nop 1
v_cvt_pk_bf16_f32 v86, v64, v65
v_add_u32 v67, s64, v67
v_cvt_pk_bf16_f32 v87, v66, s65
v_bfi_b32 v87, s66, v67, v87
v_cvt_pk_bf16_f32 v88, v68, v69
v_add_u32 v71, s64, v71
v_cvt_pk_bf16_f32 v89, v70, s65
v_bfi_b32 v89, s66, v71, v89
v_cvt_pk_bf16_f32 v90, v72, v73
v_add_u32 v75, s64, v75
v_cvt_pk_bf16_f32 v91, v74, s65
v_bfi_b32 v91, s66, v75, v91
buffer_store_dwordx4 v[84:87], v116, s[8:11], s41 offen sc1
buffer_store_dwordx4 v[88:91], v117, s[8:11], s41 offen sc1
buffer_load_dwordx2 v[124:125], v118, s[8:11], s42 offen offset:0 sc1
buffer_load_dwordx2 v[126:127], v118, s[8:11], s42 offen offset:2048 sc1
buffer_load_dwordx2 v[128:129], v119, s[8:11], s42 offen offset:0 sc1
buffer_load_dwordx2 v[130:131], v119, s[8:11], s42 offen offset:2048 sc1
buffer_load_dwordx2 v[152:153], v121, s[8:11], s47 offen sc1
buffer_load_dwordx2 v[154:155], v120, s[16:19], s47 offen
s_waitcnt vmcnt(8)
v_bitop3_b32 v162, v133, v135, s59 bitop3:0x7e
v_bitop3_b32 v163, v137, v139, s59 bitop3:0x7e
v_or_b32 v162, v162, v163
v_and_b32 v162, 0x10000, v162
v_cmp_ne_u32 vcc, 0, v162
s_cbranch_vccnz main_kernel_wj1_c2
main_kernel_wj1_k2:
v_lshlrev_b32 v140, 16, v132
v_and_b32 v141, 0xffff0000, v132
v_lshlrev_b32 v142, 16, v133
v_and_b32 v143, 0xffff0000, v133
v_lshlrev_b32 v144, 16, v134
v_and_b32 v145, 0xffff0000, v134
v_lshlrev_b32 v146, 16, v135
v_and_b32 v147, 0xffff0000, v135
v_add_f32 v140, v140, v144
v_add_f32 v141, v141, v145
v_add_f32 v142, v142, v146
v_add_f32 v143, v143, v147
v_lshlrev_b32 v144, 16, v136
v_and_b32 v145, 0xffff0000, v136
v_lshlrev_b32 v146, 16, v137
v_and_b32 v147, 0xffff0000, v137
v_add_f32 v140, v140, v144
v_add_f32 v141, v141, v145
v_add_f32 v142, v142, v146
v_add_f32 v143, v143, v147
v_lshlrev_b32 v144, 16, v138
v_and_b32 v145, 0xffff0000, v138
v_lshlrev_b32 v146, 16, v139
v_and_b32 v147, 0xffff0000, v139
v_add_f32 v140, v140, v144
v_add_f32 v141, v141, v145
v_add_f32 v142, v142, v146
v_add_f32 v143, v143, v147
v_lshlrev_b32 v144, 16, v156
v_and_b32 v145, 0xffff0000, v156
v_lshlrev_b32 v146, 16, v157
v_and_b32 v147, 0xffff0000, v157
v_lshlrev_b32 v148, 16, v158
v_and_b32 v149, 0xffff0000, v158
v_lshlrev_b32 v150, 16, v159
v_and_b32 v151, 0xffff0000, v159
v_fma_f32 v140, v140, v144, v148
v_fma_f32 v141, v141, v145, v149
v_fma_f32 v142, v142, v146, v150
v_fma_f32 v143, v143, v147, v151
v_cvt_pk_bf16_f32 v160, v140, v141
v_cvt_pk_bf16_f32 v161, v142, v143
buffer_store_dwordx2 v[160:161], v120, s[32:35], s56 offen
buffer_load_dwordx2 v[132:133], v118, s[8:11], s41 offen offset:0 sc1
buffer_load_dwordx2 v[134:135], v118, s[8:11], s41 offen offset:2048 sc1
buffer_load_dwordx2 v[136:137], v119, s[8:11], s41 offen offset:0 sc1
buffer_load_dwordx2 v[138:139], v119, s[8:11], s41 offen offset:2048 sc1
buffer_load_dwordx2 v[156:157], v121, s[8:11], s46 offen sc1
buffer_load_dwordx2 v[158:159], v120, s[16:19], s46 offen
s_waitcnt vmcnt(7)
v_bitop3_b32 v162, v125, v127, s58 bitop3:0x7e
v_bitop3_b32 v163, v129, v131, s58 bitop3:0x7e
v_or_b32 v162, v162, v163
v_and_b32 v162, 0x10000, v162
v_cmp_ne_u32 vcc, 0, v162
s_cbranch_vccnz main_kernel_wj1_c3
main_kernel_wj1_k3:
v_lshlrev_b32 v140, 16, v124
v_and_b32 v141, 0xffff0000, v124
v_lshlrev_b32 v142, 16, v125
v_and_b32 v143, 0xffff0000, v125
v_lshlrev_b32 v144, 16, v126
v_and_b32 v145, 0xffff0000, v126
v_lshlrev_b32 v146, 16, v127
v_and_b32 v147, 0xffff0000, v127
v_add_f32 v140, v140, v144
v_add_f32 v141, v141, v145
v_add_f32 v142, v142, v146
v_add_f32 v143, v143, v147
v_lshlrev_b32 v144, 16, v128
v_and_b32 v145, 0xffff0000, v128
v_lshlrev_b32 v146, 16, v129
v_and_b32 v147, 0xffff0000, v129
v_add_f32 v140, v140, v144
v_add_f32 v141, v141, v145
v_add_f32 v142, v142, v146
v_add_f32 v143, v143, v147
v_lshlrev_b32 v144, 16, v130
v_and_b32 v145, 0xffff0000, v130
v_lshlrev_b32 v146, 16, v131
v_and_b32 v147, 0xffff0000, v131
v_add_f32 v140, v140, v144
v_add_f32 v141, v141, v145
v_add_f32 v142, v142, v146
v_add_f32 v143, v143, v147
v_lshlrev_b32 v144, 16, v152
v_and_b32 v145, 0xffff0000, v152
v_lshlrev_b32 v146, 16, v153
v_and_b32 v147, 0xffff0000, v153
v_lshlrev_b32 v148, 16, v154
v_and_b32 v149, 0xffff0000, v154
v_lshlrev_b32 v150, 16, v155
v_and_b32 v151, 0xffff0000, v155
v_fma_f32 v140, v140, v144, v148
v_fma_f32 v141, v141, v145, v149
v_fma_f32 v142, v142, v146, v150
v_fma_f32 v143, v143, v147, v151
v_cvt_pk_bf16_f32 v160, v140, v141
v_cvt_pk_bf16_f32 v161, v142, v143
buffer_store_dwordx2 v[160:161], v120, s[32:35], s47 offen
s_waitcnt vmcnt(1)
v_bitop3_b32 v162, v133, v135, s57 bitop3:0x7e
v_bitop3_b32 v163, v137, v139, s57 bitop3:0x7e
v_or_b32 v162, v162, v163
v_and_b32 v162, 0x10000, v162
v_cmp_ne_u32 vcc, 0, v162
s_cbranch_vccnz main_kernel_wj1_c4
main_kernel_wj1_k4:
v_lshlrev_b32 v140, 16, v132
v_and_b32 v141, 0xffff0000, v132
v_lshlrev_b32 v142, 16, v133
v_and_b32 v143, 0xffff0000, v133
v_lshlrev_b32 v144, 16, v134
v_and_b32 v145, 0xffff0000, v134
v_lshlrev_b32 v146, 16, v135
v_and_b32 v147, 0xffff0000, v135
v_add_f32 v140, v140, v144
v_add_f32 v141, v141, v145
v_add_f32 v142, v142, v146
v_add_f32 v143, v143, v147
v_lshlrev_b32 v144, 16, v136
v_and_b32 v145, 0xffff0000, v136
v_lshlrev_b32 v146, 16, v137
v_and_b32 v147, 0xffff0000, v137
v_add_f32 v140, v140, v144
v_add_f32 v141, v141, v145
v_add_f32 v142, v142, v146
v_add_f32 v143, v143, v147
v_lshlrev_b32 v144, 16, v138
v_and_b32 v145, 0xffff0000, v138
v_lshlrev_b32 v146, 16, v139
v_and_b32 v147, 0xffff0000, v139
v_add_f32 v140, v140, v144
v_add_f32 v141, v141, v145
v_add_f32 v142, v142, v146
v_add_f32 v143, v143, v147
v_lshlrev_b32 v144, 16, v156
v_and_b32 v145, 0xffff0000, v156
v_lshlrev_b32 v146, 16, v157
v_and_b32 v147, 0xffff0000, v157
v_lshlrev_b32 v148, 16, v158
v_and_b32 v149, 0xffff0000, v158
v_lshlrev_b32 v150, 16, v159
v_and_b32 v151, 0xffff0000, v159
v_fma_f32 v140, v140, v144, v148
v_fma_f32 v141, v141, v145, v149
v_fma_f32 v142, v142, v146, v150
v_fma_f32 v143, v143, v147, v151
v_cvt_pk_bf16_f32 v160, v140, v141
v_cvt_pk_bf16_f32 v161, v142, v143
buffer_store_dwordx2 v[160:161], v120, s[32:35], s46 offen
s_branch main_kernel_wj1_dn
main_kernel_wj1_c0:
s_add_u32 s54, s54, 1
s_cmp_ge_u32 s54, 131072
s_cbranch_scc1 main_kernel_wj1_k0
buffer_load_dwordx2 v[132:133], v118, s[8:11], s55 offen offset:0 sc1
buffer_load_dwordx2 v[134:135], v118, s[8:11], s55 offen offset:2048 sc1
buffer_load_dwordx2 v[136:137], v119, s[8:11], s55 offen offset:0 sc1
buffer_load_dwordx2 v[138:139], v119, s[8:11], s55 offen offset:2048 sc1
s_waitcnt vmcnt(0)
v_bitop3_b32 v162, v133, v135, s59 bitop3:0x7e
v_bitop3_b32 v163, v137, v139, s59 bitop3:0x7e
v_or_b32 v162, v162, v163
v_and_b32 v162, 0x10000, v162
v_cmp_ne_u32 vcc, 0, v162
s_cbranch_vccnz main_kernel_wj1_c0
s_branch main_kernel_wj1_k0
main_kernel_wj1_a0:
main_kernel_wj1_w0:
buffer_load_dword v111, v109, s[8:11], s68 offen sc1
s_waitcnt vmcnt(0)
v_cmp_ge_u32 s[62:63], s38, v111
s_and_b64 s[62:63], s[62:63], s[50:51]
s_cbranch_scc0 main_kernel_wj1_w0_ok
s_add_u32 s54, s54, 1
s_cmp_ge_u32 s54, 131072
s_cbranch_scc1 main_kernel_wj1_w0_ok
s_sleep 1
s_branch main_kernel_wj1_w0
main_kernel_wj1_w0_ok:
s_branch main_kernel_wj1_b0
main_kernel_wj1_c1:
s_add_u32 s54, s54, 1
s_cmp_ge_u32 s54, 131072
s_cbranch_scc1 main_kernel_wj1_k1
buffer_load_dwordx2 v[124:125], v118, s[8:11], s55 offen offset:0 sc1
buffer_load_dwordx2 v[126:127], v118, s[8:11], s55 offen offset:2048 sc1
buffer_load_dwordx2 v[128:129], v119, s[8:11], s55 offen offset:0 sc1
buffer_load_dwordx2 v[130:131], v119, s[8:11], s55 offen offset:2048 sc1
s_waitcnt vmcnt(0)
v_bitop3_b32 v162, v125, v127, s59 bitop3:0x7e
v_bitop3_b32 v163, v129, v131, s59 bitop3:0x7e
v_or_b32 v162, v162, v163
v_and_b32 v162, 0x10000, v162
v_cmp_ne_u32 vcc, 0, v162
s_cbranch_vccnz main_kernel_wj1_c1
s_branch main_kernel_wj1_k1
main_kernel_wj1_a1:
main_kernel_wj1_w1:
buffer_load_dword v111, v109, s[8:11], s68 offen sc1
s_waitcnt vmcnt(0)
v_cmp_ge_u32 s[62:63], s38, v111
s_and_b64 s[62:63], s[62:63], s[50:51]
s_cbranch_scc0 main_kernel_wj1_w1_ok
s_add_u32 s54, s54, 1
s_cmp_ge_u32 s54, 131072
s_cbranch_scc1 main_kernel_wj1_w1_ok
s_sleep 1
s_branch main_kernel_wj1_w1
main_kernel_wj1_w1_ok:
s_branch main_kernel_wj1_b1
main_kernel_wj1_c2:
s_add_u32 s54, s54, 1
s_cmp_ge_u32 s54, 131072
s_cbranch_scc1 main_kernel_wj1_k2
buffer_load_dwordx2 v[132:133], v118, s[8:11], s55 offen offset:0 sc1
buffer_load_dwordx2 v[134:135], v118, s[8:11], s55 offen offset:2048 sc1
buffer_load_dwordx2 v[136:137], v119, s[8:11], s55 offen offset:0 sc1
buffer_load_dwordx2 v[138:139], v119, s[8:11], s55 offen offset:2048 sc1
s_waitcnt vmcnt(0)
v_bitop3_b32 v162, v133, v135, s59 bitop3:0x7e
v_bitop3_b32 v163, v137, v139, s59 bitop3:0x7e
v_or_b32 v162, v162, v163
v_and_b32 v162, 0x10000, v162
v_cmp_ne_u32 vcc, 0, v162
s_cbranch_vccnz main_kernel_wj1_c2
s_branch main_kernel_wj1_k2
main_kernel_wj1_c3:
s_add_u32 s54, s54, 1
s_cmp_ge_u32 s54, 131072
s_cbranch_scc1 main_kernel_wj1_k3
buffer_load_dwordx2 v[124:125], v118, s[8:11], s42 offen offset:0 sc1
buffer_load_dwordx2 v[126:127], v118, s[8:11], s42 offen offset:2048 sc1
buffer_load_dwordx2 v[128:129], v119, s[8:11], s42 offen offset:0 sc1
buffer_load_dwordx2 v[130:131], v119, s[8:11], s42 offen offset:2048 sc1
s_waitcnt vmcnt(0)
v_bitop3_b32 v162, v125, v127, s58 bitop3:0x7e
v_bitop3_b32 v163, v129, v131, s58 bitop3:0x7e
v_or_b32 v162, v162, v163
v_and_b32 v162, 0x10000, v162
v_cmp_ne_u32 vcc, 0, v162
s_cbranch_vccnz main_kernel_wj1_c3
s_branch main_kernel_wj1_k3
main_kernel_wj1_c4:
s_add_u32 s54, s54, 1
s_cmp_ge_u32 s54, 131072
s_cbranch_scc1 main_kernel_wj1_k4
buffer_load_dwordx2 v[132:133], v118, s[8:11], s41 offen offset:0 sc1
buffer_load_dwordx2 v[134:135], v118, s[8:11], s41 offen offset:2048 sc1
buffer_load_dwordx2 v[136:137], v119, s[8:11], s41 offen offset:0 sc1
buffer_load_dwordx2 v[138:139], v119, s[8:11], s41 offen offset:2048 sc1
s_waitcnt vmcnt(0)
v_bitop3_b32 v162, v133, v135, s57 bitop3:0x7e
v_bitop3_b32 v163, v137, v139, s57 bitop3:0x7e
v_or_b32 v162, v162, v163
v_and_b32 v162, 0x10000, v162
v_cmp_ne_u32 vcc, 0, v162
s_cbranch_vccnz main_kernel_wj1_c4
s_branch main_kernel_wj1_k4
main_kernel_wj1_dn:
s_add_u32 s24, s37, 2
main_kernel_wj1_s:
s_lshl_b32 s20, s45, 2
s_add_u32 s20, s20, s31
s_add_u32 s37, s37, 1
s_add_i32 s38, s37, s61
buffer_load_dwordx2 v[154:155], v120, s[16:19], s45 offen
s_mov_b32 s41, s43
s_mov_b32 s59, s58
s_mov_b32 s58, s57
s_mov_b32 s57, s60
s_add_u32 s43, s43, 32768
s_sub_u32 s27, s43, s44
s_cmp_eq_u32 s27, 229376
s_cselect_b32 s43, s44, s43
s_cselect_b32 s27, 0x10000, 0
s_xor_b32 s60, s60, s27
s_sub_u32 s64, 0x10000, s57
s_add_u32 s65, s57, 0x3f800000
main_kernel_wj1_s_w:
buffer_load_dword v111, v109, s[8:11], 0 offen sc1
s_waitcnt vmcnt(0)
v_cmp_gt_u32 vcc, s38, v111
s_and_b64 vcc, vcc, s[50:51]
s_cbranch_scc0 main_kernel_wj1_s_w_ok
s_add_u32 s54, s54, 1
s_cmp_ge_u32 s54, 131072
s_cbranch_scc1 main_kernel_wj1_s_w_ok
s_branch main_kernel_wj1_s_w
main_kernel_wj1_s_w_ok:
s_barrier
s_add_u32 m0, s22, 0
s_nop 0
buffer_load_dwordx4 v8, s[8:11], s20 offen sc1 lds
buffer_load_dwordx4 v8, s[8:11], s20 offen offset:1024 sc1 lds
buffer_load_dwordx4 v8, s[8:11], s20 offen offset:2048 sc1 lds
buffer_load_dwordx4 v8, s[8:11], s20 offen offset:3072 sc1 lds
s_add_u32 s20, s20, s23
s_add_u32 m0, s22, 16384
s_nop 0
buffer_load_dwordx4 v8, s[8:11], s20 offen sc1 lds
buffer_load_dwordx4 v8, s[8:11], s20 offen offset:1024 sc1 lds
buffer_load_dwordx4 v8, s[8:11], s20 offen offset:2048 sc1 lds
buffer_load_dwordx4 v8, s[8:11], s20 offen offset:3072 sc1 lds
s_add_u32 s20, s20, s23
s_add_u32 m0, s22, 32768
s_nop 0
buffer_load_dwordx4 v8, s[8:11], s20 offen sc1 lds
buffer_load_dwordx4 v8, s[8:11], s20 offen offset:1024 sc1 lds
buffer_load_dwordx4 v8, s[8:11], s20 offen offset:2048 sc1 lds
buffer_load_dwordx4 v8, s[8:11], s20 offen offset:3072 sc1 lds
s_add_u32 s20, s20, s23
s_add_u32 m0, s22, 49152
s_nop 0
buffer_load_dwordx4 v8, s[8:11], s20 offen sc1 lds
buffer_load_dwordx4 v8, s[8:11], s20 offen offset:1024 sc1 lds
buffer_load_dwordx4 v8, s[8:11], s20 offen offset:2048 sc1 lds
buffer_load_dwordx4 v8, s[8:11], s20 offen offset:3072 sc1 lds
s_add_u32 s20, s20, s28
buffer_load_dwordx2 v[152:153], v121, s[8:11], s45 offen sc1
s_waitcnt vmcnt(13)
s_barrier
ds_read_b128 v[12:15], v6 offset:0
ds_read_b128 v[16:19], v6 offset:256
ds_read_b128 v[20:23], v6 offset:2048
ds_read_b128 v[24:27], v6 offset:2304
ds_read_b128 v[28:31], v6 offset:4096
ds_read_b128 v[32:35], v6 offset:4352
s_waitcnt lgkmcnt(4)
v_mfma_f32_16x16x32_bf16 v[44:47], a[0:3], v[12:15], 0
ds_read_b128 v[36:39], v6 offset:6144
v_mfma_f32_16x16x32_bf16 v[52:55], a[0:3], v[16:19], 0
ds_read_b128 v[40:43], v6 offset:6400
v_mfma_f32_16x16x32_bf16 v[56:59], a[4:7], v[16:19], 0
v_mfma_f32_16x16x32_bf16 v[48:51], a[4:7], v[12:15], 0
s_waitcnt lgkmcnt(4)
v_mfma_f32_16x16x32_bf16 v[44:47], a[8:11], v[20:23], v[44:47]
ds_read_b128 v[12:15], v6 offset:8192
v_mfma_f32_16x16x32_bf16 v[52:55], a[8:11], v[24:27], v[52:55]
ds_read_b128 v[16:19], v6 offset:8448
v_mfma_f32_16x16x32_bf16 v[56:59], a[12:15], v[24:27], v[56:59]
v_mfma_f32_16x16x32_bf16 v[48:51], a[12:15], v[20:23], v[48:51]
s_waitcnt lgkmcnt(4)
v_mfma_f32_16x16x32_bf16 v[44:47], a[16:19], v[28:31], v[44:47]
ds_read_b128 v[20:23], v6 offset:10240
v_mfma_f32_16x16x32_bf16 v[52:55], a[16:19], v[32:35], v[52:55]
ds_read_b128 v[24:27], v6 offset:10496
v_mfma_f32_16x16x32_bf16 v[56:59], a[20:23], v[32:35], v[56:59]
v_mfma_f32_16x16x32_bf16 v[48:51], a[20:23], v[28:31], v[48:51]
s_waitcnt lgkmcnt(4)
v_mfma_f32_16x16x32_bf16 v[44:47], a[24:27], v[36:39], v[44:47]
ds_read_b128 v[28:31], v6 offset:12288
v_mfma_f32_16x16x32_bf16 v[52:55], a[24:27], v[40:43], v[52:55]
ds_read_b128 v[32:35], v6 offset:12544
v_mfma_f32_16x16x32_bf16 v[56:59], a[28:31], v[40:43], v[56:59]
v_mfma_f32_16x16x32_bf16 v[48:51], a[28:31], v[36:39], v[48:51]
s_waitcnt lgkmcnt(4)
v_mfma_f32_16x16x32_bf16 v[44:47], a[32:35], v[12:15], v[44:47]
ds_read_b128 v[36:39], v6 offset:14336
v_mfma_f32_16x16x32_bf16 v[52:55], a[32:35], v[16:19], v[52:55]
ds_read_b128 v[40:43], v6 offset:14592
v_mfma_f32_16x16x32_bf16 v[56:59], a[36:39], v[16:19], v[56:59]
v_mfma_f32_16x16x32_bf16 v[48:51], a[36:39], v[12:15], v[48:51]
s_waitcnt lgkmcnt(4)
v_mfma_f32_16x16x32_bf16 v[44:47], a[40:43], v[20:23], v[44:47]
s_waitcnt vmcnt(9)
s_barrier
ds_read_b128 v[12:15], v6 offset:16384
v_mfma_f32_16x16x32_bf16 v[52:55], a[40:43], v[24:27], v[52:55]
ds_read_b128 v[16:19], v6 offset:16640
v_mfma_f32_16x16x32_bf16 v[56:59], a[44:47], v[24:27], v[56:59]
v_mfma_f32_16x16x32_bf16 v[48:51], a[44:47], v[20:23], v[48:51]
s_waitcnt lgkmcnt(4)
v_mfma_f32_16x16x32_bf16 v[44:47], a[48:51], v[28:31], v[44:47]
ds_read_b128 v[20:23], v6 offset:18432
v_mfma_f32_16x16x32_bf16 v[52:55], a[48:51], v[32:35], v[52:55]
ds_read_b128 v[24:27], v6 offset:18688
v_mfma_f32_16x16x32_bf16 v[56:59], a[52:55], v[32:35], v[56:59]
v_mfma_f32_16x16x32_bf16 v[48:51], a[52:55], v[28:31], v[48:51]
s_waitcnt lgkmcnt(4)
v_mfma_f32_16x16x32_bf16 v[44:47], a[56:59], v[36:39], v[44:47]
ds_read_b128 v[28:31], v6 offset:20480
v_mfma_f32_16x16x32_bf16 v[52:55], a[56:59], v[40:43], v[52:55]
ds_read_b128 v[32:35], v6 offset:20736
v_mfma_f32_16x16x32_bf16 v[56:59], a[60:63], v[40:43], v[56:59]
v_mfma_f32_16x16x32_bf16 v[48:51], a[60:63], v[36:39], v[48:51]
s_waitcnt lgkmcnt(4)
v_mfma_f32_16x16x32_bf16 v[44:47], a[64:67], v[12:15], v[44:47]
ds_read_b128 v[36:39], v6 offset:22528
v_mfma_f32_16x16x32_bf16 v[52:55], a[64:67], v[16:19], v[52:55]
ds_read_b128 v[40:43], v6 offset:22784
v_mfma_f32_16x16x32_bf16 v[56:59], a[68:71], v[16:19], v[56:59]
v_mfma_f32_16x16x32_bf16 v[48:51], a[68:71], v[12:15], v[48:51]
s_waitcnt lgkmcnt(4)
v_mfma_f32_16x16x32_bf16 v[44:47], a[72:75], v[20:23], v[44:47]
ds_read_b128 v[12:15], v6 offset:24576
v_mfma_f32_16x16x32_bf16 v[52:55], a[72:75], v[24:27], v[52:55]
ds_read_b128 v[16:19], v6 offset:24832
v_mfma_f32_16x16x32_bf16 v[56:59], a[76:79], v[24:27], v[56:59]
v_mfma_f32_16x16x32_bf16 v[48:51], a[76:79], v[20:23], v[48:51]
s_waitcnt lgkmcnt(4)
v_mfma_f32_16x16x32_bf16 v[44:47], a[80:83], v[28:31], v[44:47]
ds_read_b128 v[20:23], v6 offset:26624
v_mfma_f32_16x16x32_bf16 v[52:55], a[80:83], v[32:35], v[52:55]
ds_read_b128 v[24:27], v6 offset:26880
v_mfma_f32_16x16x32_bf16 v[56:59], a[84:87], v[32:35], v[56:59]
v_mfma_f32_16x16x32_bf16 v[48:51], a[84:87], v[28:31], v[48:51]
s_waitcnt lgkmcnt(4)
v_mfma_f32_16x16x32_bf16 v[44:47], a[88:91], v[36:39], v[44:47]
ds_read_b128 v[28:31], v6 offset:28672
v_mfma_f32_16x16x32_bf16 v[52:55], a[88:91], v[40:43], v[52:55]
ds_read_b128 v[32:35], v6 offset:28928
v_mfma_f32_16x16x32_bf16 v[56:59], a[92:95], v[40:43], v[56:59]
v_mfma_f32_16x16x32_bf16 v[48:51], a[92:95], v[36:39], v[48:51]
s_waitcnt lgkmcnt(4)
v_mfma_f32_16x16x32_bf16 v[44:47], a[96:99], v[12:15], v[44:47]
ds_read_b128 v[36:39], v6 offset:30720
v_mfma_f32_16x16x32_bf16 v[52:55], a[96:99], v[16:19], v[52:55]
ds_read_b128 v[40:43], v6 offset:30976
v_mfma_f32_16x16x32_bf16 v[56:59], a[100:103], v[16:19], v[56:59]
v_mfma_f32_16x16x32_bf16 v[48:51], a[100:103], v[12:15], v[48:51]
s_waitcnt lgkmcnt(4)
v_mfma_f32_16x16x32_bf16 v[44:47], a[104:107], v[20:23], v[44:47]
s_waitcnt vmcnt(5)
s_barrier
ds_read_b128 v[12:15], v6 offset:32768
v_mfma_f32_16x16x32_bf16 v[52:55], a[104:107], v[24:27], v[52:55]
ds_read_b128 v[16:19], v6 offset:33024
v_mfma_f32_16x16x32_bf16 v[56:59], a[108:111], v[24:27], v[56:59]
v_mfma_f32_16x16x32_bf16 v[48:51], a[108:111], v[20:23], v[48:51]
s_waitcnt lgkmcnt(4)
v_mfma_f32_16x16x32_bf16 v[44:47], a[112:115], v[28:31], v[44:47]
ds_read_b128 v[20:23], v6 offset:34816
v_mfma_f32_16x16x32_bf16 v[52:55], a[112:115], v[32:35], v[52:55]
ds_read_b128 v[24:27], v6 offset:35072
v_mfma_f32_16x16x32_bf16 v[56:59], a[116:119], v[32:35], v[56:59]
v_mfma_f32_16x16x32_bf16 v[48:51], a[116:119], v[28:31], v[48:51]
s_waitcnt lgkmcnt(4)
v_mfma_f32_16x16x32_bf16 v[44:47], a[120:123], v[36:39], v[44:47]
ds_read_b128 v[28:31], v6 offset:36864
v_mfma_f32_16x16x32_bf16 v[52:55], a[120:123], v[40:43], v[52:55]
ds_read_b128 v[32:35], v6 offset:37120
v_mfma_f32_16x16x32_bf16 v[56:59], a[124:127], v[40:43], v[56:59]
v_mfma_f32_16x16x32_bf16 v[48:51], a[124:127], v[36:39], v[48:51]
s_waitcnt lgkmcnt(4)
v_mfma_f32_16x16x32_bf16 v[44:47], a[128:131], v[12:15], v[44:47]
ds_read_b128 v[36:39], v6 offset:38912
v_mfma_f32_16x16x32_bf16 v[52:55], a[128:131], v[16:19], v[52:55]
ds_read_b128 v[40:43], v6 offset:39168
v_mfma_f32_16x16x32_bf16 v[56:59], a[132:135], v[16:19], v[56:59]
v_mfma_f32_16x16x32_bf16 v[48:51], a[132:135], v[12:15], v[48:51]
s_waitcnt lgkmcnt(4)
v_mfma_f32_16x16x32_bf16 v[44:47], a[136:139], v[20:23], v[44:47]
ds_read_b128 v[12:15], v6 offset:40960
v_mfma_f32_16x16x32_bf16 v[52:55], a[136:139], v[24:27], v[52:55]
ds_read_b128 v[16:19], v6 offset:41216
v_mfma_f32_16x16x32_bf16 v[56:59], a[140:143], v[24:27], v[56:59]
v_mfma_f32_16x16x32_bf16 v[48:51], a[140:143], v[20:23], v[48:51]
s_waitcnt lgkmcnt(4)
v_mfma_f32_16x16x32_bf16 v[44:47], a[144:147], v[28:31], v[44:47]
ds_read_b128 v[20:23], v6 offset:43008
v_mfma_f32_16x16x32_bf16 v[52:55], a[144:147], v[32:35], v[52:55]
ds_read_b128 v[24:27], v6 offset:43264
v_mfma_f32_16x16x32_bf16 v[56:59], a[148:151], v[32:35], v[56:59]
v_mfma_f32_16x16x32_bf16 v[48:51], a[148:151], v[28:31], v[48:51]
s_waitcnt lgkmcnt(4)
v_mfma_f32_16x16x32_bf16 v[44:47], a[152:155], v[36:39], v[44:47]
ds_read_b128 v[28:31], v6 offset:45056
v_mfma_f32_16x16x32_bf16 v[52:55], a[152:155], v[40:43], v[52:55]
ds_read_b128 v[32:35], v6 offset:45312
v_mfma_f32_16x16x32_bf16 v[56:59], a[156:159], v[40:43], v[56:59]
v_mfma_f32_16x16x32_bf16 v[48:51], a[156:159], v[36:39], v[48:51]
s_waitcnt lgkmcnt(4)
v_mfma_f32_16x16x32_bf16 v[44:47], a[160:163], v[12:15], v[44:47]
ds_read_b128 v[36:39], v6 offset:47104
v_mfma_f32_16x16x32_bf16 v[52:55], a[160:163], v[16:19], v[52:55]
ds_read_b128 v[40:43], v6 offset:47360
v_mfma_f32_16x16x32_bf16 v[56:59], a[164:167], v[16:19], v[56:59]
v_mfma_f32_16x16x32_bf16 v[48:51], a[164:167], v[12:15], v[48:51]
s_waitcnt lgkmcnt(4)
v_mfma_f32_16x16x32_bf16 v[44:47], a[168:171], v[20:23], v[44:47]
s_waitcnt vmcnt(1)
s_barrier
ds_read_b128 v[12:15], v6 offset:49152
v_mfma_f32_16x16x32_bf16 v[52:55], a[168:171], v[24:27], v[52:55]
ds_read_b128 v[16:19], v6 offset:49408
v_mfma_f32_16x16x32_bf16 v[56:59], a[172:175], v[24:27], v[56:59]
v_mfma_f32_16x16x32_bf16 v[48:51], a[172:175], v[20:23], v[48:51]
s_waitcnt lgkmcnt(4)
v_mfma_f32_16x16x32_bf16 v[44:47], a[176:179], v[28:31], v[44:47]
ds_read_b128 v[20:23], v6 offset:51200
v_mfma_f32_16x16x32_bf16 v[52:55], a[176:179], v[32:35], v[52:55]
ds_read_b128 v[24:27], v6 offset:51456
v_mfma_f32_16x16x32_bf16 v[56:59], a[180:183], v[32:35], v[56:59]
v_mfma_f32_16x16x32_bf16 v[48:51], a[180:183], v[28:31], v[48:51]
s_waitcnt lgkmcnt(4)
v_mfma_f32_16x16x32_bf16 v[44:47], a[184:187], v[36:39], v[44:47]
ds_read_b128 v[28:31], v6 offset:53248
v_mfma_f32_16x16x32_bf16 v[52:55], a[184:187], v[40:43], v[52:55]
ds_read_b128 v[32:35], v6 offset:53504
v_mfma_f32_16x16x32_bf16 v[56:59], a[188:191], v[40:43], v[56:59]
v_mfma_f32_16x16x32_bf16 v[48:51], a[188:191], v[36:39], v[48:51]
s_waitcnt lgkmcnt(4)
v_mfma_f32_16x16x32_bf16 v[44:47], a[192:195], v[12:15], v[44:47]
ds_read_b128 v[36:39], v6 offset:55296
v_mfma_f32_16x16x32_bf16 v[52:55], a[192:195], v[16:19], v[52:55]
ds_read_b128 v[40:43], v6 offset:55552
v_mfma_f32_16x16x32_bf16 v[56:59], a[196:199], v[16:19], v[56:59]
v_mfma_f32_16x16x32_bf16 v[48:51], a[196:199], v[12:15], v[48:51]
s_waitcnt lgkmcnt(4)
v_mfma_f32_16x16x32_bf16 v[44:47], a[200:203], v[20:23], v[44:47]
ds_read_b128 v[12:15], v6 offset:57344
v_mfma_f32_16x16x32_bf16 v[52:55], a[200:203], v[24:27], v[52:55]
ds_read_b128 v[16:19], v6 offset:57600
v_mfma_f32_16x16x32_bf16 v[56:59], a[204:207], v[24:27], v[56:59]
v_mfma_f32_16x16x32_bf16 v[48:51], a[204:207], v[20:23], v[48:51]
s_waitcnt lgkmcnt(4)
v_mfma_f32_16x16x32_bf16 v[44:47], a[208:211], v[28:31], v[44:47]
ds_read_b128 v[20:23], v6 offset:59392
v_mfma_f32_16x16x32_bf16 v[52:55], a[208:211], v[32:35], v[52:55]
ds_read_b128 v[24:27], v6 offset:59648
v_mfma_f32_16x16x32_bf16 v[56:59], a[212:215], v[32:35], v[56:59]
v_mfma_f32_16x16x32_bf16 v[48:51], a[212:215], v[28:31], v[48:51]
s_waitcnt lgkmcnt(4)
v_mfma_f32_16x16x32_bf16 v[44:47], a[216:219], v[36:39], v[44:47]
ds_read_b128 v[28:31], v6 offset:61440
v_mfma_f32_16x16x32_bf16 v[52:55], a[216:219], v[40:43], v[52:55]
ds_read_b128 v[32:35], v6 offset:61696
v_mfma_f32_16x16x32_bf16 v[56:59], a[220:223], v[40:43], v[56:59]
v_mfma_f32_16x16x32_bf16 v[48:51], a[220:223], v[36:39], v[48:51]
s_waitcnt lgkmcnt(4)
v_mfma_f32_16x16x32_bf16 v[44:47], a[224:227], v[12:15], v[44:47]
ds_read_b128 v[36:39], v6 offset:63488
v_mfma_f32_16x16x32_bf16 v[52:55], a[224:227], v[16:19], v[52:55]
ds_read_b128 v[40:43], v6 offset:63744
v_mfma_f32_16x16x32_bf16 v[56:59], a[228:231], v[16:19], v[56:59]
v_mfma_f32_16x16x32_bf16 v[48:51], a[228:231], v[12:15], v[48:51]
s_waitcnt lgkmcnt(4)
v_mfma_f32_16x16x32_bf16 v[44:47], a[232:235], v[20:23], v[44:47]
v_mfma_f32_16x16x32_bf16 v[52:55], a[232:235], v[24:27], v[52:55]
v_mfma_f32_16x16x32_bf16 v[56:59], a[236:239], v[24:27], v[56:59]
v_mfma_f32_16x16x32_bf16 v[48:51], a[236:239], v[20:23], v[48:51]
s_waitcnt lgkmcnt(2)
v_mfma_f32_16x16x32_bf16 v[44:47], a[240:243], v[28:31], v[44:47]
v_mfma_f32_16x16x32_bf16 v[52:55], a[240:243], v[32:35], v[52:55]
v_mfma_f32_16x16x32_bf16 v[56:59], a[244:247], v[32:35], v[56:59]
v_mfma_f32_16x16x32_bf16 v[48:51], a[244:247], v[28:31], v[48:51]
s_waitcnt lgkmcnt(0)
v_mfma_f32_16x16x32_bf16 v[44:47], a[248:251], v[36:39], v[44:47]
v_mfma_f32_16x16x32_bf16 v[52:55], a[248:251], v[40:43], v[52:55]
v_mfma_f32_16x16x32_bf16 v[56:59], a[252:255], v[40:43], v[56:59]
v_mfma_f32_16x16x32_bf16 v[48:51], a[252:255], v[36:39], v[48:51]
s_nop 4
v_cvt_pk_bf16_f32 v84, v44, v45
v_add_u32 v47, s64, v47
v_cvt_pk_bf16_f32 v85, v46, s65
v_bfi_b32 v85, s66, v47, v85
v_cvt_pk_bf16_f32 v86, v48, v49
v_add_u32 v51, s64, v51
v_cvt_pk_bf16_f32 v87, v50, s65
v_bfi_b32 v87, s66, v51, v87
v_cvt_pk_bf16_f32 v88, v52, v53
v_add_u32 v55, s64, v55
v_cvt_pk_bf16_f32 v89, v54, s65
v_bfi_b32 v89, s66, v55, v89
v_cvt_pk_bf16_f32 v90, v56, v57
v_add_u32 v59, s64, v59
v_cvt_pk_bf16_f32 v91, v58, s65
v_bfi_b32 v91, s66, v59, v91
buffer_store_dwordx4 v[84:87], v116, s[8:11], s41 offen sc1
buffer_store_dwordx4 v[88:91], v117, s[8:11], s41 offen sc1
s_waitcnt vmcnt(0)
main_kernel_wj1_s_r:
buffer_load_dwordx2 v[124:125], v118, s[8:11], s41 offen offset:0 sc1
buffer_load_dwordx2 v[126:127], v118, s[8:11], s41 offen offset:2048 sc1
buffer_load_dwordx2 v[128:129], v119, s[8:11], s41 offen offset:0 sc1
buffer_load_dwordx2 v[130:131], v119, s[8:11], s41 offen offset:2048 sc1
s_waitcnt vmcnt(0)
v_bitop3_b32 v162, v125, v127, s57 bitop3:0x7e
v_bitop3_b32 v163, v129, v131, s57 bitop3:0x7e
v_or_b32 v162, v162, v163
v_and_b32 v162, 0x10000, v162
v_cmp_ne_u32 vcc, 0, v162
s_cbranch_vccz main_kernel_wj1_s_k
s_add_u32 s54, s54, 1
s_cmp_ge_u32 s54, 131072
s_cbranch_scc1 main_kernel_wj1_s_k
s_branch main_kernel_wj1_s_r
main_kernel_wj1_s_k:
v_lshlrev_b32 v140, 16, v124
v_and_b32 v141, 0xffff0000, v124
v_lshlrev_b32 v142, 16, v125
v_and_b32 v143, 0xffff0000, v125
v_lshlrev_b32 v144, 16, v126
v_and_b32 v145, 0xffff0000, v126
v_lshlrev_b32 v146, 16, v127
v_and_b32 v147, 0xffff0000, v127
v_add_f32 v140, v140, v144
v_add_f32 v141, v141, v145
v_add_f32 v142, v142, v146
v_add_f32 v143, v143, v147
v_lshlrev_b32 v144, 16, v128
v_and_b32 v145, 0xffff0000, v128
v_lshlrev_b32 v146, 16, v129
v_and_b32 v147, 0xffff0000, v129
v_add_f32 v140, v140, v144
v_add_f32 v141, v141, v145
v_add_f32 v142, v142, v146
v_add_f32 v143, v143, v147
v_lshlrev_b32 v144, 16, v130
v_and_b32 v145, 0xffff0000, v130
v_lshlrev_b32 v146, 16, v131
v_and_b32 v147, 0xffff0000, v131
v_add_f32 v140, v140, v144
v_add_f32 v141, v141, v145
v_add_f32 v142, v142, v146
v_add_f32 v143, v143, v147
v_lshlrev_b32 v144, 16, v152
v_and_b32 v145, 0xffff0000, v152
v_lshlrev_b32 v146, 16, v153
v_and_b32 v147, 0xffff0000, v153
v_lshlrev_b32 v148, 16, v154
v_and_b32 v149, 0xffff0000, v154
v_lshlrev_b32 v150, 16, v155
v_and_b32 v151, 0xffff0000, v155
v_fma_f32 v140, v140, v144, v148
v_fma_f32 v141, v141, v145, v149
v_fma_f32 v142, v142, v146, v150
v_fma_f32 v143, v143, v147, v151
v_cvt_pk_bf16_f32 v160, v140, v141
v_cvt_pk_bf16_f32 v161, v142, v143
buffer_store_dwordx2 v[160:161], v120, s[32:35], s45 offen
s_add_u32 s45, s45, 131072
s_cmp_lt_u32 s37, s24
s_cbranch_scc1 main_kernel_wj1_s
main_kernel_we:
main_kernel_last:
s_endpgm
.section .rodata,"a"
.p2align 6
.amdhsa_kernel main_kernel
  .amdhsa_next_free_vgpr 512
  .amdhsa_next_free_sgpr 102
  .amdhsa_accum_offset 256
  .amdhsa_group_segment_fixed_size 0
  .amdhsa_kernarg_size 120
  .amdhsa_user_sgpr_count 2
  .amdhsa_user_sgpr_kernarg_segment_ptr 1
  .amdhsa_system_sgpr_workgroup_id_x 1
  .amdhsa_float_denorm_mode_32 3
.end_amdhsa_kernel
```
